```python
import torch

def _softmax(x, axis=-1):
    return torch.softmax(x, dim=axis)
def _gelu(x):
    return torch.nn.functional.gelu(x, approximate="tanh")
def _silu(x):
    return torch.nn.functional.silu(x)
def _sigmoid(x):
    return torch.sigmoid(x)
def _layernorm(x, axis=-1, eps=1e-5):
    m = x.mean(dim=axis, keepdim=True)
    v = x.var(dim=axis, keepdim=True, unbiased=False)
    return (x - m) / torch.sqrt(v + eps)
def _scatter_add(tgt, idx, src, axis=0):
    return tgt.clone().index_add_(axis, idx, src)
def _segment_sum(src, seg, n):
    out = torch.zeros((n,) + src.shape[1:], dtype=src.dtype)
    return out.index_add_(0, seg, src)
def _pad(x, pw):
    flat = tuple(v for pair in reversed(pw) for v in pair)
    return torch.nn.functional.pad(x, flat)

kernel_name = 'recurrent_scan__sliding_local_dilated__glu_gated_geglu__prompt'

def setup_inputs():

    _w = (lambda a: (lambda t: t.to(torch.bfloat16) if t.is_floating_point() else t)(torch.as_tensor(a)))
    def _A_setup():
        B, S, D = 1, 2048, 640
        return {
            "x": _w((lambda *s: torch.randn(*s, dtype=torch.bfloat16) * 0.05)(B, S, D)),
            "wqkv": _w((lambda *s: torch.randn(*s, dtype=torch.bfloat16) * 0.2)(D, 3 * D)),
            "wo": _w((lambda *s: torch.randn(*s, dtype=torch.bfloat16) * 0.2)(D, D)),
        }
    _A_in = _A_setup()

    def _B_setup():
        B, S, Dm, Df = 1, 2048, 640, 1728
        return {
            "x": _w((lambda *s: torch.randn(*s, dtype=torch.bfloat16) * 0.05)(B, S, Dm)),
            "w_gate": _w((lambda *s: torch.randn(*s, dtype=torch.bfloat16) * 0.1)(Dm, Df) * (Dm ** -0.5)),
            "w_up": _w((lambda *s: torch.randn(*s, dtype=torch.bfloat16) * 0.1)(Dm, Df) * (Dm ** -0.5)),
            "w_down": _w((lambda *s: torch.randn(*s, dtype=torch.bfloat16) * 0.1)(Df, Dm) * (Df ** -0.5)),
        }
    _B_in = _B_setup()

    return {
        "A_x": _A_in["x"],
        "A_wqkv": _A_in["wqkv"],
        "A_wo": _A_in["wo"],
        "B_x": _B_in["x"],
        "B_w_gate": _B_in["w_gate"],
        "B_w_up": _B_in["w_up"],
        "B_w_down": _B_in["w_down"],
    }

def reference(A_x, A_wqkv, A_wo, B_x, B_w_gate, B_w_up, B_w_down):
    def _A_ref(x, wqkv, wo):
        B, S, D = x.shape
        H = 32; Dh = D // H
        W, dil = 8, 2
        qkv = (lambda x, *d: x.permute(*d))((x @ wqkv).reshape(B, S, 3, H, Dh), 2, 0, 3, 1, 4)
        q, k, v = qkv[0], qkv[1], qkv[2]
        scale = Dh ** -0.5
        pos = torch.arange(S)
        off = torch.arange(W) * dil
        idx = pos[:, None] - off[None, :]
        mask = idx >= 0
        idx_c = torch.where(mask, idx, 0).reshape(-1)
        kg = k[:, :, idx_c, :].reshape(B, H, S, W, Dh)
        vg = v[:, :, idx_c, :].reshape(B, H, S, W, Dh)
        logits = torch.einsum("bhsd,bhswd->bhsw", q, kg) * scale
        logits = torch.where(mask[None, None, :, :], logits, -1e9)
        attn = _softmax(logits, axis=-1)
        o = torch.einsum("bhsw,bhswd->bhsd", attn, vg)
        return (lambda x, *d: x.permute(*d))(o, 0, 2, 1, 3).reshape(B, S, D) @ wo

    def _B_ref(x, w_gate, w_up, w_down):
        g = torch.einsum("bsd,df->bsf", x, w_gate)
        u = torch.einsum("bsd,df->bsf", x, w_up)
        h = _gelu(g) * u
        return torch.einsum("bsf,fd->bsd", h, w_down)

    x = A_x
    xn = _layernorm(x, axis=-1)
    s = _A_ref(xn, A_wqkv, A_wo)
    g = _silu(_B_ref(xn, B_w_gate, B_w_up, B_w_down))
    return x + s * g
```

```asm
; @launch grid=(256,1,1) block=(256,1,1) lds=163840
.amdgcn_target "amdgcn-amd-amdhsa--gfx950"
.text
.globl recurrent_scan__sliding_local_dilated__glu_gated_geglu__prompt_kernel
.p2align 8
.type recurrent_scan__sliding_local_dilated__glu_gated_geglu__prompt_kernel,@function
recurrent_scan__sliding_local_dilated__glu_gated_geglu__prompt_kernel:
  s_cmp_ge_u32 s2, 256
  s_cbranch_scc1 END
  s_load_dwordx16 s[4:19], s[0:1], 0
  s_load_dwordx4 s[20:23], s[0:1], 64
  v_readfirstlane_b32 s44, v0
  s_lshr_b32 s55, s2, 3
  s_getpc_b64 s[56:57]
CPF0:
  s_mul_i32 s58, s55, 19
  v_min_u32 v1, 18, v0
  v_add_u32 v1, s58, v1
  v_lshlrev_b32 v1, 7, v1
  v_min_u32 v1, CODE_END-CPF0-4, v1
  v_mov_b32 v3, s57
  v_add_co_u32 v2, vcc, s56, v1
  s_nop 1
  v_addc_co_u32 v3, vcc, 0, v3, vcc
  global_load_dword v222, v[2:3], off
  s_lshr_b32 s44, s44, 6
  v_and_b32 v0, 63, v0
  s_and_b32 s56, s2, 3
  s_bfe_u32 s46, s2, 0x10002
  s_cmp_lt_u32 s55, 12
  s_cbranch_scc0 H_notatt
  s_lshr_b32 s53, s55, 1
  s_and_b32 s54, s55, 1
  s_lshl_b32 s56, s56, 1
  s_add_u32 s54, s54, s56
  s_mul_i32 s55, s53, 172
  s_mul_i32 s45, s44, 44
  s_add_u32 s45, s45, s55
  s_sub_u32 s45, s45, 7
  s_mul_i32 s55, s46, 6
  s_add_u32 s55, s55, s53
  s_branch H_common
H_notatt:
  s_cmp_lt_u32 s55, 30
  s_cbranch_scc1 H_two
  s_lshl_b32 s56, s56, 1
  s_add_u32 s56, s56, s55
  s_sub_u32 s56, s56, 30
  s_mul_i32 s53, s46, 6
  s_add_u32 s53, s53, s56
  s_mov_b32 s54, 13
  s_movk_i32 s76, 1000
  s_cmp_lt_u32 s56, 5
  s_cbranch_scc1 H_ffn
  s_mul_i32 s53, s46, 3
  s_add_u32 s53, s53, s56
  s_sub_u32 s53, s53, 5
  s_branch HELPER
H_two:
  s_mul_i32 s56, s56, 18
  s_add_u32 s56, s56, s55
  s_sub_u32 s56, s56, 12
  s_lshl_b32 s76, s56, 1
  s_add_u32 s76, s76, s46
  s_lshl2_add_u32 s76, s76, s44
  s_cmp_eq_u32 s46, 1
  s_cselect_b32 s57, 35, 42
  s_cmp_ge_u32 s56, s57
  s_cselect_b32 s57, s57, 0
  s_cselect_b32 s54, 7, 0
  s_cselect_b32 s59, 1, 0
  s_sub_u32 s56, s56, s57
  s_cmp_eq_u32 s46, s59
  s_cselect_b32 s57, 43, 52
  s_cselect_b32 s59, 6, 5
  s_mul_i32 s57, s57, s56
  s_lshr_b32 s57, s57, 8
  s_add_u32 s54, s54, s57
  s_mul_i32 s57, s57, s59
  s_sub_u32 s53, s56, s57
  s_sub_u32 s59, 11, s59
  s_mul_i32 s59, s59, s46
  s_add_u32 s53, s53, s59
H_ffn:
  s_lshl_b32 s55, s53, 2
  s_add_u32 s55, s55, s44
  s_cmp_ge_u32 s55, 22
  s_cselect_b32 s46, 1, 0
  s_cselect_b32 s56, 22, 0
  s_sub_u32 s55, s55, s56
  s_mul_i32 s45, s55, 47
  s_lshl_b32 s55, s46, 1
  s_sub_u32 s45, s45, s55
  s_mov_b32 s55, s53
H_common:
  s_add_u32 s47, s45, 47
  s_min_u32 s47, s47, 0x400
  s_mul_i32 s68, s55, 1
  s_mul_i32 s57, s54, 1
  s_add_u32 s68, s68, s57
  s_mul_i32 s57, s68, 21846
  s_lshr_b32 s57, s57, 16
  s_mul_i32 s57, s57, 3
  s_sub_u32 s68, s68, s57
  s_lshl_b32 s68, s68, 2
  s_mov_b32 s56, 0x210210
  s_mov_b32 s57, 0x0
  s_lshr_b64 s[56:57], s[56:57], s68
  s_and_b32 s56, s56, 0xfff
  s_or_b32 s60, s56, 0x76543000
  s_movk_i32 s61, 0x98
  s_mul_i32 s48, s44, 18816
  s_add_u32 s48, s48, 81920
  s_mul_i32 s55, s45, 2560
  s_mul_i32 s56, s46, 1280
  s_add_u32 s55, s55, s56
  s_mul_i32 s26, s47, 2560
  v_lshrrev_b32 v4, 3, v0
  v_add_u32 v5, 1, v4
  v_lshrrev_b32 v5, 1, v5
  v_xor_b32 v5, v5, v0
  v_and_b32 v5, 7, v5
  v_mul_u32_u24 v4, 2560, v4
  v_lshl_add_u32 v4, v5, 4, v4
  v_add_u32 v238, s55, v4
  v_xor_b32 v4, 64, v4
  v_add_u32 v4, s55, v4
  v_add_u32 v239, 19456, v4
  v_add_u32 v240, 38912, v238
  v_add_u32 v241, 58368, v4
  v_add_u32 v242, 81920, v238
  v_add_u32 v243, 101376, v4
  v_min_u32 v238, 0x40000000, v238
  s_waitcnt lgkmcnt(0)
  s_mov_b64 s[24:25], s[4:5]
  s_mov_b32 s27, 0x20000
  s_bfe_u32 s49, s60, 0x40000
  s_add_u32 m0, s48, 128
  s_lshl_b32 s49, s49, 7
  buffer_load_dwordx4 v238, s[24:27], s49 offen offset:0 lds
  buffer_load_dwordx4 v239, s[24:27], s49 offen offset:1024 lds
  buffer_load_dwordx4 v240, s[24:27], s49 offen offset:2048 lds
  buffer_load_dwordx4 v241, s[24:27], s49 offen offset:3072 lds
  s_add_u32 m0, s48, 4224
  s_nop 0
  buffer_load_dwordx4 v242, s[24:27], s49 offen offset:0 lds
  buffer_load_dwordx4 v243, s[24:27], s49 offen offset:1024 lds
  s_mov_b64 s[40:41], s[4:5]
  s_mov_b32 s42, 0x280000
  s_mov_b32 s43, 0x20000
  s_mov_b64 s[36:37], s[22:23]
  s_mov_b32 s38, 0x1000000
  s_mov_b32 s39, 0x20000
  s_cmp_lt_u32 s2, 96
  s_cbranch_scc0 H_fpro
H_apro:
  s_mul_i32 s50, s44, 5120
  s_and_b32 s55, s44, 1
  s_mul_i32 s73, s55, 122880
  s_mul_i32 s55, s54, 160
  s_add_u32 s73, s73, s55
  s_cmp_lt_u32 s44, 2
  s_cselect_b32 s55, 1280, 0
  s_add_u32 s52, s73, s55
  s_movk_i32 s55, 3680
  s_movk_i32 s56, 15360
  v_mul_u32_u24 v219, 205, v0
  v_lshlrev_b32 v220, 4, v0
  s_mov_b64 s[28:29], s[6:7]
  s_mov_b32 s30, 0x258000
  s_mov_b32 s31, 0x20000
  v_add_u32 v216, 0, v219
  v_bfe_u32 v217, v216, 13, 1
  v_bfe_u32 v218, v216, 14, 1
  v_lshrrev_b32 v216, 11, v216
  v_sub_u32 v217, v217, v218
  v_mad_u32_u24 v216, v216, s55, v220
  v_mad_i32_i24 v194, v217, s56, v216
  v_add_u32 v216, 13120, v219
  v_bfe_u32 v217, v216, 13, 1
  v_bfe_u32 v218, v216, 14, 1
  v_lshrrev_b32 v216, 11, v216
  v_sub_u32 v217, v217, v218
  v_mad_u32_u24 v216, v216, s55, v220
  v_mad_i32_i24 v195, v217, s56, v216
  v_add_u32 v216, 26240, v219
  v_bfe_u32 v217, v216, 13, 1
  v_bfe_u32 v218, v216, 14, 1
  v_lshrrev_b32 v216, 11, v216
  v_sub_u32 v217, v217, v218
  v_mad_u32_u24 v216, v216, s55, v220
  v_mad_i32_i24 v196, v217, s56, v216
  v_add_u32 v216, 39360, v219
  v_bfe_u32 v217, v216, 13, 1
  v_bfe_u32 v218, v216, 14, 1
  v_lshrrev_b32 v216, 11, v216
  v_sub_u32 v217, v217, v218
  v_mad_u32_u24 v216, v216, s55, v220
  v_mad_i32_i24 v197, v217, s56, v216
  v_add_u32 v216, 52480, v219
  v_bfe_u32 v217, v216, 13, 1
  v_bfe_u32 v218, v216, 14, 1
  v_lshrrev_b32 v216, 11, v216
  v_sub_u32 v217, v217, v218
  v_mad_u32_u24 v216, v216, s55, v220
  v_mad_i32_i24 v198, v217, s56, v216
  v_add_u32 v198, 4096, v198
  s_bfe_u32 s51, s60, 0x40000
  s_mul_i32 s51, s51, 245760
  s_add_u32 m0, s50, 0
  s_add_u32 s51, s51, s52
  buffer_load_dwordx4 v194, s[28:31], s51 offen offset:0 lds
  buffer_load_dwordx4 v195, s[28:31], s51 offen offset:1024 lds
  buffer_load_dwordx4 v196, s[28:31], s51 offen offset:2048 lds
  buffer_load_dwordx4 v197, s[28:31], s51 offen offset:3072 lds
  s_add_u32 m0, s50, 4096
  s_nop 0
  buffer_load_dwordx4 v198, s[28:31], s51 offen offset:0 lds
  s_branch ATT
H_fpro:
  s_lshl_b32 s50, s44, 12
  s_mul_i32 s52, s44, 55296
  s_lshl_b32 s55, s54, 8
  s_add_u32 s52, s52, s55
  v_lshrrev_b32 v224, 3, v0
  v_mul_u32_u24 v224, 3456, v224
  v_and_b32 v225, 1, v0
  v_lshl_add_u32 v224, v225, 4, v224
  v_bfe_u32 v225, v0, 1, 2
  v_bfe_u32 v226, v0, 4, 1
  v_xor_b32 v225, v225, v226
  v_lshl_add_u32 v208, v225, 5, v224
  v_xor_b32 v209, 64, v208
  v_add_u32 v209, 26624, v209
  s_mov_b64 s[28:29], s[12:13]
  s_mov_b32 s30, 0x21c000
  s_mov_b32 s31, 0x20000
  s_sub_u32 s32, s14, 2048
  s_subb_u32 s33, s15, 0
  s_mov_b32 s34, 0x21c800
  s_mov_b32 s35, 0x20000
  s_add_u32 s77, s52, 128
  s_cmp_eq_u32 s54, 13
  s_cselect_b32 s77, 0x40000000, s77
  s_bfe_u32 s51, s60, 0x40000
  s_mul_i32 s51, s51, 221184
  s_add_u32 m0, s50, 0
  s_add_u32 s51, s51, s52
  buffer_load_dwordx4 v208, s[28:31], s51 offen offset:0 lds
  buffer_load_dwordx4 v209, s[28:31], s51 offen offset:1024 lds
  buffer_load_dwordx4 v208, s[32:35], s51 offen offset:2048 lds
  buffer_load_dwordx4 v209, s[32:35], s51 offen offset:3072 lds
  s_branch FFN
FRP0:
  buffer_load_dword v221, v219, s[28:31], s21 offen
  s_add_u32 m0, s78, 0
  s_add_u32 s80, s74, 0
  buffer_load_dwordx4 v232, s[84:87], s80 offen nt lds
  s_add_u32 m0, s78, 1024
  s_add_u32 s80, s74, 10240
  buffer_load_dwordx4 v232, s[84:87], s80 offen nt lds
  s_add_u32 m0, s78, 2048
  s_add_u32 s80, s74, 20480
  buffer_load_dwordx4 v232, s[84:87], s80 offen nt lds
  s_add_u32 m0, s78, 3072
  s_add_u32 s80, s74, 30720
  buffer_load_dwordx4 v232, s[84:87], s80 offen nt lds
  s_branch FRPB0
FRP1:
  buffer_load_dword v221, v219, s[28:31], s21 offen
  s_add_u32 m0, s78, 0
  s_add_u32 s80, s74, 0
  buffer_load_dwordx4 v232, s[84:87], s80 offen nt lds
  s_add_u32 m0, s78, 1024
  s_add_u32 s80, s74, 10240
  buffer_load_dwordx4 v232, s[84:87], s80 offen nt lds
  s_add_u32 m0, s78, 2048
  s_add_u32 s80, s74, 20480
  buffer_load_dwordx4 v232, s[84:87], s80 offen nt lds
  s_add_u32 m0, s78, 3072
  s_add_u32 s80, s74, 30720
  buffer_load_dwordx4 v232, s[84:87], s80 offen nt lds
  s_branch FRPB1
FRP2:
  buffer_load_dword v221, v219, s[28:31], s21 offen
  s_add_u32 m0, s78, 0
  s_add_u32 s80, s74, 0
  buffer_load_dwordx4 v232, s[84:87], s80 offen nt lds
  s_add_u32 m0, s78, 1024
  s_add_u32 s80, s74, 10240
  buffer_load_dwordx4 v232, s[84:87], s80 offen nt lds
  s_add_u32 m0, s78, 2048
  s_add_u32 s80, s74, 20480
  buffer_load_dwordx4 v232, s[84:87], s80 offen nt lds
  s_add_u32 m0, s78, 3072
  s_add_u32 s80, s74, 30720
  buffer_load_dwordx4 v232, s[84:87], s80 offen nt lds
  s_branch FRPB2
FRP3:
  buffer_load_dword v221, v219, s[28:31], s21 offen
  s_add_u32 m0, s78, 0
  s_add_u32 s80, s74, 0
  buffer_load_dwordx4 v232, s[84:87], s80 offen nt lds
  s_add_u32 m0, s78, 1024
  s_add_u32 s80, s74, 10240
  buffer_load_dwordx4 v232, s[84:87], s80 offen nt lds
  s_add_u32 m0, s78, 2048
  s_add_u32 s80, s74, 20480
  buffer_load_dwordx4 v232, s[84:87], s80 offen nt lds
  s_add_u32 m0, s78, 3072
  s_add_u32 s80, s74, 30720
  buffer_load_dwordx4 v232, s[84:87], s80 offen nt lds
  s_branch FRPB3
FRP4:
  buffer_load_dword v221, v219, s[28:31], s21 offen
  s_add_u32 m0, s78, 0
  s_add_u32 s80, s74, 0
  buffer_load_dwordx4 v232, s[84:87], s80 offen nt lds
  s_add_u32 m0, s78, 1024
  s_add_u32 s80, s74, 10240
  buffer_load_dwordx4 v232, s[84:87], s80 offen nt lds
  s_add_u32 m0, s78, 2048
  s_add_u32 s80, s74, 20480
  buffer_load_dwordx4 v232, s[84:87], s80 offen nt lds
  s_add_u32 m0, s78, 3072
  s_add_u32 s80, s74, 30720
  buffer_load_dwordx4 v232, s[84:87], s80 offen nt lds
  s_branch FRPB4
ARP0:
  buffer_load_dword v179, v199, s[28:31], s21 offen
  buffer_load_dword v180, v178, s[32:35], s20 offen
  s_branch ARPB0
ARP1:
  buffer_load_dword v179, v199, s[28:31], s21 offen
  buffer_load_dword v180, v178, s[32:35], s20 offen
  s_branch ARPB1
ARP2:
  buffer_load_dword v179, v199, s[28:31], s21 offen
  buffer_load_dword v180, v178, s[32:35], s20 offen
  s_branch ARPB2
ARP3:
  buffer_load_dword v179, v199, s[28:31], s21 offen
  buffer_load_dword v180, v178, s[32:35], s20 offen
  s_branch ARPB3
ARP4:
  buffer_load_dword v179, v199, s[28:31], s21 offen
  buffer_load_dword v180, v178, s[32:35], s20 offen
  s_branch ARPB4
.p2align 12
FFN:
  v_and_b32 v224, 15, v0
  v_bfe_u32 v225, v0, 1, 3
  v_lshrrev_b32 v226, 4, v0
  v_xor_b32 v225, v225, v226
  v_lshlrev_b32 v224, 7, v224
  v_lshl_add_u32 v224, v225, 4, v224
  v_add_u32 v244, s48, v224
  v_xor_b32 v224, 64, v224
  v_add_u32 v245, s48, v224
  v_and_b32 v224, 31, v0
  v_lshlrev_b32 v224, 2, v224
  v_add_u32 v224, s48, v224
  v_mov_b32 v225, 0x3f803f80
  ds_write_b32 v224, v225 offset:0
  ds_write_b32 v224, v225 offset:6272
  ds_write_b32 v224, v225 offset:12544
  s_sub_u32 s55, 0, s45
  s_and_b32 s55, s55, 3
  s_sub_u32 s55, 3, s55
  v_and_b32 v212, 15, v0
  v_add_u32 v212, s55, v212
  v_lshrrev_b32 v212, 4, v212
  v_lshl_add_u32 v246, v212, 12, v244
  v_lshl_add_u32 v247, v212, 12, v245
  v_lshlrev_b32 v226, 11, v212
  v_sub_u32 v244, v244, v226
  v_sub_u32 v245, v245, v226
  v_lshrrev_b32 v224, 5, v0
  v_lshlrev_b32 v224, 12, v224
  v_bfe_u32 v225, v0, 4, 1
  v_lshl_add_u32 v224, v225, 10, v224
  v_bfe_u32 v225, v0, 2, 2
  v_lshl_add_u32 v224, v225, 7, v224
  v_and_b32 v225, 3, v0
  v_lshl_add_u32 v224, v225, 3, v224
  v_bfe_u32 v225, v0, 3, 2
  v_xor_b32 v204, 0, v225
  v_lshl_add_u32 v204, v204, 5, v224
  v_xor_b32 v205, 1, v225
  v_lshl_add_u32 v205, v205, 5, v224
  v_xor_b32 v206, 2, v225
  v_lshl_add_u32 v206, v206, 5, v224
  v_xor_b32 v207, 3, v225
  v_lshl_add_u32 v207, v207, 5, v224
  s_sub_u32 s55, s2, 96
  s_mul_i32 s67, s55, 4552
  s_lshr_b32 s67, s67, 16
  s_lshl_b32 s67, s67, 2
  s_mov_b32 s56, 0x32100321
  s_mov_b32 s57, 0xff44
  s_lshr_b64 s[56:57], s[56:57], s67
  s_and_b32 s67, s56, 15
  s_mul_i32 s55, s55, 4
  s_and_b32 s56, s44, 3
  s_add_u32 s55, s55, s56
  s_mul_i32 s21, s55, 3840
  v_min_u32 v219, 29, v0
  v_lshlrev_b32 v219, 7, v219
  s_mul_i32 s55, s76, 205
  s_lshr_b32 s55, s55, 11
  s_mul_i32 s56, s55, 10
  s_sub_u32 s56, s76, s56
  s_cmp_ge_u32 s55, 28
  s_cselect_b32 s57, 28, 0
  s_cselect_b32 s58, 64, 0
  s_sub_u32 s57, s55, s57
  s_lshr_b32 s74, s57, 1
  s_lshl_b32 s74, s74, 7
  s_and_b32 s57, s57, 1
  s_lshl_b32 s57, s57, 5
  s_add_u32 s74, s74, s57
  s_add_u32 s74, s74, s58
  s_mul_i32 s74, s74, 1280
  s_lshl_b32 s57, s56, 7
  s_add_u32 s74, s74, s57
  s_lshl_b32 s79, s56, 2
  s_mul_i32 s75, s55, 5120
  s_lshl_b32 s57, s56, 12
  s_add_u32 s75, s75, s57
  s_add_u32 s75, s75, 0xb00000
  s_lshl_b32 s55, s55, 4
  s_add_u32 s55, s55, s56
  s_lshl_b32 s55, s55, 6
  s_add_u32 s55, s55, 0x10000
  s_cmp_ge_u32 s76, 540
  s_cselect_b32 s74, 0x40000000, s74
  s_cselect_b32 s75, 0x40000000, s75
  s_cselect_b32 s76, 0x40000000, s55
  s_add_u32 s78, s50, 65536
  s_mov_b64 s[84:85], s[16:17]
  s_mov_b32 s86, 0x21c000
  s_mov_b32 s87, 0x20000
  v_lshrrev_b32 v232, 3, v0
  v_mul_u32_u24 v232, 1280, v232
  v_bfe_u32 v224, v0, 1, 2
  v_bfe_u32 v225, v0, 4, 2
  v_xor_b32 v224, v224, v225
  v_lshl_add_u32 v232, v224, 5, v232
  v_and_b32 v224, 1, v0
  v_lshl_add_u32 v232, v224, 4, v232
  v_lshrrev_b32 v224, 2, v0
  v_lshlrev_b32 v224, 7, v224
  v_and_b32 v225, 3, v0
  v_lshl_add_u32 v224, v225, 3, v224
  v_add_u32 v224, s78, v224
  v_bfe_u32 v225, v0, 3, 2
  v_xor_b32 v233, 0, v225
  v_lshl_add_u32 v233, v233, 5, v224
  v_xor_b32 v234, 1, v225
  v_lshl_add_u32 v234, v234, 5, v224
  v_xor_b32 v235, 2, v225
  v_lshl_add_u32 v235, v235, 5, v224
  v_xor_b32 v236, 3, v225
  v_lshl_add_u32 v236, v236, 5, v224
  s_add_u32 s55, s79, 0
  s_mul_i32 s55, s55, 52
  s_lshr_b32 s55, s55, 8
  s_mul_i32 s55, s55, 373760
  s_add_u32 s92, s55, s75
  s_add_u32 s55, s79, 1
  s_mul_i32 s55, s55, 52
  s_lshr_b32 s55, s55, 8
  s_mul_i32 s55, s55, 373760
  s_add_u32 s93, s55, s75
  s_add_u32 s55, s79, 2
  s_mul_i32 s55, s55, 52
  s_lshr_b32 s55, s55, 8
  s_mul_i32 s55, s55, 373760
  s_add_u32 s94, s55, s75
  s_add_u32 s55, s79, 3
  s_mul_i32 s55, s55, 52
  s_lshr_b32 s55, s55, 8
  s_mul_i32 s55, s55, 373760
  s_add_u32 s95, s55, s75
  s_mul_i32 s70, s46, 4849664
  s_lshl_b32 s55, s54, 13
  s_add_u32 s70, s70, s55
  s_add_u32 s70, s70, 0x100000
  s_max_i32 s59, s45, 0
  s_lshr_b32 s55, s59, 6
  s_mul_i32 s55, s55, 303104
  s_bfe_u32 s56, s59, 0x20004
  s_lshl_b32 s56, s56, 10
  s_add_u32 s55, s55, s56
  s_and_b32 s56, s59, 12
  s_lshl4_add_u32 s55, s56, s55
  s_cmp_eq_u32 s54, 13
  s_cselect_b32 s56, 0x40000000, 114688
  v_lshrrev_b32 v224, 5, v0
  v_mul_lo_u32 v237, v224, s56
  v_bfe_u32 v224, v0, 4, 1
  v_lshl_add_u32 v237, v224, 12, v237
  v_bfe_u32 v224, v0, 2, 2
  v_lshl_add_u32 v237, v224, 8, v237
  v_and_b32 v224, 3, v0
  v_lshl_add_u32 v237, v224, 4, v237
  v_add_u32 v237, s55, v237
  s_lshr_b32 s55, s2, 3
  s_and_b32 s68, s2, 3
  s_lshl2_add_u32 s55, s55, s68
  s_lshl2_add_u32 s55, s55, s44
  s_bfe_u32 s68, s2, 0x10002
  s_lshl2_add_u32 s55, s55, s68
  v_lshrrev_b32 v138, 5, v0
  v_lshl_add_u32 v138, v138, 1, s55
  v_mul_u32_u24 v136, 1280, v138
  v_and_b32 v139, 31, v0
  v_lshl_add_u32 v136, v139, 4, v136
  v_and_b32 v139, 16, v0
  v_lshl_add_u32 v137, v139, 26, v136
  v_mov_b32 v249, 0
  buffer_load_dwordx4 v[124:127], v136, s[40:43], 0 offen
  buffer_load_dwordx4 v[128:131], v136, s[40:43], 0 offen offset:512
  buffer_load_dwordx4 v[132:135], v137, s[40:43], 0 offen offset:1024
  buffer_load_dword v249, v249, s[36:39], 0 offen sc1
  s_waitcnt vmcnt(8) lgkmcnt(0)
  ds_read_b128 a[0:3], v246 offset:0
  ds_read_b128 a[4:7], v244 offset:2048
  ds_read_b128 a[8:11], v244 offset:4096
  ds_read_b128 a[12:15], v247 offset:0
  ds_read_b128 a[16:19], v245 offset:2048
  ds_read_b128 a[20:23], v245 offset:4096
  s_waitcnt vmcnt(4)
  s_barrier
  ds_read_b64_tr_b16 a[240:241], v204 offset:0
  ds_read_b64_tr_b16 a[242:243], v204 offset:512
  ds_read_b64_tr_b16 a[244:245], v204 offset:8192
  ds_read_b64_tr_b16 a[246:247], v204 offset:8704
  ds_read_b64_tr_b16 a[248:249], v204 offset:2048
  ds_read_b64_tr_b16 a[250:251], v204 offset:2560
  ds_read_b64_tr_b16 a[252:253], v204 offset:10240
  ds_read_b64_tr_b16 a[254:255], v204 offset:10752
  s_waitcnt lgkmcnt(4)
  v_mfma_f32_16x16x32_bf16 v[4:7], a[240:243], a[0:3], 0
  s_bfe_u32 s49, s60, 0x40004
  ds_read_b64_tr_b16 v[196:197], v205 offset:0
  ds_read_b64_tr_b16 v[198:199], v205 offset:512
  v_mfma_f32_16x16x32_bf16 v[4:7], a[244:247], a[12:15], v[4:7]
  s_add_u32 m0, s48, 6400
  s_lshl_b32 s49, s49, 7
  v_mfma_f32_16x16x32_bf16 v[8:11], a[244:247], a[16:19], 0
  ds_read_b64_tr_b16 v[200:201], v205 offset:8192
  ds_read_b64_tr_b16 v[202:203], v205 offset:8704
  v_mfma_f32_16x16x32_bf16 v[8:11], a[240:243], a[4:7], v[8:11]
  buffer_load_dwordx4 v238, s[24:27], s49 offen offset:0 lds
  v_mfma_f32_16x16x32_bf16 v[12:15], a[240:243], a[8:11], 0
  buffer_load_dwordx4 v239, s[24:27], s49 offen offset:1024 lds
  v_mfma_f32_16x16x32_bf16 v[12:15], a[244:247], a[20:23], v[12:15]
  s_waitcnt lgkmcnt(4)
  buffer_load_dwordx4 v240, s[24:27], s49 offen offset:2048 lds
  v_mfma_f32_16x16x32_bf16 v[52:55], a[248:251], a[0:3], 0
  ds_read_b64_tr_b16 a[240:241], v205 offset:2048
  ds_read_b64_tr_b16 a[242:243], v205 offset:2560
  v_mfma_f32_16x16x32_bf16 v[52:55], a[252:255], a[12:15], v[52:55]
  buffer_load_dwordx4 v241, s[24:27], s49 offen offset:3072 lds
  v_mfma_f32_16x16x32_bf16 v[56:59], a[252:255], a[16:19], 0
  s_add_u32 m0, s48, 10496
  ds_read_b64_tr_b16 a[244:245], v205 offset:10240
  ds_read_b64_tr_b16 a[246:247], v205 offset:10752
  v_mfma_f32_16x16x32_bf16 v[56:59], a[248:251], a[4:7], v[56:59]
  v_mfma_f32_16x16x32_bf16 v[60:63], a[248:251], a[8:11], 0
  buffer_load_dwordx4 v242, s[24:27], s49 offen offset:0 lds
  v_mfma_f32_16x16x32_bf16 v[60:63], a[252:255], a[20:23], v[60:63]
  s_waitcnt lgkmcnt(4)
  v_mfma_f32_16x16x32_bf16 v[16:19], v[196:199], a[0:3], 0
  ds_read_b64_tr_b16 a[248:249], v206 offset:0
  ds_read_b64_tr_b16 a[250:251], v206 offset:512
  v_mfma_f32_16x16x32_bf16 v[16:19], v[200:203], a[12:15], v[16:19]
  buffer_load_dwordx4 v243, s[24:27], s49 offen offset:1024 lds
  v_mfma_f32_16x16x32_bf16 v[20:23], v[200:203], a[16:19], 0
  s_bfe_u32 s51, s60, 0x40004
  ds_read_b64_tr_b16 a[252:253], v206 offset:8192
  ds_read_b64_tr_b16 a[254:255], v206 offset:8704
  v_mfma_f32_16x16x32_bf16 v[20:23], v[196:199], a[4:7], v[20:23]
  s_mul_i32 s51, s51, 221184
  s_add_u32 m0, s50, 16384
  s_add_u32 s51, s51, s52
  v_mfma_f32_16x16x32_bf16 v[24:27], v[196:199], a[8:11], 0
  buffer_load_dwordx4 v208, s[28:31], s51 offen offset:0 lds
  v_mfma_f32_16x16x32_bf16 v[24:27], v[200:203], a[20:23], v[24:27]
  s_waitcnt lgkmcnt(4)
  buffer_load_dwordx4 v209, s[28:31], s51 offen offset:1024 lds
  v_mfma_f32_16x16x32_bf16 v[64:67], a[240:243], a[0:3], 0
  ds_read_b64_tr_b16 v[196:197], v206 offset:2048
  ds_read_b64_tr_b16 v[198:199], v206 offset:2560
  v_mfma_f32_16x16x32_bf16 v[64:67], a[244:247], a[12:15], v[64:67]
  v_mfma_f32_16x16x32_bf16 v[68:71], a[244:247], a[16:19], 0
  ds_read_b64_tr_b16 v[200:201], v206 offset:10240
  ds_read_b64_tr_b16 v[202:203], v206 offset:10752
  v_mfma_f32_16x16x32_bf16 v[68:71], a[240:243], a[4:7], v[68:71]
  buffer_load_dwordx4 v208, s[32:35], s51 offen offset:2048 lds
  v_mfma_f32_16x16x32_bf16 v[72:75], a[240:243], a[8:11], 0
  buffer_load_dwordx4 v209, s[32:35], s51 offen offset:3072 lds
  v_mfma_f32_16x16x32_bf16 v[72:75], a[244:247], a[20:23], v[72:75]
  s_waitcnt lgkmcnt(4)
  v_mfma_f32_16x16x32_bf16 v[28:31], a[248:251], a[0:3], 0
  ds_read_b64_tr_b16 a[240:241], v207 offset:0
  ds_read_b64_tr_b16 a[242:243], v207 offset:512
  v_mfma_f32_16x16x32_bf16 v[28:31], a[252:255], a[12:15], v[28:31]
  s_cmp_eq_u32 s67, 0
  s_cbranch_scc1 FRP0
FRPB0:
  s_bfe_u32 s49, s60, 0x40008
  s_add_u32 m0, s48, 12672
  v_mfma_f32_16x16x32_bf16 v[32:35], a[252:255], a[16:19], 0
  s_lshl_b32 s49, s49, 7
  ds_read_b64_tr_b16 a[244:245], v207 offset:8192
  ds_read_b64_tr_b16 a[246:247], v207 offset:8704
  v_mfma_f32_16x16x32_bf16 v[32:35], a[248:251], a[4:7], v[32:35]
  buffer_load_dwordx4 v238, s[24:27], s49 offen offset:0 lds
  v_mfma_f32_16x16x32_bf16 v[36:39], a[248:251], a[8:11], 0
  buffer_load_dwordx4 v239, s[24:27], s49 offen offset:1024 lds
  v_mfma_f32_16x16x32_bf16 v[36:39], a[252:255], a[20:23], v[36:39]
  s_waitcnt lgkmcnt(4)
  buffer_load_dwordx4 v240, s[24:27], s49 offen offset:2048 lds
  buffer_load_dwordx4 v241, s[24:27], s49 offen offset:3072 lds
  s_add_u32 m0, s48, 16768
  v_mfma_f32_16x16x32_bf16 v[76:79], v[196:199], a[0:3], 0
  ds_read_b64_tr_b16 a[248:249], v207 offset:2048
  ds_read_b64_tr_b16 a[250:251], v207 offset:2560
  v_mfma_f32_16x16x32_bf16 v[76:79], v[200:203], a[12:15], v[76:79]
  s_waitcnt vmcnt(8)
  buffer_load_dwordx4 v242, s[24:27], s49 offen offset:0 lds
  buffer_load_dwordx4 v243, s[24:27], s49 offen offset:1024 lds
  s_bfe_u32 s51, s60, 0x40008
  s_mul_i32 s51, s51, 221184
  s_add_u32 m0, s50, 32768
  s_add_u32 s51, s51, s52
  v_mfma_f32_16x16x32_bf16 v[80:83], v[200:203], a[16:19], 0
  ds_read_b64_tr_b16 a[252:253], v207 offset:10240
  ds_read_b64_tr_b16 a[254:255], v207 offset:10752
  v_mfma_f32_16x16x32_bf16 v[80:83], v[196:199], a[4:7], v[80:83]
  ds_read_b128 a[24:27], v246 offset:6272
  ds_read_b128 a[28:31], v244 offset:8320
  buffer_load_dwordx4 v208, s[28:31], s51 offen offset:0 lds
  buffer_load_dwordx4 v209, s[28:31], s51 offen offset:1024 lds
  buffer_load_dwordx4 v208, s[32:35], s51 offen offset:2048 lds
  buffer_load_dwordx4 v209, s[32:35], s51 offen offset:3072 lds
  v_mfma_f32_16x16x32_bf16 v[84:87], v[196:199], a[8:11], 0
  s_waitcnt vmcnt(10)
  v_mfma_f32_16x16x32_bf16 v[84:87], v[200:203], a[20:23], v[84:87]
  s_waitcnt lgkmcnt(6)
  ds_read_b128 a[32:35], v244 offset:10368
  v_mfma_f32_16x16x32_bf16 v[40:43], a[240:243], a[0:3], 0
  s_barrier
  ds_read_b64_tr_b16 v[196:197], v204 offset:16384
  ds_read_b64_tr_b16 v[198:199], v204 offset:16896
  v_mfma_f32_16x16x32_bf16 v[40:43], a[244:247], a[12:15], v[40:43]
  s_cmp_eq_u32 s67, 1
  s_cbranch_scc1 FRP1
FRPB1:
  ds_read_b128 a[36:39], v247 offset:6272
  v_mfma_f32_16x16x32_bf16 v[44:47], a[244:247], a[16:19], 0
  s_bfe_u32 s49, s60, 0x4000c
  ds_read_b64_tr_b16 v[200:201], v204 offset:24576
  ds_read_b64_tr_b16 v[202:203], v204 offset:25088
  v_mfma_f32_16x16x32_bf16 v[44:47], a[240:243], a[4:7], v[44:47]
  s_add_u32 m0, s48, 128
  ds_read_b128 a[40:43], v245 offset:8320
  s_lshl_b32 s49, s49, 7
  v_mfma_f32_16x16x32_bf16 v[48:51], a[240:243], a[8:11], 0
  buffer_load_dwordx4 v238, s[24:27], s49 offen offset:0 lds
  v_mfma_f32_16x16x32_bf16 v[48:51], a[244:247], a[20:23], v[48:51]
  s_waitcnt lgkmcnt(9)
  ds_read_b128 a[44:47], v245 offset:10368
  v_mfma_f32_16x16x32_bf16 v[88:91], a[248:251], a[0:3], 0
  ds_read_b64_tr_b16 a[240:241], v204 offset:18432
  ds_read_b64_tr_b16 a[242:243], v204 offset:18944
  v_mfma_f32_16x16x32_bf16 v[88:91], a[252:255], a[12:15], v[88:91]
  buffer_load_dwordx4 v239, s[24:27], s49 offen offset:1024 lds
  v_mfma_f32_16x16x32_bf16 v[92:95], a[252:255], a[16:19], 0
  ds_read_b64_tr_b16 a[244:245], v204 offset:26624
  ds_read_b64_tr_b16 a[246:247], v204 offset:27136
  s_mov_b32 s55, 1664525
  v_lshlrev_b32 v140, 16, v124
  v_and_b32 v141, 0xffff0000, v124
  v_lshlrev_b32 v142, 16, v125
  v_and_b32 v143, 0xffff0000, v125
  v_lshlrev_b32 v144, 16, v126
  v_and_b32 v145, 0xffff0000, v126
  v_lshlrev_b32 v146, 16, v127
  v_and_b32 v147, 0xffff0000, v127
  v_lshlrev_b32 v148, 16, v128
  v_and_b32 v149, 0xffff0000, v128
  v_lshlrev_b32 v150, 16, v129
  v_and_b32 v151, 0xffff0000, v129
  v_lshlrev_b32 v152, 16, v130
  v_and_b32 v153, 0xffff0000, v130
  v_lshlrev_b32 v154, 16, v131
  v_and_b32 v155, 0xffff0000, v131
  v_lshlrev_b32 v156, 16, v132
  v_and_b32 v157, 0xffff0000, v132
  v_lshlrev_b32 v158, 16, v133
  v_mfma_f32_16x16x32_bf16 v[92:95], a[248:251], a[4:7], v[92:95]
  v_mfma_f32_16x16x32_bf16 v[96:99], a[248:251], a[8:11], 0
  buffer_load_dwordx4 v240, s[24:27], s49 offen offset:2048 lds
  v_mfma_f32_16x16x32_bf16 v[96:99], a[252:255], a[20:23], v[96:99]
  s_waitcnt lgkmcnt(4)
  v_mfma_f32_16x16x32_bf16 v[4:7], v[196:199], a[24:27], v[4:7]
  ds_read_b64_tr_b16 a[248:249], v205 offset:16384
  ds_read_b64_tr_b16 a[250:251], v205 offset:16896
  v_mfma_f32_16x16x32_bf16 v[4:7], v[200:203], a[36:39], v[4:7]
  v_mfma_f32_16x16x32_bf16 v[8:11], v[200:203], a[40:43], v[8:11]
  ds_read_b64_tr_b16 a[252:253], v205 offset:24576
  ds_read_b64_tr_b16 a[254:255], v205 offset:25088
  v_mfma_f32_16x16x32_bf16 v[8:11], v[196:199], a[28:31], v[8:11]
  buffer_load_dwordx4 v241, s[24:27], s49 offen offset:3072 lds
  v_mfma_f32_16x16x32_bf16 v[12:15], v[196:199], a[32:35], v[12:15]
  v_mfma_f32_16x16x32_bf16 v[12:15], v[200:203], a[44:47], v[12:15]
  s_waitcnt lgkmcnt(4)
  s_add_u32 m0, s48, 4224
  v_mfma_f32_16x16x32_bf16 v[52:55], a[240:243], a[24:27], v[52:55]
  ds_read_b64_tr_b16 v[196:197], v205 offset:18432
  ds_read_b64_tr_b16 v[198:199], v205 offset:18944
  v_mfma_f32_16x16x32_bf16 v[52:55], a[244:247], a[36:39], v[52:55]
  buffer_load_dwordx4 v242, s[24:27], s49 offen offset:0 lds
  v_mfma_f32_16x16x32_bf16 v[56:59], a[244:247], a[40:43], v[56:59]
  ds_read_b64_tr_b16 v[200:201], v205 offset:26624
  ds_read_b64_tr_b16 v[202:203], v205 offset:27136
  v_and_b32 v159, 0xffff0000, v133
  v_lshlrev_b32 v160, 16, v134
  v_and_b32 v161, 0xffff0000, v134
  v_lshlrev_b32 v162, 16, v135
  v_and_b32 v163, 0xffff0000, v135
  v_pk_add_f32 v[164:165], v[140:141], v[142:143]
  v_pk_add_f32 v[166:167], v[144:145], v[146:147]
  v_pk_add_f32 v[164:165], v[164:165], v[148:149]
  v_pk_add_f32 v[166:167], v[166:167], v[150:151]
  v_pk_add_f32 v[164:165], v[164:165], v[152:153]
  v_pk_add_f32 v[166:167], v[166:167], v[154:155]
  v_pk_add_f32 v[164:165], v[164:165], v[156:157]
  v_pk_add_f32 v[166:167], v[166:167], v[158:159]
  v_pk_add_f32 v[164:165], v[164:165], v[160:161]
  v_pk_add_f32 v[166:167], v[166:167], v[162:163]
  v_pk_add_f32 v[164:165], v[164:165], v[166:167]
  v_add_f32 v164, v164, v165
  s_nop 1
  v_add_f32_dpp v164, v164, v164 quad_perm:[1,0,3,2] row_mask:0xf bank_mask:0xf
  s_nop 1
  v_add_f32_dpp v164, v164, v164 quad_perm:[2,3,0,1] row_mask:0xf bank_mask:0xf
  s_nop 1
  v_add_f32_dpp v164, v164, v164 row_half_mirror row_mask:0xf bank_mask:0xf
  s_nop 1
  v_add_f32_dpp v164, v164, v164 row_mirror row_mask:0xf bank_mask:0xf
  v_mfma_f32_16x16x32_bf16 v[56:59], a[240:243], a[28:31], v[56:59]
  v_mfma_f32_16x16x32_bf16 v[60:63], a[240:243], a[32:35], v[60:63]
  v_mfma_f32_16x16x32_bf16 v[60:63], a[244:247], a[44:47], v[60:63]
  s_waitcnt lgkmcnt(4)
  buffer_load_dwordx4 v243, s[24:27], s49 offen offset:1024 lds
  v_mfma_f32_16x16x32_bf16 v[16:19], a[248:251], a[24:27], v[16:19]
  ds_read_b64_tr_b16 a[240:241], v206 offset:16384
  ds_read_b64_tr_b16 a[242:243], v206 offset:16896
  v_mfma_f32_16x16x32_bf16 v[16:19], a[252:255], a[36:39], v[16:19]
  v_mfma_f32_16x16x32_bf16 v[20:23], a[252:255], a[40:43], v[20:23]
  s_bfe_u32 s51, s60, 0x4000c
  ds_read_b64_tr_b16 a[244:245], v206 offset:24576
  ds_read_b64_tr_b16 a[246:247], v206 offset:25088
  v_mfma_f32_16x16x32_bf16 v[20:23], a[248:251], a[28:31], v[20:23]
  s_mul_i32 s51, s51, 221184
  s_add_u32 m0, s50, 49152
  s_add_u32 s51, s51, s52
  v_mfma_f32_16x16x32_bf16 v[24:27], a[248:251], a[32:35], v[24:27]
  buffer_load_dwordx4 v208, s[28:31], s51 offen offset:0 lds
  v_mfma_f32_16x16x32_bf16 v[24:27], a[252:255], a[44:47], v[24:27]
  s_waitcnt lgkmcnt(4)
  v_mfma_f32_16x16x32_bf16 v[64:67], v[196:199], a[24:27], v[64:67]
  ds_read_b64_tr_b16 a[248:249], v206 offset:18432
  ds_read_b64_tr_b16 a[250:251], v206 offset:18944
  v_mfma_f32_16x16x32_bf16 v[64:67], v[200:203], a[36:39], v[64:67]
  v_mfma_f32_16x16x32_bf16 v[68:71], v[200:203], a[40:43], v[68:71]
  ds_read_b64_tr_b16 a[252:253], v206 offset:26624
  ds_read_b64_tr_b16 a[254:255], v206 offset:27136
  v_mov_b32 v139, v164
  v_mul_lo_u32 v249, v249, s55
  v_and_b32 v137, 16, v0
  v_permlane16_swap_b32 v164, v139
  v_add_f32 v164, v164, v139
  v_add_u32 v249, 1013904223, v249
  v_cmp_eq_u32 vcc, 0, v137
  v_and_b32 v137, 1, v138
  v_lshrrev_b32 v138, 1, v138
  v_lshl_add_u32 v138, v137, 10, v138
  v_lshlrev_b32 v138, 4, v138
  v_mul_f32 v164, 0xbacccccd, v164
  v_pk_add_f32 v[140:141], v[140:141], v[164:165] op_sel_hi:[1,0]
  v_pk_add_f32 v[142:143], v[142:143], v[164:165] op_sel_hi:[1,0]
  v_pk_add_f32 v[144:145], v[144:145], v[164:165] op_sel_hi:[1,0]
  v_pk_add_f32 v[146:147], v[146:147], v[164:165] op_sel_hi:[1,0]
  v_pk_add_f32 v[148:149], v[148:149], v[164:165] op_sel_hi:[1,0]
  v_pk_add_f32 v[150:151], v[150:151], v[164:165] op_sel_hi:[1,0]
  v_pk_add_f32 v[152:153], v[152:153], v[164:165] op_sel_hi:[1,0]
  v_pk_add_f32 v[154:155], v[154:155], v[164:165] op_sel_hi:[1,0]
  v_cndmask_b32 v165, 0, v164, vcc
  v_mfma_f32_16x16x32_bf16 v[68:71], v[196:199], a[28:31], v[68:71]
  buffer_load_dwordx4 v209, s[28:31], s51 offen offset:1024 lds
  v_mfma_f32_16x16x32_bf16 v[72:75], v[196:199], a[32:35], v[72:75]
  v_mfma_f32_16x16x32_bf16 v[72:75], v[200:203], a[44:47], v[72:75]
  s_waitcnt lgkmcnt(4)
  v_mfma_f32_16x16x32_bf16 v[28:31], a[240:243], a[24:27], v[28:31]
  ds_read_b64_tr_b16 v[196:197], v207 offset:16384
  ds_read_b64_tr_b16 v[198:199], v207 offset:16896
  v_mfma_f32_16x16x32_bf16 v[28:31], a[244:247], a[36:39], v[28:31]
  buffer_load_dwordx4 v208, s[32:35], s51 offen offset:2048 lds
  v_mfma_f32_16x16x32_bf16 v[32:35], a[244:247], a[40:43], v[32:35]
  ds_read_b64_tr_b16 v[200:201], v207 offset:24576
  ds_read_b64_tr_b16 v[202:203], v207 offset:25088
  v_mfma_f32_16x16x32_bf16 v[32:35], a[240:243], a[28:31], v[32:35]
  v_mfma_f32_16x16x32_bf16 v[36:39], a[240:243], a[32:35], v[36:39]
  v_mfma_f32_16x16x32_bf16 v[36:39], a[244:247], a[44:47], v[36:39]
  s_waitcnt lgkmcnt(4)
  buffer_load_dwordx4 v209, s[32:35], s51 offen offset:3072 lds
  v_mfma_f32_16x16x32_bf16 v[76:79], a[248:251], a[24:27], v[76:79]
  ds_read_b64_tr_b16 a[240:241], v207 offset:18432
  ds_read_b64_tr_b16 a[242:243], v207 offset:18944
  v_mfma_f32_16x16x32_bf16 v[76:79], a[252:255], a[36:39], v[76:79]
  s_waitcnt vmcnt(14)
  ds_read_b128 a[48:51], v246 offset:12544
  v_mfma_f32_16x16x32_bf16 v[80:83], a[252:255], a[40:43], v[80:83]
  ds_read_b64_tr_b16 a[244:245], v207 offset:26624
  ds_read_b64_tr_b16 a[246:247], v207 offset:27136
  v_pk_add_f32 v[156:157], v[156:157], v[164:165] op_sel:[0,1] op_sel_hi:[1,1]
  v_pk_add_f32 v[158:159], v[158:159], v[164:165] op_sel:[0,1] op_sel_hi:[1,1]
  v_pk_add_f32 v[160:161], v[160:161], v[164:165] op_sel:[0,1] op_sel_hi:[1,1]
  v_pk_add_f32 v[162:163], v[162:163], v[164:165] op_sel:[0,1] op_sel_hi:[1,1]
  v_pk_mul_f32 v[166:167], v[140:141], v[140:141]
  v_pk_fma_f32 v[166:167], v[142:143], v[142:143], v[166:167]
  v_pk_fma_f32 v[166:167], v[144:145], v[144:145], v[166:167]
  v_pk_fma_f32 v[166:167], v[146:147], v[146:147], v[166:167]
  v_pk_fma_f32 v[166:167], v[148:149], v[148:149], v[166:167]
  v_pk_fma_f32 v[166:167], v[150:151], v[150:151], v[166:167]
  v_pk_fma_f32 v[166:167], v[152:153], v[152:153], v[166:167]
  v_pk_fma_f32 v[166:167], v[154:155], v[154:155], v[166:167]
  v_pk_fma_f32 v[166:167], v[156:157], v[156:157], v[166:167]
  v_pk_fma_f32 v[166:167], v[158:159], v[158:159], v[166:167]
  v_pk_fma_f32 v[166:167], v[160:161], v[160:161], v[166:167]
  v_pk_fma_f32 v[166:167], v[162:163], v[162:163], v[166:167]
  v_add_f32 v166, v166, v167
  s_nop 1
  v_add_f32_dpp v166, v166, v166 quad_perm:[1,0,3,2] row_mask:0xf bank_mask:0xf
  s_nop 1
  v_add_f32_dpp v166, v166, v166 quad_perm:[2,3,0,1] row_mask:0xf bank_mask:0xf
  s_nop 1
  v_add_f32_dpp v166, v166, v166 row_half_mirror row_mask:0xf bank_mask:0xf
  s_nop 1
  v_add_f32_dpp v166, v166, v166 row_mirror row_mask:0xf bank_mask:0xf
  v_mfma_f32_16x16x32_bf16 v[80:83], a[248:251], a[28:31], v[80:83]
  ds_read_b128 a[52:55], v244 offset:14592
  v_mfma_f32_16x16x32_bf16 v[84:87], a[248:251], a[32:35], v[84:87]
  s_waitcnt vmcnt(10)
  v_mfma_f32_16x16x32_bf16 v[84:87], a[252:255], a[44:47], v[84:87]
  s_waitcnt lgkmcnt(6)
  ds_read_b128 a[56:59], v244 offset:16640
  v_mfma_f32_16x16x32_bf16 v[40:43], v[196:199], a[24:27], v[40:43]
  s_barrier
  ds_read_b64_tr_b16 a[248:249], v204 offset:32768
  ds_read_b64_tr_b16 a[250:251], v204 offset:33280
  v_mfma_f32_16x16x32_bf16 v[40:43], v[200:203], a[36:39], v[40:43]
  s_cmp_eq_u32 s67, 2
  s_cbranch_scc1 FRP2
FRPB2:
  ds_read_b128 a[60:63], v247 offset:12544
  v_mfma_f32_16x16x32_bf16 v[44:47], v[200:203], a[40:43], v[44:47]
  s_bfe_u32 s49, s60, 0x40010
  ds_read_b64_tr_b16 a[252:253], v204 offset:40960
  ds_read_b64_tr_b16 a[254:255], v204 offset:41472
  v_mfma_f32_16x16x32_bf16 v[44:47], v[196:199], a[28:31], v[44:47]
  s_add_u32 m0, s48, 6400
  ds_read_b128 a[64:67], v245 offset:14592
  s_lshl_b32 s49, s49, 7
  v_mfma_f32_16x16x32_bf16 v[48:51], v[196:199], a[32:35], v[48:51]
  buffer_load_dwordx4 v238, s[24:27], s49 offen offset:0 lds
  v_mfma_f32_16x16x32_bf16 v[48:51], v[200:203], a[44:47], v[48:51]
  s_waitcnt lgkmcnt(8)
  ds_read_b128 a[68:71], v245 offset:16640
  v_mfma_f32_16x16x32_bf16 v[88:91], a[240:243], a[24:27], v[88:91]
  ds_read_b64_tr_b16 v[196:197], v204 offset:34816
  ds_read_b64_tr_b16 v[198:199], v204 offset:35328
  v_mfma_f32_16x16x32_bf16 v[88:91], a[244:247], a[36:39], v[88:91]
  buffer_load_dwordx4 v239, s[24:27], s49 offen offset:1024 lds
  v_mfma_f32_16x16x32_bf16 v[92:95], a[244:247], a[40:43], v[92:95]
  ds_read_b64_tr_b16 v[200:201], v204 offset:43008
  ds_read_b64_tr_b16 v[202:203], v204 offset:43520
  v_mov_b32 v139, v166
  v_cvt_pk_bf16_f32 v164, v164, v164
  v_and_b32 v137, 31, v0
  v_permlane16_swap_b32 v166, v139
  v_add_f32 v166, v166, v139
  v_lshlrev_b32 v124, 16, v164
  v_lshl_add_u32 v138, v137, 25, v138
  v_mov_b32 v125, v249
  v_add_u32 v138, 4096, v138
  v_mul_f32 v166, 0x3acccccd, v166
  v_cvt_pk_bf16_f32 v166, v166, v166
  v_lshlrev_b32 v166, 16, v166
  v_add_f32 v166, 0x3727c5ac, v166
  v_cvt_pk_bf16_f32 v166, v166, v166
  v_lshlrev_b32 v166, 16, v166
  v_sqrt_f32 v166, v166
  v_mov_b32 v127, v249
  v_cvt_pk_bf16_f32 v166, v166, v166
  v_lshlrev_b32 v126, 16, v166
  buffer_store_dwordx4 v[124:127], v138, s[36:39], 0 offen sc1
  v_lshlrev_b32 v248, 4, v0
  v_mfma_f32_16x16x32_bf16 v[92:95], a[240:243], a[28:31], v[92:95]
  v_mfma_f32_16x16x32_bf16 v[96:99], a[240:243], a[32:35], v[96:99]
  buffer_load_dwordx4 v240, s[24:27], s49 offen offset:2048 lds
  v_mfma_f32_16x16x32_bf16 v[96:99], a[244:247], a[44:47], v[96:99]
  s_waitcnt lgkmcnt(4)
  v_mfma_f32_16x16x32_bf16 v[4:7], a[248:251], a[48:51], v[4:7]
  ds_read_b64_tr_b16 a[240:241], v205 offset:32768
  ds_read_b64_tr_b16 a[242:243], v205 offset:33280
  v_mfma_f32_16x16x32_bf16 v[4:7], a[252:255], a[60:63], v[4:7]
  v_mfma_f32_16x16x32_bf16 v[8:11], a[252:255], a[64:67], v[8:11]
  s_mov_b64 exec, 0
  s_cmp_lt_u32 s44, 1
  s_cbranch_scc1 FHOP0
  s_cmp_lt_u32 s44, 2
  s_cbranch_scc1 FHOP1
  s_cmp_lt_u32 s44, 3
  s_cbranch_scc1 FHOP2
  s_branch FHOP3
FHRET:
  s_mov_b64 exec, -1
  ds_read_b64_tr_b16 a[244:245], v205 offset:40960
  ds_read_b64_tr_b16 a[246:247], v205 offset:41472
  v_mfma_f32_16x16x32_bf16 v[8:11], a[248:251], a[52:55], v[8:11]
  buffer_load_dwordx4 v241, s[24:27], s49 offen offset:3072 lds
  v_mfma_f32_16x16x32_bf16 v[12:15], a[248:251], a[56:59], v[12:15]
  v_mfma_f32_16x16x32_bf16 v[12:15], a[252:255], a[68:71], v[12:15]
  s_waitcnt lgkmcnt(4)
  s_add_u32 m0, s48, 10496
  v_mfma_f32_16x16x32_bf16 v[52:55], v[196:199], a[48:51], v[52:55]
  ds_read_b64_tr_b16 a[248:249], v205 offset:34816
  ds_read_b64_tr_b16 a[250:251], v205 offset:35328
  v_mfma_f32_16x16x32_bf16 v[52:55], v[200:203], a[60:63], v[52:55]
  buffer_load_dwordx4 v242, s[24:27], s49 offen offset:0 lds
  v_mfma_f32_16x16x32_bf16 v[56:59], v[200:203], a[64:67], v[56:59]
  s_bfe_u32 s55, s2, 0x30003
  ds_read_b64_tr_b16 a[252:253], v205 offset:43008
  ds_read_b64_tr_b16 a[254:255], v205 offset:43520
  s_mul_i32 s56, s55, 378880
  s_add_u32 s56, s56, 0xb00000
  s_mul_i32 s57, s44, 7
  s_mul_i32 s64, s57, 5120
  s_add_u32 s64, s64, s56
  s_mul_i32 s58, s44, 6
  s_mul_i32 s65, s58, 5120
  s_add_u32 s65, s65, s56
  s_add_u32 s65, s65, 143360
  s_mul_i32 s66, s44, 25600
  s_add_u32 s66, s66, s56
  s_add_u32 s66, s66, 276480
  s_mul_i32 s55, s55, 5
  s_lshr_b32 s55, s55, 2
  v_lshrrev_b32 v224, 1, v0
  v_min_u32 v224, 13, v224
  s_and_b32 s56, s44, 1
  s_add_u32 s56, s56, 39
  v_mov_b32 v225, s56
  s_add_u32 s56, s58, 21
  v_mfma_f32_16x16x32_bf16 v[56:59], v[196:199], a[52:55], v[56:59]
  v_mfma_f32_16x16x32_bf16 v[60:63], v[196:199], a[56:59], v[60:63]
  v_mfma_f32_16x16x32_bf16 v[60:63], v[200:203], a[68:71], v[60:63]
  s_waitcnt lgkmcnt(4)
  buffer_load_dwordx4 v243, s[24:27], s49 offen offset:1024 lds
  v_mfma_f32_16x16x32_bf16 v[16:19], a[240:243], a[48:51], v[16:19]
FHOP0:
  s_cbranch_execz FHOP4
  ds_read_b64_tr_b16 v[196:197], v206 offset:32768
  ds_read_b64_tr_b16 v[198:199], v206 offset:33280
  v_mfma_f32_16x16x32_bf16 v[16:19], a[244:247], a[60:63], v[16:19]
  v_mfma_f32_16x16x32_bf16 v[20:23], a[244:247], a[64:67], v[20:23]
  s_bfe_u32 s51, s60, 0x40010
  ds_read_b64_tr_b16 v[200:201], v206 offset:40960
  ds_read_b64_tr_b16 v[202:203], v206 offset:41472
  v_mfma_f32_16x16x32_bf16 v[20:23], a[240:243], a[52:55], v[20:23]
  s_mul_i32 s51, s51, 221184
  s_add_u32 m0, s50, 0
  s_add_u32 s51, s51, s52
  v_mfma_f32_16x16x32_bf16 v[24:27], a[240:243], a[56:59], v[24:27]
  buffer_load_dwordx4 v208, s[28:31], s51 offen offset:0 lds
  v_mfma_f32_16x16x32_bf16 v[24:27], a[244:247], a[68:71], v[24:27]
  s_waitcnt lgkmcnt(4)
  v_mfma_f32_16x16x32_bf16 v[64:67], a[248:251], a[48:51], v[64:67]
  ds_read_b64_tr_b16 a[240:241], v206 offset:34816
  ds_read_b64_tr_b16 a[242:243], v206 offset:35328
  v_mfma_f32_16x16x32_bf16 v[64:67], a[252:255], a[60:63], v[64:67]
  v_mfma_f32_16x16x32_bf16 v[68:71], a[252:255], a[64:67], v[68:71]
  ds_read_b64_tr_b16 a[244:245], v206 offset:43008
  ds_read_b64_tr_b16 a[246:247], v206 offset:43520
  v_mov_b32 v226, s56
  v_cmp_gt_u32 vcc, 13, v224
  s_nop 1
  v_cndmask_b32 v225, v225, v226, vcc
  v_mov_b32 v226, s57
  v_cmp_gt_u32 vcc, 7, v224
  s_nop 1
  v_cndmask_b32 v225, v225, v226, vcc
  v_add_u32 v224, v224, v225
  v_and_b32 v225, 1, v0
  v_lshl_add_u32 v224, v224, 4, v225
  v_add_u32 v224, s55, v224
  v_lshlrev_b32 v224, 6, v224
  v_add_u32 v251, 0x10000, v224
  s_and_b32 s55, s2, 7
  s_and_b32 s62, s55, 3
  s_lshl_b32 s62, s62, 2
  s_lshr_b32 s62, 0x02103210, s62
  s_and_b32 s62, s62, 0xffff
  s_or_b32 s62, s62, 0x40000
  s_lshl_b32 s56, s55, 2
  s_lshr_b32 s56, 0x40840840, s56
  s_and_b32 s56, s56, 15
  v_mfma_f32_16x16x32_bf16 v[68:71], a[248:251], a[52:55], v[68:71]
  buffer_load_dwordx4 v209, s[28:31], s51 offen offset:1024 lds
  v_mfma_f32_16x16x32_bf16 v[72:75], a[248:251], a[56:59], v[72:75]
  v_mfma_f32_16x16x32_bf16 v[72:75], a[252:255], a[68:71], v[72:75]
  s_waitcnt lgkmcnt(4)
  v_mfma_f32_16x16x32_bf16 v[28:31], v[196:199], a[48:51], v[28:31]
  ds_read_b64_tr_b16 a[248:249], v207 offset:32768
  ds_read_b64_tr_b16 a[250:251], v207 offset:33280
  v_mfma_f32_16x16x32_bf16 v[28:31], v[200:203], a[60:63], v[28:31]
  buffer_load_dwordx4 v208, s[32:35], s51 offen offset:2048 lds
  v_mfma_f32_16x16x32_bf16 v[32:35], v[200:203], a[64:67], v[32:35]
  ds_read_b64_tr_b16 a[252:253], v207 offset:40960
  ds_read_b64_tr_b16 a[254:255], v207 offset:41472
  v_mfma_f32_16x16x32_bf16 v[32:35], v[196:199], a[52:55], v[32:35]
  v_mfma_f32_16x16x32_bf16 v[36:39], v[196:199], a[56:59], v[36:39]
  v_mfma_f32_16x16x32_bf16 v[36:39], v[200:203], a[68:71], v[36:39]
  s_waitcnt lgkmcnt(4)
  buffer_load_dwordx4 v209, s[32:35], s51 offen offset:3072 lds
  v_mfma_f32_16x16x32_bf16 v[76:79], a[240:243], a[48:51], v[76:79]
  ds_read_b64_tr_b16 v[196:197], v207 offset:34816
  ds_read_b64_tr_b16 v[198:199], v207 offset:35328
  v_mfma_f32_16x16x32_bf16 v[76:79], a[244:247], a[60:63], v[76:79]
  s_waitcnt vmcnt(15)
  ds_read_b128 a[72:75], v246 offset:0
  v_mfma_f32_16x16x32_bf16 v[80:83], a[244:247], a[64:67], v[80:83]
  s_lshr_b32 s69, 0x20420, s56
  ds_read_b64_tr_b16 v[200:201], v207 offset:43008
  ds_read_b64_tr_b16 v[202:203], v207 offset:43520
  s_and_b32 s69, s69, 0xfff
  s_bitcmp1_b32 s44, 0
  s_cselect_b32 s56, 0x111, 0
  s_mov_b32 s59, 0x3165316
  s_cselect_b32 s59, 0x4206420, s59
  s_add_u32 s69, s69, s56
  s_and_b32 s56, s55, 3
  s_lshl_b32 s56, s56, 2
  s_lshr_b32 s59, s59, s56
  s_lshl_b32 s59, s59, 12
  s_or_b32 s69, s69, s59
  s_cmp_ge_u32 s55, 6
  s_cselect_b32 s56, 6, 0
  s_sub_u32 s55, s55, s56
  s_lshl_b32 s55, s55, 2
  s_lshr_b32 s23, 0x543210, s55
  s_sub_u32 s55, 24, s55
  s_lshl_b32 s55, 0x543210, s55
  s_or_b32 s23, s23, s55
  s_and_b32 s23, s23, 0xffffff
  s_and_b32 s55, s44, 1
  s_add_u32 s55, s55, 24
  s_sub_u32 s55, s55, s58
  s_lshl_b32 s55, s55, 24
  v_mfma_f32_16x16x32_bf16 v[80:83], a[240:243], a[52:55], v[80:83]
  ds_read_b128 a[76:79], v244 offset:2048
  v_mfma_f32_16x16x32_bf16 v[84:87], a[240:243], a[56:59], v[84:87]
  s_waitcnt vmcnt(11)
  v_mfma_f32_16x16x32_bf16 v[84:87], a[244:247], a[68:71], v[84:87]
  s_waitcnt lgkmcnt(6)
  ds_read_b128 a[80:83], v244 offset:4096
  v_mfma_f32_16x16x32_bf16 v[40:43], a[248:251], a[48:51], v[40:43]
  s_barrier
  ds_read_b64_tr_b16 a[240:241], v204 offset:49152
  ds_read_b64_tr_b16 a[242:243], v204 offset:49664
  v_mfma_f32_16x16x32_bf16 v[40:43], a[252:255], a[60:63], v[40:43]
  s_cmp_eq_u32 s67, 3
  s_cbranch_scc1 FRP3
FRPB3:
  ds_read_b128 a[84:87], v247 offset:0
  v_mfma_f32_16x16x32_bf16 v[44:47], a[252:255], a[64:67], v[44:47]
  s_bfe_u32 s49, s60, 0x40014
  ds_read_b64_tr_b16 a[244:245], v204 offset:57344
  ds_read_b64_tr_b16 a[246:247], v204 offset:57856
  v_mfma_f32_16x16x32_bf16 v[44:47], a[248:251], a[52:55], v[44:47]
  s_add_u32 m0, s48, 12672
  ds_read_b128 a[88:91], v245 offset:2048
  s_lshl_b32 s49, s49, 7
  v_mfma_f32_16x16x32_bf16 v[48:51], a[248:251], a[56:59], v[48:51]
  buffer_load_dwordx4 v238, s[24:27], s49 offen offset:0 lds
  v_mfma_f32_16x16x32_bf16 v[48:51], a[252:255], a[68:71], v[48:51]
  s_waitcnt lgkmcnt(8)
  ds_read_b128 a[92:95], v245 offset:4096
  v_mfma_f32_16x16x32_bf16 v[88:91], v[196:199], a[48:51], v[88:91]
  ds_read_b64_tr_b16 a[248:249], v204 offset:51200
  ds_read_b64_tr_b16 a[250:251], v204 offset:51712
  v_mfma_f32_16x16x32_bf16 v[88:91], v[200:203], a[60:63], v[88:91]
  buffer_load_dwordx4 v239, s[24:27], s49 offen offset:1024 lds
  v_mfma_f32_16x16x32_bf16 v[92:95], v[200:203], a[64:67], v[92:95]
  s_or_b32 s23, s23, s55
  ds_read_b64_tr_b16 a[252:253], v204 offset:59392
  ds_read_b64_tr_b16 a[254:255], v204 offset:59904
  s_mul_i32 s22, s44, 5120
  s_and_b32 s55, s2, 3
  s_lshl_b32 s55, s55, 2
  s_lshr_b32 s56, s2, 6
  s_add_u32 s55, s55, s56
  s_lshl_b32 s55, s55, 6
  s_bfe_u32 s59, s2, 0x10002
  s_lshl1_add_u32 s56, s59, s55
  s_mul_i32 s56, s56, 1395
  s_lshr_b32 s56, s56, 16
  v_bfe_u32 v224, v0, 3, 2
  v_add_u32 v225, s56, v224
  s_lshl1_add_u32 s56, s59, s55
  s_add_u32 s56, s56, 63
  s_mul_i32 s56, s56, 1395
  s_lshr_b32 s56, s56, 16
  v_min_u32 v225, s56, v225
  s_mul_i32 s56, s59, 22
  v_add_u32 v225, s56, v225
  v_and_b32 v226, 7, v0
  v_mfma_f32_16x16x32_bf16 v[92:95], v[196:199], a[52:55], v[92:95]
  v_mfma_f32_16x16x32_bf16 v[96:99], v[196:199], a[56:59], v[96:99]
  buffer_load_dwordx4 v240, s[24:27], s49 offen offset:2048 lds
  v_mfma_f32_16x16x32_bf16 v[96:99], v[200:203], a[68:71], v[96:99]
  s_waitcnt lgkmcnt(4)
  v_mfma_f32_16x16x32_bf16 v[4:7], a[240:243], a[72:75], v[4:7]
  ds_read_b64_tr_b16 v[196:197], v205 offset:49152
  ds_read_b64_tr_b16 v[198:199], v205 offset:49664
  v_mfma_f32_16x16x32_bf16 v[4:7], a[244:247], a[84:87], v[4:7]
  v_mfma_f32_16x16x32_bf16 v[8:11], a[244:247], a[88:91], v[8:11]
  ds_read_b64_tr_b16 v[200:201], v205 offset:57344
  ds_read_b64_tr_b16 v[202:203], v205 offset:57856
  v_mfma_f32_16x16x32_bf16 v[8:11], a[240:243], a[76:79], v[8:11]
  buffer_load_dwordx4 v241, s[24:27], s49 offen offset:3072 lds
  v_mfma_f32_16x16x32_bf16 v[12:15], a[240:243], a[80:83], v[12:15]
  v_mfma_f32_16x16x32_bf16 v[12:15], a[244:247], a[92:95], v[12:15]
  s_waitcnt lgkmcnt(4)
  s_add_u32 m0, s48, 16768
  v_mfma_f32_16x16x32_bf16 v[52:55], a[248:251], a[72:75], v[52:55]
  ds_read_b64_tr_b16 a[240:241], v205 offset:51200
  ds_read_b64_tr_b16 a[242:243], v205 offset:51712
  v_mfma_f32_16x16x32_bf16 v[52:55], a[252:255], a[84:87], v[52:55]
  buffer_load_dwordx4 v242, s[24:27], s49 offen offset:0 lds
  v_mfma_f32_16x16x32_bf16 v[56:59], a[252:255], a[88:91], v[56:59]
  ds_read_b64_tr_b16 a[244:245], v205 offset:59392
  ds_read_b64_tr_b16 a[246:247], v205 offset:59904
  v_min_u32 v252, 6, v226
  v_add_u32 v252, s57, v252
  v_lshrrev_b32 v252, 1, v252
  v_lshl_add_u32 v252, v252, 6, v225
  v_lshlrev_b32 v252, 6, v252
  v_add_u32 v252, 0x40000, v252
  v_add_u32 v253, s58, v226
  v_lshrrev_b32 v253, 1, v253
  v_cmp_gt_u32 vcc, 6, v226
  s_nop 1
  v_cndmask_b32 v253, 12, v253, vcc
  v_lshl_add_u32 v253, v253, 6, v225
  v_lshlrev_b32 v253, 6, v253
  v_add_u32 v253, 0x50000, v253
  s_mul_i32 s56, s55, 3049
  s_lshr_b32 s56, s56, 19
  s_mul_i32 s57, s56, 172
  s_sub_u32 s57, s55, s57
  s_add_u32 s57, s57, 4
  s_mul_i32 s57, s57, 1490
  s_lshr_b32 s57, s57, 16
  s_lshl_b32 s56, s56, 2
  v_mfma_f32_16x16x32_bf16 v[56:59], a[248:251], a[76:79], v[56:59]
  v_mfma_f32_16x16x32_bf16 v[60:63], a[248:251], a[80:83], v[60:63]
  v_mfma_f32_16x16x32_bf16 v[60:63], a[252:255], a[92:95], v[60:63]
  s_waitcnt lgkmcnt(4)
  buffer_load_dwordx4 v243, s[24:27], s49 offen offset:1024 lds
  v_mfma_f32_16x16x32_bf16 v[16:19], v[196:199], a[72:75], v[16:19]
  ds_read_b64_tr_b16 a[248:249], v206 offset:49152
  ds_read_b64_tr_b16 a[250:251], v206 offset:49664
  v_mfma_f32_16x16x32_bf16 v[16:19], v[200:203], a[84:87], v[16:19]
  v_mfma_f32_16x16x32_bf16 v[20:23], v[200:203], a[88:91], v[20:23]
  s_bfe_u32 s51, s60, 0x40014
  ds_read_b64_tr_b16 a[252:253], v206 offset:57344
  ds_read_b64_tr_b16 a[254:255], v206 offset:57856
  v_mfma_f32_16x16x32_bf16 v[20:23], v[196:199], a[76:79], v[20:23]
  s_mul_i32 s51, s51, 221184
  s_add_u32 m0, s50, 16384
  s_add_u32 s51, s51, s52
  v_mfma_f32_16x16x32_bf16 v[24:27], v[196:199], a[80:83], v[24:27]
  buffer_load_dwordx4 v208, s[28:31], s51 offen offset:0 lds
  v_mfma_f32_16x16x32_bf16 v[24:27], v[200:203], a[92:95], v[24:27]
  s_waitcnt lgkmcnt(4)
  v_mfma_f32_16x16x32_bf16 v[64:67], a[240:243], a[72:75], v[64:67]
  ds_read_b64_tr_b16 v[196:197], v206 offset:51200
  ds_read_b64_tr_b16 v[198:199], v206 offset:51712
  v_mfma_f32_16x16x32_bf16 v[64:67], a[244:247], a[84:87], v[64:67]
  v_mfma_f32_16x16x32_bf16 v[68:71], a[244:247], a[88:91], v[68:71]
  s_add_u32 s56, s56, s57
  ds_read_b64_tr_b16 v[200:201], v206 offset:59392
  ds_read_b64_tr_b16 v[202:203], v206 offset:59904
  v_add_u32 v224, s56, v224
  s_add_u32 s55, s55, 63
  s_mul_i32 s56, s55, 3049
  s_lshr_b32 s56, s56, 19
  s_mul_i32 s57, s56, 172
  s_sub_u32 s57, s55, s57
  s_add_u32 s57, s57, 4
  s_mul_i32 s57, s57, 1490
  s_lshr_b32 s57, s57, 16
  s_lshl_b32 s56, s56, 2
  s_add_u32 s56, s56, s57
  v_min_u32 v224, s56, v224
  s_mul_i32 s59, s59, 24
  s_lshl_b32 s56, s44, 7
  s_add_u32 s59, s59, s56
  v_add_u32 v224, s59, v224
  v_and_b32 v225, 1, v0
  v_lshl_add_u32 v224, v225, 6, v224
  v_lshlrev_b32 v224, 6, v224
  v_add_u32 v224, 0xa0000, v224
  v_mfma_f32_16x16x32_bf16 v[68:71], a[240:243], a[76:79], v[68:71]
  buffer_load_dwordx4 v209, s[28:31], s51 offen offset:1024 lds
  v_mfma_f32_16x16x32_bf16 v[72:75], a[240:243], a[80:83], v[72:75]
  v_mfma_f32_16x16x32_bf16 v[72:75], a[244:247], a[92:95], v[72:75]
  s_waitcnt lgkmcnt(4)
  v_mfma_f32_16x16x32_bf16 v[28:31], a[248:251], a[72:75], v[28:31]
  ds_read_b64_tr_b16 a[240:241], v207 offset:49152
  ds_read_b64_tr_b16 a[242:243], v207 offset:49664
  v_mfma_f32_16x16x32_bf16 v[28:31], a[252:255], a[84:87], v[28:31]
  buffer_load_dwordx4 v208, s[32:35], s51 offen offset:2048 lds
  v_mfma_f32_16x16x32_bf16 v[32:35], a[252:255], a[88:91], v[32:35]
  ds_read_b64_tr_b16 a[244:245], v207 offset:57344
  ds_read_b64_tr_b16 a[246:247], v207 offset:57856
  v_mfma_f32_16x16x32_bf16 v[32:35], a[248:251], a[76:79], v[32:35]
  v_mfma_f32_16x16x32_bf16 v[36:39], a[248:251], a[80:83], v[36:39]
  v_mfma_f32_16x16x32_bf16 v[36:39], a[252:255], a[92:95], v[36:39]
  s_waitcnt lgkmcnt(4)
  buffer_load_dwordx4 v209, s[32:35], s51 offen offset:3072 lds
  v_mfma_f32_16x16x32_bf16 v[76:79], v[196:199], a[72:75], v[76:79]
  ds_read_b64_tr_b16 a[248:249], v207 offset:51200
  ds_read_b64_tr_b16 a[250:251], v207 offset:51712
  v_mfma_f32_16x16x32_bf16 v[76:79], v[200:203], a[84:87], v[76:79]
  s_waitcnt vmcnt(14)
  ds_read_b128 a[96:99], v246 offset:6272
  v_mfma_f32_16x16x32_bf16 v[80:83], v[200:203], a[88:91], v[80:83]
  ds_read_b64_tr_b16 a[252:253], v207 offset:59392
  ds_read_b64_tr_b16 a[254:255], v207 offset:59904
  v_cmp_gt_u32 vcc, 32, v0
  v_add_u32 v225, 131072, v252
  s_nop 0
  v_cndmask_b32 v253, v224, v253, vcc
  s_mul_i32 s55, s44, 5
  s_add_u32 s55, s55, 54
  v_min_u32 v224, 3, v226
  v_add_u32 v224, s55, v224
  v_lshlrev_b32 v224, 10, v224
  v_add_u32 v224, 0x10000, v224
  v_cndmask_b32 v251, v224, v251, vcc
  v_cndmask_b32 v252, v225, v252, vcc
  v_add_u32 v224, 1024, v224
  v_cmp_eq_u32 vcc, 7, v0
  s_nop 1
  v_cndmask_b32 v252, v252, v224, vcc
  s_max_i32 s59, s45, 0
  v_and_b32 v224, 15, v0
  v_add_u32 v225, -1, v224
  v_add_u32 v225, s45, v225
  v_mad_i32_i24 v225, v212, 32, v225
  v_lshrrev_b32 v226, 6, v225
  v_mul_u32_u24 v226, 303104, v226
  v_mfma_f32_16x16x32_bf16 v[80:83], v[196:199], a[76:79], v[80:83]
  ds_read_b128 a[100:103], v244 offset:8320
  v_mfma_f32_16x16x32_bf16 v[84:87], v[196:199], a[80:83], v[84:87]
  s_waitcnt vmcnt(10)
  v_mfma_f32_16x16x32_bf16 v[84:87], v[200:203], a[92:95], v[84:87]
  s_waitcnt lgkmcnt(6)
  ds_read_b128 a[104:107], v244 offset:10368
  v_mfma_f32_16x16x32_bf16 v[40:43], a[240:243], a[72:75], v[40:43]
  s_barrier
  ds_read_b64_tr_b16 v[196:197], v204 offset:0
  ds_read_b64_tr_b16 v[198:199], v204 offset:512
  v_mfma_f32_16x16x32_bf16 v[40:43], a[244:247], a[84:87], v[40:43]
  s_cmp_eq_u32 s67, 4
  s_cbranch_scc1 FRP4
FRPB4:
  ds_read_b128 a[108:111], v247 offset:6272
  v_mfma_f32_16x16x32_bf16 v[44:47], a[244:247], a[88:91], v[44:47]
  s_bfe_u32 s49, s60, 0x40018
  ds_read_b64_tr_b16 v[200:201], v204 offset:8192
  ds_read_b64_tr_b16 v[202:203], v204 offset:8704
  v_mfma_f32_16x16x32_bf16 v[44:47], a[240:243], a[76:79], v[44:47]
  s_add_u32 m0, s48, 128
  ds_read_b128 a[112:115], v245 offset:8320
  s_lshl_b32 s49, s49, 7
  v_mfma_f32_16x16x32_bf16 v[48:51], a[240:243], a[80:83], v[48:51]
  buffer_load_dwordx4 v238, s[24:27], s49 offen offset:0 lds
  v_mfma_f32_16x16x32_bf16 v[48:51], a[244:247], a[92:95], v[48:51]
  s_waitcnt lgkmcnt(8)
  ds_read_b128 a[116:119], v245 offset:10368
  v_mfma_f32_16x16x32_bf16 v[88:91], a[248:251], a[72:75], v[88:91]
  ds_read_b64_tr_b16 a[240:241], v204 offset:2048
  ds_read_b64_tr_b16 a[242:243], v204 offset:2560
  v_mfma_f32_16x16x32_bf16 v[88:91], a[252:255], a[84:87], v[88:91]
  buffer_load_dwordx4 v239, s[24:27], s49 offen offset:1024 lds
  v_mfma_f32_16x16x32_bf16 v[92:95], a[252:255], a[88:91], v[92:95]
  ds_read_b64_tr_b16 a[244:245], v204 offset:10240
  ds_read_b64_tr_b16 a[246:247], v204 offset:10752
  v_bfe_u32 v227, v225, 4, 2
  v_lshl_add_u32 v226, v227, 10, v226
  v_and_b32 v227, 15, v225
  v_lshl_add_u32 v226, v227, 4, v226
  v_lshrrev_b32 v227, 4, v0
  v_lshl_add_u32 v226, v227, 8, v226
  v_mov_b32 v227, 0x40000000
  v_cmp_gt_i32 vcc, s47, v225
  v_and_b32 v224, 15, v0
  s_nop 0
  v_cndmask_b32 v1, v227, v226, vcc
  v_cmp_le_i32 vcc, s59, v225
  v_max_i32 v225, 0, v225
  v_min_u32 v225, 0x3ff, v225
  v_cndmask_b32 v1, v227, v1, vcc
  v_lshlrev_b32 v229, 4, v225
  v_add_u32 v225, 15, v224
  v_add_u32 v225, s45, v225
  v_mad_i32_i24 v225, v212, -16, v225
  v_lshrrev_b32 v226, 6, v225
  v_mul_u32_u24 v226, 303104, v226
  v_bfe_u32 v227, v225, 4, 2
  v_mfma_f32_16x16x32_bf16 v[92:95], a[248:251], a[76:79], v[92:95]
  v_mfma_f32_16x16x32_bf16 v[96:99], a[248:251], a[80:83], v[96:99]
  buffer_load_dwordx4 v240, s[24:27], s49 offen offset:2048 lds
  v_mfma_f32_16x16x32_bf16 v[96:99], a[252:255], a[92:95], v[96:99]
  s_waitcnt lgkmcnt(4)
  v_mfma_f32_16x16x32_bf16 v[4:7], v[196:199], a[96:99], v[4:7]
  ds_read_b64_tr_b16 a[248:249], v205 offset:0
  ds_read_b64_tr_b16 a[250:251], v205 offset:512
  v_mfma_f32_16x16x32_bf16 v[4:7], v[200:203], a[108:111], v[4:7]
  v_mfma_f32_16x16x32_bf16 v[8:11], v[200:203], a[112:115], v[8:11]
  ds_read_b64_tr_b16 a[252:253], v205 offset:8192
  ds_read_b64_tr_b16 a[254:255], v205 offset:8704
  v_mfma_f32_16x16x32_bf16 v[8:11], v[196:199], a[100:103], v[8:11]
  buffer_load_dwordx4 v241, s[24:27], s49 offen offset:3072 lds
  v_mfma_f32_16x16x32_bf16 v[12:15], v[196:199], a[104:107], v[12:15]
  v_mfma_f32_16x16x32_bf16 v[12:15], v[200:203], a[116:119], v[12:15]
  s_waitcnt lgkmcnt(4)
  s_add_u32 m0, s48, 4224
  v_mfma_f32_16x16x32_bf16 v[52:55], a[240:243], a[96:99], v[52:55]
  ds_read_b64_tr_b16 v[196:197], v205 offset:2048
  ds_read_b64_tr_b16 v[198:199], v205 offset:2560
  v_mfma_f32_16x16x32_bf16 v[52:55], a[244:247], a[108:111], v[52:55]
  buffer_load_dwordx4 v242, s[24:27], s49 offen offset:0 lds
  v_mfma_f32_16x16x32_bf16 v[56:59], a[244:247], a[112:115], v[56:59]
  ds_read_b64_tr_b16 v[200:201], v205 offset:10240
  ds_read_b64_tr_b16 v[202:203], v205 offset:10752
  v_lshl_add_u32 v226, v227, 10, v226
  v_and_b32 v227, 15, v225
  v_lshl_add_u32 v226, v227, 4, v226
  v_lshrrev_b32 v227, 4, v0
  v_lshl_add_u32 v226, v227, 8, v226
  v_mov_b32 v227, 0x40000000
  v_cmp_gt_i32 vcc, s47, v225
  v_and_b32 v224, 15, v0
  s_nop 0
  v_cndmask_b32 v2, v227, v226, vcc
  v_cmp_le_i32 vcc, s59, v225
  v_max_i32 v225, 0, v225
  v_min_u32 v225, 0x3ff, v225
  v_cndmask_b32 v2, v227, v2, vcc
  v_lshlrev_b32 v230, 4, v225
  v_add_u32 v225, 31, v224
  v_add_u32 v225, s45, v225
  v_mad_i32_i24 v225, v212, -16, v225
  v_lshrrev_b32 v226, 6, v225
  v_mul_u32_u24 v226, 303104, v226
  v_bfe_u32 v227, v225, 4, 2
  v_lshl_add_u32 v226, v227, 10, v226
  v_mfma_f32_16x16x32_bf16 v[56:59], a[240:243], a[100:103], v[56:59]
  v_mfma_f32_16x16x32_bf16 v[60:63], a[240:243], a[104:107], v[60:63]
  v_mfma_f32_16x16x32_bf16 v[60:63], a[244:247], a[116:119], v[60:63]
  s_waitcnt lgkmcnt(4)
  buffer_load_dwordx4 v243, s[24:27], s49 offen offset:1024 lds
  v_mfma_f32_16x16x32_bf16 v[16:19], a[248:251], a[96:99], v[16:19]
  ds_read_b64_tr_b16 a[240:241], v206 offset:0
  ds_read_b64_tr_b16 a[242:243], v206 offset:512
  v_mfma_f32_16x16x32_bf16 v[16:19], a[252:255], a[108:111], v[16:19]
  v_mfma_f32_16x16x32_bf16 v[20:23], a[252:255], a[112:115], v[20:23]
  s_bfe_u32 s51, s60, 0x40018
  ds_read_b64_tr_b16 a[244:245], v206 offset:8192
  ds_read_b64_tr_b16 a[246:247], v206 offset:8704
  v_mfma_f32_16x16x32_bf16 v[20:23], a[248:251], a[100:103], v[20:23]
  s_mul_i32 s51, s51, 221184
  s_add_u32 m0, s50, 32768
  s_add_u32 s51, s51, s52
  v_mfma_f32_16x16x32_bf16 v[24:27], a[248:251], a[104:107], v[24:27]
  buffer_load_dwordx4 v208, s[28:31], s51 offen offset:0 lds
  v_mfma_f32_16x16x32_bf16 v[24:27], a[252:255], a[116:119], v[24:27]
  s_waitcnt lgkmcnt(4)
  v_mfma_f32_16x16x32_bf16 v[64:67], v[196:199], a[96:99], v[64:67]
  ds_read_b64_tr_b16 a[248:249], v206 offset:2048
  ds_read_b64_tr_b16 a[250:251], v206 offset:2560
  v_mfma_f32_16x16x32_bf16 v[64:67], v[200:203], a[108:111], v[64:67]
  v_mfma_f32_16x16x32_bf16 v[68:71], v[200:203], a[112:115], v[68:71]
  ds_read_b64_tr_b16 a[252:253], v206 offset:10240
  ds_read_b64_tr_b16 a[254:255], v206 offset:10752
  v_and_b32 v227, 15, v225
  v_lshl_add_u32 v226, v227, 4, v226
  v_lshrrev_b32 v227, 4, v0
  v_lshl_add_u32 v226, v227, 8, v226
  v_mov_b32 v227, 0x40000000
  v_cmp_gt_i32 vcc, s47, v225
  s_nop 1
  v_cndmask_b32 v3, v227, v226, vcc
  v_cmp_le_i32 vcc, s59, v225
  v_max_i32 v225, 0, v225
  v_min_u32 v225, 0x3ff, v225
  v_cndmask_b32 v3, v227, v3, vcc
  v_lshlrev_b32 v231, 4, v225
  s_add_u32 s71, s70, 4096
  s_add_u32 s72, s70, 114688
  s_add_u32 s73, s70, 118784
  s_lshl_b32 s55, s54, 6
  s_lshl_b32 s56, s53, 2
  s_add_u32 s55, s55, s56
  s_add_u32 s55, s55, s44
  s_lshl_b32 s55, s55, 6
  s_add_u32 s55, s55, 0x40000
  v_mfma_f32_16x16x32_bf16 v[68:71], v[196:199], a[100:103], v[68:71]
  buffer_load_dwordx4 v209, s[28:31], s51 offen offset:1024 lds
  v_mfma_f32_16x16x32_bf16 v[72:75], v[196:199], a[104:107], v[72:75]
  v_mfma_f32_16x16x32_bf16 v[72:75], v[200:203], a[116:119], v[72:75]
  s_waitcnt lgkmcnt(4)
  v_mfma_f32_16x16x32_bf16 v[28:31], a[240:243], a[96:99], v[28:31]
  ds_read_b64_tr_b16 v[196:197], v207 offset:0
  ds_read_b64_tr_b16 v[198:199], v207 offset:512
  v_mfma_f32_16x16x32_bf16 v[28:31], a[244:247], a[108:111], v[28:31]
  buffer_load_dwordx4 v208, s[32:35], s51 offen offset:2048 lds
  v_mfma_f32_16x16x32_bf16 v[32:35], a[244:247], a[112:115], v[32:35]
  ds_read_b64_tr_b16 v[200:201], v207 offset:8192
  ds_read_b64_tr_b16 v[202:203], v207 offset:8704
  v_mfma_f32_16x16x32_bf16 v[32:35], a[240:243], a[100:103], v[32:35]
  v_mfma_f32_16x16x32_bf16 v[36:39], a[240:243], a[104:107], v[36:39]
  v_mfma_f32_16x16x32_bf16 v[36:39], a[244:247], a[116:119], v[36:39]
  s_waitcnt lgkmcnt(4)
  buffer_load_dwordx4 v209, s[32:35], s51 offen offset:3072 lds
  v_mfma_f32_16x16x32_bf16 v[76:79], a[248:251], a[96:99], v[76:79]
  ds_read_b64_tr_b16 a[240:241], v207 offset:2048
  ds_read_b64_tr_b16 a[242:243], v207 offset:2560
  v_mfma_f32_16x16x32_bf16 v[76:79], a[252:255], a[108:111], v[76:79]
  s_waitcnt vmcnt(14)
  ds_read_b128 a[120:123], v246 offset:12544
  v_mfma_f32_16x16x32_bf16 v[80:83], a[252:255], a[112:115], v[80:83]
  s_mov_b32 s63, 65536
  ds_read_b64_tr_b16 a[244:245], v207 offset:10240
  ds_read_b64_tr_b16 a[246:247], v207 offset:10752
  v_lshrrev_b32 v250, 4, v0
  v_lshlrev_b32 v250, 22, v250
  v_add_lshl_u32 v250, v250, v0, 2
  v_add_u32 v250, s55, v250
  s_lshl_b32 s81, s46, 14
  s_add_u32 s81, s81, 4096
  s_lshr_b32 s55, s2, 3
  s_sub_u32 s55, s55, 12
  s_lshl_b32 s55, s55, 2
  s_add_u32 s55, s55, s44
  s_mul_i32 s55, s55, 2
  v_min_u32 v210, 1, v0
  v_add_u32 v210, s55, v210
  v_lshlrev_b32 v210, 7, v210
  s_getpc_b64 s[56:57]
FC1_pc:
  s_add_u32 s56, s56, FC1-FC1_pc
  s_addc_u32 s57, s57, 0
  v_mov_b32 v211, s57
  v_add_co_u32 v210, vcc, s56, v210
  s_nop 1
  v_addc_co_u32 v211, vcc, 0, v211, vcc
  v_mfma_f32_16x16x32_bf16 v[80:83], a[248:251], a[100:103], v[80:83]
  ds_read_b128 a[124:127], v244 offset:14592
  v_mfma_f32_16x16x32_bf16 v[84:87], a[248:251], a[104:107], v[84:87]
  s_waitcnt vmcnt(10)
  v_mfma_f32_16x16x32_bf16 v[84:87], a[252:255], a[116:119], v[84:87]
  s_waitcnt lgkmcnt(6)
  ds_read_b128 a[128:131], v244 offset:16640
  v_mfma_f32_16x16x32_bf16 v[40:43], v[196:199], a[96:99], v[40:43]
  s_barrier
  ds_read_b64_tr_b16 a[248:249], v204 offset:16384
  ds_read_b64_tr_b16 a[250:251], v204 offset:16896
  v_mfma_f32_16x16x32_bf16 v[40:43], v[200:203], a[108:111], v[40:43]
  ds_read_b128 a[132:135], v247 offset:12544
  s_bfe_u32 s49, s60, 0x4001c
  v_mfma_f32_16x16x32_bf16 v[44:47], v[200:203], a[112:115], v[44:47]
  s_add_u32 m0, s48, 6400
  ds_read_b64_tr_b16 a[252:253], v204 offset:24576
  ds_read_b64_tr_b16 a[254:255], v204 offset:25088
  v_mfma_f32_16x16x32_bf16 v[44:47], v[196:199], a[100:103], v[44:47]
  s_lshl_b32 s49, s49, 7
  ds_read_b128 a[136:139], v245 offset:14592
  v_mfma_f32_16x16x32_bf16 v[48:51], v[196:199], a[104:107], v[48:51]
  buffer_load_dwordx4 v238, s[24:27], s49 offen offset:0 lds
  v_mfma_f32_16x16x32_bf16 v[48:51], v[200:203], a[116:119], v[48:51]
  s_waitcnt lgkmcnt(8)
  ds_read_b128 a[140:143], v245 offset:16640
  v_mfma_f32_16x16x32_bf16 v[88:91], a[240:243], a[96:99], v[88:91]
  ds_read_b64_tr_b16 v[196:197], v204 offset:18432
  ds_read_b64_tr_b16 v[198:199], v204 offset:18944
  v_mfma_f32_16x16x32_bf16 v[88:91], a[244:247], a[108:111], v[88:91]
  buffer_load_dwordx4 v239, s[24:27], s49 offen offset:1024 lds
  v_mfma_f32_16x16x32_bf16 v[92:95], a[244:247], a[112:115], v[92:95]
  ds_read_b64_tr_b16 v[200:201], v204 offset:26624
  ds_read_b64_tr_b16 v[202:203], v204 offset:27136
  v_mfma_f32_16x16x32_bf16 v[92:95], a[240:243], a[100:103], v[92:95]
  v_mfma_f32_16x16x32_bf16 v[96:99], a[240:243], a[104:107], v[96:99]
  buffer_load_dwordx4 v240, s[24:27], s49 offen offset:2048 lds
  v_mfma_f32_16x16x32_bf16 v[96:99], a[244:247], a[116:119], v[96:99]
  s_waitcnt lgkmcnt(4)
  v_mfma_f32_16x16x32_bf16 v[4:7], a[248:251], a[120:123], v[4:7]
  ds_read_b64_tr_b16 a[240:241], v205 offset:16384
  ds_read_b64_tr_b16 a[242:243], v205 offset:16896
  v_mfma_f32_16x16x32_bf16 v[4:7], a[252:255], a[132:135], v[4:7]
  v_mfma_f32_16x16x32_bf16 v[8:11], a[252:255], a[136:139], v[8:11]
  ds_read_b64_tr_b16 a[244:245], v205 offset:24576
  ds_read_b64_tr_b16 a[246:247], v205 offset:25088
  v_mfma_f32_16x16x32_bf16 v[8:11], a[248:251], a[124:127], v[8:11]
  buffer_load_dwordx4 v241, s[24:27], s49 offen offset:3072 lds
  v_mfma_f32_16x16x32_bf16 v[12:15], a[248:251], a[128:131], v[12:15]
  v_mfma_f32_16x16x32_bf16 v[12:15], a[252:255], a[140:143], v[12:15]
  s_waitcnt lgkmcnt(4)
  s_add_u32 m0, s48, 10496
  v_mfma_f32_16x16x32_bf16 v[52:55], v[196:199], a[120:123], v[52:55]
  ds_read_b64_tr_b16 a[248:249], v205 offset:18432
  ds_read_b64_tr_b16 a[250:251], v205 offset:18944
  v_mfma_f32_16x16x32_bf16 v[52:55], v[200:203], a[132:135], v[52:55]
  buffer_load_dwordx4 v242, s[24:27], s49 offen offset:0 lds
  v_mfma_f32_16x16x32_bf16 v[56:59], v[200:203], a[136:139], v[56:59]
  ds_read_b64_tr_b16 a[252:253], v205 offset:26624
  ds_read_b64_tr_b16 a[254:255], v205 offset:27136
  v_mfma_f32_16x16x32_bf16 v[56:59], v[196:199], a[124:127], v[56:59]
  v_mfma_f32_16x16x32_bf16 v[60:63], v[196:199], a[128:131], v[60:63]
  v_mfma_f32_16x16x32_bf16 v[60:63], v[200:203], a[140:143], v[60:63]
  s_waitcnt lgkmcnt(4)
  buffer_load_dwordx4 v243, s[24:27], s49 offen offset:1024 lds
  v_mfma_f32_16x16x32_bf16 v[16:19], a[240:243], a[120:123], v[16:19]
  ds_read_b64_tr_b16 v[196:197], v206 offset:16384
  ds_read_b64_tr_b16 v[198:199], v206 offset:16896
  v_mfma_f32_16x16x32_bf16 v[16:19], a[244:247], a[132:135], v[16:19]
  v_mfma_f32_16x16x32_bf16 v[20:23], a[244:247], a[136:139], v[20:23]
  s_bfe_u32 s51, s60, 0x4001c
  ds_read_b64_tr_b16 v[200:201], v206 offset:24576
  ds_read_b64_tr_b16 v[202:203], v206 offset:25088
  v_mfma_f32_16x16x32_bf16 v[20:23], a[240:243], a[124:127], v[20:23]
  s_mul_i32 s51, s51, 221184
  s_add_u32 m0, s50, 49152
  s_add_u32 s51, s51, s52
  v_mfma_f32_16x16x32_bf16 v[24:27], a[240:243], a[128:131], v[24:27]
  buffer_load_dwordx4 v208, s[28:31], s51 offen offset:0 lds
  v_mfma_f32_16x16x32_bf16 v[24:27], a[244:247], a[140:143], v[24:27]
  s_waitcnt lgkmcnt(4)
  v_mfma_f32_16x16x32_bf16 v[64:67], a[248:251], a[120:123], v[64:67]
  ds_read_b64_tr_b16 a[240:241], v206 offset:18432
  ds_read_b64_tr_b16 a[242:243], v206 offset:18944
  v_mfma_f32_16x16x32_bf16 v[64:67], a[252:255], a[132:135], v[64:67]
  v_mfma_f32_16x16x32_bf16 v[68:71], a[252:255], a[136:139], v[68:71]
  ds_read_b64_tr_b16 a[244:245], v206 offset:26624
  ds_read_b64_tr_b16 a[246:247], v206 offset:27136
  v_mfma_f32_16x16x32_bf16 v[68:71], a[248:251], a[124:127], v[68:71]
  buffer_load_dwordx4 v209, s[28:31], s51 offen offset:1024 lds
  v_mfma_f32_16x16x32_bf16 v[72:75], a[248:251], a[128:131], v[72:75]
  v_mfma_f32_16x16x32_bf16 v[72:75], a[252:255], a[140:143], v[72:75]
  s_waitcnt lgkmcnt(4)
  v_mfma_f32_16x16x32_bf16 v[28:31], v[196:199], a[120:123], v[28:31]
  ds_read_b64_tr_b16 a[248:249], v207 offset:16384
  ds_read_b64_tr_b16 a[250:251], v207 offset:16896
  v_mfma_f32_16x16x32_bf16 v[28:31], v[200:203], a[132:135], v[28:31]
  buffer_load_dwordx4 v208, s[32:35], s51 offen offset:2048 lds
  v_mfma_f32_16x16x32_bf16 v[32:35], v[200:203], a[136:139], v[32:35]
  ds_read_b64_tr_b16 a[252:253], v207 offset:24576
  ds_read_b64_tr_b16 a[254:255], v207 offset:25088
  v_mfma_f32_16x16x32_bf16 v[32:35], v[196:199], a[124:127], v[32:35]
  v_mfma_f32_16x16x32_bf16 v[36:39], v[196:199], a[128:131], v[36:39]
  v_mfma_f32_16x16x32_bf16 v[36:39], v[200:203], a[140:143], v[36:39]
  s_waitcnt lgkmcnt(4)
  buffer_load_dwordx4 v209, s[32:35], s51 offen offset:3072 lds
  v_mfma_f32_16x16x32_bf16 v[76:79], a[240:243], a[120:123], v[76:79]
FHOP1:
  s_cbranch_execz FHOP5
  ds_read_b64_tr_b16 v[196:197], v207 offset:18432
  ds_read_b64_tr_b16 v[198:199], v207 offset:18944
  v_mfma_f32_16x16x32_bf16 v[76:79], a[244:247], a[132:135], v[76:79]
  s_waitcnt vmcnt(14)
  ds_read_b128 a[144:147], v246 offset:0
  v_mfma_f32_16x16x32_bf16 v[80:83], a[244:247], a[136:139], v[80:83]
  ds_read_b64_tr_b16 v[200:201], v207 offset:26624
  ds_read_b64_tr_b16 v[202:203], v207 offset:27136
  v_mfma_f32_16x16x32_bf16 v[80:83], a[240:243], a[124:127], v[80:83]
  ds_read_b128 a[148:151], v244 offset:2048
  v_mfma_f32_16x16x32_bf16 v[84:87], a[240:243], a[128:131], v[84:87]
  s_waitcnt vmcnt(10)
  v_mfma_f32_16x16x32_bf16 v[84:87], a[244:247], a[140:143], v[84:87]
  s_waitcnt lgkmcnt(6)
  ds_read_b128 a[152:155], v244 offset:4096
  v_mfma_f32_16x16x32_bf16 v[40:43], a[248:251], a[120:123], v[40:43]
  s_barrier
  ds_read_b64_tr_b16 a[240:241], v204 offset:32768
  ds_read_b64_tr_b16 a[242:243], v204 offset:33280
  v_mfma_f32_16x16x32_bf16 v[40:43], a[252:255], a[132:135], v[40:43]
  ds_read_b128 a[156:159], v247 offset:0
  s_bfe_u32 s49, s61, 0x40000
  v_mfma_f32_16x16x32_bf16 v[44:47], a[252:255], a[136:139], v[44:47]
  s_add_u32 m0, s48, 12672
  ds_read_b64_tr_b16 a[244:245], v204 offset:40960
  ds_read_b64_tr_b16 a[246:247], v204 offset:41472
  v_mfma_f32_16x16x32_bf16 v[44:47], a[248:251], a[124:127], v[44:47]
  s_lshl_b32 s49, s49, 7
  ds_read_b128 a[160:163], v245 offset:2048
  v_mfma_f32_16x16x32_bf16 v[48:51], a[248:251], a[128:131], v[48:51]
  buffer_load_dwordx4 v238, s[24:27], s49 offen offset:0 lds
  v_mfma_f32_16x16x32_bf16 v[48:51], a[252:255], a[140:143], v[48:51]
  s_waitcnt lgkmcnt(8)
  ds_read_b128 a[164:167], v245 offset:4096
  v_mfma_f32_16x16x32_bf16 v[88:91], v[196:199], a[120:123], v[88:91]
  ds_read_b64_tr_b16 a[248:249], v204 offset:34816
  ds_read_b64_tr_b16 a[250:251], v204 offset:35328
  v_mfma_f32_16x16x32_bf16 v[88:91], v[200:203], a[132:135], v[88:91]
  buffer_load_dwordx4 v239, s[24:27], s49 offen offset:1024 lds
  v_mfma_f32_16x16x32_bf16 v[92:95], v[200:203], a[136:139], v[92:95]
  ds_read_b64_tr_b16 a[252:253], v204 offset:43008
  ds_read_b64_tr_b16 a[254:255], v204 offset:43520
  v_mfma_f32_16x16x32_bf16 v[92:95], v[196:199], a[124:127], v[92:95]
  v_mfma_f32_16x16x32_bf16 v[96:99], v[196:199], a[128:131], v[96:99]
  buffer_load_dwordx4 v240, s[24:27], s49 offen offset:2048 lds
  v_mfma_f32_16x16x32_bf16 v[96:99], v[200:203], a[140:143], v[96:99]
  s_waitcnt lgkmcnt(4)
  v_mfma_f32_16x16x32_bf16 v[4:7], a[240:243], a[144:147], v[4:7]
  ds_read_b64_tr_b16 v[196:197], v205 offset:32768
  ds_read_b64_tr_b16 v[198:199], v205 offset:33280
  v_mfma_f32_16x16x32_bf16 v[4:7], a[244:247], a[156:159], v[4:7]
  v_mfma_f32_16x16x32_bf16 v[8:11], a[244:247], a[160:163], v[8:11]
  ds_read_b64_tr_b16 v[200:201], v205 offset:40960
  ds_read_b64_tr_b16 v[202:203], v205 offset:41472
  v_mfma_f32_16x16x32_bf16 v[8:11], a[240:243], a[148:151], v[8:11]
  buffer_load_dwordx4 v241, s[24:27], s49 offen offset:3072 lds
  v_mfma_f32_16x16x32_bf16 v[12:15], a[240:243], a[152:155], v[12:15]
  v_mfma_f32_16x16x32_bf16 v[12:15], a[244:247], a[164:167], v[12:15]
  s_waitcnt lgkmcnt(4)
  s_add_u32 m0, s48, 16768
  v_mfma_f32_16x16x32_bf16 v[52:55], a[248:251], a[144:147], v[52:55]
  ds_read_b64_tr_b16 a[240:241], v205 offset:34816
  ds_read_b64_tr_b16 a[242:243], v205 offset:35328
  v_mfma_f32_16x16x32_bf16 v[52:55], a[252:255], a[156:159], v[52:55]
  buffer_load_dwordx4 v242, s[24:27], s49 offen offset:0 lds
  v_mfma_f32_16x16x32_bf16 v[56:59], a[252:255], a[160:163], v[56:59]
  ds_read_b64_tr_b16 a[244:245], v205 offset:43008
  ds_read_b64_tr_b16 a[246:247], v205 offset:43520
  v_mfma_f32_16x16x32_bf16 v[56:59], a[248:251], a[148:151], v[56:59]
  v_mfma_f32_16x16x32_bf16 v[60:63], a[248:251], a[152:155], v[60:63]
  v_mfma_f32_16x16x32_bf16 v[60:63], a[252:255], a[164:167], v[60:63]
  s_waitcnt lgkmcnt(4)
  buffer_load_dwordx4 v243, s[24:27], s49 offen offset:1024 lds
  v_mfma_f32_16x16x32_bf16 v[16:19], v[196:199], a[144:147], v[16:19]
  ds_read_b64_tr_b16 a[248:249], v206 offset:32768
  ds_read_b64_tr_b16 a[250:251], v206 offset:33280
  v_mfma_f32_16x16x32_bf16 v[16:19], v[200:203], a[156:159], v[16:19]
  v_mfma_f32_16x16x32_bf16 v[20:23], v[200:203], a[160:163], v[20:23]
  s_bfe_u32 s51, s61, 0x40000
  ds_read_b64_tr_b16 a[252:253], v206 offset:40960
  ds_read_b64_tr_b16 a[254:255], v206 offset:41472
  v_mfma_f32_16x16x32_bf16 v[20:23], v[196:199], a[148:151], v[20:23]
  s_mul_i32 s51, s51, 221184
  s_add_u32 m0, s50, 0
  s_add_u32 s51, s51, s52
  v_mfma_f32_16x16x32_bf16 v[24:27], v[196:199], a[152:155], v[24:27]
  buffer_load_dwordx4 v208, s[28:31], s51 offen offset:0 lds
  v_mfma_f32_16x16x32_bf16 v[24:27], v[200:203], a[164:167], v[24:27]
  s_waitcnt lgkmcnt(4)
  v_mfma_f32_16x16x32_bf16 v[64:67], a[240:243], a[144:147], v[64:67]
  ds_read_b64_tr_b16 v[196:197], v206 offset:34816
  ds_read_b64_tr_b16 v[198:199], v206 offset:35328
  v_mfma_f32_16x16x32_bf16 v[64:67], a[244:247], a[156:159], v[64:67]
  v_mfma_f32_16x16x32_bf16 v[68:71], a[244:247], a[160:163], v[68:71]
  ds_read_b64_tr_b16 v[200:201], v206 offset:43008
  ds_read_b64_tr_b16 v[202:203], v206 offset:43520
  v_mfma_f32_16x16x32_bf16 v[68:71], a[240:243], a[148:151], v[68:71]
  buffer_load_dwordx4 v209, s[28:31], s51 offen offset:1024 lds
  v_mfma_f32_16x16x32_bf16 v[72:75], a[240:243], a[152:155], v[72:75]
  v_mfma_f32_16x16x32_bf16 v[72:75], a[244:247], a[164:167], v[72:75]
  s_waitcnt lgkmcnt(4)
  v_mfma_f32_16x16x32_bf16 v[28:31], a[248:251], a[144:147], v[28:31]
  ds_read_b64_tr_b16 a[240:241], v207 offset:32768
  ds_read_b64_tr_b16 a[242:243], v207 offset:33280
  v_mfma_f32_16x16x32_bf16 v[28:31], a[252:255], a[156:159], v[28:31]
  buffer_load_dwordx4 v208, s[32:35], s51 offen offset:2048 lds
  v_mfma_f32_16x16x32_bf16 v[32:35], a[252:255], a[160:163], v[32:35]
  ds_read_b64_tr_b16 a[244:245], v207 offset:40960
  ds_read_b64_tr_b16 a[246:247], v207 offset:41472
  v_mfma_f32_16x16x32_bf16 v[32:35], a[248:251], a[148:151], v[32:35]
  v_mfma_f32_16x16x32_bf16 v[36:39], a[248:251], a[152:155], v[36:39]
  v_mfma_f32_16x16x32_bf16 v[36:39], a[252:255], a[164:167], v[36:39]
  s_waitcnt lgkmcnt(4)
  buffer_load_dwordx4 v209, s[32:35], s51 offen offset:3072 lds
  v_mfma_f32_16x16x32_bf16 v[76:79], v[196:199], a[144:147], v[76:79]
  ds_read_b64_tr_b16 a[248:249], v207 offset:34816
  ds_read_b64_tr_b16 a[250:251], v207 offset:35328
  v_mfma_f32_16x16x32_bf16 v[76:79], v[200:203], a[156:159], v[76:79]
  s_waitcnt vmcnt(14)
  ds_read_b128 a[168:171], v246 offset:6272
  v_mfma_f32_16x16x32_bf16 v[80:83], v[200:203], a[160:163], v[80:83]
  ds_read_b64_tr_b16 a[252:253], v207 offset:43008
  ds_read_b64_tr_b16 a[254:255], v207 offset:43520
  v_mfma_f32_16x16x32_bf16 v[80:83], v[196:199], a[148:151], v[80:83]
  ds_read_b128 a[172:175], v244 offset:8320
  v_mfma_f32_16x16x32_bf16 v[84:87], v[196:199], a[152:155], v[84:87]
  s_waitcnt vmcnt(10)
  v_mfma_f32_16x16x32_bf16 v[84:87], v[200:203], a[164:167], v[84:87]
  s_waitcnt lgkmcnt(6)
  ds_read_b128 a[176:179], v244 offset:10368
  v_mfma_f32_16x16x32_bf16 v[40:43], a[240:243], a[144:147], v[40:43]
  s_barrier
  ds_read_b64_tr_b16 v[196:197], v204 offset:49152
  ds_read_b64_tr_b16 v[198:199], v204 offset:49664
  v_mfma_f32_16x16x32_bf16 v[40:43], a[244:247], a[156:159], v[40:43]
  ds_read_b128 a[180:183], v247 offset:6272
  s_bfe_u32 s49, s61, 0x40004
  v_mfma_f32_16x16x32_bf16 v[44:47], a[244:247], a[160:163], v[44:47]
  s_add_u32 m0, s48, 128
  ds_read_b64_tr_b16 v[200:201], v204 offset:57344
  ds_read_b64_tr_b16 v[202:203], v204 offset:57856
  v_mfma_f32_16x16x32_bf16 v[44:47], a[240:243], a[148:151], v[44:47]
  s_lshl_b32 s49, s49, 7
  ds_read_b128 a[184:187], v245 offset:8320
  v_mfma_f32_16x16x32_bf16 v[48:51], a[240:243], a[152:155], v[48:51]
  buffer_load_dwordx4 v238, s[24:27], s49 offen offset:0 lds
  v_mfma_f32_16x16x32_bf16 v[48:51], a[244:247], a[164:167], v[48:51]
  s_waitcnt lgkmcnt(8)
  ds_read_b128 a[188:191], v245 offset:10368
  v_mfma_f32_16x16x32_bf16 v[88:91], a[248:251], a[144:147], v[88:91]
  ds_read_b64_tr_b16 a[240:241], v204 offset:51200
  ds_read_b64_tr_b16 a[242:243], v204 offset:51712
  v_mfma_f32_16x16x32_bf16 v[88:91], a[252:255], a[156:159], v[88:91]
  buffer_load_dwordx4 v239, s[24:27], s49 offen offset:1024 lds
  v_mfma_f32_16x16x32_bf16 v[92:95], a[252:255], a[160:163], v[92:95]
  ds_read_b64_tr_b16 a[244:245], v204 offset:59392
  ds_read_b64_tr_b16 a[246:247], v204 offset:59904
  v_mfma_f32_16x16x32_bf16 v[92:95], a[248:251], a[148:151], v[92:95]
  v_mfma_f32_16x16x32_bf16 v[96:99], a[248:251], a[152:155], v[96:99]
  buffer_load_dwordx4 v240, s[24:27], s49 offen offset:2048 lds
  v_mfma_f32_16x16x32_bf16 v[96:99], a[252:255], a[164:167], v[96:99]
  s_waitcnt lgkmcnt(4)
  v_mfma_f32_16x16x32_bf16 v[4:7], v[196:199], a[168:171], v[4:7]
  ds_read_b64_tr_b16 a[248:249], v205 offset:49152
  ds_read_b64_tr_b16 a[250:251], v205 offset:49664
  v_mfma_f32_16x16x32_bf16 v[4:7], v[200:203], a[180:183], v[4:7]
  v_mfma_f32_16x16x32_bf16 v[8:11], v[200:203], a[184:187], v[8:11]
  ds_read_b64_tr_b16 a[252:253], v205 offset:57344
  ds_read_b64_tr_b16 a[254:255], v205 offset:57856
  v_mfma_f32_16x16x32_bf16 v[8:11], v[196:199], a[172:175], v[8:11]
  buffer_load_dwordx4 v241, s[24:27], s49 offen offset:3072 lds
  v_mfma_f32_16x16x32_bf16 v[12:15], v[196:199], a[176:179], v[12:15]
  v_mfma_f32_16x16x32_bf16 v[12:15], v[200:203], a[188:191], v[12:15]
  s_waitcnt lgkmcnt(4)
  s_add_u32 m0, s48, 4224
  v_mfma_f32_16x16x32_bf16 v[52:55], a[240:243], a[168:171], v[52:55]
  ds_read_b64_tr_b16 v[196:197], v205 offset:51200
  ds_read_b64_tr_b16 v[198:199], v205 offset:51712
  v_mfma_f32_16x16x32_bf16 v[52:55], a[244:247], a[180:183], v[52:55]
  buffer_load_dwordx4 v242, s[24:27], s49 offen offset:0 lds
  v_mfma_f32_16x16x32_bf16 v[56:59], a[244:247], a[184:187], v[56:59]
  ds_read_b64_tr_b16 v[200:201], v205 offset:59392
  ds_read_b64_tr_b16 v[202:203], v205 offset:59904
  v_mfma_f32_16x16x32_bf16 v[56:59], a[240:243], a[172:175], v[56:59]
  v_mfma_f32_16x16x32_bf16 v[60:63], a[240:243], a[176:179], v[60:63]
  v_mfma_f32_16x16x32_bf16 v[60:63], a[244:247], a[188:191], v[60:63]
  s_waitcnt lgkmcnt(4)
  buffer_load_dwordx4 v243, s[24:27], s49 offen offset:1024 lds
  v_mfma_f32_16x16x32_bf16 v[16:19], a[248:251], a[168:171], v[16:19]
  ds_read_b64_tr_b16 a[240:241], v206 offset:49152
  ds_read_b64_tr_b16 a[242:243], v206 offset:49664
  v_mfma_f32_16x16x32_bf16 v[16:19], a[252:255], a[180:183], v[16:19]
  v_mfma_f32_16x16x32_bf16 v[20:23], a[252:255], a[184:187], v[20:23]
  s_bfe_u32 s51, s61, 0x40004
  ds_read_b64_tr_b16 a[244:245], v206 offset:57344
  ds_read_b64_tr_b16 a[246:247], v206 offset:57856
  v_mfma_f32_16x16x32_bf16 v[20:23], a[248:251], a[172:175], v[20:23]
  s_mul_i32 s51, s51, 221184
  s_add_u32 m0, s50, 16384
  s_add_u32 s51, s51, s52
  v_mfma_f32_16x16x32_bf16 v[24:27], a[248:251], a[176:179], v[24:27]
  buffer_load_dwordx4 v208, s[28:31], s51 offen offset:0 lds
  v_mfma_f32_16x16x32_bf16 v[24:27], a[252:255], a[188:191], v[24:27]
  s_waitcnt lgkmcnt(4)
  v_mfma_f32_16x16x32_bf16 v[64:67], v[196:199], a[168:171], v[64:67]
  ds_read_b64_tr_b16 a[248:249], v206 offset:51200
  ds_read_b64_tr_b16 a[250:251], v206 offset:51712
  v_mfma_f32_16x16x32_bf16 v[64:67], v[200:203], a[180:183], v[64:67]
  v_mfma_f32_16x16x32_bf16 v[68:71], v[200:203], a[184:187], v[68:71]
  ds_read_b64_tr_b16 a[252:253], v206 offset:59392
  ds_read_b64_tr_b16 a[254:255], v206 offset:59904
  v_mfma_f32_16x16x32_bf16 v[68:71], v[196:199], a[172:175], v[68:71]
  buffer_load_dwordx4 v209, s[28:31], s51 offen offset:1024 lds
  v_mfma_f32_16x16x32_bf16 v[72:75], v[196:199], a[176:179], v[72:75]
  v_mfma_f32_16x16x32_bf16 v[72:75], v[200:203], a[188:191], v[72:75]
  s_waitcnt lgkmcnt(4)
  v_mfma_f32_16x16x32_bf16 v[28:31], a[240:243], a[168:171], v[28:31]
  ds_read_b64_tr_b16 v[196:197], v207 offset:49152
  ds_read_b64_tr_b16 v[198:199], v207 offset:49664
  v_mfma_f32_16x16x32_bf16 v[28:31], a[244:247], a[180:183], v[28:31]
  buffer_load_dwordx4 v208, s[32:35], s51 offen offset:2048 lds
  v_mfma_f32_16x16x32_bf16 v[32:35], a[244:247], a[184:187], v[32:35]
  ds_read_b64_tr_b16 v[200:201], v207 offset:57344
  ds_read_b64_tr_b16 v[202:203], v207 offset:57856
  v_mfma_f32_16x16x32_bf16 v[32:35], a[240:243], a[172:175], v[32:35]
  v_mfma_f32_16x16x32_bf16 v[36:39], a[240:243], a[176:179], v[36:39]
  v_mfma_f32_16x16x32_bf16 v[36:39], a[244:247], a[188:191], v[36:39]
  s_waitcnt lgkmcnt(4)
  buffer_load_dwordx4 v209, s[32:35], s51 offen offset:3072 lds
  v_mfma_f32_16x16x32_bf16 v[76:79], a[248:251], a[168:171], v[76:79]
  ds_read_b64_tr_b16 a[240:241], v207 offset:51200
  ds_read_b64_tr_b16 a[242:243], v207 offset:51712
  v_mfma_f32_16x16x32_bf16 v[76:79], a[252:255], a[180:183], v[76:79]
  s_waitcnt vmcnt(14)
  ds_read_b128 a[192:195], v246 offset:12544
  v_mfma_f32_16x16x32_bf16 v[80:83], a[252:255], a[184:187], v[80:83]
  ds_read_b64_tr_b16 a[244:245], v207 offset:59392
  ds_read_b64_tr_b16 a[246:247], v207 offset:59904
  v_mfma_f32_16x16x32_bf16 v[80:83], a[248:251], a[172:175], v[80:83]
  buffer_load_dwordx4 v[212:215], v229, s[36:39], s81 offen sc1
  v_mfma_f32_16x16x32_bf16 v[84:87], a[248:251], a[176:179], v[84:87]
  s_waitcnt vmcnt(11)
  ds_read_b128 a[196:199], v244 offset:14592
  v_mfma_f32_16x16x32_bf16 v[84:87], a[252:255], a[188:191], v[84:87]
  s_waitcnt lgkmcnt(6)
  buffer_load_dwordx4 v[216:219], v230, s[36:39], s81 offen sc1
  v_mfma_f32_16x16x32_bf16 v[40:43], v[196:199], a[168:171], v[40:43]
  s_barrier
  ds_read_b64_tr_b16 a[248:249], v204 offset:0
  ds_read_b64_tr_b16 a[250:251], v204 offset:512
  v_mfma_f32_16x16x32_bf16 v[40:43], v[200:203], a[180:183], v[40:43]
  s_bfe_u32 s51, s60, 0x40000
  ds_read_b128 a[200:203], v244 offset:16640
  ds_read_b128 a[204:207], v247 offset:12544
  buffer_load_dwordx4 v[220:223], v231, s[36:39], s81 offen sc1
  v_mfma_f32_16x16x32_bf16 v[44:47], v[200:203], a[184:187], v[44:47]
  s_mul_i32 s51, s51, 221184
  ds_read_b64_tr_b16 a[252:253], v204 offset:8192
  ds_read_b64_tr_b16 a[254:255], v204 offset:8704
  v_mfma_f32_16x16x32_bf16 v[44:47], v[196:199], a[172:175], v[44:47]
  s_add_u32 m0, s50, 32768
  global_load_dword v228, v[210:211], off
  v_mfma_f32_16x16x32_bf16 v[48:51], v[196:199], a[176:179], v[48:51]
  s_add_u32 s51, s51, s77
  buffer_load_dwordx4 v208, s[28:31], s51 offen offset:0 lds
  v_mfma_f32_16x16x32_bf16 v[48:51], v[200:203], a[188:191], v[48:51]
  s_waitcnt lgkmcnt(7)
  ds_read_b128 a[208:211], v245 offset:14592
  ds_read_b128 a[212:215], v245 offset:16640
  v_mfma_f32_16x16x32_bf16 v[88:91], a[240:243], a[168:171], v[88:91]
  ds_read_b64_tr_b16 v[196:197], v204 offset:2048
  ds_read_b64_tr_b16 v[198:199], v204 offset:2560
  v_mfma_f32_16x16x32_bf16 v[88:91], a[244:247], a[180:183], v[88:91]
  ds_read_b64_tr_b16 v[100:101], v233 offset:0
  ds_read_b64_tr_b16 v[102:103], v233 offset:2048
  v_mfma_f32_16x16x32_bf16 v[92:95], a[244:247], a[184:187], v[92:95]
  ds_read_b64_tr_b16 v[200:201], v204 offset:10240
  ds_read_b64_tr_b16 v[202:203], v204 offset:10752
  v_mfma_f32_16x16x32_bf16 v[92:95], a[240:243], a[172:175], v[92:95]
  ds_read_b64_tr_b16 v[104:105], v234 offset:0
  ds_read_b64_tr_b16 v[106:107], v234 offset:2048
  v_mfma_f32_16x16x32_bf16 v[96:99], a[240:243], a[176:179], v[96:99]
  buffer_load_dwordx4 v209, s[28:31], s51 offen offset:1024 lds
  v_mfma_f32_16x16x32_bf16 v[96:99], a[244:247], a[188:191], v[96:99]
  s_waitcnt lgkmcnt(8)
  ds_read_b64_tr_b16 v[108:109], v235 offset:0
  ds_read_b64_tr_b16 v[110:111], v235 offset:2048
  v_mfma_f32_16x16x32_bf16 v[4:7], a[248:251], a[192:195], v[4:7]
  ds_read_b64_tr_b16 a[240:241], v205 offset:0
  ds_read_b64_tr_b16 a[242:243], v205 offset:512
  ds_read_b64_tr_b16 v[112:113], v236 offset:0
  ds_read_b64_tr_b16 v[114:115], v236 offset:2048
  v_mfma_f32_16x16x32_bf16 v[4:7], a[252:255], a[204:207], v[4:7]
  v_mfma_f32_16x16x32_bf16 v[8:11], a[252:255], a[208:211], v[8:11]
  ds_read_b64_tr_b16 a[244:245], v205 offset:8192
  ds_read_b64_tr_b16 a[246:247], v205 offset:8704
  v_mfma_f32_16x16x32_bf16 v[8:11], a[248:251], a[196:199], v[8:11]
  buffer_load_dwordx4 v208, s[32:35], s51 offen offset:2048 lds
  v_mfma_f32_16x16x32_bf16 v[12:15], a[248:251], a[200:203], v[12:15]
  v_mfma_f32_16x16x32_bf16 v[12:15], a[252:255], a[212:215], v[12:15]
  s_waitcnt lgkmcnt(10)
  v_mfma_f32_16x16x32_bf16 v[52:55], v[196:199], a[192:195], v[52:55]
  s_waitcnt lgkmcnt(2)
  ds_read_b64_tr_b16 a[248:249], v205 offset:2048
  ds_read_b64_tr_b16 a[250:251], v205 offset:2560
  v_mfma_f32_16x16x32_bf16 v[52:55], v[200:203], a[204:207], v[52:55]
  buffer_store_dwordx4 v[100:103], v248, s[36:39], s92 offen offset:0 sc1
  v_mfma_f32_16x16x32_bf16 v[56:59], v[200:203], a[208:211], v[56:59]
  ds_read_b64_tr_b16 a[252:253], v205 offset:10240
  ds_read_b64_tr_b16 a[254:255], v205 offset:10752
  v_mfma_f32_16x16x32_bf16 v[56:59], v[196:199], a[196:199], v[56:59]
  buffer_load_dwordx4 v209, s[32:35], s51 offen offset:3072 lds
  v_mfma_f32_16x16x32_bf16 v[60:63], v[196:199], a[200:203], v[60:63]
  v_mfma_f32_16x16x32_bf16 v[60:63], v[200:203], a[212:215], v[60:63]
  s_waitcnt lgkmcnt(4)
  v_mfma_f32_16x16x32_bf16 v[16:19], a[240:243], a[192:195], v[16:19]
  ds_read_b64_tr_b16 v[196:197], v206 offset:0
  ds_read_b64_tr_b16 v[198:199], v206 offset:512
  v_mfma_f32_16x16x32_bf16 v[16:19], a[244:247], a[204:207], v[16:19]
  v_mfma_f32_16x16x32_bf16 v[20:23], a[244:247], a[208:211], v[20:23]
  ds_read_b64_tr_b16 v[200:201], v206 offset:8192
  ds_read_b64_tr_b16 v[202:203], v206 offset:8704
  v_mfma_f32_16x16x32_bf16 v[20:23], a[240:243], a[196:199], v[20:23]
  buffer_store_dwordx4 v[104:107], v248, s[36:39], s93 offen offset:1024 sc1
  v_mfma_f32_16x16x32_bf16 v[24:27], a[240:243], a[200:203], v[24:27]
  v_mfma_f32_16x16x32_bf16 v[24:27], a[244:247], a[212:215], v[24:27]
  s_waitcnt lgkmcnt(4)
  v_mfma_f32_16x16x32_bf16 v[64:67], a[248:251], a[192:195], v[64:67]
  ds_read_b64_tr_b16 a[240:241], v206 offset:2048
  ds_read_b64_tr_b16 a[242:243], v206 offset:2560
  v_mfma_f32_16x16x32_bf16 v[64:67], a[252:255], a[204:207], v[64:67]
  v_mfma_f32_16x16x32_bf16 v[68:71], a[252:255], a[208:211], v[68:71]
  ds_read_b64_tr_b16 a[244:245], v206 offset:10240
  ds_read_b64_tr_b16 a[246:247], v206 offset:10752
  v_mfma_f32_16x16x32_bf16 v[68:71], a[248:251], a[196:199], v[68:71]
  v_mfma_f32_16x16x32_bf16 v[72:75], a[248:251], a[200:203], v[72:75]
  buffer_store_dwordx4 v[108:111], v248, s[36:39], s94 offen offset:2048 sc1
  v_mfma_f32_16x16x32_bf16 v[72:75], a[252:255], a[212:215], v[72:75]
  s_waitcnt lgkmcnt(4)
  v_mfma_f32_16x16x32_bf16 v[28:31], v[196:199], a[192:195], v[28:31]
  ds_read_b64_tr_b16 a[248:249], v207 offset:0
  ds_read_b64_tr_b16 a[250:251], v207 offset:512
  v_mfma_f32_16x16x32_bf16 v[28:31], v[200:203], a[204:207], v[28:31]
  v_mfma_f32_16x16x32_bf16 v[32:35], v[200:203], a[208:211], v[32:35]
  ds_read_b64_tr_b16 a[252:253], v207 offset:8192
  ds_read_b64_tr_b16 a[254:255], v207 offset:8704
  v_mfma_f32_16x16x32_bf16 v[32:35], v[196:199], a[196:199], v[32:35]
  v_mfma_f32_16x16x32_bf16 v[36:39], v[196:199], a[200:203], v[36:39]
  v_mfma_f32_16x16x32_bf16 v[36:39], v[200:203], a[212:215], v[36:39]
  s_waitcnt lgkmcnt(4)
  v_mfma_f32_16x16x32_bf16 v[76:79], a[240:243], a[192:195], v[76:79]
  ds_read_b64_tr_b16 v[196:197], v207 offset:2048
  ds_read_b64_tr_b16 v[198:199], v207 offset:2560
  v_mfma_f32_16x16x32_bf16 v[76:79], a[244:247], a[204:207], v[76:79]
  s_waitcnt vmcnt(15)
  ds_read_b128 a[216:219], v246 offset:0
  v_mfma_f32_16x16x32_bf16 v[80:83], a[244:247], a[208:211], v[80:83]
  s_waitcnt vmcnt(8)
  ds_read_b64_tr_b16 v[200:201], v207 offset:10240
  ds_read_b64_tr_b16 v[202:203], v207 offset:10752
  v_mfma_f32_16x16x32_bf16 v[80:83], a[240:243], a[196:199], v[80:83]
  buffer_store_dwordx4 v[112:115], v248, s[36:39], s95 offen offset:3072 sc1
  v_mfma_f32_16x16x32_bf16 v[84:87], a[240:243], a[200:203], v[84:87]
  ds_read_b128 a[220:223], v244 offset:2048
  v_xor_b32 v213, v213, v249
  v_mfma_f32_16x16x32_bf16 v[84:87], a[244:247], a[212:215], v[84:87]
  s_waitcnt lgkmcnt(6)
  ds_read_b128 a[224:227], v244 offset:4096
  v_xor_b32 v215, v215, v249
  v_mfma_f32_16x16x32_bf16 v[40:43], a[248:251], a[192:195], v[40:43]
  s_barrier
  ds_read_b64_tr_b16 a[240:241], v204 offset:16384
  ds_read_b64_tr_b16 a[242:243], v204 offset:16896
  v_mfma_f32_16x16x32_bf16 v[40:43], a[252:255], a[204:207], v[40:43]
  s_bfe_u32 s51, s60, 0x40004
  ds_read_b128 a[228:231], v247 offset:0
  v_xor_b32 v217, v217, v249
  v_mfma_f32_16x16x32_bf16 v[44:47], a[252:255], a[208:211], v[44:47]
  s_mul_i32 s51, s51, 221184
  ds_read_b64_tr_b16 a[244:245], v204 offset:24576
  ds_read_b64_tr_b16 a[246:247], v204 offset:25088
  v_mfma_f32_16x16x32_bf16 v[44:47], a[248:251], a[196:199], v[44:47]
  s_add_u32 m0, s50, 49152
  ds_read_b128 a[232:235], v245 offset:2048
  v_xor_b32 v219, v219, v249
  v_mfma_f32_16x16x32_bf16 v[48:51], a[248:251], a[200:203], v[48:51]
  s_add_u32 s51, s51, s77
  buffer_load_dwordx4 v208, s[28:31], s51 offen offset:0 lds
  v_mfma_f32_16x16x32_bf16 v[48:51], a[252:255], a[212:215], v[48:51]
  s_waitcnt lgkmcnt(8)
  buffer_store_dwordx4 v[204:207], v237, s[36:39], s70 offen sc1
  v_mfma_f32_16x16x32_bf16 v[88:91], v[196:199], a[192:195], v[88:91]
  ds_read_b64_tr_b16 a[248:249], v204 offset:18432
  ds_read_b64_tr_b16 a[250:251], v204 offset:18944
  v_mfma_f32_16x16x32_bf16 v[88:91], v[200:203], a[204:207], v[88:91]
  ds_read_b128 a[236:239], v245 offset:4096
  v_xor_b32 v221, v221, v249
  v_mfma_f32_16x16x32_bf16 v[92:95], v[200:203], a[208:211], v[92:95]
  ds_read_b64_tr_b16 a[252:253], v204 offset:26624
  ds_read_b64_tr_b16 a[254:255], v204 offset:27136
  v_mfma_f32_16x16x32_bf16 v[92:95], v[196:199], a[196:199], v[92:95]
  buffer_load_dwordx4 v209, s[28:31], s51 offen offset:1024 lds
  v_mfma_f32_16x16x32_bf16 v[96:99], v[196:199], a[200:203], v[96:99]
  v_xor_b32 v223, v223, v249
  v_or3_b32 v224, v213, v215, v217
  v_mfma_f32_16x16x32_bf16 v[96:99], v[200:203], a[212:215], v[96:99]
  s_waitcnt lgkmcnt(2)
  buffer_load_dwordx4 v208, s[32:35], s51 offen offset:2048 lds
  v_mfma_f32_16x16x32_bf16 v[4:7], a[240:243], a[216:219], v[4:7]
  ds_read_b64_tr_b16 v[196:197], v205 offset:16384
  ds_read_b64_tr_b16 v[198:199], v205 offset:16896
  v_mfma_f32_16x16x32_bf16 v[4:7], a[244:247], a[228:231], v[4:7]
  v_or3_b32 v224, v224, v219, v221
  v_or_b32 v224, v224, v223
  v_mfma_f32_16x16x32_bf16 v[8:11], a[244:247], a[232:235], v[8:11]
  ds_read_b64_tr_b16 v[200:201], v205 offset:24576
  ds_read_b64_tr_b16 v[202:203], v205 offset:25088
  v_mfma_f32_16x16x32_bf16 v[8:11], a[240:243], a[220:223], v[8:11]
  v_cmp_ne_u32 vcc, 0, v224
  s_cbranch_vccnz SFs
BFs:
  v_mfma_f32_16x16x32_bf16 v[12:15], a[240:243], a[224:227], v[12:15]
  v_rcp_f32 v213, v214
  v_mfma_f32_16x16x32_bf16 v[12:15], a[244:247], a[236:239], v[12:15]
  s_waitcnt lgkmcnt(4)
  buffer_load_dwordx4 v209, s[32:35], s51 offen offset:3072 lds
  v_mfma_f32_16x16x32_bf16 v[52:55], a[248:251], a[216:219], v[52:55]
  ds_read_b64_tr_b16 a[240:241], v205 offset:18432
  ds_read_b64_tr_b16 a[242:243], v205 offset:18944
  v_mfma_f32_16x16x32_bf16 v[52:55], a[252:255], a[228:231], v[52:55]
  v_mul_f32 v215, v214, v214
  v_mul_f32 v214, v213, v213
  v_mfma_f32_16x16x32_bf16 v[56:59], a[252:255], a[232:235], v[56:59]
  ds_read_b64_tr_b16 a[244:245], v205 offset:26624
  ds_read_b64_tr_b16 a[246:247], v205 offset:27136
  v_mfma_f32_16x16x32_bf16 v[56:59], a[248:251], a[220:223], v[56:59]
  v_mul_f32 v214, v214, v213
  v_mul_f32 v213, 0xc0135761, v213
  v_mfma_f32_16x16x32_bf16 v[60:63], a[248:251], a[224:227], v[60:63]
  v_mul_f32 v214, 0xbdd2d3e8, v214
  v_mfma_f32_16x16x32_bf16 v[60:63], a[252:255], a[236:239], v[60:63]
  s_waitcnt lgkmcnt(4)
  v_rcp_f32 v217, v218
  v_mfma_f32_16x16x32_bf16 v[16:19], v[196:199], a[216:219], v[16:19]
  ds_read_b64_tr_b16 a[248:249], v206 offset:16384
  ds_read_b64_tr_b16 a[250:251], v206 offset:16896
  v_mul_f32 v219, v218, v218
  v_mul_f32 v218, v217, v217
  v_mul_f32 v218, v218, v217
  v_mul_f32 v217, 0xc0135761, v217
  v_mul_f32 v218, 0xbdd2d3e8, v218
  v_rcp_f32 v221, v222
  v_mul_f32 v223, v222, v222
  v_mul_f32 v222, v221, v221
  v_mul_f32 v222, v222, v221
  v_mul_f32 v221, 0xc0135761, v221
  v_mul_f32 v222, 0xbdd2d3e8, v222
  v_mfma_f32_16x16x32_bf16 v[16:19], v[200:203], a[228:231], v[16:19]
  s_cmp_eq_u32 s54, 13
  s_cbranch_scc1 SINGLE
  s_bfm_b64 exec, 32, 32
  buffer_load_dword v254, v251, s[36:39], 0 offen sc1
  s_mov_b64 exec, -1
FC1:
  v_mfma_f32_16x16x32_bf16 v[20:23], v[200:203], a[232:235], v[20:23]
  ds_read_b64_tr_b16 a[252:253], v206 offset:24576
  ds_read_b64_tr_b16 a[254:255], v206 offset:25088
  v_mfma_f32_16x16x32_bf16 v[20:23], v[196:199], a[220:223], v[20:23]
  v_fmac_f32_dpp v8, v4, v216 row_newbcast:0 row_mask:0xf bank_mask:0xf
  v_fmac_f32_dpp v9, v5, v216 row_newbcast:0 row_mask:0xf bank_mask:0xf
  v_mfma_f32_16x16x32_bf16 v[24:27], v[196:199], a[224:227], v[24:27]
  v_fmac_f32_dpp v10, v6, v216 row_newbcast:0 row_mask:0xf bank_mask:0xf
  v_fmac_f32_dpp v11, v7, v216 row_newbcast:0 row_mask:0xf bank_mask:0xf
  v_mfma_f32_16x16x32_bf16 v[24:27], v[200:203], a[236:239], v[24:27]
  s_waitcnt lgkmcnt(4)
  v_fmac_f32_dpp v56, v52, v216 row_newbcast:0 row_mask:0xf bank_mask:0xf
  v_fmac_f32_dpp v57, v53, v216 row_newbcast:0 row_mask:0xf bank_mask:0xf
  v_mfma_f32_16x16x32_bf16 v[64:67], a[240:243], a[216:219], v[64:67]
  ds_read_b64_tr_b16 v[196:197], v206 offset:18432
  ds_read_b64_tr_b16 v[198:199], v206 offset:18944
  v_mfma_f32_16x16x32_bf16 v[64:67], a[244:247], a[228:231], v[64:67]
  v_fmac_f32_dpp v58, v54, v216 row_newbcast:0 row_mask:0xf bank_mask:0xf
  v_fmac_f32_dpp v59, v55, v216 row_newbcast:0 row_mask:0xf bank_mask:0xf
  v_mfma_f32_16x16x32_bf16 v[68:71], a[244:247], a[232:235], v[68:71]
  ds_read_b64_tr_b16 v[200:201], v206 offset:26624
  ds_read_b64_tr_b16 v[202:203], v206 offset:27136
  v_mfma_f32_16x16x32_bf16 v[68:71], a[240:243], a[220:223], v[68:71]
  v_fmac_f32_dpp v12, v4, v220 row_newbcast:0 row_mask:0xf bank_mask:0xf
  v_fmac_f32_dpp v13, v5, v220 row_newbcast:0 row_mask:0xf bank_mask:0xf
  v_mfma_f32_16x16x32_bf16 v[72:75], a[240:243], a[224:227], v[72:75]
  v_fmac_f32_dpp v14, v6, v220 row_newbcast:0 row_mask:0xf bank_mask:0xf
  v_fmac_f32_dpp v15, v7, v220 row_newbcast:0 row_mask:0xf bank_mask:0xf
  v_mfma_f32_16x16x32_bf16 v[72:75], a[244:247], a[236:239], v[72:75]
  s_waitcnt lgkmcnt(4)
  v_fmac_f32_dpp v60, v52, v220 row_newbcast:0 row_mask:0xf bank_mask:0xf
  v_fmac_f32_dpp v61, v53, v220 row_newbcast:0 row_mask:0xf bank_mask:0xf
  v_mfma_f32_16x16x32_bf16 v[28:31], a[248:251], a[216:219], v[28:31]
  ds_read_b64_tr_b16 a[240:241], v207 offset:16384
  ds_read_b64_tr_b16 a[242:243], v207 offset:16896
  v_mfma_f32_16x16x32_bf16 v[28:31], a[252:255], a[228:231], v[28:31]
  v_fmac_f32_dpp v62, v54, v220 row_newbcast:0 row_mask:0xf bank_mask:0xf
  v_fmac_f32_dpp v63, v55, v220 row_newbcast:0 row_mask:0xf bank_mask:0xf
  v_mfma_f32_16x16x32_bf16 v[32:35], a[252:255], a[232:235], v[32:35]
  ds_read_b64_tr_b16 a[244:245], v207 offset:24576
  ds_read_b64_tr_b16 a[246:247], v207 offset:25088
  v_mfma_f32_16x16x32_bf16 v[32:35], a[248:251], a[220:223], v[32:35]
  v_fmac_f32_dpp v4, v4, v212 row_newbcast:0 row_mask:0xf bank_mask:0xf
  v_fmac_f32_dpp v5, v5, v212 row_newbcast:0 row_mask:0xf bank_mask:0xf
  v_mfma_f32_16x16x32_bf16 v[36:39], a[248:251], a[224:227], v[36:39]
  v_fmac_f32_dpp v6, v6, v212 row_newbcast:0 row_mask:0xf bank_mask:0xf
  v_fmac_f32_dpp v7, v7, v212 row_newbcast:0 row_mask:0xf bank_mask:0xf
  v_mfma_f32_16x16x32_bf16 v[36:39], a[252:255], a[236:239], v[36:39]
  s_waitcnt lgkmcnt(4)
  v_fmac_f32_dpp v52, v52, v212 row_newbcast:0 row_mask:0xf bank_mask:0xf
  v_fmac_f32_dpp v53, v53, v212 row_newbcast:0 row_mask:0xf bank_mask:0xf
  v_mfma_f32_16x16x32_bf16 v[76:79], v[196:199], a[216:219], v[76:79]
  ds_read_b64_tr_b16 a[248:249], v207 offset:18432
  ds_read_b64_tr_b16 a[250:251], v207 offset:18944
  v_mfma_f32_16x16x32_bf16 v[76:79], v[200:203], a[228:231], v[76:79]
  v_fmac_f32_dpp v54, v54, v212 row_newbcast:0 row_mask:0xf bank_mask:0xf
  v_fmac_f32_dpp v55, v55, v212 row_newbcast:0 row_mask:0xf bank_mask:0xf
  v_mfma_f32_16x16x32_bf16 v[80:83], v[200:203], a[232:235], v[80:83]
  ds_read_b64_tr_b16 a[252:253], v207 offset:26624
  ds_read_b64_tr_b16 a[254:255], v207 offset:27136
  v_mfma_f32_16x16x32_bf16 v[80:83], v[196:199], a[220:223], v[80:83]
  v_fmac_f32_dpp v20, v16, v216 row_newbcast:0 row_mask:0xf bank_mask:0xf
  v_fmac_f32_dpp v21, v17, v216 row_newbcast:0 row_mask:0xf bank_mask:0xf
  v_mfma_f32_16x16x32_bf16 v[84:87], v[196:199], a[224:227], v[84:87]
  s_waitcnt vmcnt(4)
  v_fmac_f32_dpp v22, v18, v216 row_newbcast:0 row_mask:0xf bank_mask:0xf
  v_fmac_f32_dpp v23, v19, v216 row_newbcast:0 row_mask:0xf bank_mask:0xf
  v_mfma_f32_16x16x32_bf16 v[84:87], v[200:203], a[236:239], v[84:87]
  s_waitcnt lgkmcnt(4)
  v_fmac_f32_dpp v68, v64, v216 row_newbcast:0 row_mask:0xf bank_mask:0xf
  v_fmac_f32_dpp v69, v65, v216 row_newbcast:0 row_mask:0xf bank_mask:0xf
  v_mfma_f32_16x16x32_bf16 v[40:43], a[240:243], a[216:219], v[40:43]
  s_barrier
  ds_read_b64_tr_b16 v[196:197], v204 offset:32768
  ds_read_b64_tr_b16 v[198:199], v204 offset:33280
  v_mfma_f32_16x16x32_bf16 v[40:43], a[244:247], a[228:231], v[40:43]
  s_bfe_u32 s51, s60, 0x40008
  v_fmac_f32_dpp v70, v66, v216 row_newbcast:0 row_mask:0xf bank_mask:0xf
  v_fmac_f32_dpp v71, v67, v216 row_newbcast:0 row_mask:0xf bank_mask:0xf
  v_mfma_f32_16x16x32_bf16 v[44:47], a[244:247], a[232:235], v[44:47]
  s_mul_i32 s51, s51, 221184
  ds_read_b64_tr_b16 v[200:201], v204 offset:40960
  ds_read_b64_tr_b16 v[202:203], v204 offset:41472
  v_mfma_f32_16x16x32_bf16 v[44:47], a[240:243], a[220:223], v[44:47]
  s_add_u32 m0, s50, 0
  v_fmac_f32_dpp v24, v16, v220 row_newbcast:0 row_mask:0xf bank_mask:0xf
  v_fmac_f32_dpp v25, v17, v220 row_newbcast:0 row_mask:0xf bank_mask:0xf
  v_mfma_f32_16x16x32_bf16 v[48:51], a[240:243], a[224:227], v[48:51]
  s_add_u32 s51, s51, s77
  buffer_load_dwordx4 v208, s[28:31], s51 offen offset:0 lds
  v_mfma_f32_16x16x32_bf16 v[48:51], a[244:247], a[236:239], v[48:51]
  s_waitcnt lgkmcnt(4)
  buffer_load_dwordx4 v209, s[28:31], s51 offen offset:1024 lds
  v_mfma_f32_16x16x32_bf16 v[88:91], a[248:251], a[216:219], v[88:91]
FHOP2:
  s_cbranch_execz FHOP6
  ds_read_b64_tr_b16 a[240:241], v204 offset:34816
  ds_read_b64_tr_b16 a[242:243], v204 offset:35328
  v_mfma_f32_16x16x32_bf16 v[88:91], a[252:255], a[228:231], v[88:91]
  v_fmac_f32_dpp v26, v18, v220 row_newbcast:0 row_mask:0xf bank_mask:0xf
  v_fmac_f32_dpp v27, v19, v220 row_newbcast:0 row_mask:0xf bank_mask:0xf
  v_mfma_f32_16x16x32_bf16 v[92:95], a[252:255], a[232:235], v[92:95]
  ds_read_b64_tr_b16 a[244:245], v204 offset:43008
  ds_read_b64_tr_b16 a[246:247], v204 offset:43520
  v_mfma_f32_16x16x32_bf16 v[92:95], a[248:251], a[220:223], v[92:95]
  v_fmac_f32_dpp v72, v64, v220 row_newbcast:0 row_mask:0xf bank_mask:0xf
  v_fmac_f32_dpp v73, v65, v220 row_newbcast:0 row_mask:0xf bank_mask:0xf
  v_mfma_f32_16x16x32_bf16 v[96:99], a[248:251], a[224:227], v[96:99]
  buffer_load_dwordx4 v208, s[32:35], s51 offen offset:2048 lds
  v_mfma_f32_16x16x32_bf16 v[96:99], a[252:255], a[236:239], v[96:99]
  s_waitcnt lgkmcnt(4)
  v_fmac_f32_dpp v74, v66, v220 row_newbcast:0 row_mask:0xf bank_mask:0xf
  v_fmac_f32_dpp v75, v67, v220 row_newbcast:0 row_mask:0xf bank_mask:0xf
  v_mfma_f32_16x16x32_bf16 v[100:103], v[196:199], a[0:3], 0
  ds_read_b64_tr_b16 a[248:249], v205 offset:32768
  ds_read_b64_tr_b16 a[250:251], v205 offset:33280
  v_mfma_f32_16x16x32_bf16 v[100:103], v[200:203], a[12:15], v[100:103]
  v_fmac_f32_dpp v16, v16, v212 row_newbcast:0 row_mask:0xf bank_mask:0xf
  v_fmac_f32_dpp v17, v17, v212 row_newbcast:0 row_mask:0xf bank_mask:0xf
  v_mfma_f32_16x16x32_bf16 v[104:107], v[200:203], a[16:19], 0
  ds_read_b64_tr_b16 a[252:253], v205 offset:40960
  ds_read_b64_tr_b16 a[254:255], v205 offset:41472
  v_fmac_f32_dpp v18, v18, v212 row_newbcast:0 row_mask:0xf bank_mask:0xf
  v_fmac_f32_dpp v19, v19, v212 row_newbcast:0 row_mask:0xf bank_mask:0xf
  v_fmac_f32_dpp v64, v64, v212 row_newbcast:0 row_mask:0xf bank_mask:0xf
  v_fmac_f32_dpp v65, v65, v212 row_newbcast:0 row_mask:0xf bank_mask:0xf
  v_fmac_f32_dpp v66, v66, v212 row_newbcast:0 row_mask:0xf bank_mask:0xf
  v_fmac_f32_dpp v67, v67, v212 row_newbcast:0 row_mask:0xf bank_mask:0xf
  v_pk_mul_f32 v[232:233], v[4:5], v[4:5]
  v_pk_mul_f32 v[234:235], v[6:7], v[6:7]
  v_pk_fma_f32 v[232:233], v[232:233], v[214:215], v[212:213] op_sel:[0,0,1] op_sel_hi:[1,0,1]
  v_pk_fma_f32 v[234:235], v[234:235], v[214:215], v[212:213] op_sel:[0,0,1] op_sel_hi:[1,0,1]
  v_pk_mul_f32 v[232:233], v[232:233], v[4:5]
  v_pk_mul_f32 v[234:235], v[234:235], v[6:7]
  v_exp_f32 v232, v232
  v_exp_f32 v233, v233
  v_exp_f32 v234, v234
  v_exp_f32 v235, v235
  v_pk_mul_f32 v[4:5], v[4:5], v[52:53]
  v_pk_mul_f32 v[6:7], v[6:7], v[54:55]
  v_pk_fma_f32 v[232:233], v[232:233], v[214:215], v[214:215] op_sel:[0,1,1] op_sel_hi:[1,1,1]
  v_pk_fma_f32 v[234:235], v[234:235], v[214:215], v[214:215] op_sel:[0,1,1] op_sel_hi:[1,1,1]
  v_rcp_f32 v232, v232
  v_rcp_f32 v234, v234
  v_rcp_f32 v233, v233
  v_rcp_f32 v235, v235
  v_pk_mul_f32 v[4:5], v[4:5], v[232:233]
  v_pk_mul_f32 v[6:7], v[6:7], v[234:235]
  v_cvt_pk_bf16_f32 v52, v4, v5
  v_cvt_pk_bf16_f32 v53, v6, v7
  v_pk_mul_f32 v[236:237], v[16:17], v[16:17]
  v_pk_mul_f32 v[238:239], v[18:19], v[18:19]
  v_pk_fma_f32 v[236:237], v[236:237], v[214:215], v[212:213] op_sel:[0,0,1] op_sel_hi:[1,0,1]
  v_pk_fma_f32 v[238:239], v[238:239], v[214:215], v[212:213] op_sel:[0,0,1] op_sel_hi:[1,0,1]
  v_pk_mul_f32 v[236:237], v[236:237], v[16:17]
  v_pk_mul_f32 v[238:239], v[238:239], v[18:19]
  v_exp_f32 v236, v236
  v_exp_f32 v237, v237
  v_exp_f32 v238, v238
  v_exp_f32 v239, v239
  v_pk_mul_f32 v[16:17], v[16:17], v[64:65]
  v_pk_mul_f32 v[18:19], v[18:19], v[66:67]
  v_pk_fma_f32 v[236:237], v[236:237], v[214:215], v[214:215] op_sel:[0,1,1] op_sel_hi:[1,1,1]
  v_pk_fma_f32 v[238:239], v[238:239], v[214:215], v[214:215] op_sel:[0,1,1] op_sel_hi:[1,1,1]
  v_rcp_f32 v236, v236
  v_rcp_f32 v238, v238
  v_rcp_f32 v237, v237
  v_rcp_f32 v239, v239
  v_pk_mul_f32 v[16:17], v[16:17], v[236:237]
  v_pk_mul_f32 v[18:19], v[18:19], v[238:239]
  v_cvt_pk_bf16_f32 v54, v16, v17
  v_cvt_pk_bf16_f32 v55, v18, v19
  buffer_store_dwordx4 v[52:55], v1, s[36:39], s70 offen sc1
  v_pk_mul_f32 v[240:241], v[8:9], v[8:9]
  v_pk_mul_f32 v[242:243], v[10:11], v[10:11]
  v_pk_fma_f32 v[240:241], v[240:241], v[218:219], v[216:217] op_sel:[0,0,1] op_sel_hi:[1,0,1]
  v_pk_fma_f32 v[242:243], v[242:243], v[218:219], v[216:217] op_sel:[0,0,1] op_sel_hi:[1,0,1]
  v_pk_mul_f32 v[240:241], v[240:241], v[8:9]
  v_pk_mul_f32 v[242:243], v[242:243], v[10:11]
  v_exp_f32 v240, v240
  v_exp_f32 v241, v241
  v_exp_f32 v242, v242
  v_exp_f32 v243, v243
  v_pk_mul_f32 v[8:9], v[8:9], v[56:57]
  v_pk_mul_f32 v[10:11], v[10:11], v[58:59]
  v_pk_fma_f32 v[240:241], v[240:241], v[218:219], v[218:219] op_sel:[0,1,1] op_sel_hi:[1,1,1]
  v_pk_fma_f32 v[242:243], v[242:243], v[218:219], v[218:219] op_sel:[0,1,1] op_sel_hi:[1,1,1]
  v_rcp_f32 v240, v240
  v_rcp_f32 v242, v242
  v_rcp_f32 v241, v241
  v_rcp_f32 v243, v243
  v_pk_mul_f32 v[8:9], v[8:9], v[240:241]
  v_pk_mul_f32 v[10:11], v[10:11], v[242:243]
  v_cvt_pk_bf16_f32 v56, v8, v9
  v_cvt_pk_bf16_f32 v57, v10, v11
  v_pk_mul_f32 v[244:245], v[20:21], v[20:21]
  v_pk_mul_f32 v[246:247], v[22:23], v[22:23]
  v_pk_fma_f32 v[244:245], v[244:245], v[218:219], v[216:217] op_sel:[0,0,1] op_sel_hi:[1,0,1]
  v_pk_fma_f32 v[246:247], v[246:247], v[218:219], v[216:217] op_sel:[0,0,1] op_sel_hi:[1,0,1]
  v_pk_mul_f32 v[244:245], v[244:245], v[20:21]
  v_pk_mul_f32 v[246:247], v[246:247], v[22:23]
  v_exp_f32 v244, v244
  v_exp_f32 v245, v245
  v_exp_f32 v246, v246
  v_exp_f32 v247, v247
  v_pk_mul_f32 v[20:21], v[20:21], v[68:69]
  v_pk_mul_f32 v[22:23], v[22:23], v[70:71]
  v_pk_fma_f32 v[244:245], v[244:245], v[218:219], v[218:219] op_sel:[0,1,1] op_sel_hi:[1,1,1]
  v_pk_fma_f32 v[246:247], v[246:247], v[218:219], v[218:219] op_sel:[0,1,1] op_sel_hi:[1,1,1]
  v_rcp_f32 v244, v244
  v_rcp_f32 v246, v246
  v_rcp_f32 v245, v245
  v_rcp_f32 v247, v247
  v_pk_mul_f32 v[20:21], v[20:21], v[244:245]
  v_pk_mul_f32 v[22:23], v[22:23], v[246:247]
  v_cvt_pk_bf16_f32 v58, v20, v21
  v_cvt_pk_bf16_f32 v59, v22, v23
  buffer_store_dwordx4 v[56:59], v2, s[36:39], s70 offen sc1
  v_mfma_f32_16x16x32_bf16 v[104:107], v[196:199], a[4:7], v[104:107]
  buffer_load_dwordx4 v209, s[32:35], s51 offen offset:3072 lds
  v_mfma_f32_16x16x32_bf16 v[108:111], v[196:199], a[8:11], 0
  v_mul_f32 v232, v12, v12
  v_mul_f32 v233, v13, v13
  v_mfma_f32_16x16x32_bf16 v[108:111], v[200:203], a[20:23], v[108:111]
  s_waitcnt lgkmcnt(4)
  v_mul_f32 v234, v14, v14
  v_mul_f32 v235, v15, v15
  v_mfma_f32_16x16x32_bf16 v[148:151], a[240:243], a[0:3], 0
  ds_read_b64_tr_b16 v[196:197], v205 offset:34816
  ds_read_b64_tr_b16 v[198:199], v205 offset:35328
  v_mfma_f32_16x16x32_bf16 v[148:151], a[244:247], a[12:15], v[148:151]
  s_waitcnt vmcnt(6)
  v_cmp_ne_u32 vcc, v254, v249
  v_fma_f32 v232, v232, v222, v221
  v_mfma_f32_16x16x32_bf16 v[152:155], a[244:247], a[16:19], 0
  ds_read_b64_tr_b16 v[200:201], v205 offset:43008
  ds_read_b64_tr_b16 v[202:203], v205 offset:43520
  v_mfma_f32_16x16x32_bf16 v[152:155], a[240:243], a[4:7], v[152:155]
  v_fma_f32 v233, v233, v222, v221
  v_fma_f32 v234, v234, v222, v221
  v_mfma_f32_16x16x32_bf16 v[156:159], a[240:243], a[8:11], 0
  s_cmp_lg_u32 vcc_hi, 0
  s_cbranch_scc1 SFo
BFo:
  v_fma_f32 v235, v235, v222, v221
  v_mul_f32 v232, v232, v12
  v_mfma_f32_16x16x32_bf16 v[156:159], a[244:247], a[20:23], v[156:159]
  s_waitcnt lgkmcnt(4)
  s_bfe_u32 s49, s62, 0x40000
  s_mul_i32 s49, s49, 5120
  s_add_u32 s49, s49, s66
  s_add_u32 m0, s22, 126976
  v_mfma_f32_16x16x32_bf16 v[112:115], a[248:251], a[0:3], 0
  ds_read_b64_tr_b16 a[240:241], v206 offset:32768
  ds_read_b64_tr_b16 a[242:243], v206 offset:33280
  v_mfma_f32_16x16x32_bf16 v[112:115], a[252:255], a[12:15], v[112:115]
  buffer_load_dwordx4 v248, s[36:39], s49 offen offset:0 sc1 lds
  v_mfma_f32_16x16x32_bf16 v[116:119], a[252:255], a[16:19], 0
  ds_read_b64_tr_b16 a[244:245], v206 offset:40960
  ds_read_b64_tr_b16 a[246:247], v206 offset:41472
  v_mfma_f32_16x16x32_bf16 v[116:119], a[248:251], a[4:7], v[116:119]
  v_lshrrev_b32 v227, 4, v0
  v_lshlrev_b32 v227, 22, v227
  v_add_lshl_u32 v227, v227, v0, 2
  buffer_store_dword v249, v227, s[36:39], s76 offen sc1
  v_mfma_f32_16x16x32_bf16 v[120:123], a[248:251], a[8:11], 0
  buffer_load_dwordx4 v248, s[36:39], s49 offen offset:1024 sc1 lds
  v_mfma_f32_16x16x32_bf16 v[120:123], a[252:255], a[20:23], v[120:123]
  s_waitcnt lgkmcnt(4)
  v_mul_f32 v233, v233, v13
  v_mul_f32 v234, v234, v14
  v_mfma_f32_16x16x32_bf16 v[160:163], v[196:199], a[0:3], 0
  s_and_b32 s58, s2, 7
  ds_read_b64_tr_b16 a[248:249], v206 offset:34816
  ds_read_b64_tr_b16 a[250:251], v206 offset:35328
  v_mfma_f32_16x16x32_bf16 v[160:163], v[200:203], a[12:15], v[160:163]
  s_lshr_b32 s13, s2, 6
  buffer_load_dwordx4 v248, s[36:39], s49 offen offset:2048 sc1 lds
  v_mfma_f32_16x16x32_bf16 v[164:167], v[200:203], a[16:19], 0
  s_lshl2_add_u32 s58, s58, s13
  ds_read_b64_tr_b16 a[252:253], v206 offset:43008
  ds_read_b64_tr_b16 a[254:255], v206 offset:43520
  v_mfma_f32_16x16x32_bf16 v[164:167], v[196:199], a[4:7], v[164:167]
  s_mul_i32 s12, s58, 303104
  v_mul_f32 v235, v235, v15
  v_mul_f32 v12, v12, v60
  v_mfma_f32_16x16x32_bf16 v[168:171], v[196:199], a[8:11], 0
  s_add_u32 s12, s12, 0x100000
  v_exp_f32 v232, v232
  v_mfma_f32_16x16x32_bf16 v[168:171], v[200:203], a[20:23], v[168:171]
  s_waitcnt lgkmcnt(4)
  v_exp_f32 v233, v233
  v_mfma_f32_16x16x32_bf16 v[124:127], a[240:243], a[0:3], 0
  s_mul_i32 s14, s44, 28672
  ds_read_b64_tr_b16 v[196:197], v207 offset:32768
  ds_read_b64_tr_b16 v[198:199], v207 offset:33280
  v_mfma_f32_16x16x32_bf16 v[124:127], a[244:247], a[12:15], v[124:127]
  s_mul_i32 s16, s44, 24576
  buffer_load_dwordx4 v248, s[36:39], s49 offen offset:3072 sc1 lds
  v_mfma_f32_16x16x32_bf16 v[128:131], a[244:247], a[16:19], 0
  s_add_u32 s16, s16, 114688
  ds_read_b64_tr_b16 v[200:201], v207 offset:40960
  ds_read_b64_tr_b16 v[202:203], v207 offset:41472
  v_mfma_f32_16x16x32_bf16 v[128:131], a[240:243], a[4:7], v[128:131]
  s_add_u32 s49, s49, 4096
  v_exp_f32 v234, v234
  v_mfma_f32_16x16x32_bf16 v[132:135], a[240:243], a[8:11], 0
  s_add_u32 m0, s22, 131072
  v_exp_f32 v235, v235
  v_mfma_f32_16x16x32_bf16 v[132:135], a[244:247], a[20:23], v[132:135]
  s_waitcnt lgkmcnt(4)
  buffer_load_dwordx4 v248, s[36:39], s49 offen offset:0 sc1 lds
  v_mfma_f32_16x16x32_bf16 v[172:175], a[248:251], a[0:3], 0
  s_mul_i32 s17, s44, 20480
  ds_read_b64_tr_b16 a[240:241], v207 offset:34816
  ds_read_b64_tr_b16 a[242:243], v207 offset:35328
  v_mfma_f32_16x16x32_bf16 v[172:175], a[252:255], a[12:15], v[172:175]
  s_add_u32 s17, s17, 221184
  v_mul_f32 v13, v13, v61
  v_mul_f32 v14, v14, v62
  v_mfma_f32_16x16x32_bf16 v[176:179], a[252:255], a[16:19], 0
  s_sub_u32 s17, s17, s14
  ds_read_b64_tr_b16 a[244:245], v207 offset:43008
  ds_read_b64_tr_b16 a[246:247], v207 offset:43520
  v_mfma_f32_16x16x32_bf16 v[176:179], a[248:251], a[4:7], v[176:179]
  s_sub_u32 s16, s16, s14
  v_mul_f32 v15, v15, v63
  v_fma_f32 v232, v232, v223, v223
  v_mfma_f32_16x16x32_bf16 v[180:183], a[248:251], a[8:11], 0
  v_fma_f32 v233, v233, v223, v223
  v_fma_f32 v234, v234, v223, v223
  v_mfma_f32_16x16x32_bf16 v[180:183], a[252:255], a[20:23], v[180:183]
  s_waitcnt lgkmcnt(4)
  v_fma_f32 v235, v235, v223, v223
  v_mul_f32 v236, v24, v24
  v_mfma_f32_16x16x32_bf16 v[136:139], v[196:199], a[0:3], 0
  s_barrier
  ds_read_b64_tr_b16 a[248:249], v204 offset:49152
  ds_read_b64_tr_b16 a[250:251], v204 offset:49664
  v_mfma_f32_16x16x32_bf16 v[136:139], v[200:203], a[12:15], v[136:139]
  s_bfe_u32 s51, s60, 0x4000c
  v_rcp_f32 v232, v232
  v_mfma_f32_16x16x32_bf16 v[140:143], v[200:203], a[16:19], 0
  s_mul_i32 s51, s51, 221184
  ds_read_b64_tr_b16 a[252:253], v204 offset:57344
  ds_read_b64_tr_b16 a[254:255], v204 offset:57856
  v_mfma_f32_16x16x32_bf16 v[140:143], v[196:199], a[4:7], v[140:143]
  s_add_u32 m0, s50, 16384
  v_rcp_f32 v233, v233
  v_mfma_f32_16x16x32_bf16 v[144:147], v[196:199], a[8:11], 0
  s_add_u32 s51, s51, s77
  buffer_load_dwordx4 v208, s[28:31], s51 offen offset:0 lds
  v_mfma_f32_16x16x32_bf16 v[144:147], v[200:203], a[20:23], v[144:147]
  s_waitcnt lgkmcnt(4)
  v_rcp_f32 v234, v234
  v_mfma_f32_16x16x32_bf16 v[184:187], a[240:243], a[0:3], 0
  s_add_u32 s12, s12, s14
  ds_read_b64_tr_b16 v[196:197], v204 offset:51200
  ds_read_b64_tr_b16 v[198:199], v204 offset:51712
  v_mfma_f32_16x16x32_bf16 v[184:187], a[244:247], a[12:15], v[184:187]
  s_mov_b32 s14, 0xbfb8aa3b
  buffer_load_dwordx4 v209, s[28:31], s51 offen offset:1024 lds
  v_mfma_f32_16x16x32_bf16 v[188:191], a[244:247], a[16:19], 0
  s_add_u32 s13, s44, 0
  ds_read_b64_tr_b16 v[200:201], v204 offset:59392
  ds_read_b64_tr_b16 v[202:203], v204 offset:59904
  v_mfma_f32_16x16x32_bf16 v[188:191], a[240:243], a[4:7], v[188:191]
  s_and_b32 s13, s13, 3
  v_rcp_f32 v235, v235
  v_mfma_f32_16x16x32_bf16 v[192:195], a[240:243], a[8:11], 0
  s_lshl_b32 s13, s13, 10
  v_mul_f32 v12, v12, v232
  v_mul_f32 v13, v13, v233
  v_mfma_f32_16x16x32_bf16 v[192:195], a[244:247], a[20:23], v[192:195]
  s_waitcnt lgkmcnt(4)
  buffer_load_dwordx4 v208, s[32:35], s51 offen offset:2048 lds
  v_mfma_f32_16x16x32_bf16 v[100:103], a[248:251], a[24:27], v[100:103]
  s_add_u32 s4, s12, s13
  ds_read_b64_tr_b16 a[240:241], v205 offset:49152
  ds_read_b64_tr_b16 a[242:243], v205 offset:49664
  v_mfma_f32_16x16x32_bf16 v[100:103], a[252:255], a[36:39], v[100:103]
  s_add_u32 s13, s44, 1
  v_mul_f32 v14, v14, v234
  v_mul_f32 v15, v15, v235
  v_mfma_f32_16x16x32_bf16 v[104:107], a[252:255], a[40:43], v[104:107]
  s_and_b32 s13, s13, 3
  ds_read_b64_tr_b16 a[244:245], v205 offset:57344
  ds_read_b64_tr_b16 a[246:247], v205 offset:57856
  v_mfma_f32_16x16x32_bf16 v[104:107], a[248:251], a[28:31], v[104:107]
  s_lshl_b32 s13, s13, 10
  v_cvt_pk_bf16_f32 v60, v12, v13
  v_cvt_pk_bf16_f32 v61, v14, v15
  v_mfma_f32_16x16x32_bf16 v[108:111], a[248:251], a[32:35], v[108:111]
  s_add_u32 s5, s12, s13
  buffer_load_dwordx4 v209, s[32:35], s51 offen offset:3072 lds
  v_mfma_f32_16x16x32_bf16 v[108:111], a[252:255], a[44:47], v[108:111]
  s_waitcnt lgkmcnt(4)
  v_mul_f32 v237, v25, v25
  v_mul_f32 v238, v26, v26
  v_mfma_f32_16x16x32_bf16 v[148:151], v[196:199], a[24:27], v[148:151]
  s_add_u32 s13, s44, 2
  ds_read_b64_tr_b16 a[248:249], v205 offset:51200
  ds_read_b64_tr_b16 a[250:251], v205 offset:51712
  v_mfma_f32_16x16x32_bf16 v[148:151], v[200:203], a[36:39], v[148:151]
  s_bfe_u32 s49, s62, 0x40004
  v_mul_f32 v239, v27, v27
  v_fma_f32 v236, v236, v222, v221
  v_mfma_f32_16x16x32_bf16 v[152:155], v[200:203], a[40:43], v[152:155]
  s_mul_i32 s49, s49, 5120
  ds_read_b64_tr_b16 a[252:253], v205 offset:59392
  ds_read_b64_tr_b16 a[254:255], v205 offset:59904
  v_mfma_f32_16x16x32_bf16 v[152:155], v[196:199], a[28:31], v[152:155]
  s_add_u32 s49, s49, s66
  v_fma_f32 v237, v237, v222, v221
  v_fma_f32 v238, v238, v222, v221
  v_mfma_f32_16x16x32_bf16 v[156:159], v[196:199], a[32:35], v[156:159]
  s_add_u32 m0, s22, 106496
  v_fma_f32 v239, v239, v222, v221
  v_mul_f32 v236, v236, v24
  v_mfma_f32_16x16x32_bf16 v[156:159], v[200:203], a[44:47], v[156:159]
  s_waitcnt lgkmcnt(4)
  buffer_load_dwordx4 v248, s[36:39], s49 offen offset:0 sc1 lds
  v_mfma_f32_16x16x32_bf16 v[112:115], a[240:243], a[24:27], v[112:115]
  s_and_b32 s13, s13, 3
  ds_read_b64_tr_b16 v[196:197], v206 offset:49152
  ds_read_b64_tr_b16 v[198:199], v206 offset:49664
  v_mfma_f32_16x16x32_bf16 v[112:115], a[244:247], a[36:39], v[112:115]
  s_lshl_b32 s13, s13, 10
  v_mul_f32 v237, v237, v25
  v_mul_f32 v238, v238, v26
  v_mfma_f32_16x16x32_bf16 v[116:119], a[244:247], a[40:43], v[116:119]
  s_add_u32 s6, s12, s13
  ds_read_b64_tr_b16 v[200:201], v206 offset:57344
  ds_read_b64_tr_b16 v[202:203], v206 offset:57856
  v_mfma_f32_16x16x32_bf16 v[116:119], a[240:243], a[28:31], v[116:119]
  s_add_u32 s13, s44, 3
  buffer_load_dwordx4 v248, s[36:39], s49 offen offset:1024 sc1 lds
  v_mfma_f32_16x16x32_bf16 v[120:123], a[240:243], a[32:35], v[120:123]
  s_and_b32 s13, s13, 3
  v_mul_f32 v239, v239, v27
  v_mul_f32 v24, v24, v72
  v_mfma_f32_16x16x32_bf16 v[120:123], a[244:247], a[44:47], v[120:123]
  s_waitcnt lgkmcnt(4)
  v_exp_f32 v236, v236
  v_mfma_f32_16x16x32_bf16 v[160:163], a[248:251], a[24:27], v[160:163]
  s_lshl_b32 s13, s13, 10
  ds_read_b64_tr_b16 a[240:241], v206 offset:51200
  ds_read_b64_tr_b16 a[242:243], v206 offset:51712
  v_mfma_f32_16x16x32_bf16 v[160:163], a[252:255], a[36:39], v[160:163]
  s_add_u32 s7, s12, s13
  buffer_load_dwordx4 v248, s[36:39], s49 offen offset:2048 sc1 lds
  v_mfma_f32_16x16x32_bf16 v[164:167], a[252:255], a[40:43], v[164:167]
  s_bfe_u32 s56, s69, 0x40000
  ds_read_b64_tr_b16 a[244:245], v206 offset:59392
  ds_read_b64_tr_b16 a[246:247], v206 offset:59904
  v_mfma_f32_16x16x32_bf16 v[164:167], a[248:251], a[28:31], v[164:167]
  s_lshl_b32 s56, s56, 12
  v_exp_f32 v237, v237
  v_mfma_f32_16x16x32_bf16 v[168:171], a[248:251], a[32:35], v[168:171]
  s_bfe_u32 s57, s69, 0x40004
  v_exp_f32 v238, v238
  v_mfma_f32_16x16x32_bf16 v[168:171], a[252:255], a[44:47], v[168:171]
  s_waitcnt lgkmcnt(4)
  v_exp_f32 v239, v239
  v_mfma_f32_16x16x32_bf16 v[124:127], v[196:199], a[24:27], v[124:127]
  s_lshl_b32 s57, s57, 12
  ds_read_b64_tr_b16 a[248:249], v207 offset:49152
  ds_read_b64_tr_b16 a[250:251], v207 offset:49664
  v_mfma_f32_16x16x32_bf16 v[124:127], v[200:203], a[36:39], v[124:127]
  s_bfe_u32 s59, s69, 0x40008
  buffer_load_dwordx4 v248, s[36:39], s49 offen offset:3072 sc1 lds
  v_mfma_f32_16x16x32_bf16 v[128:131], v[200:203], a[40:43], v[128:131]
  s_lshl_b32 s59, s59, 12
  ds_read_b64_tr_b16 a[252:253], v207 offset:57344
  ds_read_b64_tr_b16 a[254:255], v207 offset:57856
  v_mfma_f32_16x16x32_bf16 v[128:131], v[196:199], a[28:31], v[128:131]
  s_add_u32 s49, s49, 4096
  v_mul_f32 v25, v25, v73
  v_mul_f32 v26, v26, v74
  v_mfma_f32_16x16x32_bf16 v[132:135], v[196:199], a[32:35], v[132:135]
  s_add_u32 m0, s22, 110592
  v_mul_f32 v27, v27, v75
  v_fma_f32 v236, v236, v223, v223
  v_mfma_f32_16x16x32_bf16 v[132:135], v[200:203], a[44:47], v[132:135]
  s_waitcnt lgkmcnt(4)
  buffer_load_dwordx4 v248, s[36:39], s49 offen offset:0 sc1 lds
  v_mfma_f32_16x16x32_bf16 v[172:175], a[240:243], a[24:27], v[172:175]
  s_bfe_u32 s20, s69, 0x4000c
  ds_read_b64_tr_b16 v[196:197], v207 offset:51200
  ds_read_b64_tr_b16 v[198:199], v207 offset:51712
  v_mfma_f32_16x16x32_bf16 v[172:175], a[244:247], a[36:39], v[172:175]
  s_lshl_b32 s20, s20, 12
  v_fma_f32 v237, v237, v223, v223
  v_fma_f32 v238, v238, v223, v223
  v_mfma_f32_16x16x32_bf16 v[176:179], a[244:247], a[40:43], v[176:179]
  s_bfe_u32 s21, s69, 0x40010
  ds_read_b64_tr_b16 v[200:201], v207 offset:59392
  ds_read_b64_tr_b16 v[202:203], v207 offset:59904
  v_mfma_f32_16x16x32_bf16 v[176:179], a[240:243], a[28:31], v[176:179]
  s_lshl_b32 s21, s21, 12
  v_fma_f32 v239, v239, v223, v223
  v_fmac_f32_dpp v32, v28, v216 row_newbcast:0 row_mask:0xf bank_mask:0xf
  v_mfma_f32_16x16x32_bf16 v[180:183], a[240:243], a[32:35], v[180:183]
  s_waitcnt vmcnt(15)
  v_rcp_f32 v236, v236
  v_mfma_f32_16x16x32_bf16 v[180:183], a[244:247], a[44:47], v[180:183]
  s_waitcnt lgkmcnt(4)
  v_rcp_f32 v237, v237
  v_mfma_f32_16x16x32_bf16 v[136:139], a[248:251], a[24:27], v[136:139]
  s_barrier
  ds_read_b64_tr_b16 a[240:241], v204 offset:0
  ds_read_b64_tr_b16 a[242:243], v204 offset:512
  v_mfma_f32_16x16x32_bf16 v[136:139], a[252:255], a[36:39], v[136:139]
  s_bfe_u32 s51, s60, 0x40010
  v_rcp_f32 v238, v238
  v_mfma_f32_16x16x32_bf16 v[140:143], a[252:255], a[40:43], v[140:143]
  s_mul_i32 s51, s51, 221184
  ds_read_b64_tr_b16 a[244:245], v204 offset:8192
  ds_read_b64_tr_b16 a[246:247], v204 offset:8704
  v_mfma_f32_16x16x32_bf16 v[140:143], a[248:251], a[28:31], v[140:143]
  s_add_u32 m0, s50, 32768
  v_rcp_f32 v239, v239
  v_mfma_f32_16x16x32_bf16 v[144:147], a[248:251], a[32:35], v[144:147]
  s_add_u32 s51, s51, s77
  buffer_load_dwordx4 v208, s[28:31], s51 offen offset:0 lds
  v_mfma_f32_16x16x32_bf16 v[144:147], a[252:255], a[44:47], v[144:147]
  s_waitcnt lgkmcnt(4)
  v_mul_f32 v24, v24, v236
  v_mul_f32 v25, v25, v237
  v_mfma_f32_16x16x32_bf16 v[184:187], v[196:199], a[24:27], v[184:187]
  s_bfe_u32 s45, s69, 0x40014
  ds_read_b64_tr_b16 a[248:249], v204 offset:2048
  ds_read_b64_tr_b16 a[250:251], v204 offset:2560
  v_mfma_f32_16x16x32_bf16 v[184:187], v[200:203], a[36:39], v[184:187]
  s_lshl_b32 s45, s45, 12
  buffer_load_dwordx4 v209, s[28:31], s51 offen offset:1024 lds
  v_mfma_f32_16x16x32_bf16 v[188:191], v[200:203], a[40:43], v[188:191]
  s_bfe_u32 s46, s69, 0x40018
  ds_read_b64_tr_b16 a[252:253], v204 offset:10240
  ds_read_b64_tr_b16 a[254:255], v204 offset:10752
  v_mfma_f32_16x16x32_bf16 v[188:191], v[196:199], a[28:31], v[188:191]
  s_lshl_b32 s46, s46, 12
  v_mul_f32 v26, v26, v238
  v_mul_f32 v27, v27, v239
  v_mfma_f32_16x16x32_bf16 v[192:195], v[196:199], a[32:35], v[192:195]
  v_cvt_pk_bf16_f32 v62, v24, v25
  v_cvt_pk_bf16_f32 v63, v26, v27
  v_mfma_f32_16x16x32_bf16 v[192:195], v[200:203], a[44:47], v[192:195]
  s_waitcnt lgkmcnt(4)
  buffer_load_dwordx4 v208, s[32:35], s51 offen offset:2048 lds
  v_mfma_f32_16x16x32_bf16 v[100:103], a[240:243], a[48:51], v[100:103]
  ds_read_b64_tr_b16 v[196:197], v205 offset:0
  ds_read_b64_tr_b16 v[198:199], v205 offset:512
  v_mfma_f32_16x16x32_bf16 v[100:103], a[244:247], a[60:63], v[100:103]
  buffer_store_dwordx4 v[60:63], v3, s[36:39], s70 offen sc1
  v_mfma_f32_16x16x32_bf16 v[104:107], a[244:247], a[64:67], v[104:107]
  ds_read_b64_tr_b16 v[200:201], v205 offset:8192
  ds_read_b64_tr_b16 v[202:203], v205 offset:8704
  v_mfma_f32_16x16x32_bf16 v[104:107], a[240:243], a[52:55], v[104:107]
  v_fmac_f32_dpp v33, v29, v216 row_newbcast:0 row_mask:0xf bank_mask:0xf
  v_fmac_f32_dpp v34, v30, v216 row_newbcast:0 row_mask:0xf bank_mask:0xf
  v_mfma_f32_16x16x32_bf16 v[108:111], a[240:243], a[56:59], v[108:111]
  buffer_load_dwordx4 v209, s[32:35], s51 offen offset:3072 lds
  v_mfma_f32_16x16x32_bf16 v[108:111], a[244:247], a[68:71], v[108:111]
  s_waitcnt lgkmcnt(4)
  v_fmac_f32_dpp v35, v31, v216 row_newbcast:0 row_mask:0xf bank_mask:0xf
  v_fmac_f32_dpp v80, v76, v216 row_newbcast:0 row_mask:0xf bank_mask:0xf
  v_mfma_f32_16x16x32_bf16 v[148:151], a[248:251], a[48:51], v[148:151]
  ds_read_b64_tr_b16 a[240:241], v205 offset:2048
  ds_read_b64_tr_b16 a[242:243], v205 offset:2560
  v_mfma_f32_16x16x32_bf16 v[148:151], a[252:255], a[60:63], v[148:151]
  s_bfe_u32 s49, s62, 0x40008
  v_fmac_f32_dpp v81, v77, v216 row_newbcast:0 row_mask:0xf bank_mask:0xf
  v_fmac_f32_dpp v82, v78, v216 row_newbcast:0 row_mask:0xf bank_mask:0xf
  v_mfma_f32_16x16x32_bf16 v[152:155], a[252:255], a[64:67], v[152:155]
  s_mul_i32 s49, s49, 5120
  ds_read_b64_tr_b16 a[244:245], v205 offset:10240
  ds_read_b64_tr_b16 a[246:247], v205 offset:10752
  v_mfma_f32_16x16x32_bf16 v[152:155], a[248:251], a[52:55], v[152:155]
  s_add_u32 s49, s49, s66
  v_fmac_f32_dpp v83, v79, v216 row_newbcast:0 row_mask:0xf bank_mask:0xf
  v_fmac_f32_dpp v36, v28, v220 row_newbcast:0 row_mask:0xf bank_mask:0xf
  v_mfma_f32_16x16x32_bf16 v[156:159], a[248:251], a[56:59], v[156:159]
  s_add_u32 m0, s22, 86016
  v_fmac_f32_dpp v37, v29, v220 row_newbcast:0 row_mask:0xf bank_mask:0xf
  v_fmac_f32_dpp v38, v30, v220 row_newbcast:0 row_mask:0xf bank_mask:0xf
  v_mfma_f32_16x16x32_bf16 v[156:159], a[252:255], a[68:71], v[156:159]
  s_waitcnt lgkmcnt(4)
  buffer_load_dwordx4 v248, s[36:39], s49 offen offset:0 sc1 lds
  v_mfma_f32_16x16x32_bf16 v[112:115], v[196:199], a[48:51], v[112:115]
  ds_read_b64_tr_b16 a[248:249], v206 offset:0
  ds_read_b64_tr_b16 a[250:251], v206 offset:512
  v_mfma_f32_16x16x32_bf16 v[112:115], v[200:203], a[60:63], v[112:115]
  v_fmac_f32_dpp v39, v31, v220 row_newbcast:0 row_mask:0xf bank_mask:0xf
  v_fmac_f32_dpp v84, v76, v220 row_newbcast:0 row_mask:0xf bank_mask:0xf
  v_mfma_f32_16x16x32_bf16 v[116:119], v[200:203], a[64:67], v[116:119]
  ds_read_b64_tr_b16 a[252:253], v206 offset:8192
  ds_read_b64_tr_b16 a[254:255], v206 offset:8704
  v_mfma_f32_16x16x32_bf16 v[116:119], v[196:199], a[52:55], v[116:119]
  buffer_load_dwordx4 v248, s[36:39], s49 offen offset:1024 sc1 lds
  v_mfma_f32_16x16x32_bf16 v[120:123], v[196:199], a[56:59], v[120:123]
  v_fmac_f32_dpp v85, v77, v220 row_newbcast:0 row_mask:0xf bank_mask:0xf
  v_fmac_f32_dpp v86, v78, v220 row_newbcast:0 row_mask:0xf bank_mask:0xf
  v_mfma_f32_16x16x32_bf16 v[120:123], v[200:203], a[68:71], v[120:123]
  s_waitcnt lgkmcnt(4)
  v_fmac_f32_dpp v87, v79, v220 row_newbcast:0 row_mask:0xf bank_mask:0xf
  v_fmac_f32_dpp v28, v28, v212 row_newbcast:0 row_mask:0xf bank_mask:0xf
  v_mfma_f32_16x16x32_bf16 v[160:163], a[240:243], a[48:51], v[160:163]
  ds_read_b64_tr_b16 v[196:197], v206 offset:2048
  ds_read_b64_tr_b16 v[198:199], v206 offset:2560
  v_mfma_f32_16x16x32_bf16 v[160:163], a[244:247], a[60:63], v[160:163]
  buffer_load_dwordx4 v248, s[36:39], s49 offen offset:2048 sc1 lds
  v_mfma_f32_16x16x32_bf16 v[164:167], a[244:247], a[64:67], v[164:167]
  ds_read_b64_tr_b16 v[200:201], v206 offset:10240
  ds_read_b64_tr_b16 v[202:203], v206 offset:10752
  v_mfma_f32_16x16x32_bf16 v[164:167], a[240:243], a[52:55], v[164:167]
  v_fmac_f32_dpp v29, v29, v212 row_newbcast:0 row_mask:0xf bank_mask:0xf
  v_fmac_f32_dpp v30, v30, v212 row_newbcast:0 row_mask:0xf bank_mask:0xf
  v_mfma_f32_16x16x32_bf16 v[168:171], a[240:243], a[56:59], v[168:171]
  v_fmac_f32_dpp v31, v31, v212 row_newbcast:0 row_mask:0xf bank_mask:0xf
  v_fmac_f32_dpp v76, v76, v212 row_newbcast:0 row_mask:0xf bank_mask:0xf
  v_mfma_f32_16x16x32_bf16 v[168:171], a[244:247], a[68:71], v[168:171]
  s_waitcnt lgkmcnt(4)
  v_fmac_f32_dpp v77, v77, v212 row_newbcast:0 row_mask:0xf bank_mask:0xf
  v_fmac_f32_dpp v78, v78, v212 row_newbcast:0 row_mask:0xf bank_mask:0xf
  v_mfma_f32_16x16x32_bf16 v[124:127], a[248:251], a[48:51], v[124:127]
  ds_read_b64_tr_b16 a[240:241], v207 offset:0
  ds_read_b64_tr_b16 a[242:243], v207 offset:512
  v_mfma_f32_16x16x32_bf16 v[124:127], a[252:255], a[60:63], v[124:127]
  buffer_load_dwordx4 v248, s[36:39], s49 offen offset:3072 sc1 lds
  v_mfma_f32_16x16x32_bf16 v[128:131], a[252:255], a[64:67], v[128:131]
  ds_read_b64_tr_b16 a[244:245], v207 offset:8192
  ds_read_b64_tr_b16 a[246:247], v207 offset:8704
  v_mfma_f32_16x16x32_bf16 v[128:131], a[248:251], a[52:55], v[128:131]
  s_add_u32 s49, s49, 4096
  v_fmac_f32_dpp v79, v79, v212 row_newbcast:0 row_mask:0xf bank_mask:0xf
  v_fmac_f32_dpp v44, v40, v216 row_newbcast:0 row_mask:0xf bank_mask:0xf
  v_mfma_f32_16x16x32_bf16 v[132:135], a[248:251], a[56:59], v[132:135]
  s_add_u32 m0, s22, 90112
  v_fmac_f32_dpp v45, v41, v216 row_newbcast:0 row_mask:0xf bank_mask:0xf
  v_fmac_f32_dpp v46, v42, v216 row_newbcast:0 row_mask:0xf bank_mask:0xf
  v_mfma_f32_16x16x32_bf16 v[132:135], a[252:255], a[68:71], v[132:135]
  s_waitcnt lgkmcnt(4)
  buffer_load_dwordx4 v248, s[36:39], s49 offen offset:0 sc1 lds
  v_mfma_f32_16x16x32_bf16 v[172:175], v[196:199], a[48:51], v[172:175]
  ds_read_b64_tr_b16 a[248:249], v207 offset:2048
  ds_read_b64_tr_b16 a[250:251], v207 offset:2560
  v_mfma_f32_16x16x32_bf16 v[172:175], v[200:203], a[60:63], v[172:175]
  v_fmac_f32_dpp v47, v43, v216 row_newbcast:0 row_mask:0xf bank_mask:0xf
  v_fmac_f32_dpp v92, v88, v216 row_newbcast:0 row_mask:0xf bank_mask:0xf
  v_mfma_f32_16x16x32_bf16 v[176:179], v[200:203], a[64:67], v[176:179]
  ds_read_b64_tr_b16 a[252:253], v207 offset:10240
  ds_read_b64_tr_b16 a[254:255], v207 offset:10752
  v_mfma_f32_16x16x32_bf16 v[176:179], v[196:199], a[52:55], v[176:179]
  v_fmac_f32_dpp v93, v89, v216 row_newbcast:0 row_mask:0xf bank_mask:0xf
  v_fmac_f32_dpp v94, v90, v216 row_newbcast:0 row_mask:0xf bank_mask:0xf
  v_mfma_f32_16x16x32_bf16 v[180:183], v[196:199], a[56:59], v[180:183]
  s_waitcnt vmcnt(15)
  v_fmac_f32_dpp v95, v91, v216 row_newbcast:0 row_mask:0xf bank_mask:0xf
  v_fmac_f32_dpp v48, v40, v220 row_newbcast:0 row_mask:0xf bank_mask:0xf
  v_mfma_f32_16x16x32_bf16 v[180:183], v[200:203], a[68:71], v[180:183]
  s_waitcnt lgkmcnt(4)
  v_fmac_f32_dpp v49, v41, v220 row_newbcast:0 row_mask:0xf bank_mask:0xf
  v_fmac_f32_dpp v50, v42, v220 row_newbcast:0 row_mask:0xf bank_mask:0xf
  v_mfma_f32_16x16x32_bf16 v[136:139], a[240:243], a[48:51], v[136:139]
  s_barrier
  ds_read_b64_tr_b16 v[196:197], v204 offset:16384
  ds_read_b64_tr_b16 v[198:199], v204 offset:16896
  v_mfma_f32_16x16x32_bf16 v[136:139], a[244:247], a[60:63], v[136:139]
  s_bfe_u32 s51, s60, 0x40014
  v_fmac_f32_dpp v51, v43, v220 row_newbcast:0 row_mask:0xf bank_mask:0xf
  v_fmac_f32_dpp v96, v88, v220 row_newbcast:0 row_mask:0xf bank_mask:0xf
  v_mfma_f32_16x16x32_bf16 v[140:143], a[244:247], a[64:67], v[140:143]
  s_mul_i32 s51, s51, 221184
  ds_read_b64_tr_b16 v[200:201], v204 offset:24576
  ds_read_b64_tr_b16 v[202:203], v204 offset:25088
  v_mfma_f32_16x16x32_bf16 v[140:143], a[240:243], a[52:55], v[140:143]
  s_add_u32 m0, s50, 49152
  v_fmac_f32_dpp v97, v89, v220 row_newbcast:0 row_mask:0xf bank_mask:0xf
  v_fmac_f32_dpp v98, v90, v220 row_newbcast:0 row_mask:0xf bank_mask:0xf
  v_mfma_f32_16x16x32_bf16 v[144:147], a[240:243], a[56:59], v[144:147]
FHOP3:
  s_cbranch_execz FHOP7
  s_add_u32 s51, s51, s77
  buffer_load_dwordx4 v208, s[28:31], s51 offen offset:0 lds
  v_mfma_f32_16x16x32_bf16 v[144:147], a[244:247], a[68:71], v[144:147]
  s_waitcnt lgkmcnt(4)
  v_fmac_f32_dpp v99, v91, v220 row_newbcast:0 row_mask:0xf bank_mask:0xf
  v_fmac_f32_dpp v40, v40, v212 row_newbcast:0 row_mask:0xf bank_mask:0xf
  v_mfma_f32_16x16x32_bf16 v[184:187], a[248:251], a[48:51], v[184:187]
  ds_read_b64_tr_b16 a[240:241], v204 offset:18432
  ds_read_b64_tr_b16 a[242:243], v204 offset:18944
  v_mfma_f32_16x16x32_bf16 v[184:187], a[252:255], a[60:63], v[184:187]
  buffer_load_dwordx4 v209, s[28:31], s51 offen offset:1024 lds
  v_mfma_f32_16x16x32_bf16 v[188:191], a[252:255], a[64:67], v[188:191]
  ds_read_b64_tr_b16 a[244:245], v204 offset:26624
  ds_read_b64_tr_b16 a[246:247], v204 offset:27136
  v_mfma_f32_16x16x32_bf16 v[188:191], a[248:251], a[52:55], v[188:191]
  v_fmac_f32_dpp v41, v41, v212 row_newbcast:0 row_mask:0xf bank_mask:0xf
  v_fmac_f32_dpp v42, v42, v212 row_newbcast:0 row_mask:0xf bank_mask:0xf
  v_mfma_f32_16x16x32_bf16 v[192:195], a[248:251], a[56:59], v[192:195]
  v_fmac_f32_dpp v43, v43, v212 row_newbcast:0 row_mask:0xf bank_mask:0xf
  v_fmac_f32_dpp v88, v88, v212 row_newbcast:0 row_mask:0xf bank_mask:0xf
  v_mfma_f32_16x16x32_bf16 v[192:195], a[252:255], a[68:71], v[192:195]
  s_waitcnt lgkmcnt(4)
  buffer_load_dwordx4 v208, s[32:35], s51 offen offset:2048 lds
  v_mfma_f32_16x16x32_bf16 v[100:103], v[196:199], a[72:75], v[100:103]
  ds_read_b64_tr_b16 a[248:249], v205 offset:16384
  ds_read_b64_tr_b16 a[250:251], v205 offset:16896
  v_mfma_f32_16x16x32_bf16 v[100:103], v[200:203], a[84:87], v[100:103]
  v_fmac_f32_dpp v89, v89, v212 row_newbcast:0 row_mask:0xf bank_mask:0xf
  v_fmac_f32_dpp v90, v90, v212 row_newbcast:0 row_mask:0xf bank_mask:0xf
  v_mfma_f32_16x16x32_bf16 v[104:107], v[200:203], a[88:91], v[104:107]
  ds_read_b64_tr_b16 a[252:253], v205 offset:24576
  ds_read_b64_tr_b16 a[254:255], v205 offset:25088
  v_mfma_f32_16x16x32_bf16 v[104:107], v[196:199], a[76:79], v[104:107]
  v_fmac_f32_dpp v91, v91, v212 row_newbcast:0 row_mask:0xf bank_mask:0xf
  v_mul_f32 v240, v28, v28
  v_mfma_f32_16x16x32_bf16 v[108:111], v[196:199], a[80:83], v[108:111]
  buffer_load_dwordx4 v209, s[32:35], s51 offen offset:3072 lds
  v_mfma_f32_16x16x32_bf16 v[108:111], v[200:203], a[92:95], v[108:111]
  s_waitcnt lgkmcnt(4)
  v_mul_f32 v241, v29, v29
  v_mul_f32 v242, v30, v30
  v_mfma_f32_16x16x32_bf16 v[148:151], a[240:243], a[72:75], v[148:151]
  ds_read_b64_tr_b16 v[196:197], v205 offset:18432
  ds_read_b64_tr_b16 v[198:199], v205 offset:18944
  v_mfma_f32_16x16x32_bf16 v[148:151], a[244:247], a[84:87], v[148:151]
  s_bfe_u32 s49, s62, 0x4000c
  v_mul_f32 v243, v31, v31
  v_fma_f32 v240, v240, v214, v213
  v_mfma_f32_16x16x32_bf16 v[152:155], a[244:247], a[88:91], v[152:155]
  s_mul_i32 s49, s49, 5120
  ds_read_b64_tr_b16 v[200:201], v205 offset:26624
  ds_read_b64_tr_b16 v[202:203], v205 offset:27136
  v_mfma_f32_16x16x32_bf16 v[152:155], a[240:243], a[76:79], v[152:155]
  s_add_u32 s49, s49, s66
  v_fma_f32 v241, v241, v214, v213
  v_fma_f32 v242, v242, v214, v213
  v_mfma_f32_16x16x32_bf16 v[156:159], a[240:243], a[80:83], v[156:159]
  s_add_u32 m0, s22, 65536
  v_fma_f32 v243, v243, v214, v213
  v_mul_f32 v240, v240, v28
  v_mfma_f32_16x16x32_bf16 v[156:159], a[244:247], a[92:95], v[156:159]
  s_waitcnt lgkmcnt(4)
  buffer_load_dwordx4 v248, s[36:39], s49 offen offset:0 sc1 lds
  v_mfma_f32_16x16x32_bf16 v[112:115], a[248:251], a[72:75], v[112:115]
  ds_read_b64_tr_b16 a[240:241], v206 offset:16384
  ds_read_b64_tr_b16 a[242:243], v206 offset:16896
  v_mfma_f32_16x16x32_bf16 v[112:115], a[252:255], a[84:87], v[112:115]
  v_mul_f32 v241, v241, v29
  v_mul_f32 v242, v242, v30
  v_mfma_f32_16x16x32_bf16 v[116:119], a[252:255], a[88:91], v[116:119]
  ds_read_b64_tr_b16 a[244:245], v206 offset:24576
  ds_read_b64_tr_b16 a[246:247], v206 offset:25088
  v_mfma_f32_16x16x32_bf16 v[116:119], a[248:251], a[76:79], v[116:119]
  buffer_load_dwordx4 v248, s[36:39], s49 offen offset:1024 sc1 lds
  v_mfma_f32_16x16x32_bf16 v[120:123], a[248:251], a[80:83], v[120:123]
  v_mul_f32 v243, v243, v31
  v_mul_f32 v28, v28, v76
  v_mfma_f32_16x16x32_bf16 v[120:123], a[252:255], a[92:95], v[120:123]
  s_waitcnt lgkmcnt(4)
  v_exp_f32 v240, v240
  v_mfma_f32_16x16x32_bf16 v[160:163], v[196:199], a[72:75], v[160:163]
  ds_read_b64_tr_b16 a[248:249], v206 offset:18432
  ds_read_b64_tr_b16 a[250:251], v206 offset:18944
  v_mfma_f32_16x16x32_bf16 v[160:163], v[200:203], a[84:87], v[160:163]
  buffer_load_dwordx4 v248, s[36:39], s49 offen offset:2048 sc1 lds
  v_mfma_f32_16x16x32_bf16 v[164:167], v[200:203], a[88:91], v[164:167]
  ds_read_b64_tr_b16 a[252:253], v206 offset:26624
  ds_read_b64_tr_b16 a[254:255], v206 offset:27136
  v_mfma_f32_16x16x32_bf16 v[164:167], v[196:199], a[76:79], v[164:167]
  v_exp_f32 v241, v241
  v_mfma_f32_16x16x32_bf16 v[168:171], v[196:199], a[80:83], v[168:171]
  v_exp_f32 v242, v242
  v_mfma_f32_16x16x32_bf16 v[168:171], v[200:203], a[92:95], v[168:171]
  s_waitcnt lgkmcnt(4)
  v_exp_f32 v243, v243
  v_mfma_f32_16x16x32_bf16 v[124:127], a[240:243], a[72:75], v[124:127]
  ds_read_b64_tr_b16 v[196:197], v207 offset:16384
  ds_read_b64_tr_b16 v[198:199], v207 offset:16896
  v_mfma_f32_16x16x32_bf16 v[124:127], a[244:247], a[84:87], v[124:127]
  buffer_load_dwordx4 v248, s[36:39], s49 offen offset:3072 sc1 lds
  v_mfma_f32_16x16x32_bf16 v[128:131], a[244:247], a[88:91], v[128:131]
  ds_read_b64_tr_b16 v[200:201], v207 offset:24576
  ds_read_b64_tr_b16 v[202:203], v207 offset:25088
  v_mfma_f32_16x16x32_bf16 v[128:131], a[240:243], a[76:79], v[128:131]
  s_add_u32 s49, s49, 4096
  v_mul_f32 v29, v29, v77
  v_mul_f32 v30, v30, v78
  v_mfma_f32_16x16x32_bf16 v[132:135], a[240:243], a[80:83], v[132:135]
  s_add_u32 m0, s22, 69632
  v_mul_f32 v31, v31, v79
  v_fma_f32 v240, v240, v215, v215
  v_mfma_f32_16x16x32_bf16 v[132:135], a[244:247], a[92:95], v[132:135]
  s_waitcnt lgkmcnt(4)
  buffer_load_dwordx4 v248, s[36:39], s49 offen offset:0 sc1 lds
  v_mfma_f32_16x16x32_bf16 v[172:175], a[248:251], a[72:75], v[172:175]
  ds_read_b64_tr_b16 a[240:241], v207 offset:18432
  ds_read_b64_tr_b16 a[242:243], v207 offset:18944
  v_mfma_f32_16x16x32_bf16 v[172:175], a[252:255], a[84:87], v[172:175]
  s_mov_b32 s48, 131072
  v_fma_f32 v241, v241, v215, v215
  v_fma_f32 v242, v242, v215, v215
  v_mfma_f32_16x16x32_bf16 v[176:179], a[252:255], a[88:91], v[176:179]
  s_waitcnt vmcnt(15)
  ds_read_b64_tr_b16 a[244:245], v207 offset:26624
  ds_read_b64_tr_b16 a[246:247], v207 offset:27136
  v_mfma_f32_16x16x32_bf16 v[176:179], a[248:251], a[76:79], v[176:179]
  buffer_store_dword v249, v250, s[36:39], s48 offen sc1
  v_mfma_f32_16x16x32_bf16 v[180:183], a[248:251], a[80:83], v[180:183]
  s_waitcnt vmcnt(15)
  v_fma_f32 v243, v243, v215, v215
  v_mul_f32 v244, v40, v40
  v_mfma_f32_16x16x32_bf16 v[180:183], a[252:255], a[92:95], v[180:183]
  s_waitcnt lgkmcnt(4)
  v_rcp_f32 v240, v240
  v_mfma_f32_16x16x32_bf16 v[136:139], v[196:199], a[72:75], v[136:139]
  s_barrier
  ds_read_b64_tr_b16 a[248:249], v204 offset:32768
  ds_read_b64_tr_b16 a[250:251], v204 offset:33280
  v_mfma_f32_16x16x32_bf16 v[136:139], v[200:203], a[84:87], v[136:139]
  s_bfe_u32 s51, s60, 0x40018
  v_rcp_f32 v241, v241
  v_mfma_f32_16x16x32_bf16 v[140:143], v[200:203], a[88:91], v[140:143]
  s_mul_i32 s51, s51, 221184
  ds_read_b64_tr_b16 a[252:253], v204 offset:40960
  ds_read_b64_tr_b16 a[254:255], v204 offset:41472
  v_mfma_f32_16x16x32_bf16 v[140:143], v[196:199], a[76:79], v[140:143]
  s_add_u32 m0, s50, 0
  v_rcp_f32 v242, v242
  v_mfma_f32_16x16x32_bf16 v[144:147], v[196:199], a[80:83], v[144:147]
  s_add_u32 s51, s51, s77
  buffer_load_dwordx4 v208, s[28:31], s51 offen offset:0 lds
  v_mfma_f32_16x16x32_bf16 v[144:147], v[200:203], a[92:95], v[144:147]
  s_waitcnt lgkmcnt(4)
  s_bfm_b64 exec, 32, 0
  buffer_load_dword v254, v251, s[36:39], 0 offen sc1
  s_mov_b64 exec, -1
  v_mfma_f32_16x16x32_bf16 v[184:187], a[240:243], a[72:75], v[184:187]
  ds_read_b64_tr_b16 v[196:197], v204 offset:34816
  ds_read_b64_tr_b16 v[198:199], v204 offset:35328
  v_mfma_f32_16x16x32_bf16 v[184:187], a[244:247], a[84:87], v[184:187]
  buffer_load_dwordx4 v209, s[28:31], s51 offen offset:1024 lds
  v_mfma_f32_16x16x32_bf16 v[188:191], a[244:247], a[88:91], v[188:191]
  ds_read_b64_tr_b16 v[200:201], v204 offset:43008
  ds_read_b64_tr_b16 v[202:203], v204 offset:43520
  v_mfma_f32_16x16x32_bf16 v[188:191], a[240:243], a[76:79], v[188:191]
  v_rcp_f32 v243, v243
  v_mfma_f32_16x16x32_bf16 v[192:195], a[240:243], a[80:83], v[192:195]
  v_mul_f32 v28, v28, v240
  v_mul_f32 v29, v29, v241
  v_mfma_f32_16x16x32_bf16 v[192:195], a[244:247], a[92:95], v[192:195]
  s_waitcnt lgkmcnt(4)
  v_mul_f32 v30, v30, v242
  v_mul_f32 v31, v31, v243
  v_mfma_f32_16x16x32_bf16 v[100:103], a[248:251], a[96:99], v[100:103]
  ds_read_b64_tr_b16 a[240:241], v205 offset:32768
  ds_read_b64_tr_b16 a[242:243], v205 offset:33280
  v_mfma_f32_16x16x32_bf16 v[100:103], a[252:255], a[108:111], v[100:103]
  v_cvt_pk_bf16_f32 v76, v28, v29
  v_cvt_pk_bf16_f32 v77, v30, v31
  v_mfma_f32_16x16x32_bf16 v[104:107], a[252:255], a[112:115], v[104:107]
  ds_read_b64_tr_b16 a[244:245], v205 offset:40960
  ds_read_b64_tr_b16 a[246:247], v205 offset:41472
  v_mfma_f32_16x16x32_bf16 v[104:107], a[248:251], a[100:103], v[104:107]
  buffer_load_dwordx4 v208, s[32:35], s51 offen offset:2048 lds
  v_mfma_f32_16x16x32_bf16 v[108:111], a[248:251], a[104:107], v[108:111]
  v_mul_f32 v245, v41, v41
  v_mul_f32 v246, v42, v42
  v_mfma_f32_16x16x32_bf16 v[108:111], a[252:255], a[116:119], v[108:111]
  s_waitcnt lgkmcnt(4)
  v_mul_f32 v247, v43, v43
  v_fma_f32 v244, v244, v214, v213
  v_mfma_f32_16x16x32_bf16 v[148:151], v[196:199], a[96:99], v[148:151]
  ds_read_b64_tr_b16 a[248:249], v205 offset:34816
  ds_read_b64_tr_b16 a[250:251], v205 offset:35328
  v_mfma_f32_16x16x32_bf16 v[148:151], v[200:203], a[108:111], v[148:151]
  v_fma_f32 v245, v245, v214, v213
  v_fma_f32 v246, v246, v214, v213
  v_mfma_f32_16x16x32_bf16 v[152:155], v[200:203], a[112:115], v[152:155]
  ds_read_b64_tr_b16 a[252:253], v205 offset:43008
  ds_read_b64_tr_b16 a[254:255], v205 offset:43520
  v_mfma_f32_16x16x32_bf16 v[152:155], v[196:199], a[100:103], v[152:155]
  buffer_load_dwordx4 v209, s[32:35], s51 offen offset:3072 lds
  v_mfma_f32_16x16x32_bf16 v[156:159], v[196:199], a[104:107], v[156:159]
  v_fma_f32 v247, v247, v214, v213
  v_mul_f32 v244, v244, v40
  v_mfma_f32_16x16x32_bf16 v[156:159], v[200:203], a[116:119], v[156:159]
  s_waitcnt lgkmcnt(4)
  v_mul_f32 v245, v245, v41
  v_mul_f32 v246, v246, v42
  v_mfma_f32_16x16x32_bf16 v[112:115], a[240:243], a[96:99], v[112:115]
  ds_read_b64_tr_b16 v[196:197], v206 offset:32768
  ds_read_b64_tr_b16 v[198:199], v206 offset:33280
  v_mfma_f32_16x16x32_bf16 v[112:115], a[244:247], a[108:111], v[112:115]
  v_mul_f32 v247, v247, v43
  v_mul_f32 v40, v40, v88
  v_mfma_f32_16x16x32_bf16 v[116:119], a[244:247], a[112:115], v[116:119]
  ds_read_b64_tr_b16 v[200:201], v206 offset:40960
  ds_read_b64_tr_b16 v[202:203], v206 offset:41472
  v_mfma_f32_16x16x32_bf16 v[116:119], a[240:243], a[100:103], v[116:119]
  v_exp_f32 v244, v244
  v_mfma_f32_16x16x32_bf16 v[120:123], a[240:243], a[104:107], v[120:123]
  v_exp_f32 v245, v245
  v_mfma_f32_16x16x32_bf16 v[120:123], a[244:247], a[116:119], v[120:123]
  s_waitcnt lgkmcnt(4)
  v_exp_f32 v246, v246
  v_mfma_f32_16x16x32_bf16 v[160:163], a[248:251], a[96:99], v[160:163]
  ds_read_b64_tr_b16 a[240:241], v206 offset:34816
  ds_read_b64_tr_b16 a[242:243], v206 offset:35328
  v_mfma_f32_16x16x32_bf16 v[160:163], a[252:255], a[108:111], v[160:163]
  v_exp_f32 v247, v247
  v_mfma_f32_16x16x32_bf16 v[164:167], a[252:255], a[112:115], v[164:167]
  ds_read_b64_tr_b16 a[244:245], v206 offset:43008
  ds_read_b64_tr_b16 a[246:247], v206 offset:43520
  v_mfma_f32_16x16x32_bf16 v[164:167], a[248:251], a[100:103], v[164:167]
  v_mul_f32 v41, v41, v89
  v_mul_f32 v42, v42, v90
  v_mfma_f32_16x16x32_bf16 v[168:171], a[248:251], a[104:107], v[168:171]
  v_mul_f32 v43, v43, v91
  v_fma_f32 v244, v244, v215, v215
  v_mfma_f32_16x16x32_bf16 v[168:171], a[252:255], a[116:119], v[168:171]
  s_waitcnt lgkmcnt(4)
  v_fma_f32 v245, v245, v215, v215
  v_fma_f32 v246, v246, v215, v215
  v_mfma_f32_16x16x32_bf16 v[124:127], v[196:199], a[96:99], v[124:127]
  ds_read_b64_tr_b16 a[248:249], v207 offset:32768
  ds_read_b64_tr_b16 a[250:251], v207 offset:33280
  v_mfma_f32_16x16x32_bf16 v[124:127], v[200:203], a[108:111], v[124:127]
  v_fma_f32 v247, v247, v215, v215
  v_mul_f32 v232, v32, v32
  v_mfma_f32_16x16x32_bf16 v[128:131], v[200:203], a[112:115], v[128:131]
  ds_read_b64_tr_b16 a[252:253], v207 offset:40960
  ds_read_b64_tr_b16 a[254:255], v207 offset:41472
  v_mfma_f32_16x16x32_bf16 v[128:131], v[196:199], a[100:103], v[128:131]
  v_rcp_f32 v244, v244
  v_mfma_f32_16x16x32_bf16 v[132:135], v[196:199], a[104:107], v[132:135]
  v_rcp_f32 v245, v245
  v_mfma_f32_16x16x32_bf16 v[132:135], v[200:203], a[116:119], v[132:135]
  s_waitcnt lgkmcnt(4)
  v_rcp_f32 v246, v246
  v_mfma_f32_16x16x32_bf16 v[172:175], a[240:243], a[96:99], v[172:175]
  ds_read_b64_tr_b16 v[196:197], v207 offset:34816
  ds_read_b64_tr_b16 v[198:199], v207 offset:35328
  v_mfma_f32_16x16x32_bf16 v[172:175], a[244:247], a[108:111], v[172:175]
  v_rcp_f32 v247, v247
  v_mfma_f32_16x16x32_bf16 v[176:179], a[244:247], a[112:115], v[176:179]
  ds_read_b64_tr_b16 v[200:201], v207 offset:43008
  ds_read_b64_tr_b16 v[202:203], v207 offset:43520
  v_mfma_f32_16x16x32_bf16 v[176:179], a[240:243], a[100:103], v[176:179]
  v_mul_f32 v40, v40, v244
  v_mul_f32 v41, v41, v245
  v_mfma_f32_16x16x32_bf16 v[180:183], a[240:243], a[104:107], v[180:183]
  s_waitcnt vmcnt(11)
  v_mul_f32 v42, v42, v246
  v_mul_f32 v43, v43, v247
  v_mfma_f32_16x16x32_bf16 v[180:183], a[244:247], a[116:119], v[180:183]
  s_waitcnt lgkmcnt(4)
  v_cvt_pk_bf16_f32 v78, v40, v41
  v_cvt_pk_bf16_f32 v79, v42, v43
  v_mfma_f32_16x16x32_bf16 v[136:139], a[248:251], a[96:99], v[136:139]
  s_barrier
  ds_read_b64_tr_b16 a[240:241], v204 offset:49152
  ds_read_b64_tr_b16 a[242:243], v204 offset:49664
  v_mfma_f32_16x16x32_bf16 v[136:139], a[252:255], a[108:111], v[136:139]
  s_bfe_u32 s51, s60, 0x4001c
  buffer_store_dwordx4 v[76:79], v1, s[36:39], s71 offen sc1
  v_mfma_f32_16x16x32_bf16 v[140:143], a[252:255], a[112:115], v[140:143]
  s_mul_i32 s51, s51, 221184
  ds_read_b64_tr_b16 a[244:245], v204 offset:57344
  ds_read_b64_tr_b16 a[246:247], v204 offset:57856
  v_mfma_f32_16x16x32_bf16 v[140:143], a[248:251], a[100:103], v[140:143]
  s_add_u32 m0, s50, 16384
  v_mul_f32 v233, v33, v33
  v_mul_f32 v234, v34, v34
  v_mfma_f32_16x16x32_bf16 v[144:147], a[248:251], a[104:107], v[144:147]
  s_add_u32 s51, s51, s77
  buffer_load_dwordx4 v208, s[28:31], s51 offen offset:0 lds
  v_mfma_f32_16x16x32_bf16 v[144:147], a[252:255], a[116:119], v[144:147]
  s_waitcnt lgkmcnt(4)
  v_mul_f32 v235, v35, v35
  v_fma_f32 v232, v232, v218, v217
  v_mfma_f32_16x16x32_bf16 v[184:187], v[196:199], a[96:99], v[184:187]
  ds_read_b64_tr_b16 a[248:249], v204 offset:51200
  ds_read_b64_tr_b16 a[250:251], v204 offset:51712
  v_mfma_f32_16x16x32_bf16 v[184:187], v[200:203], a[108:111], v[184:187]
  buffer_load_dwordx4 v209, s[28:31], s51 offen offset:1024 lds
  v_mfma_f32_16x16x32_bf16 v[188:191], v[200:203], a[112:115], v[188:191]
  ds_read_b64_tr_b16 a[252:253], v204 offset:59392
  ds_read_b64_tr_b16 a[254:255], v204 offset:59904
  v_mfma_f32_16x16x32_bf16 v[188:191], v[196:199], a[100:103], v[188:191]
  v_fma_f32 v233, v233, v218, v217
  v_fma_f32 v234, v234, v218, v217
  v_mfma_f32_16x16x32_bf16 v[192:195], v[196:199], a[104:107], v[192:195]
  v_fma_f32 v235, v235, v218, v217
  v_mul_f32 v232, v232, v32
  v_mfma_f32_16x16x32_bf16 v[192:195], v[200:203], a[116:119], v[192:195]
  s_waitcnt lgkmcnt(4)
  v_mul_f32 v233, v233, v33
  v_mul_f32 v234, v234, v34
  v_mfma_f32_16x16x32_bf16 v[100:103], a[240:243], a[120:123], v[100:103]
  ds_read_b64_tr_b16 v[196:197], v205 offset:49152
  ds_read_b64_tr_b16 v[198:199], v205 offset:49664
  v_mfma_f32_16x16x32_bf16 v[100:103], a[244:247], a[132:135], v[100:103]
  v_mul_f32 v235, v235, v35
  v_mul_f32 v32, v32, v80
  v_mfma_f32_16x16x32_bf16 v[104:107], a[244:247], a[136:139], v[104:107]
  ds_read_b64_tr_b16 v[200:201], v205 offset:57344
  ds_read_b64_tr_b16 v[202:203], v205 offset:57856
  v_mfma_f32_16x16x32_bf16 v[104:107], a[240:243], a[124:127], v[104:107]
  buffer_load_dwordx4 v208, s[32:35], s51 offen offset:2048 lds
  v_mfma_f32_16x16x32_bf16 v[108:111], a[240:243], a[128:131], v[108:111]
  s_waitcnt vmcnt(7)
  v_exp_f32 v232, v232
  v_mfma_f32_16x16x32_bf16 v[108:111], a[244:247], a[140:143], v[108:111]
  s_waitcnt lgkmcnt(4)
  v_exp_f32 v233, v233
  v_mfma_f32_16x16x32_bf16 v[148:151], a[248:251], a[120:123], v[148:151]
  ds_read_b64_tr_b16 a[240:241], v205 offset:51200
  ds_read_b64_tr_b16 a[242:243], v205 offset:51712
  v_mfma_f32_16x16x32_bf16 v[148:151], a[252:255], a[132:135], v[148:151]
  v_cmp_ne_u32 vcc, v254, v249
  v_mul_f32 v33, v33, v81
  v_mfma_f32_16x16x32_bf16 v[152:155], a[252:255], a[136:139], v[152:155]
  s_cmp_lg_u32 vcc_lo, 0
  s_cbranch_scc1 SFb
BFb:
  ds_read_b64_tr_b16 a[244:245], v205 offset:59392
  ds_read_b64_tr_b16 a[246:247], v205 offset:59904
  v_mfma_f32_16x16x32_bf16 v[152:155], a[248:251], a[124:127], v[152:155]
  buffer_load_dwordx4 v209, s[32:35], s51 offen offset:3072 lds
  v_mfma_f32_16x16x32_bf16 v[156:159], a[248:251], a[128:131], v[156:159]
  s_bfe_u32 s67, s69, 0x40000
  v_exp_f32 v234, v234
  v_mfma_f32_16x16x32_bf16 v[156:159], a[252:255], a[140:143], v[156:159]
  s_waitcnt lgkmcnt(4)
  v_exp_f32 v235, v235
  v_mfma_f32_16x16x32_bf16 v[112:115], v[196:199], a[120:123], v[112:115]
  s_mul_i32 s67, s67, 5120
  ds_read_b64_tr_b16 a[248:249], v206 offset:49152
  ds_read_b64_tr_b16 a[250:251], v206 offset:49664
  v_mfma_f32_16x16x32_bf16 v[112:115], v[200:203], a[132:135], v[112:115]
  s_add_u32 s67, s67, s64
  buffer_load_dwordx4 a[0:3], v248, s[36:39], s67 offen offset:0 sc1
  v_mfma_f32_16x16x32_bf16 v[116:119], v[200:203], a[136:139], v[116:119]
  ds_read_b64_tr_b16 a[252:253], v206 offset:57344
  ds_read_b64_tr_b16 a[254:255], v206 offset:57856
  v_mfma_f32_16x16x32_bf16 v[116:119], v[196:199], a[124:127], v[116:119]
  v_mul_f32 v34, v34, v82
  v_mul_f32 v35, v35, v83
  v_mfma_f32_16x16x32_bf16 v[120:123], v[196:199], a[128:131], v[120:123]
  buffer_load_dwordx4 a[4:7], v248, s[36:39], s67 offen offset:1024 sc1
  v_mfma_f32_16x16x32_bf16 v[120:123], v[200:203], a[140:143], v[120:123]
  s_waitcnt lgkmcnt(4)
  v_fma_f32 v232, v232, v219, v219
  v_fma_f32 v233, v233, v219, v219
  v_mfma_f32_16x16x32_bf16 v[160:163], a[240:243], a[120:123], v[160:163]
  ds_read_b64_tr_b16 v[196:197], v206 offset:51200
  ds_read_b64_tr_b16 v[198:199], v206 offset:51712
  v_mfma_f32_16x16x32_bf16 v[160:163], a[244:247], a[132:135], v[160:163]
  v_fma_f32 v234, v234, v219, v219
  v_fma_f32 v235, v235, v219, v219
  v_mfma_f32_16x16x32_bf16 v[164:167], a[244:247], a[136:139], v[164:167]
  ds_read_b64_tr_b16 v[200:201], v206 offset:59392
  ds_read_b64_tr_b16 v[202:203], v206 offset:59904
  v_mfma_f32_16x16x32_bf16 v[164:167], a[240:243], a[124:127], v[164:167]
  v_rcp_f32 v232, v232
  v_mfma_f32_16x16x32_bf16 v[168:171], a[240:243], a[128:131], v[168:171]
  buffer_load_dwordx4 a[8:11], v248, s[36:39], s67 offen offset:2048 sc1
  v_mfma_f32_16x16x32_bf16 v[168:171], a[244:247], a[140:143], v[168:171]
  s_waitcnt lgkmcnt(4)
  v_rcp_f32 v233, v233
  v_mfma_f32_16x16x32_bf16 v[124:127], a[248:251], a[120:123], v[124:127]
  ds_read_b64_tr_b16 a[240:241], v207 offset:49152
  ds_read_b64_tr_b16 a[242:243], v207 offset:49664
  v_mfma_f32_16x16x32_bf16 v[124:127], a[252:255], a[132:135], v[124:127]
  v_rcp_f32 v234, v234
  v_mfma_f32_16x16x32_bf16 v[128:131], a[252:255], a[136:139], v[128:131]
  ds_read_b64_tr_b16 a[244:245], v207 offset:57344
  ds_read_b64_tr_b16 a[246:247], v207 offset:57856
  v_mfma_f32_16x16x32_bf16 v[128:131], a[248:251], a[124:127], v[128:131]
  v_rcp_f32 v235, v235
  v_mfma_f32_16x16x32_bf16 v[132:135], a[248:251], a[128:131], v[132:135]
  buffer_load_dwordx4 a[12:15], v248, s[36:39], s67 offen offset:3072 sc1
  v_mfma_f32_16x16x32_bf16 v[132:135], a[252:255], a[140:143], v[132:135]
  s_waitcnt lgkmcnt(4)
  v_mul_f32 v32, v32, v232
  v_mul_f32 v33, v33, v233
  v_mfma_f32_16x16x32_bf16 v[172:175], v[196:199], a[120:123], v[172:175]
  ds_read_b64_tr_b16 a[248:249], v207 offset:51200
  ds_read_b64_tr_b16 a[250:251], v207 offset:51712
  v_mfma_f32_16x16x32_bf16 v[172:175], v[200:203], a[132:135], v[172:175]
  v_mul_f32 v34, v34, v234
  v_mul_f32 v35, v35, v235
  v_mfma_f32_16x16x32_bf16 v[176:179], v[200:203], a[136:139], v[176:179]
  s_add_u32 s67, s67, 4096
  ds_read_b64_tr_b16 a[252:253], v207 offset:59392
  ds_read_b64_tr_b16 a[254:255], v207 offset:59904
  v_mfma_f32_16x16x32_bf16 v[176:179], v[196:199], a[124:127], v[176:179]
  v_cvt_pk_bf16_f32 v80, v32, v33
  v_cvt_pk_bf16_f32 v81, v34, v35
  v_mfma_f32_16x16x32_bf16 v[180:183], v[196:199], a[128:131], v[180:183]
  s_waitcnt vmcnt(9)
  buffer_load_dwordx4 a[16:19], v248, s[36:39], s67 offen offset:0 sc1
  v_mfma_f32_16x16x32_bf16 v[180:183], v[200:203], a[140:143], v[180:183]
  s_waitcnt lgkmcnt(4)
  v_mul_f32 v236, v44, v44
  v_mul_f32 v237, v45, v45
  v_mfma_f32_16x16x32_bf16 v[136:139], a[240:243], a[120:123], v[136:139]
  s_barrier
  ds_read_b64_tr_b16 v[196:197], v204 offset:0
  ds_read_b64_tr_b16 v[198:199], v204 offset:512
  v_mfma_f32_16x16x32_bf16 v[136:139], a[244:247], a[132:135], v[136:139]
  s_bfe_u32 s51, s61, 0x40000
  v_mul_f32 v238, v46, v46
  v_mul_f32 v239, v47, v47
  v_mfma_f32_16x16x32_bf16 v[140:143], a[244:247], a[136:139], v[140:143]
  s_mul_i32 s51, s51, 221184
  ds_read_b64_tr_b16 v[200:201], v204 offset:8192
  ds_read_b64_tr_b16 v[202:203], v204 offset:8704
  v_mfma_f32_16x16x32_bf16 v[140:143], a[240:243], a[124:127], v[140:143]
  s_add_u32 m0, s50, 32768
  v_fma_f32 v236, v236, v218, v217
  v_fma_f32 v237, v237, v218, v217
  v_mfma_f32_16x16x32_bf16 v[144:147], a[240:243], a[128:131], v[144:147]
  s_add_u32 s51, s51, s77
  buffer_load_dwordx4 v208, s[28:31], s51 offen offset:0 lds
  v_mfma_f32_16x16x32_bf16 v[144:147], a[244:247], a[140:143], v[144:147]
  s_waitcnt lgkmcnt(4)
  s_bfe_u32 s67, s69, 0x40004
  s_mul_i32 s67, s67, 5120
  s_add_u32 s67, s67, s64
  v_mfma_f32_16x16x32_bf16 v[184:187], a[248:251], a[120:123], v[184:187]
  ds_read_b64_tr_b16 a[240:241], v204 offset:2048
  ds_read_b64_tr_b16 a[242:243], v204 offset:2560
  v_mfma_f32_16x16x32_bf16 v[184:187], a[252:255], a[132:135], v[184:187]
  buffer_load_dwordx4 a[20:23], v248, s[36:39], s67 offen offset:0 sc1
  v_mfma_f32_16x16x32_bf16 v[188:191], a[252:255], a[136:139], v[188:191]
  ds_read_b64_tr_b16 a[244:245], v204 offset:10240
  ds_read_b64_tr_b16 a[246:247], v204 offset:10752
  v_mfma_f32_16x16x32_bf16 v[188:191], a[248:251], a[124:127], v[188:191]
  buffer_load_dwordx4 v209, s[28:31], s51 offen offset:1024 lds
  v_mfma_f32_16x16x32_bf16 v[192:195], a[248:251], a[128:131], v[192:195]
  buffer_load_dwordx4 a[24:27], v248, s[36:39], s67 offen offset:1024 sc1
  v_mfma_f32_16x16x32_bf16 v[192:195], a[252:255], a[140:143], v[192:195]
  s_waitcnt lgkmcnt(4)
  v_fma_f32 v238, v238, v218, v217
  v_fma_f32 v239, v239, v218, v217
  v_mfma_f32_16x16x32_bf16 v[100:103], v[196:199], a[144:147], v[100:103]
  ds_read_b64_tr_b16 a[248:249], v205 offset:0
  ds_read_b64_tr_b16 a[250:251], v205 offset:512
  v_mfma_f32_16x16x32_bf16 v[100:103], v[200:203], a[156:159], v[100:103]
  v_mul_f32 v236, v236, v44
  v_mul_f32 v237, v237, v45
  v_mfma_f32_16x16x32_bf16 v[104:107], v[200:203], a[160:163], v[104:107]
  ds_read_b64_tr_b16 a[252:253], v205 offset:8192
  ds_read_b64_tr_b16 a[254:255], v205 offset:8704
  v_mfma_f32_16x16x32_bf16 v[104:107], v[196:199], a[148:151], v[104:107]
  buffer_load_dwordx4 v208, s[32:35], s51 offen offset:2048 lds
  v_mfma_f32_16x16x32_bf16 v[108:111], v[196:199], a[152:155], v[108:111]
  buffer_load_dwordx4 a[28:31], v248, s[36:39], s67 offen offset:2048 sc1
  v_mfma_f32_16x16x32_bf16 v[108:111], v[200:203], a[164:167], v[108:111]
  s_waitcnt lgkmcnt(4)
  v_mul_f32 v238, v238, v46
  v_mul_f32 v239, v239, v47
  v_mfma_f32_16x16x32_bf16 v[148:151], a[240:243], a[144:147], v[148:151]
  ds_read_b64_tr_b16 v[196:197], v205 offset:2048
  ds_read_b64_tr_b16 v[198:199], v205 offset:2560
  v_mfma_f32_16x16x32_bf16 v[148:151], a[244:247], a[156:159], v[148:151]
  v_exp_f32 v236, v236
  v_mfma_f32_16x16x32_bf16 v[152:155], a[244:247], a[160:163], v[152:155]
  ds_read_b64_tr_b16 v[200:201], v205 offset:10240
  ds_read_b64_tr_b16 v[202:203], v205 offset:10752
  v_mfma_f32_16x16x32_bf16 v[152:155], a[240:243], a[148:151], v[152:155]
  buffer_load_dwordx4 v209, s[32:35], s51 offen offset:3072 lds
  v_mfma_f32_16x16x32_bf16 v[156:159], a[240:243], a[152:155], v[156:159]
  buffer_load_dwordx4 a[32:35], v248, s[36:39], s67 offen offset:3072 sc1
  v_mfma_f32_16x16x32_bf16 v[156:159], a[244:247], a[164:167], v[156:159]
  s_waitcnt lgkmcnt(4)
  v_exp_f32 v237, v237
  v_mfma_f32_16x16x32_bf16 v[112:115], a[248:251], a[144:147], v[112:115]
  ds_read_b64_tr_b16 a[240:241], v206 offset:0
  ds_read_b64_tr_b16 a[242:243], v206 offset:512
  v_mfma_f32_16x16x32_bf16 v[112:115], a[252:255], a[156:159], v[112:115]
  v_exp_f32 v238, v238
  v_mfma_f32_16x16x32_bf16 v[116:119], a[252:255], a[160:163], v[116:119]
  s_add_u32 s67, s67, 4096
  ds_read_b64_tr_b16 a[244:245], v206 offset:8192
  ds_read_b64_tr_b16 a[246:247], v206 offset:8704
  v_mfma_f32_16x16x32_bf16 v[116:119], a[248:251], a[148:151], v[116:119]
  v_exp_f32 v239, v239
  v_mfma_f32_16x16x32_bf16 v[120:123], a[248:251], a[152:155], v[120:123]
  buffer_load_dwordx4 a[36:39], v248, s[36:39], s67 offen offset:0 sc1
  v_mfma_f32_16x16x32_bf16 v[120:123], a[252:255], a[164:167], v[120:123]
  s_waitcnt lgkmcnt(4)
  v_mul_f32 v44, v44, v92
  v_mul_f32 v45, v45, v93
  v_mfma_f32_16x16x32_bf16 v[160:163], v[196:199], a[144:147], v[160:163]
  ds_read_b64_tr_b16 a[248:249], v206 offset:2048
  ds_read_b64_tr_b16 a[250:251], v206 offset:2560
  v_mfma_f32_16x16x32_bf16 v[160:163], v[200:203], a[156:159], v[160:163]
  v_mul_f32 v46, v46, v94
  v_mul_f32 v47, v47, v95
  v_mfma_f32_16x16x32_bf16 v[164:167], v[200:203], a[160:163], v[164:167]
  s_bfe_u32 s67, s69, 0x40008
  ds_read_b64_tr_b16 a[252:253], v206 offset:10240
  ds_read_b64_tr_b16 a[254:255], v206 offset:10752
  v_mfma_f32_16x16x32_bf16 v[164:167], v[196:199], a[148:151], v[164:167]
  s_mul_i32 s67, s67, 5120
  v_fma_f32 v236, v236, v219, v219
  v_fma_f32 v237, v237, v219, v219
  v_mfma_f32_16x16x32_bf16 v[168:171], v[196:199], a[152:155], v[168:171]
  s_add_u32 s67, s67, s64
  v_fma_f32 v238, v238, v219, v219
  v_fma_f32 v239, v239, v219, v219
  v_mfma_f32_16x16x32_bf16 v[168:171], v[200:203], a[164:167], v[168:171]
  s_waitcnt lgkmcnt(4)
  buffer_load_dwordx4 a[40:43], v248, s[36:39], s67 offen offset:0 sc1
  v_mfma_f32_16x16x32_bf16 v[124:127], a[240:243], a[144:147], v[124:127]
  ds_read_b64_tr_b16 v[196:197], v207 offset:0
  ds_read_b64_tr_b16 v[198:199], v207 offset:512
  v_mfma_f32_16x16x32_bf16 v[124:127], a[244:247], a[156:159], v[124:127]
  v_rcp_f32 v236, v236
  v_mfma_f32_16x16x32_bf16 v[128:131], a[244:247], a[160:163], v[128:131]
  ds_read_b64_tr_b16 v[200:201], v207 offset:8192
  ds_read_b64_tr_b16 v[202:203], v207 offset:8704
  v_mfma_f32_16x16x32_bf16 v[128:131], a[240:243], a[148:151], v[128:131]
  v_rcp_f32 v237, v237
  v_mfma_f32_16x16x32_bf16 v[132:135], a[240:243], a[152:155], v[132:135]
  buffer_load_dwordx4 a[44:47], v248, s[36:39], s67 offen offset:1024 sc1
  v_mfma_f32_16x16x32_bf16 v[132:135], a[244:247], a[164:167], v[132:135]
  s_waitcnt lgkmcnt(4)
  v_rcp_f32 v238, v238
  v_mfma_f32_16x16x32_bf16 v[172:175], a[248:251], a[144:147], v[172:175]
  ds_read_b64_tr_b16 a[240:241], v207 offset:2048
  ds_read_b64_tr_b16 a[242:243], v207 offset:2560
  v_mfma_f32_16x16x32_bf16 v[172:175], a[252:255], a[156:159], v[172:175]
  v_rcp_f32 v239, v239
  v_mfma_f32_16x16x32_bf16 v[176:179], a[252:255], a[160:163], v[176:179]
  ds_read_b64_tr_b16 a[244:245], v207 offset:10240
  ds_read_b64_tr_b16 a[246:247], v207 offset:10752
  v_mfma_f32_16x16x32_bf16 v[176:179], a[248:251], a[148:151], v[176:179]
  v_mul_f32 v44, v44, v236
  v_mul_f32 v45, v45, v237
  v_mfma_f32_16x16x32_bf16 v[180:183], a[248:251], a[152:155], v[180:183]
  s_waitcnt vmcnt(16)
  v_add_co_u32 v210, vcc, FC2-FC1, v210
  v_mul_f32 v46, v46, v238
  v_mfma_f32_16x16x32_bf16 v[180:183], a[252:255], a[164:167], v[180:183]
  s_waitcnt lgkmcnt(4)
  v_addc_co_u32 v211, vcc, 0, v211, vcc
  v_mul_f32 v47, v47, v239
  v_mfma_f32_16x16x32_bf16 v[136:139], v[196:199], a[144:147], v[136:139]
  s_barrier
  ds_read_b64_tr_b16 a[248:249], v204 offset:16384
  ds_read_b64_tr_b16 a[250:251], v204 offset:16896
  v_mfma_f32_16x16x32_bf16 v[136:139], v[200:203], a[156:159], v[136:139]
  s_bfe_u32 s51, s61, 0x40004
  global_load_dword v210, v[210:211], off
  buffer_load_dwordx4 a[48:51], v248, s[36:39], s67 offen offset:2048 sc1
  v_mfma_f32_16x16x32_bf16 v[140:143], v[200:203], a[160:163], v[140:143]
  s_mul_i32 s51, s51, 221184
  ds_read_b64_tr_b16 a[252:253], v204 offset:24576
  ds_read_b64_tr_b16 a[254:255], v204 offset:25088
  v_mfma_f32_16x16x32_bf16 v[140:143], v[196:199], a[148:151], v[140:143]
  s_add_u32 m0, s50, 49152
  v_cvt_pk_bf16_f32 v82, v44, v45
  v_cvt_pk_bf16_f32 v83, v46, v47
  v_mfma_f32_16x16x32_bf16 v[144:147], v[196:199], a[152:155], v[144:147]
  s_add_u32 s51, s51, s77
  buffer_load_dwordx4 v208, s[28:31], s51 offen offset:0 lds
  v_mfma_f32_16x16x32_bf16 v[144:147], v[200:203], a[164:167], v[144:147]
  s_waitcnt lgkmcnt(4)
  buffer_load_dwordx4 a[52:55], v248, s[36:39], s67 offen offset:3072 sc1
  v_mfma_f32_16x16x32_bf16 v[184:187], a[240:243], a[144:147], v[184:187]
FHOP4:
  s_cbranch_execz FHRET
  ds_read_b64_tr_b16 v[196:197], v204 offset:18432
  ds_read_b64_tr_b16 v[198:199], v204 offset:18944
  v_mfma_f32_16x16x32_bf16 v[184:187], a[244:247], a[156:159], v[184:187]
  buffer_load_dwordx4 v209, s[28:31], s51 offen offset:1024 lds
  v_mfma_f32_16x16x32_bf16 v[188:191], a[244:247], a[160:163], v[188:191]
  s_add_u32 s67, s67, 4096
  ds_read_b64_tr_b16 v[200:201], v204 offset:26624
  ds_read_b64_tr_b16 v[202:203], v204 offset:27136
  v_mfma_f32_16x16x32_bf16 v[188:191], a[240:243], a[148:151], v[188:191]
  buffer_store_dwordx4 v[80:83], v2, s[36:39], s71 offen sc1
  v_mfma_f32_16x16x32_bf16 v[192:195], a[240:243], a[152:155], v[192:195]
  buffer_load_dwordx4 a[56:59], v248, s[36:39], s67 offen offset:0 sc1
  v_mfma_f32_16x16x32_bf16 v[192:195], a[244:247], a[164:167], v[192:195]
  s_waitcnt lgkmcnt(4)
  v_mul_f32 v240, v36, v36
  v_mul_f32 v241, v37, v37
  v_mfma_f32_16x16x32_bf16 v[100:103], a[248:251], a[168:171], v[100:103]
  ds_read_b64_tr_b16 a[240:241], v205 offset:16384
  ds_read_b64_tr_b16 a[242:243], v205 offset:16896
  v_mfma_f32_16x16x32_bf16 v[100:103], a[252:255], a[180:183], v[100:103]
  v_mul_f32 v242, v38, v38
  v_mul_f32 v243, v39, v39
  v_mfma_f32_16x16x32_bf16 v[104:107], a[252:255], a[184:187], v[104:107]
  s_bfe_u32 s67, s69, 0x4000c
  ds_read_b64_tr_b16 a[244:245], v205 offset:24576
  ds_read_b64_tr_b16 a[246:247], v205 offset:25088
  v_mfma_f32_16x16x32_bf16 v[104:107], a[248:251], a[172:175], v[104:107]
  s_mul_i32 s67, s67, 5120
  buffer_load_dwordx4 v208, s[32:35], s51 offen offset:2048 lds
  v_mfma_f32_16x16x32_bf16 v[108:111], a[248:251], a[176:179], v[108:111]
  s_add_u32 s67, s67, s64
  v_fma_f32 v240, v240, v222, v221
  v_fma_f32 v241, v241, v222, v221
  v_mfma_f32_16x16x32_bf16 v[108:111], a[252:255], a[188:191], v[108:111]
  s_waitcnt lgkmcnt(4)
  buffer_load_dwordx4 a[60:63], v248, s[36:39], s67 offen offset:0 sc1
  v_mfma_f32_16x16x32_bf16 v[148:151], v[196:199], a[168:171], v[148:151]
  ds_read_b64_tr_b16 a[248:249], v205 offset:18432
  ds_read_b64_tr_b16 a[250:251], v205 offset:18944
  v_mfma_f32_16x16x32_bf16 v[148:151], v[200:203], a[180:183], v[148:151]
  v_fma_f32 v242, v242, v222, v221
  v_fma_f32 v243, v243, v222, v221
  v_mfma_f32_16x16x32_bf16 v[152:155], v[200:203], a[184:187], v[152:155]
  ds_read_b64_tr_b16 a[252:253], v205 offset:26624
  ds_read_b64_tr_b16 a[254:255], v205 offset:27136
  v_mfma_f32_16x16x32_bf16 v[152:155], v[196:199], a[172:175], v[152:155]
  buffer_load_dwordx4 v209, s[32:35], s51 offen offset:3072 lds
  v_mfma_f32_16x16x32_bf16 v[156:159], v[196:199], a[176:179], v[156:159]
  buffer_load_dwordx4 a[64:67], v248, s[36:39], s67 offen offset:1024 sc1
  v_mfma_f32_16x16x32_bf16 v[156:159], v[200:203], a[188:191], v[156:159]
  s_waitcnt lgkmcnt(4)
  v_mul_f32 v240, v240, v36
  v_mul_f32 v241, v241, v37
  v_mfma_f32_16x16x32_bf16 v[112:115], a[240:243], a[168:171], v[112:115]
  ds_read_b64_tr_b16 v[196:197], v206 offset:16384
  ds_read_b64_tr_b16 v[198:199], v206 offset:16896
  v_mfma_f32_16x16x32_bf16 v[112:115], a[244:247], a[180:183], v[112:115]
  v_mul_f32 v242, v242, v38
  v_mul_f32 v243, v243, v39
  v_mfma_f32_16x16x32_bf16 v[116:119], a[244:247], a[184:187], v[116:119]
  ds_read_b64_tr_b16 v[200:201], v206 offset:24576
  ds_read_b64_tr_b16 v[202:203], v206 offset:25088
  v_mfma_f32_16x16x32_bf16 v[116:119], a[240:243], a[172:175], v[116:119]
  v_exp_f32 v240, v240
  v_mfma_f32_16x16x32_bf16 v[120:123], a[240:243], a[176:179], v[120:123]
  buffer_load_dwordx4 a[68:71], v248, s[36:39], s67 offen offset:2048 sc1
  v_mfma_f32_16x16x32_bf16 v[120:123], a[244:247], a[188:191], v[120:123]
  s_waitcnt lgkmcnt(4)
  v_exp_f32 v241, v241
  v_mfma_f32_16x16x32_bf16 v[160:163], a[248:251], a[168:171], v[160:163]
  ds_read_b64_tr_b16 a[240:241], v206 offset:18432
  ds_read_b64_tr_b16 a[242:243], v206 offset:18944
  v_mfma_f32_16x16x32_bf16 v[160:163], a[252:255], a[180:183], v[160:163]
  v_exp_f32 v242, v242
  v_mfma_f32_16x16x32_bf16 v[164:167], a[252:255], a[184:187], v[164:167]
  ds_read_b64_tr_b16 a[244:245], v206 offset:26624
  ds_read_b64_tr_b16 a[246:247], v206 offset:27136
  v_mfma_f32_16x16x32_bf16 v[164:167], a[248:251], a[172:175], v[164:167]
  v_exp_f32 v243, v243
  v_mfma_f32_16x16x32_bf16 v[168:171], a[248:251], a[176:179], v[168:171]
  buffer_load_dwordx4 a[72:75], v248, s[36:39], s67 offen offset:3072 sc1
  v_mfma_f32_16x16x32_bf16 v[168:171], a[252:255], a[188:191], v[168:171]
  s_waitcnt lgkmcnt(4)
  v_mul_f32 v36, v36, v84
  v_mul_f32 v37, v37, v85
  v_mfma_f32_16x16x32_bf16 v[124:127], v[196:199], a[168:171], v[124:127]
  ds_read_b64_tr_b16 a[248:249], v207 offset:16384
  ds_read_b64_tr_b16 a[250:251], v207 offset:16896
  v_mfma_f32_16x16x32_bf16 v[124:127], v[200:203], a[180:183], v[124:127]
  v_mul_f32 v38, v38, v86
  v_mul_f32 v39, v39, v87
  v_mfma_f32_16x16x32_bf16 v[128:131], v[200:203], a[184:187], v[128:131]
  s_add_u32 s67, s67, 4096
  ds_read_b64_tr_b16 a[252:253], v207 offset:24576
  ds_read_b64_tr_b16 a[254:255], v207 offset:25088
  v_mfma_f32_16x16x32_bf16 v[128:131], v[196:199], a[172:175], v[128:131]
  v_fma_f32 v240, v240, v223, v223
  v_fma_f32 v241, v241, v223, v223
  v_mfma_f32_16x16x32_bf16 v[132:135], v[196:199], a[176:179], v[132:135]
  buffer_load_dwordx4 a[76:79], v248, s[36:39], s67 offen offset:0 sc1
  v_mfma_f32_16x16x32_bf16 v[132:135], v[200:203], a[188:191], v[132:135]
  s_waitcnt lgkmcnt(4)
  v_fma_f32 v242, v242, v223, v223
  v_fma_f32 v243, v243, v223, v223
  v_mfma_f32_16x16x32_bf16 v[172:175], a[240:243], a[168:171], v[172:175]
  ds_read_b64_tr_b16 v[196:197], v207 offset:18432
  ds_read_b64_tr_b16 v[198:199], v207 offset:18944
  v_mfma_f32_16x16x32_bf16 v[172:175], a[244:247], a[180:183], v[172:175]
  v_rcp_f32 v240, v240
  v_mfma_f32_16x16x32_bf16 v[176:179], a[244:247], a[184:187], v[176:179]
  ds_read_b64_tr_b16 v[200:201], v207 offset:26624
  ds_read_b64_tr_b16 v[202:203], v207 offset:27136
  v_mfma_f32_16x16x32_bf16 v[176:179], a[240:243], a[172:175], v[176:179]
  s_bfe_u32 s67, s69, 0x40010
  v_rcp_f32 v241, v241
  v_mfma_f32_16x16x32_bf16 v[180:183], a[240:243], a[176:179], v[180:183]
  s_waitcnt vmcnt(18)
  v_rcp_f32 v242, v242
  v_mfma_f32_16x16x32_bf16 v[180:183], a[244:247], a[188:191], v[180:183]
  s_waitcnt lgkmcnt(4)
  v_rcp_f32 v243, v243
  v_mfma_f32_16x16x32_bf16 v[136:139], a[248:251], a[168:171], v[136:139]
  s_barrier
  ds_read_b64_tr_b16 a[240:241], v204 offset:32768
  ds_read_b64_tr_b16 a[242:243], v204 offset:33280
  s_mul_i32 s67, s67, 5120
  s_add_u32 s67, s67, s64
  v_mfma_f32_16x16x32_bf16 v[136:139], a[252:255], a[180:183], v[136:139]
  buffer_load_dwordx4 a[80:83], v248, s[36:39], s67 offen offset:0 sc1
  v_mfma_f32_16x16x32_bf16 v[140:143], a[252:255], a[184:187], v[140:143]
  ds_read_b64_tr_b16 a[244:245], v204 offset:40960
  ds_read_b64_tr_b16 a[246:247], v204 offset:41472
  v_mfma_f32_16x16x32_bf16 v[140:143], a[248:251], a[172:175], v[140:143]
  buffer_load_dwordx4 a[84:87], v248, s[36:39], s67 offen offset:1024 sc1
  v_mfma_f32_16x16x32_bf16 v[144:147], a[248:251], a[176:179], v[144:147]
  v_mul_f32 v36, v36, v240
  v_mul_f32 v37, v37, v241
  v_mfma_f32_16x16x32_bf16 v[144:147], a[252:255], a[188:191], v[144:147]
  s_waitcnt lgkmcnt(4)
  v_mul_f32 v38, v38, v242
  v_mul_f32 v39, v39, v243
  v_mfma_f32_16x16x32_bf16 v[184:187], v[196:199], a[168:171], v[184:187]
  ds_read_b64_tr_b16 a[248:249], v204 offset:34816
  ds_read_b64_tr_b16 a[250:251], v204 offset:35328
  v_mfma_f32_16x16x32_bf16 v[184:187], v[200:203], a[180:183], v[184:187]
  v_cvt_pk_bf16_f32 v84, v36, v37
  v_cvt_pk_bf16_f32 v85, v38, v39
  v_mfma_f32_16x16x32_bf16 v[188:191], v[200:203], a[184:187], v[188:191]
  ds_read_b64_tr_b16 a[252:253], v204 offset:43008
  ds_read_b64_tr_b16 a[254:255], v204 offset:43520
  v_mfma_f32_16x16x32_bf16 v[188:191], v[196:199], a[172:175], v[188:191]
  buffer_load_dwordx4 a[88:91], v248, s[36:39], s67 offen offset:2048 sc1
  v_mfma_f32_16x16x32_bf16 v[192:195], v[196:199], a[176:179], v[192:195]
  v_mul_f32 v244, v48, v48
  v_mul_f32 v245, v49, v49
  v_mfma_f32_16x16x32_bf16 v[192:195], v[200:203], a[188:191], v[192:195]
  s_waitcnt lgkmcnt(4)
  v_mul_f32 v246, v50, v50
  v_mul_f32 v247, v51, v51
  v_mfma_f32_16x16x32_bf16 v[100:103], a[240:243], a[192:195], v[100:103]
  ds_read_b64_tr_b16 v[196:197], v205 offset:32768
  ds_read_b64_tr_b16 v[198:199], v205 offset:33280
  v_mfma_f32_16x16x32_bf16 v[100:103], a[244:247], a[204:207], v[100:103]
  buffer_load_dwordx4 a[92:95], v248, s[36:39], s67 offen offset:3072 sc1
  v_mfma_f32_16x16x32_bf16 v[104:107], a[244:247], a[208:211], v[104:107]
  ds_read_b64_tr_b16 v[200:201], v205 offset:40960
  ds_read_b64_tr_b16 v[202:203], v205 offset:41472
  v_mfma_f32_16x16x32_bf16 v[104:107], a[240:243], a[196:199], v[104:107]
  s_add_u32 s67, s67, 4096
  v_fma_f32 v244, v244, v222, v221
  v_fma_f32 v245, v245, v222, v221
  v_mfma_f32_16x16x32_bf16 v[108:111], a[240:243], a[200:203], v[108:111]
  v_fma_f32 v246, v246, v222, v221
  v_fma_f32 v247, v247, v222, v221
  v_mfma_f32_16x16x32_bf16 v[108:111], a[244:247], a[212:215], v[108:111]
  s_waitcnt lgkmcnt(4)
  buffer_load_dwordx4 a[96:99], v248, s[36:39], s67 offen offset:0 sc1
  v_mfma_f32_16x16x32_bf16 v[148:151], a[248:251], a[192:195], v[148:151]
  ds_read_b64_tr_b16 a[240:241], v205 offset:34816
  ds_read_b64_tr_b16 a[242:243], v205 offset:35328
  v_mfma_f32_16x16x32_bf16 v[148:151], a[252:255], a[204:207], v[148:151]
  v_mul_f32 v244, v244, v48
  v_mul_f32 v245, v245, v49
  v_mfma_f32_16x16x32_bf16 v[152:155], a[252:255], a[208:211], v[152:155]
  s_bfe_u32 s67, s69, 0x40014
  ds_read_b64_tr_b16 a[244:245], v205 offset:43008
  ds_read_b64_tr_b16 a[246:247], v205 offset:43520
  v_mfma_f32_16x16x32_bf16 v[152:155], a[248:251], a[196:199], v[152:155]
  s_mul_i32 s67, s67, 5120
  v_mul_f32 v246, v246, v50
  v_mul_f32 v247, v247, v51
  v_mfma_f32_16x16x32_bf16 v[156:159], a[248:251], a[200:203], v[156:159]
  s_add_u32 s67, s67, s64
  v_exp_f32 v244, v244
  v_mfma_f32_16x16x32_bf16 v[156:159], a[252:255], a[212:215], v[156:159]
  s_waitcnt lgkmcnt(4)
  buffer_load_dwordx4 a[100:103], v248, s[36:39], s67 offen offset:0 sc1
  v_mfma_f32_16x16x32_bf16 v[112:115], v[196:199], a[192:195], v[112:115]
  ds_read_b64_tr_b16 a[248:249], v206 offset:32768
  ds_read_b64_tr_b16 a[250:251], v206 offset:33280
  v_mfma_f32_16x16x32_bf16 v[112:115], v[200:203], a[204:207], v[112:115]
  v_exp_f32 v245, v245
  v_mfma_f32_16x16x32_bf16 v[116:119], v[200:203], a[208:211], v[116:119]
  ds_read_b64_tr_b16 a[252:253], v206 offset:40960
  ds_read_b64_tr_b16 a[254:255], v206 offset:41472
  v_mfma_f32_16x16x32_bf16 v[116:119], v[196:199], a[196:199], v[116:119]
  buffer_load_dwordx4 a[104:107], v248, s[36:39], s67 offen offset:1024 sc1
  v_mfma_f32_16x16x32_bf16 v[120:123], v[196:199], a[200:203], v[120:123]
  v_exp_f32 v246, v246
  v_mfma_f32_16x16x32_bf16 v[120:123], v[200:203], a[212:215], v[120:123]
  s_waitcnt lgkmcnt(4)
  v_exp_f32 v247, v247
  v_mfma_f32_16x16x32_bf16 v[160:163], a[240:243], a[192:195], v[160:163]
  ds_read_b64_tr_b16 v[196:197], v206 offset:34816
  ds_read_b64_tr_b16 v[198:199], v206 offset:35328
  v_mfma_f32_16x16x32_bf16 v[160:163], a[244:247], a[204:207], v[160:163]
  buffer_load_dwordx4 a[108:111], v248, s[36:39], s67 offen offset:2048 sc1
  v_mfma_f32_16x16x32_bf16 v[164:167], a[244:247], a[208:211], v[164:167]
  ds_read_b64_tr_b16 v[200:201], v206 offset:43008
  ds_read_b64_tr_b16 v[202:203], v206 offset:43520
  v_mfma_f32_16x16x32_bf16 v[164:167], a[240:243], a[196:199], v[164:167]
  v_mul_f32 v48, v48, v96
  v_mul_f32 v49, v49, v97
  v_mfma_f32_16x16x32_bf16 v[168:171], a[240:243], a[200:203], v[168:171]
  v_mul_f32 v50, v50, v98
  v_mul_f32 v51, v51, v99
  v_mfma_f32_16x16x32_bf16 v[168:171], a[244:247], a[212:215], v[168:171]
  s_waitcnt lgkmcnt(4)
  v_fma_f32 v244, v244, v223, v223
  v_fma_f32 v245, v245, v223, v223
  v_mfma_f32_16x16x32_bf16 v[124:127], a[248:251], a[192:195], v[124:127]
  ds_read_b64_tr_b16 a[240:241], v207 offset:32768
  ds_read_b64_tr_b16 a[242:243], v207 offset:33280
  v_mfma_f32_16x16x32_bf16 v[124:127], a[252:255], a[204:207], v[124:127]
  buffer_load_dwordx4 a[112:115], v248, s[36:39], s67 offen offset:3072 sc1
  v_mfma_f32_16x16x32_bf16 v[128:131], a[252:255], a[208:211], v[128:131]
  ds_read_b64_tr_b16 a[244:245], v207 offset:40960
  ds_read_b64_tr_b16 a[246:247], v207 offset:41472
  v_mfma_f32_16x16x32_bf16 v[128:131], a[248:251], a[196:199], v[128:131]
  s_add_u32 s67, s67, 4096
  s_bfm_b64 exec, 32, 32
  buffer_load_dword v254, v252, s[36:39], 0 offen sc1
  s_mov_b64 exec, -1
  v_mfma_f32_16x16x32_bf16 v[132:135], a[248:251], a[200:203], v[132:135]
  v_fma_f32 v246, v246, v223, v223
  v_fma_f32 v247, v247, v223, v223
  v_mfma_f32_16x16x32_bf16 v[132:135], a[252:255], a[212:215], v[132:135]
  s_waitcnt lgkmcnt(4)
  buffer_load_dwordx4 a[116:119], v248, s[36:39], s67 offen offset:0 sc1
  v_mfma_f32_16x16x32_bf16 v[172:175], v[196:199], a[192:195], v[172:175]
  ds_read_b64_tr_b16 a[248:249], v207 offset:34816
  ds_read_b64_tr_b16 a[250:251], v207 offset:35328
  v_mfma_f32_16x16x32_bf16 v[172:175], v[200:203], a[204:207], v[172:175]
  s_bfe_u32 s67, s69, 0x40018
  v_rcp_f32 v244, v244
  v_mfma_f32_16x16x32_bf16 v[176:179], v[200:203], a[208:211], v[176:179]
  s_mul_i32 s67, s67, 5120
  ds_read_b64_tr_b16 a[252:253], v207 offset:43008
  ds_read_b64_tr_b16 a[254:255], v207 offset:43520
  v_mfma_f32_16x16x32_bf16 v[176:179], v[196:199], a[196:199], v[176:179]
  s_add_u32 s67, s67, s64
  v_rcp_f32 v245, v245
  v_mfma_f32_16x16x32_bf16 v[180:183], v[196:199], a[200:203], v[180:183]
  s_waitcnt vmcnt(15)
  buffer_load_dwordx4 a[120:123], v248, s[36:39], s67 offen offset:0 sc1
  v_mfma_f32_16x16x32_bf16 v[180:183], v[200:203], a[212:215], v[180:183]
  s_waitcnt lgkmcnt(4)
  v_rcp_f32 v246, v246
  v_mfma_f32_16x16x32_bf16 v[136:139], a[240:243], a[192:195], v[136:139]
  s_barrier
  ds_read_b64_tr_b16 v[196:197], v204 offset:49152
  ds_read_b64_tr_b16 v[198:199], v204 offset:49664
  v_mfma_f32_16x16x32_bf16 v[136:139], a[244:247], a[204:207], v[136:139]
  v_rcp_f32 v247, v247
  v_mfma_f32_16x16x32_bf16 v[140:143], a[244:247], a[208:211], v[140:143]
  ds_read_b64_tr_b16 v[200:201], v204 offset:57344
  ds_read_b64_tr_b16 v[202:203], v204 offset:57856
  v_mfma_f32_16x16x32_bf16 v[140:143], a[240:243], a[196:199], v[140:143]
  buffer_load_dwordx4 a[124:127], v248, s[36:39], s67 offen offset:1024 sc1
  v_mfma_f32_16x16x32_bf16 v[144:147], a[240:243], a[200:203], v[144:147]
  v_mul_f32 v48, v48, v244
  v_mul_f32 v49, v49, v245
  v_mfma_f32_16x16x32_bf16 v[144:147], a[244:247], a[212:215], v[144:147]
  s_waitcnt lgkmcnt(4)
  v_mul_f32 v50, v50, v246
  v_mul_f32 v51, v51, v247
  v_mfma_f32_16x16x32_bf16 v[184:187], a[248:251], a[192:195], v[184:187]
  ds_read_b64_tr_b16 a[240:241], v204 offset:51200
  ds_read_b64_tr_b16 a[242:243], v204 offset:51712
  v_mfma_f32_16x16x32_bf16 v[184:187], a[252:255], a[204:207], v[184:187]
  buffer_load_dwordx4 a[128:131], v248, s[36:39], s67 offen offset:2048 sc1
  v_mfma_f32_16x16x32_bf16 v[188:191], a[252:255], a[208:211], v[188:191]
  ds_read_b64_tr_b16 a[244:245], v204 offset:59392
  ds_read_b64_tr_b16 a[246:247], v204 offset:59904
  v_mfma_f32_16x16x32_bf16 v[188:191], a[248:251], a[196:199], v[188:191]
  v_cvt_pk_bf16_f32 v86, v48, v49
  v_cvt_pk_bf16_f32 v87, v50, v51
  v_mfma_f32_16x16x32_bf16 v[192:195], a[248:251], a[200:203], v[192:195]
  buffer_store_dwordx4 v[84:87], v3, s[36:39], s71 offen sc1
  v_mfma_f32_16x16x32_bf16 v[192:195], a[252:255], a[212:215], v[192:195]
  s_waitcnt lgkmcnt(4)
  v_mfma_f32_16x16x32_bf16 v[100:103], v[196:199], a[216:219], v[100:103]
  ds_read_b64_tr_b16 a[248:249], v205 offset:49152
  ds_read_b64_tr_b16 a[250:251], v205 offset:49664
  v_mfma_f32_16x16x32_bf16 v[100:103], v[200:203], a[228:231], v[100:103]
  buffer_load_dwordx4 a[132:135], v248, s[36:39], s67 offen offset:3072 sc1
  v_mfma_f32_16x16x32_bf16 v[104:107], v[200:203], a[232:235], v[104:107]
  s_add_u32 s67, s67, 4096
  ds_read_b64_tr_b16 a[252:253], v205 offset:57344
  ds_read_b64_tr_b16 a[254:255], v205 offset:57856
  v_mfma_f32_16x16x32_bf16 v[104:107], v[196:199], a[220:223], v[104:107]
  v_mfma_f32_16x16x32_bf16 v[108:111], v[196:199], a[224:227], v[108:111]
  buffer_load_dwordx4 a[136:139], v248, s[36:39], s67 offen offset:0 sc1
  v_mfma_f32_16x16x32_bf16 v[108:111], v[200:203], a[236:239], v[108:111]
  s_waitcnt lgkmcnt(4)
  v_mfma_f32_16x16x32_bf16 v[148:151], a[240:243], a[216:219], v[148:151]
  ds_read_b64_tr_b16 v[196:197], v205 offset:51200
  ds_read_b64_tr_b16 v[198:199], v205 offset:51712
  v_mfma_f32_16x16x32_bf16 v[148:151], a[244:247], a[228:231], v[148:151]
  s_bfe_u32 s67, s23, 0x40000
  s_mul_i32 s67, s67, 5120
  s_add_u32 s67, s67, s65
  v_mfma_f32_16x16x32_bf16 v[152:155], a[244:247], a[232:235], v[152:155]
  ds_read_b64_tr_b16 v[200:201], v205 offset:59392
  ds_read_b64_tr_b16 v[202:203], v205 offset:59904
  v_mfma_f32_16x16x32_bf16 v[152:155], a[240:243], a[220:223], v[152:155]
  buffer_load_dwordx4 a[140:143], v248, s[36:39], s67 offen offset:0 sc1
  v_mfma_f32_16x16x32_bf16 v[156:159], a[240:243], a[224:227], v[156:159]
  v_mfma_f32_16x16x32_bf16 v[156:159], a[244:247], a[236:239], v[156:159]
  s_waitcnt lgkmcnt(4)
  v_mfma_f32_16x16x32_bf16 v[112:115], a[248:251], a[216:219], v[112:115]
  ds_read_b64_tr_b16 a[240:241], v206 offset:49152
  ds_read_b64_tr_b16 a[242:243], v206 offset:49664
  v_mfma_f32_16x16x32_bf16 v[112:115], a[252:255], a[228:231], v[112:115]
  v_mfma_f32_16x16x32_bf16 v[116:119], a[252:255], a[232:235], v[116:119]
  ds_read_b64_tr_b16 a[244:245], v206 offset:57344
  ds_read_b64_tr_b16 a[246:247], v206 offset:57856
  v_mfma_f32_16x16x32_bf16 v[116:119], a[248:251], a[220:223], v[116:119]
  buffer_load_dwordx4 a[144:147], v248, s[36:39], s67 offen offset:1024 sc1
  v_mfma_f32_16x16x32_bf16 v[120:123], a[248:251], a[224:227], v[120:123]
  v_fmac_f32_dpp v104, v100, v216 row_newbcast:0 row_mask:0xf bank_mask:0xf
  v_fmac_f32_dpp v105, v101, v216 row_newbcast:0 row_mask:0xf bank_mask:0xf
  v_mfma_f32_16x16x32_bf16 v[120:123], a[252:255], a[236:239], v[120:123]
  s_waitcnt lgkmcnt(4)
  v_fmac_f32_dpp v106, v102, v216 row_newbcast:0 row_mask:0xf bank_mask:0xf
  v_fmac_f32_dpp v107, v103, v216 row_newbcast:0 row_mask:0xf bank_mask:0xf
FC2:
  v_mfma_f32_16x16x32_bf16 v[160:163], v[196:199], a[216:219], v[160:163]
  ds_read_b64_tr_b16 a[248:249], v206 offset:51200
  ds_read_b64_tr_b16 a[250:251], v206 offset:51712
  v_mfma_f32_16x16x32_bf16 v[160:163], v[200:203], a[228:231], v[160:163]
  buffer_load_dwordx4 a[148:151], v248, s[36:39], s67 offen offset:2048 sc1
  v_mfma_f32_16x16x32_bf16 v[164:167], v[200:203], a[232:235], v[164:167]
  ds_read_b64_tr_b16 a[252:253], v206 offset:59392
  ds_read_b64_tr_b16 a[254:255], v206 offset:59904
  v_mfma_f32_16x16x32_bf16 v[164:167], v[196:199], a[220:223], v[164:167]
  v_fmac_f32_dpp v152, v148, v216 row_newbcast:0 row_mask:0xf bank_mask:0xf
  v_fmac_f32_dpp v153, v149, v216 row_newbcast:0 row_mask:0xf bank_mask:0xf
  v_mfma_f32_16x16x32_bf16 v[168:171], v[196:199], a[224:227], v[168:171]
  v_fmac_f32_dpp v154, v150, v216 row_newbcast:0 row_mask:0xf bank_mask:0xf
  v_fmac_f32_dpp v155, v151, v216 row_newbcast:0 row_mask:0xf bank_mask:0xf
  v_mfma_f32_16x16x32_bf16 v[168:171], v[200:203], a[236:239], v[168:171]
  s_waitcnt lgkmcnt(4)
  buffer_load_dwordx4 a[152:155], v248, s[36:39], s67 offen offset:3072 sc1
  v_mfma_f32_16x16x32_bf16 v[124:127], a[240:243], a[216:219], v[124:127]
  ds_read_b64_tr_b16 v[196:197], v207 offset:49152
  ds_read_b64_tr_b16 v[198:199], v207 offset:49664
  v_mfma_f32_16x16x32_bf16 v[124:127], a[244:247], a[228:231], v[124:127]
  v_fmac_f32_dpp v108, v100, v220 row_newbcast:0 row_mask:0xf bank_mask:0xf
  v_fmac_f32_dpp v109, v101, v220 row_newbcast:0 row_mask:0xf bank_mask:0xf
  v_mfma_f32_16x16x32_bf16 v[128:131], a[244:247], a[232:235], v[128:131]
  s_add_u32 s67, s67, 4096
  ds_read_b64_tr_b16 v[200:201], v207 offset:57344
  ds_read_b64_tr_b16 v[202:203], v207 offset:57856
  v_mfma_f32_16x16x32_bf16 v[128:131], a[240:243], a[220:223], v[128:131]
  v_fmac_f32_dpp v110, v102, v220 row_newbcast:0 row_mask:0xf bank_mask:0xf
  v_fmac_f32_dpp v111, v103, v220 row_newbcast:0 row_mask:0xf bank_mask:0xf
  v_mfma_f32_16x16x32_bf16 v[132:135], a[240:243], a[224:227], v[132:135]
  buffer_load_dwordx4 a[156:159], v248, s[36:39], s67 offen offset:0 sc1
  v_mfma_f32_16x16x32_bf16 v[132:135], a[244:247], a[236:239], v[132:135]
  s_waitcnt lgkmcnt(4)
  v_fmac_f32_dpp v156, v148, v220 row_newbcast:0 row_mask:0xf bank_mask:0xf
  v_fmac_f32_dpp v157, v149, v220 row_newbcast:0 row_mask:0xf bank_mask:0xf
  v_mfma_f32_16x16x32_bf16 v[172:175], a[248:251], a[216:219], v[172:175]
  s_bfe_u32 s67, s23, 0x40004
  ds_read_b64_tr_b16 a[240:241], v207 offset:51200
  ds_read_b64_tr_b16 a[242:243], v207 offset:51712
  v_mfma_f32_16x16x32_bf16 v[172:175], a[252:255], a[228:231], v[172:175]
  s_mul_i32 s67, s67, 5120
  v_fmac_f32_dpp v158, v150, v220 row_newbcast:0 row_mask:0xf bank_mask:0xf
  v_fmac_f32_dpp v159, v151, v220 row_newbcast:0 row_mask:0xf bank_mask:0xf
  v_mfma_f32_16x16x32_bf16 v[176:179], a[252:255], a[232:235], v[176:179]
  s_add_u32 s67, s67, s65
  ds_read_b64_tr_b16 a[244:245], v207 offset:59392
  ds_read_b64_tr_b16 a[246:247], v207 offset:59904
  v_mfma_f32_16x16x32_bf16 v[176:179], a[248:251], a[220:223], v[176:179]
  buffer_load_dwordx4 a[160:163], v248, s[36:39], s67 offen offset:0 sc1
  v_mfma_f32_16x16x32_bf16 v[180:183], a[248:251], a[224:227], v[180:183]
  s_waitcnt vmcnt(13)
  v_cmp_ne_u32 vcc, v254, v249
  v_fmac_f32_dpp v100, v100, v212 row_newbcast:0 row_mask:0xf bank_mask:0xf
  v_mfma_f32_16x16x32_bf16 v[180:183], a[252:255], a[236:239], v[180:183]
  s_waitcnt lgkmcnt(4)
  v_fmac_f32_dpp v101, v101, v212 row_newbcast:0 row_mask:0xf bank_mask:0xf
  v_fmac_f32_dpp v102, v102, v212 row_newbcast:0 row_mask:0xf bank_mask:0xf
  v_mfma_f32_16x16x32_bf16 v[136:139], v[196:199], a[216:219], v[136:139]
  s_cmp_lg_u32 vcc_hi, 0
  s_cbranch_scc1 SF0
BF0:
  v_fmac_f32_dpp v103, v103, v212 row_newbcast:0 row_mask:0xf bank_mask:0xf
  v_fmac_f32_dpp v148, v148, v212 row_newbcast:0 row_mask:0xf bank_mask:0xf
  v_mfma_f32_16x16x32_bf16 v[136:139], v[200:203], a[228:231], v[136:139]
  buffer_load_dwordx4 a[164:167], v248, s[36:39], s67 offen offset:1024 sc1
  v_mfma_f32_16x16x32_bf16 v[140:143], v[200:203], a[232:235], v[140:143]
  v_fmac_f32_dpp v149, v149, v212 row_newbcast:0 row_mask:0xf bank_mask:0xf
  v_fmac_f32_dpp v150, v150, v212 row_newbcast:0 row_mask:0xf bank_mask:0xf
  v_mfma_f32_16x16x32_bf16 v[140:143], v[196:199], a[220:223], v[140:143]
  v_fmac_f32_dpp v151, v151, v212 row_newbcast:0 row_mask:0xf bank_mask:0xf
  v_fmac_f32_dpp v116, v112, v216 row_newbcast:0 row_mask:0xf bank_mask:0xf
  v_mfma_f32_16x16x32_bf16 v[144:147], v[196:199], a[224:227], v[144:147]
  v_fmac_f32_dpp v117, v113, v216 row_newbcast:0 row_mask:0xf bank_mask:0xf
  v_fmac_f32_dpp v118, v114, v216 row_newbcast:0 row_mask:0xf bank_mask:0xf
  v_mfma_f32_16x16x32_bf16 v[144:147], v[200:203], a[236:239], v[144:147]
  s_waitcnt lgkmcnt(0)
  v_fmac_f32_dpp v119, v115, v216 row_newbcast:0 row_mask:0xf bank_mask:0xf
  v_fmac_f32_dpp v164, v160, v216 row_newbcast:0 row_mask:0xf bank_mask:0xf
  v_mfma_f32_16x16x32_bf16 v[184:187], a[240:243], a[216:219], v[184:187]
  buffer_load_dwordx4 a[168:171], v248, s[36:39], s67 offen offset:2048 sc1
  v_mfma_f32_16x16x32_bf16 v[184:187], a[244:247], a[228:231], v[184:187]
  v_fmac_f32_dpp v165, v161, v216 row_newbcast:0 row_mask:0xf bank_mask:0xf
  v_fmac_f32_dpp v166, v162, v216 row_newbcast:0 row_mask:0xf bank_mask:0xf
  v_mfma_f32_16x16x32_bf16 v[188:191], a[244:247], a[232:235], v[188:191]
  v_fmac_f32_dpp v167, v163, v216 row_newbcast:0 row_mask:0xf bank_mask:0xf
  v_fmac_f32_dpp v120, v112, v220 row_newbcast:0 row_mask:0xf bank_mask:0xf
  v_mfma_f32_16x16x32_bf16 v[188:191], a[240:243], a[220:223], v[188:191]
  v_fmac_f32_dpp v121, v113, v220 row_newbcast:0 row_mask:0xf bank_mask:0xf
  v_fmac_f32_dpp v122, v114, v220 row_newbcast:0 row_mask:0xf bank_mask:0xf
  v_mfma_f32_16x16x32_bf16 v[192:195], a[240:243], a[224:227], v[192:195]
  v_fmac_f32_dpp v123, v115, v220 row_newbcast:0 row_mask:0xf bank_mask:0xf
  v_fmac_f32_dpp v168, v160, v220 row_newbcast:0 row_mask:0xf bank_mask:0xf
  v_mfma_f32_16x16x32_bf16 v[192:195], a[244:247], a[236:239], v[192:195]
  v_fmac_f32_dpp v169, v161, v220 row_newbcast:0 row_mask:0xf bank_mask:0xf
  v_fmac_f32_dpp v170, v162, v220 row_newbcast:0 row_mask:0xf bank_mask:0xf
  v_fmac_f32_dpp v171, v163, v220 row_newbcast:0 row_mask:0xf bank_mask:0xf
  v_fmac_f32_dpp v112, v112, v212 row_newbcast:0 row_mask:0xf bank_mask:0xf
  v_fmac_f32_dpp v113, v113, v212 row_newbcast:0 row_mask:0xf bank_mask:0xf
  v_fmac_f32_dpp v114, v114, v212 row_newbcast:0 row_mask:0xf bank_mask:0xf
  v_fmac_f32_dpp v115, v115, v212 row_newbcast:0 row_mask:0xf bank_mask:0xf
  v_fmac_f32_dpp v160, v160, v212 row_newbcast:0 row_mask:0xf bank_mask:0xf
  v_fmac_f32_dpp v161, v161, v212 row_newbcast:0 row_mask:0xf bank_mask:0xf
  v_fmac_f32_dpp v162, v162, v212 row_newbcast:0 row_mask:0xf bank_mask:0xf
  v_fmac_f32_dpp v163, v163, v212 row_newbcast:0 row_mask:0xf bank_mask:0xf
  v_pk_mul_f32 v[232:233], v[100:101], v[100:101]
  v_pk_mul_f32 v[234:235], v[102:103], v[102:103]
  v_pk_fma_f32 v[232:233], v[232:233], v[214:215], v[212:213] op_sel:[0,0,1] op_sel_hi:[1,0,1]
  v_pk_fma_f32 v[234:235], v[234:235], v[214:215], v[212:213] op_sel:[0,0,1] op_sel_hi:[1,0,1]
  v_pk_mul_f32 v[232:233], v[232:233], v[100:101]
  s_add_u32 s12, s4, s57
  v_pk_mul_f32 v[234:235], v[234:235], v[102:103]
  buffer_load_dwordx4 v[84:87], v248, s[36:39], s12 offen sc1
  s_waitcnt vmcnt(11)
  buffer_store_dword v249, v250, s[36:39], 0 offen sc1
  v_exp_f32 v232, v232
  v_exp_f32 v233, v233
  v_exp_f32 v234, v234
  v_exp_f32 v235, v235
  v_pk_mul_f32 v[100:101], v[100:101], v[148:149]
  v_pk_mul_f32 v[102:103], v[102:103], v[150:151]
  v_pk_fma_f32 v[232:233], v[232:233], v[214:215], v[214:215] op_sel:[0,1,1] op_sel_hi:[1,1,1]
  v_pk_fma_f32 v[234:235], v[234:235], v[214:215], v[214:215] op_sel:[0,1,1] op_sel_hi:[1,1,1]
  s_add_u32 s12, s5, s57
  v_rcp_f32 v232, v232
  buffer_load_dwordx4 v[88:91], v248, s[36:39], s12 offen sc1
  v_rcp_f32 v234, v234
  v_rcp_f32 v233, v233
  v_rcp_f32 v235, v235
  v_pk_mul_f32 v[100:101], v[100:101], v[232:233]
  v_pk_mul_f32 v[102:103], v[102:103], v[234:235]
  v_cvt_pk_bf16_f32 v148, v100, v101
  v_cvt_pk_bf16_f32 v149, v102, v103
  v_pk_mul_f32 v[236:237], v[112:113], v[112:113]
  v_pk_mul_f32 v[238:239], v[114:115], v[114:115]
  v_pk_fma_f32 v[236:237], v[236:237], v[214:215], v[212:213] op_sel:[0,0,1] op_sel_hi:[1,0,1]
  v_pk_fma_f32 v[238:239], v[238:239], v[214:215], v[212:213] op_sel:[0,0,1] op_sel_hi:[1,0,1]
  v_pk_mul_f32 v[236:237], v[236:237], v[112:113]
  v_pk_mul_f32 v[238:239], v[238:239], v[114:115]
  s_add_u32 s12, s6, s57
  v_exp_f32 v236, v236
  buffer_load_dwordx4 v[92:95], v248, s[36:39], s12 offen sc1
  v_exp_f32 v237, v237
  v_exp_f32 v238, v238
  v_exp_f32 v239, v239
  v_pk_mul_f32 v[112:113], v[112:113], v[160:161]
  v_pk_mul_f32 v[114:115], v[114:115], v[162:163]
  v_pk_fma_f32 v[236:237], v[236:237], v[214:215], v[214:215] op_sel:[0,1,1] op_sel_hi:[1,1,1]
  v_pk_fma_f32 v[238:239], v[238:239], v[214:215], v[214:215] op_sel:[0,1,1] op_sel_hi:[1,1,1]
  v_rcp_f32 v236, v236
  v_rcp_f32 v238, v238
  v_rcp_f32 v237, v237
  s_add_u32 s12, s7, s57
  v_rcp_f32 v239, v239
  buffer_load_dwordx4 v[96:99], v248, s[36:39], s12 offen sc1
  v_pk_mul_f32 v[112:113], v[112:113], v[236:237]
  v_pk_mul_f32 v[114:115], v[114:115], v[238:239]
  v_cvt_pk_bf16_f32 v150, v112, v113
  v_cvt_pk_bf16_f32 v151, v114, v115
  buffer_store_dwordx4 v[148:151], v1, s[36:39], s72 offen sc1
  v_pk_mul_f32 v[240:241], v[104:105], v[104:105]
  v_pk_mul_f32 v[242:243], v[106:107], v[106:107]
  v_pk_fma_f32 v[240:241], v[240:241], v[218:219], v[216:217] op_sel:[0,0,1] op_sel_hi:[1,0,1]
  v_pk_fma_f32 v[242:243], v[242:243], v[218:219], v[216:217] op_sel:[0,0,1] op_sel_hi:[1,0,1]
  v_pk_mul_f32 v[240:241], v[240:241], v[104:105]
  v_pk_mul_f32 v[242:243], v[242:243], v[106:107]
  v_exp_f32 v240, v240
  s_add_u32 s12, s4, s59
  v_exp_f32 v241, v241
  buffer_load_dwordx4 v[4:7], v248, s[36:39], s12 offen sc1
  v_exp_f32 v242, v242
  v_exp_f32 v243, v243
  v_pk_mul_f32 v[104:105], v[104:105], v[152:153]
  v_pk_mul_f32 v[106:107], v[106:107], v[154:155]
  v_pk_fma_f32 v[240:241], v[240:241], v[218:219], v[218:219] op_sel:[0,1,1] op_sel_hi:[1,1,1]
  v_pk_fma_f32 v[242:243], v[242:243], v[218:219], v[218:219] op_sel:[0,1,1] op_sel_hi:[1,1,1]
  v_rcp_f32 v240, v240
  v_rcp_f32 v242, v242
  v_rcp_f32 v241, v241
  v_rcp_f32 v243, v243
  v_pk_mul_f32 v[104:105], v[104:105], v[240:241]
  s_add_u32 s12, s5, s59
  v_pk_mul_f32 v[106:107], v[106:107], v[242:243]
  buffer_load_dwordx4 v[8:11], v248, s[36:39], s12 offen sc1
  v_cvt_pk_bf16_f32 v152, v104, v105
  v_cvt_pk_bf16_f32 v153, v106, v107
  v_pk_mul_f32 v[244:245], v[116:117], v[116:117]
  v_pk_mul_f32 v[246:247], v[118:119], v[118:119]
  v_pk_fma_f32 v[244:245], v[244:245], v[218:219], v[216:217] op_sel:[0,0,1] op_sel_hi:[1,0,1]
  v_pk_fma_f32 v[246:247], v[246:247], v[218:219], v[216:217] op_sel:[0,0,1] op_sel_hi:[1,0,1]
  v_pk_mul_f32 v[244:245], v[244:245], v[116:117]
  v_pk_mul_f32 v[246:247], v[246:247], v[118:119]
  v_exp_f32 v244, v244
  v_exp_f32 v245, v245
  v_exp_f32 v246, v246
  v_exp_f32 v247, v247
  v_pk_mul_f32 v[116:117], v[116:117], v[164:165]
  s_add_u32 s12, s6, s59
  v_pk_mul_f32 v[118:119], v[118:119], v[166:167]
  buffer_load_dwordx4 v[12:15], v248, s[36:39], s12 offen sc1
  v_pk_fma_f32 v[244:245], v[244:245], v[218:219], v[218:219] op_sel:[0,1,1] op_sel_hi:[1,1,1]
  v_pk_fma_f32 v[246:247], v[246:247], v[218:219], v[218:219] op_sel:[0,1,1] op_sel_hi:[1,1,1]
  v_rcp_f32 v244, v244
  v_rcp_f32 v246, v246
  v_rcp_f32 v245, v245
  v_rcp_f32 v247, v247
  v_pk_mul_f32 v[116:117], v[116:117], v[244:245]
  v_pk_mul_f32 v[118:119], v[118:119], v[246:247]
  v_cvt_pk_bf16_f32 v154, v116, v117
  v_cvt_pk_bf16_f32 v155, v118, v119
  s_add_u32 s12, s7, s59
  buffer_store_dwordx4 v[152:155], v2, s[36:39], s72 offen sc1
  buffer_load_dwordx4 v[16:19], v248, s[36:39], s12 offen sc1
  v_pk_mul_f32 v[232:233], v[108:109], v[108:109]
  v_pk_mul_f32 v[234:235], v[110:111], v[110:111]
  v_pk_fma_f32 v[232:233], v[232:233], v[222:223], v[220:221] op_sel:[0,0,1] op_sel_hi:[1,0,1]
  v_pk_fma_f32 v[234:235], v[234:235], v[222:223], v[220:221] op_sel:[0,0,1] op_sel_hi:[1,0,1]
  v_pk_mul_f32 v[232:233], v[232:233], v[108:109]
  v_pk_mul_f32 v[234:235], v[234:235], v[110:111]
  v_exp_f32 v232, v232
  v_exp_f32 v233, v233
  v_exp_f32 v234, v234
  v_exp_f32 v235, v235
  v_pk_mul_f32 v[108:109], v[108:109], v[156:157]
  v_pk_mul_f32 v[110:111], v[110:111], v[158:159]
  v_pk_fma_f32 v[232:233], v[232:233], v[222:223], v[222:223] op_sel:[0,1,1] op_sel_hi:[1,1,1]
  s_add_u32 s12, s4, s56
  v_pk_fma_f32 v[234:235], v[234:235], v[222:223], v[222:223] op_sel:[0,1,1] op_sel_hi:[1,1,1]
  buffer_load_dwordx4 a[240:243], v248, s[36:39], s12 offen sc1
FHOP5:
  s_cbranch_execz FHRET
  v_rcp_f32 v232, v232
  v_rcp_f32 v234, v234
  v_rcp_f32 v233, v233
  v_rcp_f32 v235, v235
  v_pk_mul_f32 v[108:109], v[108:109], v[232:233]
  v_pk_mul_f32 v[110:111], v[110:111], v[234:235]
  v_cvt_pk_bf16_f32 v156, v108, v109
  v_cvt_pk_bf16_f32 v157, v110, v111
  v_pk_mul_f32 v[236:237], v[120:121], v[120:121]
  v_pk_mul_f32 v[238:239], v[122:123], v[122:123]
  v_pk_fma_f32 v[236:237], v[236:237], v[222:223], v[220:221] op_sel:[0,0,1] op_sel_hi:[1,0,1]
  v_pk_fma_f32 v[238:239], v[238:239], v[222:223], v[220:221] op_sel:[0,0,1] op_sel_hi:[1,0,1]
  v_pk_mul_f32 v[236:237], v[236:237], v[120:121]
  s_add_u32 s12, s5, s56
  v_pk_mul_f32 v[238:239], v[238:239], v[122:123]
  buffer_load_dwordx4 a[244:247], v248, s[36:39], s12 offen sc1
  v_exp_f32 v236, v236
  v_exp_f32 v237, v237
  v_exp_f32 v238, v238
  v_exp_f32 v239, v239
  v_pk_mul_f32 v[120:121], v[120:121], v[168:169]
  v_pk_mul_f32 v[122:123], v[122:123], v[170:171]
  v_pk_fma_f32 v[236:237], v[236:237], v[222:223], v[222:223] op_sel:[0,1,1] op_sel_hi:[1,1,1]
  v_pk_fma_f32 v[238:239], v[238:239], v[222:223], v[222:223] op_sel:[0,1,1] op_sel_hi:[1,1,1]
  v_rcp_f32 v236, v236
  v_rcp_f32 v238, v238
  s_add_u32 s12, s6, s56
  v_rcp_f32 v237, v237
  buffer_load_dwordx4 a[248:251], v248, s[36:39], s12 offen sc1
  v_rcp_f32 v239, v239
  v_pk_mul_f32 v[120:121], v[120:121], v[236:237]
  v_pk_mul_f32 v[122:123], v[122:123], v[238:239]
  v_cvt_pk_bf16_f32 v158, v120, v121
  v_cvt_pk_bf16_f32 v159, v122, v123
  buffer_store_dwordx4 v[156:159], v3, s[36:39], s72 offen sc1
  v_fmac_f32_dpp v128, v124, v216 row_newbcast:0 row_mask:0xf bank_mask:0xf
  v_fmac_f32_dpp v129, v125, v216 row_newbcast:0 row_mask:0xf bank_mask:0xf
  v_fmac_f32_dpp v130, v126, v216 row_newbcast:0 row_mask:0xf bank_mask:0xf
  v_fmac_f32_dpp v131, v127, v216 row_newbcast:0 row_mask:0xf bank_mask:0xf
  v_fmac_f32_dpp v176, v172, v216 row_newbcast:0 row_mask:0xf bank_mask:0xf
  v_fmac_f32_dpp v177, v173, v216 row_newbcast:0 row_mask:0xf bank_mask:0xf
  s_add_u32 s12, s7, s56
  v_fmac_f32_dpp v178, v174, v216 row_newbcast:0 row_mask:0xf bank_mask:0xf
  buffer_load_dwordx4 a[252:255], v248, s[36:39], s12 offen sc1
  v_fmac_f32_dpp v179, v175, v216 row_newbcast:0 row_mask:0xf bank_mask:0xf
  v_fmac_f32_dpp v132, v124, v220 row_newbcast:0 row_mask:0xf bank_mask:0xf
  v_fmac_f32_dpp v133, v125, v220 row_newbcast:0 row_mask:0xf bank_mask:0xf
  v_fmac_f32_dpp v134, v126, v220 row_newbcast:0 row_mask:0xf bank_mask:0xf
  v_fmac_f32_dpp v135, v127, v220 row_newbcast:0 row_mask:0xf bank_mask:0xf
  v_fmac_f32_dpp v180, v172, v220 row_newbcast:0 row_mask:0xf bank_mask:0xf
  v_fmac_f32_dpp v181, v173, v220 row_newbcast:0 row_mask:0xf bank_mask:0xf
  v_fmac_f32_dpp v182, v174, v220 row_newbcast:0 row_mask:0xf bank_mask:0xf
  v_fmac_f32_dpp v183, v175, v220 row_newbcast:0 row_mask:0xf bank_mask:0xf
  v_fmac_f32_dpp v124, v124, v212 row_newbcast:0 row_mask:0xf bank_mask:0xf
  v_fmac_f32_dpp v125, v125, v212 row_newbcast:0 row_mask:0xf bank_mask:0xf
  v_fmac_f32_dpp v126, v126, v212 row_newbcast:0 row_mask:0xf bank_mask:0xf
  v_fmac_f32_dpp v127, v127, v212 row_newbcast:0 row_mask:0xf bank_mask:0xf
  v_fmac_f32_dpp v172, v172, v212 row_newbcast:0 row_mask:0xf bank_mask:0xf
  v_fmac_f32_dpp v173, v173, v212 row_newbcast:0 row_mask:0xf bank_mask:0xf
  v_fmac_f32_dpp v174, v174, v212 row_newbcast:0 row_mask:0xf bank_mask:0xf
  v_fmac_f32_dpp v175, v175, v212 row_newbcast:0 row_mask:0xf bank_mask:0xf
  v_fmac_f32_dpp v140, v136, v216 row_newbcast:0 row_mask:0xf bank_mask:0xf
  buffer_load_dwordx4 a[172:175], v248, s[36:39], s67 offen offset:3072 sc1
  v_fmac_f32_dpp v141, v137, v216 row_newbcast:0 row_mask:0xf bank_mask:0xf
  v_fmac_f32_dpp v142, v138, v216 row_newbcast:0 row_mask:0xf bank_mask:0xf
  v_fmac_f32_dpp v143, v139, v216 row_newbcast:0 row_mask:0xf bank_mask:0xf
  v_fmac_f32_dpp v188, v184, v216 row_newbcast:0 row_mask:0xf bank_mask:0xf
  v_fmac_f32_dpp v189, v185, v216 row_newbcast:0 row_mask:0xf bank_mask:0xf
  v_fmac_f32_dpp v190, v186, v216 row_newbcast:0 row_mask:0xf bank_mask:0xf
  v_fmac_f32_dpp v191, v187, v216 row_newbcast:0 row_mask:0xf bank_mask:0xf
  v_fmac_f32_dpp v144, v136, v220 row_newbcast:0 row_mask:0xf bank_mask:0xf
  v_fmac_f32_dpp v145, v137, v220 row_newbcast:0 row_mask:0xf bank_mask:0xf
  v_fmac_f32_dpp v146, v138, v220 row_newbcast:0 row_mask:0xf bank_mask:0xf
  v_fmac_f32_dpp v147, v139, v220 row_newbcast:0 row_mask:0xf bank_mask:0xf
  v_fmac_f32_dpp v192, v184, v220 row_newbcast:0 row_mask:0xf bank_mask:0xf
  v_fmac_f32_dpp v193, v185, v220 row_newbcast:0 row_mask:0xf bank_mask:0xf
  v_fmac_f32_dpp v194, v186, v220 row_newbcast:0 row_mask:0xf bank_mask:0xf
  v_fmac_f32_dpp v195, v187, v220 row_newbcast:0 row_mask:0xf bank_mask:0xf
  v_fmac_f32_dpp v136, v136, v212 row_newbcast:0 row_mask:0xf bank_mask:0xf
  v_fmac_f32_dpp v137, v137, v212 row_newbcast:0 row_mask:0xf bank_mask:0xf
  s_add_u32 s67, s67, 4096
  v_fmac_f32_dpp v138, v138, v212 row_newbcast:0 row_mask:0xf bank_mask:0xf
  buffer_load_dwordx4 a[176:179], v248, s[36:39], s67 offen offset:0 sc1
  v_fmac_f32_dpp v139, v139, v212 row_newbcast:0 row_mask:0xf bank_mask:0xf
  v_fmac_f32_dpp v184, v184, v212 row_newbcast:0 row_mask:0xf bank_mask:0xf
  v_fmac_f32_dpp v185, v185, v212 row_newbcast:0 row_mask:0xf bank_mask:0xf
  v_fmac_f32_dpp v186, v186, v212 row_newbcast:0 row_mask:0xf bank_mask:0xf
  v_fmac_f32_dpp v187, v187, v212 row_newbcast:0 row_mask:0xf bank_mask:0xf
  v_pk_mul_f32 v[240:241], v[124:125], v[124:125]
  v_pk_mul_f32 v[242:243], v[126:127], v[126:127]
  v_pk_fma_f32 v[240:241], v[240:241], v[214:215], v[212:213] op_sel:[0,0,1] op_sel_hi:[1,0,1]
  v_pk_fma_f32 v[242:243], v[242:243], v[214:215], v[212:213] op_sel:[0,0,1] op_sel_hi:[1,0,1]
  v_pk_mul_f32 v[240:241], v[240:241], v[124:125]
  v_pk_mul_f32 v[242:243], v[242:243], v[126:127]
  v_exp_f32 v240, v240
  v_exp_f32 v241, v241
  v_exp_f32 v242, v242
  s_bfe_u32 s67, s23, 0x40008
  s_mul_i32 s67, s67, 5120
  s_add_u32 s67, s67, s65
  v_exp_f32 v243, v243
  buffer_load_dwordx4 a[180:183], v248, s[36:39], s67 offen offset:0 sc1
  v_pk_mul_f32 v[124:125], v[124:125], v[172:173]
  v_pk_mul_f32 v[126:127], v[126:127], v[174:175]
  v_pk_fma_f32 v[240:241], v[240:241], v[214:215], v[214:215] op_sel:[0,1,1] op_sel_hi:[1,1,1]
  v_pk_fma_f32 v[242:243], v[242:243], v[214:215], v[214:215] op_sel:[0,1,1] op_sel_hi:[1,1,1]
  v_rcp_f32 v240, v240
  v_rcp_f32 v242, v242
  v_rcp_f32 v241, v241
  v_rcp_f32 v243, v243
  v_pk_mul_f32 v[124:125], v[124:125], v[240:241]
  v_pk_mul_f32 v[126:127], v[126:127], v[242:243]
  v_cvt_pk_bf16_f32 v172, v124, v125
  v_cvt_pk_bf16_f32 v173, v126, v127
  v_pk_mul_f32 v[244:245], v[136:137], v[136:137]
  v_pk_mul_f32 v[246:247], v[138:139], v[138:139]
  buffer_load_dwordx4 a[184:187], v248, s[36:39], s67 offen offset:1024 sc1
  v_pk_fma_f32 v[244:245], v[244:245], v[214:215], v[212:213] op_sel:[0,0,1] op_sel_hi:[1,0,1]
  v_pk_fma_f32 v[246:247], v[246:247], v[214:215], v[212:213] op_sel:[0,0,1] op_sel_hi:[1,0,1]
  v_pk_mul_f32 v[244:245], v[244:245], v[136:137]
  v_pk_mul_f32 v[246:247], v[246:247], v[138:139]
  v_exp_f32 v244, v244
  v_exp_f32 v245, v245
  v_exp_f32 v246, v246
  v_exp_f32 v247, v247
  v_pk_mul_f32 v[136:137], v[136:137], v[184:185]
  v_pk_mul_f32 v[138:139], v[138:139], v[186:187]
  v_pk_fma_f32 v[244:245], v[244:245], v[214:215], v[214:215] op_sel:[0,1,1] op_sel_hi:[1,1,1]
  v_pk_fma_f32 v[246:247], v[246:247], v[214:215], v[214:215] op_sel:[0,1,1] op_sel_hi:[1,1,1]
  v_rcp_f32 v244, v244
  buffer_load_dwordx4 a[188:191], v248, s[36:39], s67 offen offset:2048 sc1
  v_rcp_f32 v246, v246
  v_rcp_f32 v245, v245
  s_bfm_b64 exec, 32, 0
  buffer_load_dword v254, v252, s[36:39], 0 offen sc1
  s_mov_b64 exec, -1
  v_rcp_f32 v247, v247
  v_pk_mul_f32 v[136:137], v[136:137], v[244:245]
  v_pk_mul_f32 v[138:139], v[138:139], v[246:247]
  v_cvt_pk_bf16_f32 v174, v136, v137
  v_cvt_pk_bf16_f32 v175, v138, v139
  buffer_store_dwordx4 v[172:175], v1, s[36:39], s73 offen sc1
  v_pk_mul_f32 v[232:233], v[128:129], v[128:129]
  buffer_load_dwordx4 a[192:195], v248, s[36:39], s67 offen offset:3072 sc1
  v_pk_mul_f32 v[234:235], v[130:131], v[130:131]
  v_pk_fma_f32 v[232:233], v[232:233], v[218:219], v[216:217] op_sel:[0,0,1] op_sel_hi:[1,0,1]
  v_pk_fma_f32 v[234:235], v[234:235], v[218:219], v[216:217] op_sel:[0,0,1] op_sel_hi:[1,0,1]
  v_pk_mul_f32 v[232:233], v[232:233], v[128:129]
  v_pk_mul_f32 v[234:235], v[234:235], v[130:131]
  v_exp_f32 v232, v232
  v_exp_f32 v233, v233
  v_exp_f32 v234, v234
  v_exp_f32 v235, v235
  v_pk_mul_f32 v[128:129], v[128:129], v[176:177]
  v_pk_mul_f32 v[130:131], v[130:131], v[178:179]
  v_pk_fma_f32 v[232:233], v[232:233], v[218:219], v[218:219] op_sel:[0,1,1] op_sel_hi:[1,1,1]
  v_pk_fma_f32 v[234:235], v[234:235], v[218:219], v[218:219] op_sel:[0,1,1] op_sel_hi:[1,1,1]
  s_add_u32 s67, s67, 4096
  v_rcp_f32 v232, v232
  buffer_load_dwordx4 a[196:199], v248, s[36:39], s67 offen offset:0 sc1
  v_rcp_f32 v234, v234
  v_rcp_f32 v233, v233
  v_rcp_f32 v235, v235
  v_pk_mul_f32 v[128:129], v[128:129], v[232:233]
  v_pk_mul_f32 v[130:131], v[130:131], v[234:235]
  v_cvt_pk_bf16_f32 v176, v128, v129
  v_cvt_pk_bf16_f32 v177, v130, v131
  v_pk_mul_f32 v[236:237], v[140:141], v[140:141]
  v_pk_mul_f32 v[238:239], v[142:143], v[142:143]
  v_pk_fma_f32 v[236:237], v[236:237], v[218:219], v[216:217] op_sel:[0,0,1] op_sel_hi:[1,0,1]
  v_pk_fma_f32 v[238:239], v[238:239], v[218:219], v[216:217] op_sel:[0,0,1] op_sel_hi:[1,0,1]
  v_pk_mul_f32 v[236:237], v[236:237], v[140:141]
  v_pk_mul_f32 v[238:239], v[238:239], v[142:143]
  s_bfe_u32 s67, s23, 0x4000c
  s_mul_i32 s67, s67, 5120
  s_add_u32 s67, s67, s65
  v_exp_f32 v236, v236
  buffer_load_dwordx4 a[200:203], v248, s[36:39], s67 offen offset:0 sc1
  v_exp_f32 v237, v237
  v_exp_f32 v238, v238
  v_exp_f32 v239, v239
  v_pk_mul_f32 v[140:141], v[140:141], v[188:189]
  v_pk_mul_f32 v[142:143], v[142:143], v[190:191]
  v_pk_fma_f32 v[236:237], v[236:237], v[218:219], v[218:219] op_sel:[0,1,1] op_sel_hi:[1,1,1]
  v_pk_fma_f32 v[238:239], v[238:239], v[218:219], v[218:219] op_sel:[0,1,1] op_sel_hi:[1,1,1]
  v_rcp_f32 v236, v236
  v_rcp_f32 v238, v238
  v_rcp_f32 v237, v237
  v_rcp_f32 v239, v239
  buffer_load_dwordx4 a[204:207], v248, s[36:39], s67 offen offset:1024 sc1
  v_pk_mul_f32 v[140:141], v[140:141], v[236:237]
  v_pk_mul_f32 v[142:143], v[142:143], v[238:239]
  v_cvt_pk_bf16_f32 v178, v140, v141
  v_cvt_pk_bf16_f32 v179, v142, v143
  buffer_store_dwordx4 v[176:179], v2, s[36:39], s73 offen sc1
  v_pk_mul_f32 v[240:241], v[132:133], v[132:133]
  v_pk_mul_f32 v[242:243], v[134:135], v[134:135]
  v_pk_fma_f32 v[240:241], v[240:241], v[222:223], v[220:221] op_sel:[0,0,1] op_sel_hi:[1,0,1]
  v_pk_fma_f32 v[242:243], v[242:243], v[222:223], v[220:221] op_sel:[0,0,1] op_sel_hi:[1,0,1]
  v_pk_mul_f32 v[240:241], v[240:241], v[132:133]
  v_pk_mul_f32 v[242:243], v[242:243], v[134:135]
  v_exp_f32 v240, v240
  v_exp_f32 v241, v241
  buffer_load_dwordx4 a[208:211], v248, s[36:39], s67 offen offset:2048 sc1
  v_exp_f32 v242, v242
  v_exp_f32 v243, v243
  v_pk_mul_f32 v[132:133], v[132:133], v[180:181]
  v_pk_mul_f32 v[134:135], v[134:135], v[182:183]
  v_pk_fma_f32 v[240:241], v[240:241], v[222:223], v[222:223] op_sel:[0,1,1] op_sel_hi:[1,1,1]
  v_pk_fma_f32 v[242:243], v[242:243], v[222:223], v[222:223] op_sel:[0,1,1] op_sel_hi:[1,1,1]
  v_rcp_f32 v240, v240
  v_rcp_f32 v242, v242
  v_rcp_f32 v241, v241
  v_rcp_f32 v243, v243
  v_pk_mul_f32 v[132:133], v[132:133], v[240:241]
  v_pk_mul_f32 v[134:135], v[134:135], v[242:243]
  buffer_load_dwordx4 a[212:215], v248, s[36:39], s67 offen offset:3072 sc1
  v_cvt_pk_bf16_f32 v180, v132, v133
  v_cvt_pk_bf16_f32 v181, v134, v135
  v_pk_mul_f32 v[244:245], v[144:145], v[144:145]
  v_pk_mul_f32 v[246:247], v[146:147], v[146:147]
  v_pk_fma_f32 v[244:245], v[244:245], v[222:223], v[220:221] op_sel:[0,0,1] op_sel_hi:[1,0,1]
  v_pk_fma_f32 v[246:247], v[246:247], v[222:223], v[220:221] op_sel:[0,0,1] op_sel_hi:[1,0,1]
  v_pk_mul_f32 v[244:245], v[244:245], v[144:145]
  v_pk_mul_f32 v[246:247], v[246:247], v[146:147]
  v_exp_f32 v244, v244
  v_exp_f32 v245, v245
  v_exp_f32 v246, v246
  v_exp_f32 v247, v247
  v_pk_mul_f32 v[144:145], v[144:145], v[192:193]
  s_add_u32 s67, s67, 4096
  v_pk_mul_f32 v[146:147], v[146:147], v[194:195]
  buffer_load_dwordx4 a[216:219], v248, s[36:39], s67 offen offset:0 sc1
  v_pk_fma_f32 v[244:245], v[244:245], v[222:223], v[222:223] op_sel:[0,1,1] op_sel_hi:[1,1,1]
  v_pk_fma_f32 v[246:247], v[246:247], v[222:223], v[222:223] op_sel:[0,1,1] op_sel_hi:[1,1,1]
  v_rcp_f32 v244, v244
  v_rcp_f32 v246, v246
  v_rcp_f32 v245, v245
  v_rcp_f32 v247, v247
  v_pk_mul_f32 v[144:145], v[144:145], v[244:245]
  v_pk_mul_f32 v[146:147], v[146:147], v[246:247]
  v_cvt_pk_bf16_f32 v182, v144, v145
  v_cvt_pk_bf16_f32 v183, v146, v147
  buffer_store_dwordx4 v[180:183], v3, s[36:39], s73 offen sc1
  s_bfe_u32 s67, s23, 0x40010
  s_mul_i32 s67, s67, 5120
  s_add_u32 s67, s67, s65
  buffer_load_dwordx4 a[220:223], v248, s[36:39], s67 offen offset:0 sc1
  buffer_load_dwordx4 a[224:227], v248, s[36:39], s67 offen offset:1024 sc1
  buffer_load_dwordx4 a[228:231], v248, s[36:39], s67 offen offset:2048 sc1
  buffer_load_dwordx4 a[232:235], v248, s[36:39], s67 offen offset:3072 sc1
  s_add_u32 s67, s67, 4096
  buffer_load_dwordx4 a[236:239], v248, s[36:39], s67 offen offset:0 sc1
  s_waitcnt vmcnt(21)
  s_waitcnt vmcnt(15)
  v_cmp_ne_u32 vcc, v254, v249
  s_cmp_lg_u32 vcc_lo, 0
  s_cbranch_scc1 SFe
BFe:
JOIN:
AHOP6:
  s_cbranch_execz AHRET
  s_add_u32 s12, s4, s20
  buffer_load_dwordx4 v[20:23], v248, s[36:39], s12 offen sc1
  s_add_u32 s12, s4, s21
  buffer_load_dwordx4 v[36:39], v248, s[36:39], s12 offen sc1
  v_mfma_f32_16x16x32_bf16 v[100:103], a[0:3], a[240:243], 0
  s_add_u32 s12, s5, s20
  v_add_u32 v3, s22, v248
  v_add_u32 v3, 65536, v3
  v_mfma_f32_16x16x32_bf16 v[104:107], a[4:7], a[240:243], 0
  buffer_load_dwordx4 v[24:27], v248, s[36:39], s12 offen sc1
  v_mfma_f32_16x16x32_bf16 v[108:111], a[8:11], a[240:243], 0
  s_add_u32 s12, s5, s21
  v_add_u32 v2, 4096, v3
  v_mfma_f32_16x16x32_bf16 v[112:115], a[12:15], a[240:243], 0
  buffer_load_dwordx4 v[40:43], v248, s[36:39], s12 offen sc1
  v_mfma_f32_16x16x32_bf16 v[116:119], a[16:19], a[240:243], 0
  s_add_u32 s13, s44, 1
  s_and_b32 s13, s13, 3
  s_mul_i32 s13, s13, 15360
  v_mfma_f32_16x16x32_bf16 v[136:139], a[16:19], a[244:247], 0
  s_add_u32 s12, s6, s20
  s_add_u32 s13, s13, 0
  v_add_u32 v236, s13, v248
  v_mfma_f32_16x16x32_bf16 v[132:135], a[12:15], a[244:247], 0
  s_add_u32 s13, s44, 2
  s_and_b32 s13, s13, 3
  s_mul_i32 s13, s13, 15360
  v_mfma_f32_16x16x32_bf16 v[128:131], a[8:11], a[244:247], 0
  s_add_u32 s13, s13, 5120
  buffer_load_dwordx4 v[28:31], v248, s[36:39], s12 offen sc1
  v_mfma_f32_16x16x32_bf16 v[124:127], a[4:7], a[244:247], 0
  s_add_u32 s12, s6, s21
  v_add_u32 v237, s13, v248
  s_add_u32 s13, s44, 3
  v_mfma_f32_16x16x32_bf16 v[120:123], a[0:3], a[244:247], 0
  s_and_b32 s13, s13, 3
  s_mul_i32 s13, s13, 15360
  s_add_u32 s13, s13, 10240
  v_mfma_f32_16x16x32_bf16 v[140:143], a[0:3], a[248:251], 0
  buffer_load_dwordx4 v[44:47], v248, s[36:39], s12 offen sc1
  v_mfma_f32_16x16x32_bf16 v[144:147], a[4:7], a[248:251], 0
  v_add_u32 v238, s13, v248
  s_mul_i32 s13, s44, 15360
  v_mfma_f32_16x16x32_bf16 v[148:151], a[8:11], a[248:251], 0
  s_add_u32 s12, s7, s20
  v_add_u32 v239, s13, v248
  s_and_b32 s13, s58, 15
  v_mfma_f32_16x16x32_bf16 v[152:155], a[12:15], a[248:251], 0
  s_lshl_b32 s13, s13, 2
  s_add_u32 s13, s13, s44
  s_mul_i32 s13, s13, 40960
  v_mfma_f32_16x16x32_bf16 v[156:159], a[16:19], a[248:251], 0
  s_lshr_b32 s58, s58, 4
  buffer_load_dwordx4 v[32:35], v248, s[36:39], s12 offen sc1
  v_mfma_f32_16x16x32_bf16 v[176:179], a[16:19], a[252:255], 0
  s_add_u32 s12, s7, s21
  s_mul_i32 s58, s58, 1280
  s_add_u32 s13, s13, s58
  v_mfma_f32_16x16x32_bf16 v[172:175], a[12:15], a[252:255], 0
  s_bfe_u32 s58, s2, 0x30003
  s_mul_i32 s58, s58, 160
  s_add_u32 s13, s13, s58
  v_mfma_f32_16x16x32_bf16 v[168:171], a[8:11], a[252:255], 0
  s_mul_i32 s58, s44, 3072
  buffer_load_dwordx4 v[48:51], v248, s[36:39], s12 offen sc1
  v_mfma_f32_16x16x32_bf16 v[164:167], a[4:7], a[252:255], 0
  s_waitcnt vmcnt(8)
  buffer_store_dword v249, v250, s[36:39], s63 offen sc1
  v_mfma_f32_16x16x32_bf16 v[160:163], a[0:3], a[252:255], 0
  s_barrier
  s_add_u32 s12, s4, s45
  s_add_u32 s58, s58, 147456
  v_mfma_f32_16x16x32_bf16 v[100:103], a[20:23], v[84:87], v[100:103]
  ds_read_b128 a[0:3], v2 offset:57344
  v_add_u32 v232, 0, v0
  v_mfma_f32_16x16x32_bf16 v[100:103], a[40:43], v[4:7], v[100:103]
  s_bfe_u32 s82, s62, 0x40000
  buffer_load_dwordx4 v[52:55], v248, s[36:39], s12 offen sc1
  v_mfma_f32_16x16x32_bf16 v[104:107], a[44:47], v[4:7], v[104:107]
  s_lshl_b32 s82, s82, 12
  ds_read_b128 a[4:7], v2 offset:58368
  v_mul_u32_u24 v233, 205, v232
  v_mfma_f32_16x16x32_bf16 v[104:107], a[24:27], v[84:87], v[104:107]
  s_add_u32 s12, s4, s46
  v_lshrrev_b32 v233, 11, v233
  v_mul_u32_u24 v233, 2400, v233
  v_mfma_f32_16x16x32_bf16 v[108:111], a[28:31], v[84:87], v[108:111]
  s_add_u32 s82, s82, s17
  ds_read_b128 a[8:11], v2 offset:59392
  v_lshl_add_u32 v233, v232, 4, v233
  v_mfma_f32_16x16x32_bf16 v[108:111], a[48:51], v[4:7], v[108:111]
  s_bfe_u32 s83, s62, 0x40004
  buffer_load_dwordx4 v[68:71], v248, s[36:39], s12 offen sc1
  v_mfma_f32_16x16x32_bf16 v[112:115], a[52:55], v[4:7], v[112:115]
  s_add_u32 s12, s5, s45
  ds_read_b128 a[12:15], v2 offset:60416
  v_add_u32 v242, s13, v233
  v_mfma_f32_16x16x32_bf16 v[112:115], a[32:35], v[84:87], v[112:115]
  s_lshl_b32 s83, s83, 12
  v_add_u32 v232, 64, v0
  v_mul_u32_u24 v233, 205, v232
  v_mfma_f32_16x16x32_bf16 v[116:119], a[36:39], v[84:87], v[116:119]
  s_add_u32 s83, s83, s17
  ds_read_b128 a[16:19], v2 offset:61440
  v_lshrrev_b32 v233, 11, v233
  v_mfma_f32_16x16x32_bf16 v[116:119], a[56:59], v[4:7], v[116:119]
  s_bfe_u32 s84, s62, 0x40008
  buffer_load_dwordx4 v[56:59], v248, s[36:39], s12 offen sc1
  v_mfma_f32_16x16x32_bf16 v[136:139], a[36:39], v[88:91], v[136:139]
  s_add_u32 s12, s5, s46
  v_mul_u32_u24 v233, 2400, v233
  v_lshl_add_u32 v233, v232, 4, v233
  v_mfma_f32_16x16x32_bf16 v[136:139], a[56:59], v[8:11], v[136:139]
  s_lshl_b32 s84, s84, 12
  v_add_u32 v243, s13, v233
  v_add_u32 v232, 128, v0
  v_mfma_f32_16x16x32_bf16 v[132:135], a[52:55], v[8:11], v[132:135]
  s_add_u32 s84, s84, s17
  buffer_load_dwordx4 v[72:75], v248, s[36:39], s12 offen sc1
  v_mfma_f32_16x16x32_bf16 v[132:135], a[32:35], v[88:91], v[132:135]
  s_add_u32 s12, s6, s45
  v_mul_u32_u24 v233, 205, v232
  v_lshrrev_b32 v233, 11, v233
  v_mfma_f32_16x16x32_bf16 v[128:131], a[28:31], v[88:91], v[128:131]
  s_bfe_u32 s85, s62, 0x4000c
  v_mul_u32_u24 v233, 2400, v233
  v_lshl_add_u32 v233, v232, 4, v233
  v_mfma_f32_16x16x32_bf16 v[128:131], a[48:51], v[8:11], v[128:131]
  s_lshl_b32 s85, s85, 12
  buffer_load_dwordx4 v[60:63], v248, s[36:39], s12 offen sc1
  v_mfma_f32_16x16x32_bf16 v[124:127], a[44:47], v[8:11], v[124:127]
  s_add_u32 s85, s85, s17
  v_add_u32 v244, s13, v233
  v_and_b32 v232, 32, v0
  v_mfma_f32_16x16x32_bf16 v[124:127], a[24:27], v[88:91], v[124:127]
  s_add_u32 s12, s6, s46
  s_bfe_u32 s86, s62, 0x40010
  s_lshl_b32 s86, s86, 12
  v_mfma_f32_16x16x32_bf16 v[120:123], a[20:23], v[88:91], v[120:123]
  s_add_u32 s86, s86, s17
  v_lshl_add_u32 v244, v232, 25, v244
  v_mfma_f32_16x16x32_bf16 v[120:123], a[40:43], v[8:11], v[120:123]
  buffer_load_dwordx4 v[76:79], v248, s[36:39], s12 offen sc1
  v_mfma_f32_16x16x32_bf16 v[140:143], a[20:23], v[92:95], v[140:143]
  s_add_u32 s12, s7, s45
  v_and_b32 v232, 15, v0
  v_mfma_f32_16x16x32_bf16 v[140:143], a[40:43], v[12:15], v[140:143]
  v_mul_u32_u24 v232, 160, v232
  v_mfma_f32_16x16x32_bf16 v[144:147], a[44:47], v[12:15], v[144:147]
  buffer_load_dwordx4 v[64:67], v248, s[36:39], s12 offen sc1
  v_mfma_f32_16x16x32_bf16 v[144:147], a[24:27], v[92:95], v[144:147]
  v_lshrrev_b32 v233, 4, v0
  v_mfma_f32_16x16x32_bf16 v[148:151], a[28:31], v[92:95], v[148:151]
  s_add_u32 s12, s7, s46
  v_lshl_add_u32 v232, v233, 3, v232
  v_mfma_f32_16x16x32_bf16 v[148:151], a[48:51], v[12:15], v[148:151]
  v_add_u32 v240, s58, v232
  v_mfma_f32_16x16x32_bf16 v[152:155], a[52:55], v[12:15], v[152:155]
  buffer_load_dwordx4 v[80:83], v248, s[36:39], s12 offen sc1
  v_mfma_f32_16x16x32_bf16 v[152:155], a[32:35], v[92:95], v[152:155]
  v_add_u32 v241, s58, v248
  v_mfma_f32_16x16x32_bf16 v[156:159], a[36:39], v[92:95], v[156:159]
  v_bfe_u32 v232, v0, 2, 2
  v_mfma_f32_16x16x32_bf16 v[156:159], a[56:59], v[12:15], v[156:159]
  v_mfma_f32_16x16x32_bf16 v[176:179], a[36:39], v[96:99], v[176:179]
  s_waitcnt lgkmcnt(0)
  v_lshlrev_b32 v232, 7, v232
  s_bfe_u32 s49, s62, 0x40010
  v_mfma_f32_16x16x32_bf16 v[176:179], a[56:59], v[16:19], v[176:179]
  s_mul_i32 s49, s49, 5120
  s_add_u32 s49, s49, s66
  s_add_u32 m0, s22, 126976
  v_mfma_f32_16x16x32_bf16 v[172:175], a[52:55], v[16:19], v[172:175]
  buffer_load_dwordx4 v248, s[36:39], s49 offen offset:0 sc1 lds
  v_mfma_f32_16x16x32_bf16 v[172:175], a[32:35], v[96:99], v[172:175]
  buffer_load_dwordx4 v248, s[36:39], s49 offen offset:1024 sc1 lds
  v_mfma_f32_16x16x32_bf16 v[168:171], a[28:31], v[96:99], v[168:171]
  v_lshl_add_u32 v232, v233, 5, v232
  v_and_b32 v233, 3, v0
  v_mfma_f32_16x16x32_bf16 v[168:171], a[48:51], v[16:19], v[168:171]
  v_lshl_add_u32 v245, v233, 3, v232
  v_mfma_f32_16x16x32_bf16 v[164:167], a[44:47], v[16:19], v[164:167]
  v_and_b32 v232, 15, v0
  v_mfma_f32_16x16x32_bf16 v[164:167], a[24:27], v[96:99], v[164:167]
  buffer_load_dwordx4 v248, s[36:39], s49 offen offset:2048 sc1 lds
  v_mfma_f32_16x16x32_bf16 v[160:163], a[20:23], v[96:99], v[160:163]
  v_mul_u32_u24 v232, 2560, v232
  v_mfma_f32_16x16x32_bf16 v[160:163], a[40:43], v[16:19], v[160:163]
  s_waitcnt vmcnt(18)
  ds_read_b128 a[20:23], v3 offset:40960
  v_add_u32 v232, s13, v232
  v_mfma_f32_16x16x32_bf16 v[100:103], a[60:63], v[20:23], v[100:103]
  buffer_load_dwordx4 v248, s[36:39], s49 offen offset:3072 sc1 lds
  v_mfma_f32_16x16x32_bf16 v[100:103], a[80:83], v[36:39], v[100:103]
  s_add_u32 s49, s49, 4096
  ds_read_b128 a[24:27], v3 offset:41984
  v_bfe_u32 v233, v0, 4, 1
  v_mfma_f32_16x16x32_bf16 v[104:107], a[84:87], v[36:39], v[104:107]
  s_add_u32 m0, s22, 131072
  v_lshl_add_u32 v246, v233, 5, v232
  v_mfma_f32_16x16x32_bf16 v[104:107], a[64:67], v[20:23], v[104:107]
  ds_read_b128 a[28:31], v3 offset:43008
  v_lshrrev_b32 v233, 5, v0
  v_mfma_f32_16x16x32_bf16 v[108:111], a[68:71], v[20:23], v[108:111]
  buffer_load_dwordx4 v248, s[36:39], s49 offen offset:0 sc1 lds
  v_mfma_f32_16x16x32_bf16 v[108:111], a[88:91], v[36:39], v[108:111]
  ds_read_b128 a[32:35], v3 offset:44032
  v_lshl_add_u32 v246, v233, 4, v246
  v_mfma_f32_16x16x32_bf16 v[112:115], a[92:95], v[36:39], v[112:115]
  v_lshrrev_b32 v233, 4, v0
  v_mfma_f32_16x16x32_bf16 v[112:115], a[72:75], v[20:23], v[112:115]
  ds_read_b128 a[36:39], v3 offset:45056
  v_mfma_f32_16x16x32_bf16 v[116:119], a[76:79], v[20:23], v[116:119]
  v_lshl_add_u32 v247, v233, 3, v232
  v_mfma_f32_16x16x32_bf16 v[116:119], a[96:99], v[36:39], v[116:119]
  s_waitcnt vmcnt(18)
  ds_read_b128 a[40:43], v3 offset:20480
  v_add_u32 v247, 128, v247
  v_mfma_f32_16x16x32_bf16 v[136:139], a[76:79], v[24:27], v[136:139]
  s_mov_b64 s[28:29], s[18:19]
  s_mov_b32 s30, 0x280000
  s_mov_b32 s31, 0x20000
  v_mfma_f32_16x16x32_bf16 v[136:139], a[96:99], v[40:43], v[136:139]
  s_bfm_b64 exec, 32, 32
  buffer_load_dword v254, v253, s[36:39], 0 offen sc1
  s_mov_b64 exec, -1
  v_mfma_f32_16x16x32_bf16 v[132:135], a[92:95], v[40:43], v[132:135]
  ds_read_b128 a[44:47], v3 offset:21504
  v_mfma_f32_16x16x32_bf16 v[132:135], a[72:75], v[24:27], v[132:135]
  s_waitcnt lgkmcnt(2)
  s_bfe_u32 s49, s23, 0x40014
  s_mul_i32 s49, s49, 5120
  s_add_u32 s49, s49, s65
  s_add_u32 m0, s22, 106496
  s_nop 0
  buffer_load_dwordx4 v248, s[36:39], s49 offen offset:0 sc1 lds
  v_mfma_f32_16x16x32_bf16 v[128:131], a[68:71], v[24:27], v[128:131]
  ds_read_b128 a[48:51], v3 offset:22528
  v_mfma_f32_16x16x32_bf16 v[128:131], a[88:91], v[40:43], v[128:131]
  buffer_load_dwordx4 v248, s[36:39], s49 offen offset:1024 sc1 lds
  v_mfma_f32_16x16x32_bf16 v[124:127], a[84:87], v[40:43], v[124:127]
  ds_read_b128 a[52:55], v3 offset:23552
  v_mfma_f32_16x16x32_bf16 v[124:127], a[64:67], v[24:27], v[124:127]
  ds_read_b128 a[56:59], v3 offset:24576
  v_mfma_f32_16x16x32_bf16 v[120:123], a[60:63], v[24:27], v[120:123]
  buffer_load_dwordx4 v248, s[36:39], s49 offen offset:2048 sc1 lds
  v_mfma_f32_16x16x32_bf16 v[120:123], a[80:83], v[40:43], v[120:123]
  s_waitcnt vmcnt(20)
  buffer_load_dwordx4 v248, s[36:39], s49 offen offset:3072 sc1 lds
  v_mfma_f32_16x16x32_bf16 v[140:143], a[60:63], v[28:31], v[140:143]
  s_add_u32 s49, s49, 4096
  s_add_u32 m0, s22, 110592
  s_bfe_u32 s87, s23, 0x40000
  v_mfma_f32_16x16x32_bf16 v[140:143], a[80:83], v[44:47], v[140:143]
  s_lshl_b32 s87, s87, 12
  s_add_u32 s87, s87, s16
  s_bfe_u32 s88, s23, 0x40004
  v_mfma_f32_16x16x32_bf16 v[144:147], a[84:87], v[44:47], v[144:147]
  s_lshl_b32 s88, s88, 12
  buffer_load_dwordx4 v248, s[36:39], s49 offen offset:0 sc1 lds
  v_mfma_f32_16x16x32_bf16 v[144:147], a[64:67], v[28:31], v[144:147]
  s_add_u32 s88, s88, s16
  s_bfe_u32 s89, s23, 0x40008
  s_lshl_b32 s89, s89, 12
  v_mfma_f32_16x16x32_bf16 v[148:151], a[68:71], v[28:31], v[148:151]
  s_add_u32 s89, s89, s16
  s_bfe_u32 s90, s23, 0x4000c
  s_lshl_b32 s90, s90, 12
  v_mfma_f32_16x16x32_bf16 v[148:151], a[88:91], v[44:47], v[148:151]
  s_waitcnt lgkmcnt(0)
  s_bfe_u32 s49, s23, 0x80018
  s_mul_i32 s49, s49, 5120
  v_mfma_f32_16x16x32_bf16 v[152:155], a[92:95], v[44:47], v[152:155]
  s_add_u32 s49, s49, s65
  s_add_u32 m0, s22, 86016
  s_add_u32 s90, s90, s16
  v_mfma_f32_16x16x32_bf16 v[152:155], a[72:75], v[28:31], v[152:155]
  s_bfe_u32 s91, s23, 0x40010
  buffer_load_dwordx4 v248, s[36:39], s49 offen offset:0 sc1 lds
  v_mfma_f32_16x16x32_bf16 v[156:159], a[76:79], v[28:31], v[156:159]
  s_lshl_b32 s91, s91, 12
  buffer_load_dwordx4 v248, s[36:39], s49 offen offset:1024 sc1 lds
  v_mfma_f32_16x16x32_bf16 v[156:159], a[96:99], v[44:47], v[156:159]
  s_waitcnt vmcnt(22)
  s_add_u32 s91, s91, s16
  s_bfe_u32 s92, s23, 0x40014
  v_mfma_f32_16x16x32_bf16 v[176:179], a[76:79], v[32:35], v[176:179]
  s_lshl_b32 s92, s92, 12
  s_add_u32 s92, s92, s16
  s_bfe_u32 s93, s23, 0x80018
  v_mfma_f32_16x16x32_bf16 v[176:179], a[96:99], v[48:51], v[176:179]
  s_lshl_b32 s93, s93, 12
  buffer_load_dwordx4 v248, s[36:39], s49 offen offset:2048 sc1 lds
  v_mfma_f32_16x16x32_bf16 v[172:175], a[92:95], v[48:51], v[172:175]
  s_add_u32 s93, s93, s16
  v_mfma_f32_16x16x32_bf16 v[172:175], a[72:75], v[32:35], v[172:175]
  v_mfma_f32_16x16x32_bf16 v[168:171], a[68:71], v[32:35], v[168:171]
  buffer_load_dwordx4 v248, s[36:39], s49 offen offset:3072 sc1 lds
  v_mfma_f32_16x16x32_bf16 v[168:171], a[88:91], v[48:51], v[168:171]
  s_add_u32 s49, s49, 4096
  s_add_u32 m0, s22, 90112
  v_mfma_f32_16x16x32_bf16 v[164:167], a[84:87], v[48:51], v[164:167]
  v_mfma_f32_16x16x32_bf16 v[164:167], a[64:67], v[32:35], v[164:167]
  buffer_load_dwordx4 v248, s[36:39], s49 offen offset:0 sc1 lds
  v_mfma_f32_16x16x32_bf16 v[160:163], a[60:63], v[32:35], v[160:163]
  v_mfma_f32_16x16x32_bf16 v[160:163], a[80:83], v[48:51], v[160:163]
  s_waitcnt vmcnt(22)
  ds_read_b128 a[60:63], v3 offset:0
  v_mfma_f32_16x16x32_bf16 v[100:103], a[100:103], v[52:55], v[100:103]
  s_waitcnt vmcnt(10)
  v_cmp_ne_u32 vcc, v254, v249
  s_cmp_lg_u32 vcc_hi, 0
  s_cbranch_scc1 SPo
BPo:
  v_mfma_f32_16x16x32_bf16 v[100:103], a[120:123], v[68:71], v[100:103]
  s_add_u32 s12, s5, s82
  ds_read_b128 a[64:67], v3 offset:1024
  v_mfma_f32_16x16x32_bf16 v[104:107], a[124:127], v[68:71], v[104:107]
  buffer_load_dwordx4 v[180:183], v248, s[36:39], s12 offen sc1
  v_mfma_f32_16x16x32_bf16 v[104:107], a[104:107], v[52:55], v[104:107]
  s_add_u32 s12, s5, s83
  ds_read_b128 a[68:71], v3 offset:2048
  v_mfma_f32_16x16x32_bf16 v[108:111], a[108:111], v[52:55], v[108:111]
  buffer_load_dwordx4 v[184:187], v248, s[36:39], s12 offen sc1
  v_mfma_f32_16x16x32_bf16 v[108:111], a[128:131], v[68:71], v[108:111]
  s_add_u32 s12, s5, s84
  ds_read_b128 a[72:75], v3 offset:3072
  v_mfma_f32_16x16x32_bf16 v[112:115], a[132:135], v[68:71], v[112:115]
  v_mfma_f32_16x16x32_bf16 v[112:115], a[112:115], v[52:55], v[112:115]
  ds_read_b128 a[76:79], v3 offset:4096
  v_mfma_f32_16x16x32_bf16 v[116:119], a[116:119], v[52:55], v[116:119]
  buffer_load_dwordx4 v[188:191], v248, s[36:39], s12 offen sc1
  v_mfma_f32_16x16x32_bf16 v[116:119], a[136:139], v[68:71], v[116:119]
  s_add_u32 s12, s5, s85
  v_mfma_f32_16x16x32_bf16 v[136:139], a[116:119], v[56:59], v[136:139]
  buffer_load_dwordx4 v[192:195], v248, s[36:39], s12 offen sc1
  v_mfma_f32_16x16x32_bf16 v[136:139], a[136:139], v[72:75], v[136:139]
  s_add_u32 s12, s5, s86
  v_mfma_f32_16x16x32_bf16 v[132:135], a[132:135], v[72:75], v[132:135]
  ds_read_b128 a[80:83], v2 offset:57344
  v_mfma_f32_16x16x32_bf16 v[132:135], a[112:115], v[56:59], v[132:135]
  buffer_load_dwordx2 v[196:197], v245, s[36:39], s12 offen offset:0 sc1
  v_mfma_f32_16x16x32_bf16 v[128:131], a[108:111], v[56:59], v[128:131]
FHOP6:
  s_cbranch_execz FHRET
AHOP7:
  s_cbranch_execz AHRET
  ds_read_b128 a[84:87], v2 offset:58368
  v_mfma_f32_16x16x32_bf16 v[128:131], a[128:131], v[72:75], v[128:131]
  buffer_load_dwordx2 v[198:199], v245, s[36:39], s12 offen offset:512 sc1
  v_mfma_f32_16x16x32_bf16 v[124:127], a[124:127], v[72:75], v[124:127]
  ds_read_b128 a[88:91], v2 offset:59392
  v_mfma_f32_16x16x32_bf16 v[124:127], a[104:107], v[56:59], v[124:127]
  v_mfma_f32_16x16x32_bf16 v[120:123], a[100:103], v[56:59], v[120:123]
  ds_read_b128 a[92:95], v2 offset:60416
  v_mfma_f32_16x16x32_bf16 v[120:123], a[120:123], v[72:75], v[120:123]
  s_bfm_b64 exec, 32, 0
  buffer_load_dword v254, v253, s[36:39], 0 offen sc1
  s_mov_b64 exec, -1
  v_mfma_f32_16x16x32_bf16 v[140:143], a[100:103], v[60:63], v[140:143]
  s_add_u32 s12, s6, s82
  ds_read_b128 a[96:99], v2 offset:61440
  v_mfma_f32_16x16x32_bf16 v[140:143], a[120:123], v[76:79], v[140:143]
  buffer_load_dwordx4 v[200:203], v248, s[36:39], s12 offen sc1
  v_mfma_f32_16x16x32_bf16 v[144:147], a[124:127], v[76:79], v[144:147]
  s_add_u32 s12, s6, s83
  v_mfma_f32_16x16x32_bf16 v[144:147], a[104:107], v[60:63], v[144:147]
  buffer_load_dwordx4 v[204:207], v248, s[36:39], s12 offen sc1
  v_mfma_f32_16x16x32_bf16 v[148:151], a[108:111], v[60:63], v[148:151]
  s_add_u32 s12, s6, s84
  v_mfma_f32_16x16x32_bf16 v[148:151], a[128:131], v[76:79], v[148:151]
  v_mfma_f32_16x16x32_bf16 v[152:155], a[132:135], v[76:79], v[152:155]
  buffer_load_dwordx4 v[208:211], v248, s[36:39], s12 offen sc1
  v_mfma_f32_16x16x32_bf16 v[152:155], a[112:115], v[60:63], v[152:155]
  s_add_u32 s12, s6, s85
  v_mfma_f32_16x16x32_bf16 v[156:159], a[116:119], v[60:63], v[156:159]
  v_mfma_f32_16x16x32_bf16 v[156:159], a[136:139], v[76:79], v[156:159]
  buffer_load_dwordx4 v[212:215], v248, s[36:39], s12 offen sc1
  v_mfma_f32_16x16x32_bf16 v[176:179], a[116:119], v[64:67], v[176:179]
  s_add_u32 s12, s6, s86
  v_mfma_f32_16x16x32_bf16 v[176:179], a[136:139], v[80:83], v[176:179]
  v_mfma_f32_16x16x32_bf16 v[172:175], a[132:135], v[80:83], v[172:175]
  buffer_load_dwordx2 v[216:217], v245, s[36:39], s12 offen offset:0 sc1
  v_mfma_f32_16x16x32_bf16 v[172:175], a[112:115], v[64:67], v[172:175]
  buffer_load_dwordx2 v[218:219], v245, s[36:39], s12 offen offset:512 sc1
  v_mfma_f32_16x16x32_bf16 v[168:171], a[108:111], v[64:67], v[168:171]
  v_mfma_f32_16x16x32_bf16 v[168:171], a[128:131], v[80:83], v[168:171]
  s_add_u32 s12, s7, s82
  v_mfma_f32_16x16x32_bf16 v[164:167], a[124:127], v[80:83], v[164:167]
  v_mfma_f32_16x16x32_bf16 v[164:167], a[104:107], v[64:67], v[164:167]
  buffer_load_dwordx4 v[220:223], v248, s[36:39], s12 offen sc1
  v_mfma_f32_16x16x32_bf16 v[160:163], a[100:103], v[64:67], v[160:163]
  s_waitcnt vmcnt(19)
  s_add_u32 s12, s7, s83
  v_mfma_f32_16x16x32_bf16 v[160:163], a[120:123], v[80:83], v[160:163]
  s_waitcnt vmcnt(13)
  ds_read_b128 a[100:103], v3 offset:40960
  v_mfma_f32_16x16x32_bf16 v[24:27], a[0:3], v[180:183], 0
  buffer_load_dwordx4 v[224:227], v248, s[36:39], s12 offen sc1
  v_mfma_f32_16x16x32_bf16 v[28:31], a[4:7], v[180:183], 0
  s_add_u32 s12, s7, s84
  ds_read_b128 a[104:107], v3 offset:41984
  v_mfma_f32_16x16x32_bf16 v[32:35], a[8:11], v[180:183], 0
  v_mfma_f32_16x16x32_bf16 v[36:39], a[12:15], v[180:183], 0
  ds_read_b128 a[108:111], v3 offset:43008
  v_mfma_f32_16x16x32_bf16 v[40:43], a[16:19], v[180:183], 0
  s_waitcnt vmcnt(13)
  buffer_load_dwordx4 v[228:231], v248, s[36:39], s12 offen sc1
  v_mfma_f32_16x16x32_bf16 v[24:27], a[20:23], v[184:187], v[24:27]
  s_add_u32 s12, s7, s85
  ds_read_b128 a[112:115], v3 offset:44032
  v_mfma_f32_16x16x32_bf16 v[28:31], a[24:27], v[184:187], v[28:31]
  buffer_load_dwordx4 v[232:235], v248, s[36:39], s12 offen sc1
  v_mfma_f32_16x16x32_bf16 v[32:35], a[28:31], v[184:187], v[32:35]
  s_add_u32 s12, s7, s86
  ds_read_b128 a[116:119], v3 offset:45056
  v_mfma_f32_16x16x32_bf16 v[36:39], a[32:35], v[184:187], v[36:39]
  buffer_load_dwordx2 a[240:241], v245, s[36:39], s12 offen offset:0 sc1
  v_mfma_f32_16x16x32_bf16 v[40:43], a[36:39], v[184:187], v[40:43]
  s_waitcnt vmcnt(15)
  ds_read_b128 a[120:123], v3 offset:20480
  v_mfma_f32_16x16x32_bf16 v[24:27], a[40:43], v[188:191], v[24:27]
  v_mfma_f32_16x16x32_bf16 v[28:31], a[44:47], v[188:191], v[28:31]
  ds_read_b128 a[124:127], v3 offset:21504
  v_mfma_f32_16x16x32_bf16 v[32:35], a[48:51], v[188:191], v[32:35]
  buffer_load_dwordx2 a[242:243], v245, s[36:39], s12 offen offset:512 sc1
  v_mfma_f32_16x16x32_bf16 v[36:39], a[52:55], v[188:191], v[36:39]
  ds_read_b128 a[128:131], v3 offset:22528
  v_mfma_f32_16x16x32_bf16 v[40:43], a[56:59], v[188:191], v[40:43]
  s_waitcnt vmcnt(15) lgkmcnt(13)
  s_waitcnt vmcnt(12)
  v_cmp_ne_u32 vcc, v254, v249
  v_mfma_f32_16x16x32_bf16 v[24:27], a[60:63], v[192:195], v[24:27]
  s_cmp_lg_u32 vcc_lo, 0
  s_cbranch_scc1 SPl
BPl:
  ds_read_b128 a[132:135], v3 offset:23552
  s_add_u32 s12, s5, s87
  v_mfma_f32_16x16x32_bf16 v[28:31], a[64:67], v[192:195], v[28:31]
  buffer_load_dwordx4 a[244:247], v248, s[36:39], s12 offen sc1
  v_mfma_f32_16x16x32_bf16 v[32:35], a[68:71], v[192:195], v[32:35]
  s_add_u32 s12, s5, s88
  ds_read_b128 a[136:139], v3 offset:24576
  v_mfma_f32_16x16x32_bf16 v[36:39], a[72:75], v[192:195], v[36:39]
  v_mfma_f32_16x16x32_bf16 v[40:43], a[76:79], v[192:195], v[40:43]
  s_waitcnt lgkmcnt(10)
  buffer_load_dwordx4 a[248:251], v248, s[36:39], s12 offen sc1
  v_mfma_f32_16x16x32_bf16 v[24:27], a[80:83], v[196:199], v[24:27]
  s_add_u32 s12, s5, s89
  v_mfma_f32_16x16x32_bf16 v[28:31], a[84:87], v[196:199], v[28:31]
  v_mfma_f32_16x16x32_bf16 v[32:35], a[88:91], v[196:199], v[32:35]
  buffer_load_dwordx4 a[252:255], v248, s[36:39], s12 offen sc1
  v_mfma_f32_16x16x32_bf16 v[36:39], a[92:95], v[196:199], v[36:39]
  s_add_u32 s12, s5, s90
  v_mfma_f32_16x16x32_bf16 v[40:43], a[96:99], v[196:199], v[40:43]
  s_waitcnt vmcnt(9)
  v_mfma_f32_16x16x32_bf16 v[44:47], a[0:3], v[200:203], 0
  buffer_load_dwordx4 v[84:87], v248, s[36:39], s12 offen sc1
  v_mfma_f32_16x16x32_bf16 v[44:47], a[20:23], v[204:207], v[44:47]
  v_mfma_f32_16x16x32_bf16 v[44:47], a[40:43], v[208:211], v[44:47]
  s_add_u32 s12, s5, s91
  ds_write_b128 v236, v[24:27] offset:0
  v_mfma_f32_16x16x32_bf16 v[44:47], a[60:63], v[212:215], v[44:47]
  v_mfma_f32_16x16x32_bf16 v[44:47], a[80:83], v[216:219], v[44:47]
  ds_write_b128 v236, v[28:31] offset:1024
  v_mfma_f32_16x16x32_bf16 v[48:51], a[4:7], v[200:203], 0
  buffer_load_dwordx4 v[88:91], v248, s[36:39], s12 offen sc1
  v_mfma_f32_16x16x32_bf16 v[48:51], a[24:27], v[204:207], v[48:51]
  s_add_u32 s12, s5, s92
  ds_write_b128 v236, v[32:35] offset:2048
  v_mfma_f32_16x16x32_bf16 v[48:51], a[44:47], v[208:211], v[48:51]
  buffer_load_dwordx4 v[92:95], v248, s[36:39], s12 offen sc1
  v_mfma_f32_16x16x32_bf16 v[48:51], a[64:67], v[212:215], v[48:51]
  s_add_u32 s12, s5, s93
  ds_write_b128 v236, v[36:39] offset:3072
  v_mfma_f32_16x16x32_bf16 v[48:51], a[84:87], v[216:219], v[48:51]
  v_mfma_f32_16x16x32_bf16 v[52:55], a[8:11], v[200:203], 0
  ds_write_b128 v236, v[40:43] offset:4096
  v_mfma_f32_16x16x32_bf16 v[52:55], a[28:31], v[204:207], v[52:55]
  buffer_load_dwordx4 v[96:99], v248, s[36:39], s12 offen sc1
  v_mfma_f32_16x16x32_bf16 v[52:55], a[48:51], v[208:211], v[52:55]
  s_add_u32 s12, s6, s87
  ds_write_b128 v237, v[44:47] offset:0
  v_mfma_f32_16x16x32_bf16 v[52:55], a[68:71], v[212:215], v[52:55]
  v_mfma_f32_16x16x32_bf16 v[52:55], a[88:91], v[216:219], v[52:55]
  buffer_load_dwordx4 v[180:183], v248, s[36:39], s12 offen sc1
  v_mfma_f32_16x16x32_bf16 v[56:59], a[12:15], v[200:203], 0
  s_add_u32 s12, s6, s88
  v_mfma_f32_16x16x32_bf16 v[56:59], a[32:35], v[204:207], v[56:59]
  ds_write_b128 v237, v[48:51] offset:1024
  v_mfma_f32_16x16x32_bf16 v[56:59], a[52:55], v[208:211], v[56:59]
  buffer_load_dwordx4 v[184:187], v248, s[36:39], s12 offen sc1
  v_mfma_f32_16x16x32_bf16 v[56:59], a[72:75], v[212:215], v[56:59]
  s_add_u32 s12, s6, s89
  v_mfma_f32_16x16x32_bf16 v[56:59], a[92:95], v[216:219], v[56:59]
  v_mfma_f32_16x16x32_bf16 v[60:63], a[16:19], v[200:203], 0
  buffer_load_dwordx4 v[188:191], v248, s[36:39], s12 offen sc1
  v_mfma_f32_16x16x32_bf16 v[60:63], a[36:39], v[204:207], v[60:63]
  s_add_u32 s12, s6, s90
  ds_write_b128 v237, v[52:55] offset:2048
  v_mfma_f32_16x16x32_bf16 v[60:63], a[56:59], v[208:211], v[60:63]
  v_mfma_f32_16x16x32_bf16 v[60:63], a[76:79], v[212:215], v[60:63]
  buffer_load_dwordx4 v[192:195], v248, s[36:39], s12 offen sc1
  v_mfma_f32_16x16x32_bf16 v[60:63], a[96:99], v[216:219], v[60:63]
  s_waitcnt vmcnt(11)
  v_mfma_f32_16x16x32_bf16 v[64:67], a[0:3], v[220:223], 0
  s_add_u32 s12, s6, s91
  v_mfma_f32_16x16x32_bf16 v[64:67], a[20:23], v[224:227], v[64:67]
  ds_write_b128 v237, v[56:59] offset:3072
  v_mfma_f32_16x16x32_bf16 v[64:67], a[40:43], v[228:231], v[64:67]
  buffer_load_dwordx4 v[196:199], v248, s[36:39], s12 offen sc1
  v_mfma_f32_16x16x32_bf16 v[64:67], a[60:63], v[232:235], v[64:67]
  s_add_u32 s12, s6, s92
  v_mfma_f32_16x16x32_bf16 v[64:67], a[80:83], a[240:243], v[64:67]
  v_mfma_f32_16x16x32_bf16 v[68:71], a[4:7], v[220:223], 0
  buffer_load_dwordx4 v[200:203], v248, s[36:39], s12 offen sc1
  v_mfma_f32_16x16x32_bf16 v[68:71], a[24:27], v[224:227], v[68:71]
  s_add_u32 s12, s6, s93
  ds_write_b128 v237, v[60:63] offset:4096
  v_mfma_f32_16x16x32_bf16 v[68:71], a[44:47], v[228:231], v[68:71]
  v_mfma_f32_16x16x32_bf16 v[68:71], a[64:67], v[232:235], v[68:71]
  buffer_load_dwordx4 v[204:207], v248, s[36:39], s12 offen sc1
  v_mfma_f32_16x16x32_bf16 v[68:71], a[84:87], a[240:243], v[68:71]
  v_mfma_f32_16x16x32_bf16 v[72:75], a[8:11], v[220:223], 0
  s_add_u32 m0, s58, 0
  v_mfma_f32_16x16x32_bf16 v[72:75], a[28:31], v[224:227], v[72:75]
  ds_write_b128 v238, v[64:67] offset:0
  v_mfma_f32_16x16x32_bf16 v[72:75], a[48:51], v[228:231], v[72:75]
  buffer_load_dwordx4 v242, s[40:43], 0 offen lds
  v_mfma_f32_16x16x32_bf16 v[72:75], a[68:71], v[232:235], v[72:75]
  s_add_u32 m0, s58, 1024
  v_mfma_f32_16x16x32_bf16 v[72:75], a[88:91], a[240:243], v[72:75]
  v_mfma_f32_16x16x32_bf16 v[76:79], a[12:15], v[220:223], 0
  buffer_load_dwordx4 v243, s[40:43], 0 offen lds
  v_mfma_f32_16x16x32_bf16 v[76:79], a[32:35], v[224:227], v[76:79]
  s_add_u32 m0, s58, 2048
  ds_write_b128 v238, v[68:71] offset:1024
  v_mfma_f32_16x16x32_bf16 v[76:79], a[52:55], v[228:231], v[76:79]
  v_mfma_f32_16x16x32_bf16 v[76:79], a[72:75], v[232:235], v[76:79]
  buffer_load_dwordx4 v244, s[40:43], 0 offen lds
  v_mfma_f32_16x16x32_bf16 v[76:79], a[92:95], a[240:243], v[76:79]
  s_add_u32 s12, s7, s87
  v_mfma_f32_16x16x32_bf16 v[80:83], a[16:19], v[220:223], 0
  v_mfma_f32_16x16x32_bf16 v[80:83], a[36:39], v[224:227], v[80:83]
  ds_write_b128 v238, v[72:75] offset:2048
  v_mfma_f32_16x16x32_bf16 v[80:83], a[56:59], v[228:231], v[80:83]
  buffer_load_dwordx4 v[208:211], v248, s[36:39], s12 offen sc1
  v_mfma_f32_16x16x32_bf16 v[80:83], a[76:79], v[232:235], v[80:83]
  s_add_u32 s12, s7, s88
  v_mfma_f32_16x16x32_bf16 v[80:83], a[96:99], a[240:243], v[80:83]
  s_waitcnt vmcnt(17)
  v_mfma_f32_16x16x32_bf16 v[120:123], a[140:143], a[244:247], v[120:123]
  buffer_load_dwordx4 v[212:215], v248, s[36:39], s12 offen sc1
  v_mfma_f32_16x16x32_bf16 v[124:127], a[144:147], a[244:247], v[124:127]
  s_add_u32 s12, s7, s89
  ds_write_b128 v238, v[76:79] offset:3072
  v_mfma_f32_16x16x32_bf16 v[128:131], a[148:151], a[244:247], v[128:131]
  v_mfma_f32_16x16x32_bf16 v[132:135], a[152:155], a[244:247], v[132:135]
  buffer_load_dwordx4 v[216:219], v248, s[36:39], s12 offen sc1
  v_mfma_f32_16x16x32_bf16 v[136:139], a[156:159], a[244:247], v[136:139]
  s_waitcnt vmcnt(18)
  ds_write_b128 v238, v[80:83] offset:4096
  v_mfma_f32_16x16x32_bf16 v[120:123], a[160:163], a[248:251], v[120:123]
  s_add_u32 s12, s7, s90
  v_mfma_f32_16x16x32_bf16 v[124:127], a[164:167], a[248:251], v[124:127]
  buffer_load_dwordx4 v[220:223], v248, s[36:39], s12 offen sc1
  v_mfma_f32_16x16x32_bf16 v[128:131], a[168:171], a[248:251], v[128:131]
  v_mfma_f32_16x16x32_bf16 v[132:135], a[172:175], a[248:251], v[132:135]
  s_add_u32 s12, s7, s91
  v_mfma_f32_16x16x32_bf16 v[136:139], a[176:179], a[248:251], v[136:139]
  s_waitcnt vmcnt(18)
  v_mfma_f32_16x16x32_bf16 v[120:123], a[180:183], a[252:255], v[120:123]
  s_waitcnt lgkmcnt(0)
  buffer_load_dwordx4 v[224:227], v248, s[36:39], s12 offen sc1
  v_mfma_f32_16x16x32_bf16 v[124:127], a[184:187], a[252:255], v[124:127]
  s_barrier
  ds_read_b128 v[24:27], v239 offset:0
  s_add_u32 s12, s7, s92
  v_mfma_f32_16x16x32_bf16 v[128:131], a[188:191], a[252:255], v[128:131]
  ds_read_b128 v[44:47], v239 offset:5120
  v_mfma_f32_16x16x32_bf16 v[132:135], a[192:195], a[252:255], v[132:135]
  ds_read_b128 v[64:67], v239 offset:10240
  v_mfma_f32_16x16x32_bf16 v[136:139], a[196:199], a[252:255], v[136:139]
  s_waitcnt vmcnt(18)
  ds_read_b128 v[28:31], v239 offset:1024
  v_mfma_f32_16x16x32_bf16 v[120:123], a[200:203], v[84:87], v[120:123]
  buffer_load_dwordx4 v[228:231], v248, s[36:39], s12 offen sc1
  v_mfma_f32_16x16x32_bf16 v[124:127], a[204:207], v[84:87], v[124:127]
  s_add_u32 s12, s4, s87
  ds_read_b128 v[48:51], v239 offset:6144
  ds_read_b128 v[68:71], v239 offset:11264
  v_mfma_f32_16x16x32_bf16 v[128:131], a[208:211], v[84:87], v[128:131]
  ds_read_b128 v[32:35], v239 offset:2048
  v_mfma_f32_16x16x32_bf16 v[132:135], a[212:215], v[84:87], v[132:135]
  buffer_load_dwordx4 v[232:235], v248, s[36:39], s12 offen sc1
  v_mfma_f32_16x16x32_bf16 v[136:139], a[216:219], v[84:87], v[136:139]
  s_waitcnt vmcnt(19)
  ds_read_b128 v[52:55], v239 offset:7168
  ds_read_b128 v[72:75], v239 offset:12288
  v_mfma_f32_16x16x32_bf16 v[120:123], a[220:223], v[88:91], v[120:123]
  s_add_u32 s12, s4, s88
  ds_read_b128 v[36:39], v239 offset:3072
  v_mfma_f32_16x16x32_bf16 v[124:127], a[224:227], v[88:91], v[124:127]
  buffer_load_dwordx4 a[240:243], v248, s[36:39], s12 offen sc1
  v_mfma_f32_16x16x32_bf16 v[128:131], a[228:231], v[88:91], v[128:131]
  s_add_u32 s12, s4, s89
  ds_read_b128 v[56:59], v239 offset:8192
  ds_read_b128 v[76:79], v239 offset:13312
  v_mfma_f32_16x16x32_bf16 v[132:135], a[232:235], v[88:91], v[132:135]
  ds_read_b128 v[40:43], v239 offset:4096
  v_mfma_f32_16x16x32_bf16 v[136:139], a[236:239], v[88:91], v[136:139]
  s_waitcnt vmcnt(19)
  ds_read_b128 v[60:63], v239 offset:9216
  v_mfma_f32_16x16x32_bf16 v[120:123], a[100:103], v[92:95], v[120:123]
  buffer_load_dwordx4 a[244:247], v248, s[36:39], s12 offen sc1
  v_mfma_f32_16x16x32_bf16 v[124:127], a[104:107], v[92:95], v[124:127]
  s_add_u32 s12, s4, s90
  ds_read_b128 v[80:83], v239 offset:14336
  v_add_u32 v236, 65536, v236
  v_mfma_f32_16x16x32_bf16 v[128:131], a[108:111], v[92:95], v[128:131]
  buffer_load_dwordx4 a[248:251], v248, s[36:39], s12 offen sc1
  v_mfma_f32_16x16x32_bf16 v[132:135], a[112:115], v[92:95], v[132:135]
  s_add_u32 s12, s4, s91
  v_add_u32 v237, 65536, v237
  v_add_u32 v238, 65536, v238
  v_mfma_f32_16x16x32_bf16 v[136:139], a[116:119], v[92:95], v[136:139]
  s_waitcnt vmcnt(20)
  v_add_u32 v239, 65536, v239
  v_mfma_f32_16x16x32_bf16 v[120:123], a[120:123], v[96:99], v[120:123]
  buffer_load_dwordx4 a[252:255], v248, s[36:39], s12 offen sc1
  v_mfma_f32_16x16x32_bf16 v[124:127], a[124:127], v[96:99], v[124:127]
  s_waitcnt lgkmcnt(0)
  v_add_f32 v24, v24, v44
  v_add_f32 v24, v24, v64
  v_mfma_f32_16x16x32_bf16 v[128:131], a[128:131], v[96:99], v[128:131]
  s_add_u32 s12, s4, s92
  v_add_f32 v25, v25, v45
  v_add_f32 v25, v25, v65
  v_mfma_f32_16x16x32_bf16 v[132:135], a[132:135], v[96:99], v[132:135]
  buffer_load_dwordx4 v[84:87], v248, s[36:39], s12 offen sc1
  v_mfma_f32_16x16x32_bf16 v[136:139], a[136:139], v[96:99], v[136:139]
  s_waitcnt vmcnt(15)
  v_add_f32 v26, v26, v46
  v_add_f32 v26, v26, v66
  v_mfma_f32_16x16x32_bf16 v[140:143], a[140:143], v[180:183], v[140:143]
  s_add_u32 s12, s4, s82
  v_add_f32 v27, v27, v47
  v_add_f32 v27, v27, v67
  v_mfma_f32_16x16x32_bf16 v[140:143], a[160:163], v[184:187], v[140:143]
  buffer_load_dwordx4 v[88:91], v248, s[36:39], s12 offen sc1
  v_mfma_f32_16x16x32_bf16 v[140:143], a[180:183], v[188:191], v[140:143]
  s_add_u32 s12, s4, s83
  ds_write_b128 v236, v[120:123] offset:0
  v_mfma_f32_16x16x32_bf16 v[140:143], a[200:203], v[192:195], v[140:143]
  v_add_f32 v28, v28, v48
  v_add_f32 v28, v28, v68
  v_mfma_f32_16x16x32_bf16 v[140:143], a[220:223], v[196:199], v[140:143]
  ds_write_b128 v236, v[124:127] offset:1024
  v_mfma_f32_16x16x32_bf16 v[140:143], a[100:103], v[200:203], v[140:143]
  buffer_load_dwordx4 v[92:95], v248, s[36:39], s12 offen sc1
  v_mfma_f32_16x16x32_bf16 v[140:143], a[120:123], v[204:207], v[140:143]
  s_add_u32 s12, s4, s84
  ds_write_b128 v236, v[128:131] offset:2048
  v_mfma_f32_16x16x32_bf16 v[144:147], a[144:147], v[180:183], v[144:147]
  buffer_load_dwordx4 v[96:99], v248, s[36:39], s12 offen sc1
  v_mfma_f32_16x16x32_bf16 v[144:147], a[164:167], v[184:187], v[144:147]
  ds_write_b128 v236, v[132:135] offset:3072
  v_mfma_f32_16x16x32_bf16 v[144:147], a[184:187], v[188:191], v[144:147]
  s_add_u32 s12, s4, s85
  v_add_f32 v29, v29, v49
  v_add_f32 v29, v29, v69
  v_mfma_f32_16x16x32_bf16 v[144:147], a[204:207], v[192:195], v[144:147]
  ds_write_b128 v236, v[136:139] offset:4096
  v_mfma_f32_16x16x32_bf16 v[144:147], a[224:227], v[196:199], v[144:147]
  v_add_f32 v30, v30, v50
  v_add_f32 v30, v30, v70
  v_mfma_f32_16x16x32_bf16 v[144:147], a[104:107], v[200:203], v[144:147]
  v_add_f32 v31, v31, v51
  v_add_f32 v31, v31, v71
  v_mfma_f32_16x16x32_bf16 v[144:147], a[124:127], v[204:207], v[144:147]
  ds_write_b128 v237, v[140:143] offset:0
  v_mfma_f32_16x16x32_bf16 v[148:151], a[148:151], v[180:183], v[148:151]
  v_add_f32 v32, v32, v52
  v_add_f32 v32, v32, v72
  v_mfma_f32_16x16x32_bf16 v[148:151], a[168:171], v[184:187], v[148:151]
  v_add_f32 v33, v33, v53
  v_add_f32 v33, v33, v73
  v_mfma_f32_16x16x32_bf16 v[148:151], a[188:191], v[188:191], v[148:151]
  v_add_f32 v34, v34, v54
  v_add_f32 v34, v34, v74
  v_mfma_f32_16x16x32_bf16 v[148:151], a[208:211], v[192:195], v[148:151]
  v_add_f32 v35, v35, v55
  v_add_f32 v35, v35, v75
  v_mfma_f32_16x16x32_bf16 v[148:151], a[228:231], v[196:199], v[148:151]
  v_add_f32 v36, v36, v56
  v_add_f32 v36, v36, v76
  v_mfma_f32_16x16x32_bf16 v[148:151], a[108:111], v[200:203], v[148:151]
  v_add_f32 v37, v37, v57
  v_add_f32 v37, v37, v77
  v_mfma_f32_16x16x32_bf16 v[148:151], a[128:131], v[204:207], v[148:151]
  ds_write_b128 v237, v[144:147] offset:1024
  v_mfma_f32_16x16x32_bf16 v[152:155], a[152:155], v[180:183], v[152:155]
  v_add_f32 v38, v38, v58
  v_add_f32 v38, v38, v78
  v_mfma_f32_16x16x32_bf16 v[152:155], a[172:175], v[184:187], v[152:155]
  v_add_f32 v39, v39, v59
  v_add_f32 v39, v39, v79
  v_mfma_f32_16x16x32_bf16 v[152:155], a[192:195], v[188:191], v[152:155]
  v_add_f32 v40, v40, v60
  v_add_f32 v40, v40, v80
  v_mfma_f32_16x16x32_bf16 v[152:155], a[212:215], v[192:195], v[152:155]
  v_add_f32 v41, v41, v61
  v_add_f32 v41, v41, v81
  v_mfma_f32_16x16x32_bf16 v[152:155], a[232:235], v[196:199], v[152:155]
  v_add_f32 v42, v42, v62
  v_add_f32 v42, v42, v82
  v_mfma_f32_16x16x32_bf16 v[152:155], a[112:115], v[200:203], v[152:155]
  v_add_f32 v43, v43, v63
  v_add_f32 v43, v43, v83
  v_mfma_f32_16x16x32_bf16 v[152:155], a[132:135], v[204:207], v[152:155]
  ds_write_b128 v237, v[148:151] offset:2048
  v_mfma_f32_16x16x32_bf16 v[156:159], a[156:159], v[180:183], v[156:159]
  buffer_load_dwordx4 v[180:183], v248, s[36:39], s12 offen sc1
  s_add_u32 s12, s4, s86
  v_mfma_f32_16x16x32_bf16 v[156:159], a[176:179], v[184:187], v[156:159]
  buffer_load_dwordx2 v[184:185], v245, s[36:39], s12 offen offset:0 sc1
  v_mfma_f32_16x16x32_bf16 v[156:159], a[196:199], v[188:191], v[156:159]
  buffer_load_dwordx2 v[186:187], v245, s[36:39], s12 offen offset:512 sc1
  v_mfma_f32_16x16x32_bf16 v[156:159], a[216:219], v[192:195], v[156:159]
  v_mfma_f32_16x16x32_bf16 v[156:159], a[236:239], v[196:199], v[156:159]
  v_mfma_f32_16x16x32_bf16 v[156:159], a[116:119], v[200:203], v[156:159]
  v_mfma_f32_16x16x32_bf16 v[156:159], a[136:139], v[204:207], v[156:159]
  s_waitcnt vmcnt(12)
  ds_write_b128 v237, v[152:155] offset:3072
  v_mfma_f32_16x16x32_bf16 v[160:163], a[140:143], v[208:211], v[160:163]
  v_mfma_f32_16x16x32_bf16 v[160:163], a[160:163], v[212:215], v[160:163]
  v_mfma_f32_16x16x32_bf16 v[160:163], a[180:183], v[216:219], v[160:163]
  v_mfma_f32_16x16x32_bf16 v[160:163], a[200:203], v[220:223], v[160:163]
  v_mfma_f32_16x16x32_bf16 v[160:163], a[220:223], v[224:227], v[160:163]
  v_mfma_f32_16x16x32_bf16 v[160:163], a[100:103], v[228:231], v[160:163]
  v_mfma_f32_16x16x32_bf16 v[164:167], a[144:147], v[208:211], v[164:167]
  ds_write_b128 v237, v[156:159] offset:4096
  v_mfma_f32_16x16x32_bf16 v[164:167], a[164:167], v[212:215], v[164:167]
  v_mfma_f32_16x16x32_bf16 v[164:167], a[184:187], v[216:219], v[164:167]
  v_mfma_f32_16x16x32_bf16 v[164:167], a[204:207], v[220:223], v[164:167]
  ds_read_b64 v[64:65], v240 offset:0
  ds_read_b64 v[66:67], v240 offset:32
  v_mfma_f32_16x16x32_bf16 v[164:167], a[224:227], v[224:227], v[164:167]
  ds_read_b64 v[68:69], v240 offset:64
  ds_read_b64 v[70:71], v240 offset:96
  v_mfma_f32_16x16x32_bf16 v[164:167], a[104:107], v[228:231], v[164:167]
  ds_read_b64 v[72:73], v240 offset:128
  v_mfma_f32_16x16x32_bf16 v[168:171], a[148:151], v[208:211], v[168:171]
  ds_write_b128 v238, v[160:163] offset:0
  v_mfma_f32_16x16x32_bf16 v[168:171], a[168:171], v[212:215], v[168:171]
  v_mfma_f32_16x16x32_bf16 v[168:171], a[188:191], v[216:219], v[168:171]
  v_mfma_f32_16x16x32_bf16 v[168:171], a[208:211], v[220:223], v[168:171]
  v_mfma_f32_16x16x32_bf16 v[168:171], a[228:231], v[224:227], v[168:171]
  v_mfma_f32_16x16x32_bf16 v[168:171], a[108:111], v[228:231], v[168:171]
  v_mfma_f32_16x16x32_bf16 v[172:175], a[152:155], v[208:211], v[172:175]
  s_waitcnt lgkmcnt(1)
  ds_write_b128 v238, v[164:167] offset:1024
  v_mfma_f32_16x16x32_bf16 v[172:175], a[172:175], v[212:215], v[172:175]
  v_lshlrev_b32 v44, 16, v64
  v_and_b32 v45, 0xffff0000, v64
  v_mfma_f32_16x16x32_bf16 v[172:175], a[192:195], v[216:219], v[172:175]
  v_lshlrev_b32 v46, 16, v65
  v_and_b32 v47, 0xffff0000, v65
  v_mfma_f32_16x16x32_bf16 v[172:175], a[212:215], v[220:223], v[172:175]
  v_lshlrev_b32 v48, 16, v66
  v_and_b32 v49, 0xffff0000, v66
  v_mfma_f32_16x16x32_bf16 v[172:175], a[232:235], v[224:227], v[172:175]
  v_lshlrev_b32 v50, 16, v67
  v_and_b32 v51, 0xffff0000, v67
  v_mfma_f32_16x16x32_bf16 v[172:175], a[112:115], v[228:231], v[172:175]
  v_lshlrev_b32 v52, 16, v68
  v_and_b32 v53, 0xffff0000, v68
  v_mfma_f32_16x16x32_bf16 v[176:179], a[156:159], v[208:211], v[176:179]
  ds_write_b128 v238, v[168:171] offset:2048
  v_mfma_f32_16x16x32_bf16 v[176:179], a[176:179], v[212:215], v[176:179]
  v_lshlrev_b32 v54, 16, v69
  v_and_b32 v55, 0xffff0000, v69
  v_mfma_f32_16x16x32_bf16 v[176:179], a[196:199], v[216:219], v[176:179]
  v_lshlrev_b32 v56, 16, v70
  v_and_b32 v57, 0xffff0000, v70
  v_mfma_f32_16x16x32_bf16 v[176:179], a[216:219], v[220:223], v[176:179]
  v_lshlrev_b32 v58, 16, v71
  v_and_b32 v59, 0xffff0000, v71
  v_mfma_f32_16x16x32_bf16 v[176:179], a[236:239], v[224:227], v[176:179]
  v_lshlrev_b32 v60, 16, v72
  v_and_b32 v61, 0xffff0000, v72
  v_mfma_f32_16x16x32_bf16 v[176:179], a[116:119], v[228:231], v[176:179]
  s_waitcnt vmcnt(6)
  v_lshlrev_b32 v62, 16, v73
  v_and_b32 v63, 0xffff0000, v73
  v_mfma_f32_16x16x32_bf16 v[100:103], a[140:143], v[232:235], v[100:103]
  ds_write_b128 v238, v[172:175] offset:3072
  v_mfma_f32_16x16x32_bf16 v[100:103], a[160:163], a[240:243], v[100:103]
  v_mfma_f32_16x16x32_bf16 v[100:103], a[180:183], a[244:247], v[100:103]
  v_mfma_f32_16x16x32_bf16 v[100:103], a[200:203], a[248:251], v[100:103]
  v_mfma_f32_16x16x32_bf16 v[100:103], a[220:223], a[252:255], v[100:103]
  ds_write_b128 v238, v[176:179] offset:4096
  v_mfma_f32_16x16x32_bf16 v[100:103], a[100:103], v[84:87], v[100:103]
  v_mfma_f32_16x16x32_bf16 v[104:107], a[144:147], v[232:235], v[104:107]
  v_mfma_f32_16x16x32_bf16 v[104:107], a[164:167], a[240:243], v[104:107]
  v_mfma_f32_16x16x32_bf16 v[104:107], a[184:187], a[244:247], v[104:107]
  v_mfma_f32_16x16x32_bf16 v[104:107], a[204:207], a[248:251], v[104:107]
  s_waitcnt lgkmcnt(0)
  v_mfma_f32_16x16x32_bf16 v[104:107], a[224:227], a[252:255], v[104:107]
  s_barrier
  ds_read_b128 v[120:123], v239 offset:0
  v_mfma_f32_16x16x32_bf16 v[104:107], a[104:107], v[84:87], v[104:107]
  ds_read_b128 v[140:143], v239 offset:5120
  v_mfma_f32_16x16x32_bf16 v[108:111], a[148:151], v[232:235], v[108:111]
  ds_read_b128 v[160:163], v239 offset:10240
  v_mfma_f32_16x16x32_bf16 v[108:111], a[168:171], a[240:243], v[108:111]
  ds_read_b128 v[124:127], v239 offset:1024
  v_mfma_f32_16x16x32_bf16 v[108:111], a[188:191], a[244:247], v[108:111]
  ds_read_b128 v[144:147], v239 offset:6144
  v_mfma_f32_16x16x32_bf16 v[108:111], a[208:211], a[248:251], v[108:111]
  ds_read_b128 v[164:167], v239 offset:11264
  v_mfma_f32_16x16x32_bf16 v[108:111], a[228:231], a[252:255], v[108:111]
  ds_read_b128 v[128:131], v239 offset:2048
  v_mfma_f32_16x16x32_bf16 v[108:111], a[108:111], v[84:87], v[108:111]
  s_waitcnt lgkmcnt(4)
  ds_read_b128 v[148:151], v239 offset:7168
  v_add_f32 v120, v120, v140
  v_mfma_f32_16x16x32_bf16 v[112:115], a[152:155], v[232:235], v[112:115]
  ds_read_b128 v[168:171], v239 offset:12288
  v_add_f32 v121, v121, v141
  v_mfma_f32_16x16x32_bf16 v[112:115], a[172:175], a[240:243], v[112:115]
  ds_read_b128 v[132:135], v239 offset:3072
  v_add_f32 v122, v122, v142
  v_mfma_f32_16x16x32_bf16 v[112:115], a[192:195], a[244:247], v[112:115]
  ds_read_b128 v[152:155], v239 offset:8192
  v_add_f32 v123, v123, v143
  v_mfma_f32_16x16x32_bf16 v[112:115], a[212:215], a[248:251], v[112:115]
  ds_read_b128 v[172:175], v239 offset:13312
  v_add_f32 v120, v120, v160
  v_mfma_f32_16x16x32_bf16 v[112:115], a[232:235], a[252:255], v[112:115]
  ds_read_b128 v[136:139], v239 offset:4096
  v_add_f32 v121, v121, v161
  v_mfma_f32_16x16x32_bf16 v[112:115], a[112:115], v[84:87], v[112:115]
  ds_read_b128 v[156:159], v239 offset:9216
  v_add_f32 v122, v122, v162
  v_mfma_f32_16x16x32_bf16 v[116:119], a[156:159], v[232:235], v[116:119]
  ds_read_b128 v[176:179], v239 offset:14336
  v_add_f32 v123, v123, v163
  v_mfma_f32_16x16x32_bf16 v[116:119], a[176:179], a[240:243], v[116:119]
  v_add_f32 v100, v100, v120
  v_add_f32 v101, v101, v121
  v_mfma_f32_16x16x32_bf16 v[116:119], a[196:199], a[244:247], v[116:119]
  v_add_f32 v102, v102, v122
  v_add_f32 v103, v103, v123
  v_mfma_f32_16x16x32_bf16 v[116:119], a[216:219], a[248:251], v[116:119]
  v_mul_f32 v120, 0xbfb8aa3b, v100
  v_mul_f32 v121, 0xbfb8aa3b, v101
  v_mfma_f32_16x16x32_bf16 v[116:119], a[236:239], a[252:255], v[116:119]
  v_mul_f32 v122, 0xbfb8aa3b, v102
  v_mul_f32 v123, 0xbfb8aa3b, v103
  v_mfma_f32_16x16x32_bf16 v[116:119], a[116:119], v[84:87], v[116:119]
  s_waitcnt vmcnt(0)
  v_exp_f32 v120, v120
  v_mfma_f32_16x16x32_bf16 v[4:7], a[0:3], v[88:91], v[24:27]
  v_exp_f32 v121, v121
  v_mfma_f32_16x16x32_bf16 v[4:7], a[20:23], v[92:95], v[4:7]
  v_exp_f32 v122, v122
  v_mfma_f32_16x16x32_bf16 v[4:7], a[40:43], v[96:99], v[4:7]
  v_exp_f32 v123, v123
  v_mfma_f32_16x16x32_bf16 v[4:7], a[60:63], v[180:183], v[4:7]
  v_add_f32 v120, 1.0, v120
  v_add_f32 v121, 1.0, v121
  v_mfma_f32_16x16x32_bf16 v[4:7], a[80:83], v[184:187], v[4:7]
  v_add_f32 v122, 1.0, v122
  v_add_f32 v123, 1.0, v123
  v_mfma_f32_16x16x32_bf16 v[8:11], a[4:7], v[88:91], v[28:31]
  v_rcp_f32 v120, v120
  v_mfma_f32_16x16x32_bf16 v[8:11], a[24:27], v[92:95], v[8:11]
  v_rcp_f32 v121, v121
  v_mfma_f32_16x16x32_bf16 v[8:11], a[44:47], v[96:99], v[8:11]
  v_rcp_f32 v122, v122
  v_mfma_f32_16x16x32_bf16 v[8:11], a[64:67], v[180:183], v[8:11]
  v_rcp_f32 v123, v123
  v_mfma_f32_16x16x32_bf16 v[8:11], a[84:87], v[184:187], v[8:11]
  v_mul_f32 v100, v100, v120
  v_mul_f32 v101, v101, v121
  v_mfma_f32_16x16x32_bf16 v[12:15], a[8:11], v[88:91], v[32:35]
  v_mul_f32 v102, v102, v122
  v_mul_f32 v103, v103, v123
  v_mfma_f32_16x16x32_bf16 v[12:15], a[28:31], v[92:95], v[12:15]
  s_waitcnt lgkmcnt(9)
  v_add_f32 v124, v124, v144
  v_add_f32 v125, v125, v145
  v_mfma_f32_16x16x32_bf16 v[12:15], a[48:51], v[96:99], v[12:15]
  v_add_f32 v126, v126, v146
  v_add_f32 v127, v127, v147
  v_mfma_f32_16x16x32_bf16 v[12:15], a[68:71], v[180:183], v[12:15]
  v_add_f32 v124, v124, v164
  v_add_f32 v125, v125, v165
  v_mfma_f32_16x16x32_bf16 v[12:15], a[88:91], v[184:187], v[12:15]
  v_add_f32 v126, v126, v166
  v_add_f32 v127, v127, v167
  v_mfma_f32_16x16x32_bf16 v[16:19], a[12:15], v[88:91], v[36:39]
  v_add_f32 v104, v104, v124
  v_add_f32 v105, v105, v125
  v_mfma_f32_16x16x32_bf16 v[16:19], a[32:35], v[92:95], v[16:19]
  v_add_f32 v106, v106, v126
  v_add_f32 v107, v107, v127
  v_mfma_f32_16x16x32_bf16 v[16:19], a[52:55], v[96:99], v[16:19]
  v_mul_f32 v124, 0xbfb8aa3b, v104
  v_mul_f32 v125, 0xbfb8aa3b, v105
  v_mfma_f32_16x16x32_bf16 v[16:19], a[72:75], v[180:183], v[16:19]
  v_mul_f32 v126, 0xbfb8aa3b, v106
  v_mul_f32 v127, 0xbfb8aa3b, v107
  v_mfma_f32_16x16x32_bf16 v[16:19], a[92:95], v[184:187], v[16:19]
  v_exp_f32 v124, v124
  v_mfma_f32_16x16x32_bf16 v[20:23], a[16:19], v[88:91], v[40:43]
  v_exp_f32 v125, v125
  v_mfma_f32_16x16x32_bf16 v[20:23], a[36:39], v[92:95], v[20:23]
  v_exp_f32 v126, v126
  v_mfma_f32_16x16x32_bf16 v[20:23], a[56:59], v[96:99], v[20:23]
  v_exp_f32 v127, v127
  v_mfma_f32_16x16x32_bf16 v[20:23], a[76:79], v[180:183], v[20:23]
  v_add_f32 v124, 1.0, v124
  v_add_f32 v125, 1.0, v125
  v_mfma_f32_16x16x32_bf16 v[20:23], a[96:99], v[184:187], v[20:23]
  v_add_f32 v126, 1.0, v126
  v_add_f32 v127, 1.0, v127
  v_rcp_f32 v124, v124
  v_rcp_f32 v125, v125
  v_rcp_f32 v126, v126
  v_rcp_f32 v127, v127
  v_mul_f32 v104, v104, v124
  v_mul_f32 v105, v105, v125
  v_mul_f32 v106, v106, v126
  v_mul_f32 v107, v107, v127
  v_pk_fma_f32 v[4:5], v[4:5], v[100:101], v[44:45]
  v_pk_fma_f32 v[6:7], v[6:7], v[102:103], v[46:47]
  v_cvt_pk_bf16_f32 v64, v4, v5
  v_cvt_pk_bf16_f32 v65, v6, v7
  v_pk_fma_f32 v[8:9], v[8:9], v[104:105], v[48:49]
  v_pk_fma_f32 v[10:11], v[10:11], v[106:107], v[50:51]
  v_cvt_pk_bf16_f32 v66, v8, v9
  v_cvt_pk_bf16_f32 v67, v10, v11
  s_nop 0
  v_permlane16_swap_b32 v64, v66
  v_permlane16_swap_b32 v65, v67
  buffer_store_dwordx4 v[64:67], v246, s[28:31], 0 offen offset:0
  s_waitcnt lgkmcnt(6)
  v_pk_add_f32 v[128:129], v[128:129], v[148:149]
FHOP7:
  s_cbranch_execz FHRET
AHOP8:
  s_cbranch_execz AHRET
  v_pk_add_f32 v[130:131], v[130:131], v[150:151]
  v_pk_add_f32 v[108:109], v[108:109], v[168:169]
  v_pk_add_f32 v[110:111], v[110:111], v[170:171]
  v_pk_add_f32 v[108:109], v[108:109], v[128:129]
  v_pk_add_f32 v[110:111], v[110:111], v[130:131]
  v_pk_mul_f32 v[128:129], v[108:109], s[14:15] op_sel_hi:[1,0]
  v_pk_mul_f32 v[130:131], v[110:111], s[14:15] op_sel_hi:[1,0]
  v_exp_f32 v128, v128
  v_exp_f32 v129, v129
  v_exp_f32 v130, v130
  v_exp_f32 v131, v131
  v_pk_add_f32 v[128:129], v[128:129], 1.0 op_sel_hi:[1,0]
  v_pk_add_f32 v[130:131], v[130:131], 1.0 op_sel_hi:[1,0]
  v_rcp_f32 v128, v128
  v_rcp_f32 v129, v129
  v_rcp_f32 v130, v130
  v_rcp_f32 v131, v131
  v_pk_mul_f32 v[108:109], v[108:109], v[128:129]
  v_pk_mul_f32 v[110:111], v[110:111], v[130:131]
  v_pk_fma_f32 v[12:13], v[12:13], v[108:109], v[52:53]
  v_pk_fma_f32 v[14:15], v[14:15], v[110:111], v[54:55]
  v_cvt_pk_bf16_f32 v68, v12, v13
  v_cvt_pk_bf16_f32 v69, v14, v15
  s_waitcnt lgkmcnt(3)
  v_pk_add_f32 v[132:133], v[132:133], v[152:153]
  v_pk_add_f32 v[134:135], v[134:135], v[154:155]
  v_pk_add_f32 v[112:113], v[112:113], v[172:173]
  v_pk_add_f32 v[114:115], v[114:115], v[174:175]
  v_pk_add_f32 v[112:113], v[112:113], v[132:133]
  v_pk_add_f32 v[114:115], v[114:115], v[134:135]
  v_pk_mul_f32 v[132:133], v[112:113], s[14:15] op_sel_hi:[1,0]
  v_pk_mul_f32 v[134:135], v[114:115], s[14:15] op_sel_hi:[1,0]
  v_exp_f32 v132, v132
  v_exp_f32 v133, v133
  v_exp_f32 v134, v134
  v_exp_f32 v135, v135
  v_pk_add_f32 v[132:133], v[132:133], 1.0 op_sel_hi:[1,0]
  v_pk_add_f32 v[134:135], v[134:135], 1.0 op_sel_hi:[1,0]
  v_rcp_f32 v132, v132
  v_rcp_f32 v133, v133
  v_rcp_f32 v134, v134
  v_rcp_f32 v135, v135
  v_pk_mul_f32 v[112:113], v[112:113], v[132:133]
  v_pk_mul_f32 v[114:115], v[114:115], v[134:135]
  v_pk_fma_f32 v[16:17], v[16:17], v[112:113], v[56:57]
  v_pk_fma_f32 v[18:19], v[18:19], v[114:115], v[58:59]
  v_cvt_pk_bf16_f32 v70, v16, v17
  v_cvt_pk_bf16_f32 v71, v18, v19
  s_nop 0
  v_permlane16_swap_b32 v68, v70
  v_permlane16_swap_b32 v69, v71
  buffer_store_dwordx4 v[68:71], v246, s[28:31], 0 offen offset:64
  s_waitcnt lgkmcnt(0)
  v_pk_add_f32 v[136:137], v[136:137], v[156:157]
  v_pk_add_f32 v[138:139], v[138:139], v[158:159]
  v_pk_add_f32 v[116:117], v[116:117], v[176:177]
  v_pk_add_f32 v[118:119], v[118:119], v[178:179]
  v_pk_add_f32 v[116:117], v[116:117], v[136:137]
  v_pk_add_f32 v[118:119], v[118:119], v[138:139]
  v_pk_mul_f32 v[136:137], v[116:117], s[14:15] op_sel_hi:[1,0]
  v_pk_mul_f32 v[138:139], v[118:119], s[14:15] op_sel_hi:[1,0]
  v_exp_f32 v136, v136
  v_exp_f32 v137, v137
  v_exp_f32 v138, v138
  v_exp_f32 v139, v139
  v_pk_add_f32 v[136:137], v[136:137], 1.0 op_sel_hi:[1,0]
  v_pk_add_f32 v[138:139], v[138:139], 1.0 op_sel_hi:[1,0]
  v_rcp_f32 v136, v136
  v_rcp_f32 v137, v137
  v_rcp_f32 v138, v138
  v_rcp_f32 v139, v139
  v_pk_mul_f32 v[116:117], v[116:117], v[136:137]
  v_pk_mul_f32 v[118:119], v[118:119], v[138:139]
  v_pk_fma_f32 v[20:21], v[20:21], v[116:117], v[60:61]
  v_pk_fma_f32 v[22:23], v[22:23], v[118:119], v[62:63]
  v_cvt_pk_bf16_f32 v72, v20, v21
  v_cvt_pk_bf16_f32 v73, v22, v23
  buffer_store_dwordx2 v[72:73], v247, s[28:31], 0 offen
  s_endpgm
P2END:
.p2align 12
ATT:
  v_and_b32 v168, 15, v0
  v_bfe_u32 v169, v0, 1, 3
  v_lshrrev_b32 v170, 4, v0
  v_xor_b32 v169, v169, v170
  v_lshlrev_b32 v168, 7, v168
  v_lshl_add_u32 v168, v169, 4, v168
  v_add_u32 v244, s48, v168
  v_xor_b32 v168, 64, v168
  v_add_u32 v245, s48, v168
  v_and_b32 v168, 31, v0
  v_lshlrev_b32 v168, 2, v168
  v_add_u32 v168, s48, v168
  v_mov_b32 v169, 0x3f803f80
  ds_write_b32 v168, v169 offset:0
  ds_write_b32 v168, v169 offset:6272
  ds_write_b32 v168, v169 offset:12544
  v_lshrrev_b32 v168, 5, v0
  v_lshlrev_b32 v168, 4, v168
  v_bfe_u32 v169, v0, 2, 3
  v_add_u32 v168, v168, v169
  v_mul_u32_u24 v168, 160, v168
  v_and_b32 v169, 3, v0
  v_lshl_add_u32 v192, v169, 3, v168
  v_add_u32 v193, 40960, v192
  s_sub_u32 s55, s2, 0
  s_mul_i32 s67, s55, 6827
  s_lshr_b32 s67, s67, 16
  s_lshl_b32 s67, s67, 2
  s_mov_b32 s56, 0x32100321
  s_mov_b32 s57, 0xff44
  s_lshr_b64 s[56:57], s[56:57], s67
  s_and_b32 s67, s56, 15
  s_mul_i32 s55, s55, 4
  s_and_b32 s56, s44, 3
  s_add_u32 s55, s55, s56
  s_mul_i32 s21, s55, 6400
  v_min_u32 v199, 49, v0
  v_lshlrev_b32 v199, 7, v199
  s_mul_i32 s20, s55, 5760
  v_min_u32 v178, 5632, v199
  s_mov_b64 s[32:33], s[14:15]
  s_mov_b32 s34, 0x21c000
  s_mov_b32 s35, 0x20000
  s_lshr_b32 s55, s2, 3
  s_sub_u32 s55, s55, 0
  s_lshl_b32 s55, s55, 2
  s_add_u32 s55, s55, s44
  s_mul_i32 s55, s55, 3
  v_min_u32 v176, 2, v0
  v_add_u32 v176, s55, v176
  v_lshlrev_b32 v176, 7, v176
  s_getpc_b64 s[56:57]
AC1_pc:
  s_add_u32 s56, s56, AC1-AC1_pc
  s_addc_u32 s57, s57, 0
  v_mov_b32 v177, s57
  v_add_co_u32 v176, vcc, s56, v176
  v_and_b32 v168, 15, v0
  v_add_u32 v169, -1, v168
  v_addc_co_u32 v177, vcc, 0, v177, vcc
  s_add_u32 s73, s73, 2560
  s_and_b32 s55, s44, 2
  s_lshl_b32 s55, s55, 1
  s_lshr_b64 s[74:75], s[60:61], s55
  s_mul_i32 s56, s53, 172
  s_add_u32 s57, s45, 3
  s_max_i32 s56, s56, s57
  v_add_u32 v169, s45, v169
  v_lshrrev_b32 v170, 6, v169
  v_mul_u32_u24 v170, 303104, v170
  v_bfe_u32 v171, v169, 4, 2
  v_lshl_add_u32 v170, v171, 10, v170
  v_and_b32 v171, 15, v169
  v_lshl_add_u32 v170, v171, 4, v170
  v_lshrrev_b32 v171, 4, v0
  v_lshl_add_u32 v170, v171, 8, v170
  v_mov_b32 v171, 0x40000000
  v_cmp_gt_i32 vcc, s47, v169
  v_and_b32 v168, 15, v0
  s_nop 0
  v_cndmask_b32 v1, v171, v170, vcc
  v_cmp_le_i32 vcc, s56, v169
  v_add_u32 v169, 15, v168
  v_add_u32 v169, s45, v169
  v_cndmask_b32 v1, v171, v1, vcc
  v_lshrrev_b32 v170, 6, v169
  v_mul_u32_u24 v170, 303104, v170
  v_bfe_u32 v171, v169, 4, 2
  v_lshl_add_u32 v170, v171, 10, v170
  v_and_b32 v171, 15, v169
  v_lshl_add_u32 v170, v171, 4, v170
  v_lshrrev_b32 v171, 4, v0
  v_lshl_add_u32 v170, v171, 8, v170
  v_mov_b32 v171, 0x40000000
  v_cmp_gt_i32 vcc, s47, v169
  v_and_b32 v168, 15, v0
  s_nop 0
  v_cndmask_b32 v2, v171, v170, vcc
  v_cmp_le_i32 vcc, s56, v169
  v_add_u32 v169, 31, v168
  v_add_u32 v169, s45, v169
  v_cndmask_b32 v2, v171, v2, vcc
  v_lshrrev_b32 v170, 6, v169
  v_mul_u32_u24 v170, 303104, v170
  v_bfe_u32 v171, v169, 4, 2
  v_lshl_add_u32 v170, v171, 10, v170
  v_and_b32 v171, 15, v169
  v_lshl_add_u32 v170, v171, 4, v170
  v_lshrrev_b32 v171, 4, v0
  v_lshl_add_u32 v170, v171, 8, v170
  v_mov_b32 v171, 0x40000000
  v_cmp_gt_i32 vcc, s47, v169
  v_bfe_u32 v168, v169, 2, 2
  v_lshlrev_b32 v213, 6, v168
  v_cndmask_b32 v3, v171, v170, vcc
  v_cmp_le_i32 vcc, s56, v169
  v_and_b32 v168, 3, v169
  v_lshlrev_b32 v168, 3, v168
  v_cndmask_b32 v3, v171, v3, vcc
  v_sub_u32 v213, v213, v168
  v_lshrrev_b32 v168, 4, v0
  v_mul_u32_u24 v168, 224, v168
  v_sub_u32 v213, v213, v168
  s_lshr_b32 s70, s54, 1
  s_lshr_b32 s55, s2, 3
  s_and_b32 s68, s2, 3
  s_lshl2_add_u32 s55, s55, s68
  s_lshl2_add_u32 s55, s55, s44
  s_bfe_u32 s68, s2, 0x10002
  s_lshl2_add_u32 s55, s55, s68
  v_lshrrev_b32 v138, 5, v0
  v_lshl_add_u32 v138, v138, 1, s55
  v_mul_u32_u24 v136, 1280, v138
  v_and_b32 v139, 31, v0
  v_lshl_add_u32 v136, v139, 4, v136
  v_and_b32 v139, 16, v0
  v_lshl_add_u32 v137, v139, 26, v136
  v_mov_b32 v249, 0
  buffer_load_dwordx4 v[124:127], v136, s[40:43], 0 offen
  buffer_load_dwordx4 v[128:131], v136, s[40:43], 0 offen offset:512
  buffer_load_dwordx4 v[132:135], v137, s[40:43], 0 offen offset:1024
  buffer_load_dword v249, v249, s[36:39], 0 offen sc1
  s_waitcnt vmcnt(9) lgkmcnt(0)
  ds_read_b128 a[0:3], v244 offset:0
  ds_read_b128 a[4:7], v244 offset:2048
  ds_read_b128 a[8:11], v244 offset:4096
  ds_read_b128 a[12:15], v245 offset:0
  ds_read_b128 a[16:19], v245 offset:2048
  ds_read_b128 a[20:23], v245 offset:4096
  s_waitcnt vmcnt(4)
  s_barrier
  ds_read_b64_tr_b16 a[240:241], v192 offset:0
  ds_read_b64_tr_b16 a[242:243], v192 offset:1280
  ds_read_b64_tr_b16 a[244:245], v192 offset:5120
  ds_read_b64_tr_b16 a[246:247], v192 offset:6400
  ds_read_b64_tr_b16 a[248:249], v192 offset:32
  ds_read_b64_tr_b16 a[250:251], v192 offset:1312
  ds_read_b64_tr_b16 a[252:253], v192 offset:5152
  ds_read_b64_tr_b16 a[254:255], v192 offset:6432
  s_waitcnt lgkmcnt(4)
  v_mfma_f32_16x16x32_bf16 v[4:7], a[240:243], a[0:3], 0
  s_bfe_u32 s49, s60, 0x40004
  ds_read_b64_tr_b16 v[184:185], v192 offset:64
  ds_read_b64_tr_b16 v[186:187], v192 offset:1344
  v_mfma_f32_16x16x32_bf16 v[4:7], a[244:247], a[12:15], v[4:7]
  s_add_u32 m0, s48, 6400
  s_lshl_b32 s49, s49, 7
  v_mfma_f32_16x16x32_bf16 v[24:27], a[244:247], a[16:19], 0
  ds_read_b64_tr_b16 v[188:189], v192 offset:5184
  ds_read_b64_tr_b16 v[190:191], v192 offset:6464
  v_mfma_f32_16x16x32_bf16 v[24:27], a[240:243], a[4:7], v[24:27]
  buffer_load_dwordx4 v238, s[24:27], s49 offen offset:0 lds
  v_mfma_f32_16x16x32_bf16 v[44:47], a[240:243], a[8:11], 0
  buffer_load_dwordx4 v239, s[24:27], s49 offen offset:1024 lds
  v_mfma_f32_16x16x32_bf16 v[44:47], a[244:247], a[20:23], v[44:47]
  s_waitcnt lgkmcnt(4)
  buffer_load_dwordx4 v240, s[24:27], s49 offen offset:2048 lds
  v_mfma_f32_16x16x32_bf16 v[8:11], a[248:251], a[0:3], 0
  ds_read_b64_tr_b16 a[240:241], v192 offset:96
  ds_read_b64_tr_b16 a[242:243], v192 offset:1376
  v_mfma_f32_16x16x32_bf16 v[8:11], a[252:255], a[12:15], v[8:11]
  buffer_load_dwordx4 v241, s[24:27], s49 offen offset:3072 lds
  v_mfma_f32_16x16x32_bf16 v[28:31], a[252:255], a[16:19], 0
  s_add_u32 m0, s48, 10496
  ds_read_b64_tr_b16 a[244:245], v192 offset:5216
  ds_read_b64_tr_b16 a[246:247], v192 offset:6496
  v_mfma_f32_16x16x32_bf16 v[28:31], a[248:251], a[4:7], v[28:31]
  buffer_load_dwordx4 v242, s[24:27], s49 offen offset:0 lds
  v_mfma_f32_16x16x32_bf16 v[48:51], a[248:251], a[8:11], 0
  v_mfma_f32_16x16x32_bf16 v[48:51], a[252:255], a[20:23], v[48:51]
  s_waitcnt lgkmcnt(4)
  buffer_load_dwordx4 v243, s[24:27], s49 offen offset:1024 lds
  v_mfma_f32_16x16x32_bf16 v[12:15], v[184:187], a[0:3], 0
  s_bfe_u32 s51, s60, 0x40004
  ds_read_b64_tr_b16 a[248:249], v192 offset:128
  ds_read_b64_tr_b16 a[250:251], v192 offset:1408
  v_mfma_f32_16x16x32_bf16 v[12:15], v[188:191], a[12:15], v[12:15]
  s_mul_i32 s51, s51, 245760
  s_add_u32 m0, s50, 20480
  s_add_u32 s51, s51, s52
  v_mfma_f32_16x16x32_bf16 v[32:35], v[188:191], a[16:19], 0
  ds_read_b64_tr_b16 a[252:253], v192 offset:5248
  ds_read_b64_tr_b16 a[254:255], v192 offset:6528
  v_mfma_f32_16x16x32_bf16 v[32:35], v[184:187], a[4:7], v[32:35]
  buffer_load_dwordx4 v194, s[28:31], s51 offen offset:0 lds
  v_mfma_f32_16x16x32_bf16 v[52:55], v[184:187], a[8:11], 0
  buffer_load_dwordx4 v195, s[28:31], s51 offen offset:1024 lds
  v_mfma_f32_16x16x32_bf16 v[52:55], v[188:191], a[20:23], v[52:55]
  s_waitcnt lgkmcnt(4)
  v_mfma_f32_16x16x32_bf16 v[16:19], a[240:243], a[0:3], 0
  ds_read_b64_tr_b16 v[184:185], v192 offset:10240
  ds_read_b64_tr_b16 v[186:187], v192 offset:11520
  v_mfma_f32_16x16x32_bf16 v[16:19], a[244:247], a[12:15], v[16:19]
  buffer_load_dwordx4 v196, s[28:31], s51 offen offset:2048 lds
  v_mfma_f32_16x16x32_bf16 v[36:39], a[244:247], a[16:19], 0
  ds_read_b64_tr_b16 v[188:189], v192 offset:15360
  ds_read_b64_tr_b16 v[190:191], v192 offset:16640
  v_mfma_f32_16x16x32_bf16 v[36:39], a[240:243], a[4:7], v[36:39]
  buffer_load_dwordx4 v197, s[28:31], s51 offen offset:3072 lds
  v_mfma_f32_16x16x32_bf16 v[56:59], a[240:243], a[8:11], 0
  s_add_u32 m0, s50, 24576
  v_mfma_f32_16x16x32_bf16 v[56:59], a[244:247], a[20:23], v[56:59]
  s_waitcnt lgkmcnt(4)
  buffer_load_dwordx4 v198, s[28:31], s51 offen offset:0 lds
  v_mfma_f32_16x16x32_bf16 v[20:23], a[248:251], a[0:3], 0
  ds_read_b64_tr_b16 a[240:241], v192 offset:10272
  ds_read_b64_tr_b16 a[242:243], v192 offset:11552
  v_mfma_f32_16x16x32_bf16 v[20:23], a[252:255], a[12:15], v[20:23]
  s_cmp_eq_u32 s67, 0
  s_cbranch_scc1 ARP0
ARPB0:
  s_bfe_u32 s49, s60, 0x40008
  s_add_u32 m0, s48, 12672
  v_mfma_f32_16x16x32_bf16 v[40:43], a[252:255], a[16:19], 0
  s_lshl_b32 s49, s49, 7
  ds_read_b64_tr_b16 a[244:245], v192 offset:15392
  ds_read_b64_tr_b16 a[246:247], v192 offset:16672
  v_mfma_f32_16x16x32_bf16 v[40:43], a[248:251], a[4:7], v[40:43]
  buffer_load_dwordx4 v238, s[24:27], s49 offen offset:0 lds
  v_mfma_f32_16x16x32_bf16 v[60:63], a[248:251], a[8:11], 0
  buffer_load_dwordx4 v239, s[24:27], s49 offen offset:1024 lds
  v_mfma_f32_16x16x32_bf16 v[60:63], a[252:255], a[20:23], v[60:63]
  s_waitcnt lgkmcnt(4)
  buffer_load_dwordx4 v240, s[24:27], s49 offen offset:2048 lds
  v_mfma_f32_16x16x32_bf16 v[64:67], v[184:187], a[0:3], 0
  ds_read_b64_tr_b16 a[248:249], v192 offset:10304
  ds_read_b64_tr_b16 a[250:251], v192 offset:11584
  v_mfma_f32_16x16x32_bf16 v[64:67], v[188:191], a[12:15], v[64:67]
  buffer_load_dwordx4 v241, s[24:27], s49 offen offset:3072 lds
  v_mfma_f32_16x16x32_bf16 v[84:87], v[188:191], a[16:19], 0
  s_add_u32 m0, s48, 16768
  ds_read_b64_tr_b16 a[252:253], v192 offset:15424
  ds_read_b64_tr_b16 a[254:255], v192 offset:16704
  v_mfma_f32_16x16x32_bf16 v[84:87], v[184:187], a[4:7], v[84:87]
  buffer_load_dwordx4 v242, s[24:27], s49 offen offset:0 lds
  v_mfma_f32_16x16x32_bf16 v[104:107], v[184:187], a[8:11], 0
  buffer_load_dwordx4 v243, s[24:27], s49 offen offset:1024 lds
  v_mfma_f32_16x16x32_bf16 v[104:107], v[188:191], a[20:23], v[104:107]
  s_waitcnt lgkmcnt(4)
  s_bfe_u32 s51, s60, 0x40008
  s_mul_i32 s51, s51, 245760
  v_mfma_f32_16x16x32_bf16 v[68:71], a[240:243], a[0:3], 0
  s_add_u32 m0, s50, 40960
  ds_read_b64_tr_b16 v[184:185], v192 offset:10336
  ds_read_b64_tr_b16 v[186:187], v192 offset:11616
  v_mfma_f32_16x16x32_bf16 v[68:71], a[244:247], a[12:15], v[68:71]
  s_add_u32 s51, s51, s52
  v_mfma_f32_16x16x32_bf16 v[88:91], a[244:247], a[16:19], 0
  ds_read_b64_tr_b16 v[188:189], v192 offset:15456
  ds_read_b64_tr_b16 v[190:191], v192 offset:16736
  v_mfma_f32_16x16x32_bf16 v[88:91], a[240:243], a[4:7], v[88:91]
  buffer_load_dwordx4 v194, s[28:31], s51 offen offset:0 lds
  v_mfma_f32_16x16x32_bf16 v[108:111], a[240:243], a[8:11], 0
  buffer_load_dwordx4 v195, s[28:31], s51 offen offset:1024 lds
  v_mfma_f32_16x16x32_bf16 v[108:111], a[244:247], a[20:23], v[108:111]
  s_waitcnt lgkmcnt(4)
  buffer_load_dwordx4 v196, s[28:31], s51 offen offset:2048 lds
  v_mfma_f32_16x16x32_bf16 v[72:75], a[248:251], a[0:3], 0
  ds_read_b64_tr_b16 a[240:241], v192 offset:10368
  ds_read_b64_tr_b16 a[242:243], v192 offset:11648
  v_mfma_f32_16x16x32_bf16 v[72:75], a[252:255], a[12:15], v[72:75]
  s_waitcnt vmcnt(14)
  ds_read_b128 a[24:27], v244 offset:6272
  v_mfma_f32_16x16x32_bf16 v[92:95], a[252:255], a[16:19], 0
  ds_read_b64_tr_b16 a[244:245], v192 offset:15488
  ds_read_b64_tr_b16 a[246:247], v192 offset:16768
  s_mov_b32 s55, 1664525
  v_lshlrev_b32 v140, 16, v124
  v_and_b32 v141, 0xffff0000, v124
  v_lshlrev_b32 v142, 16, v125
  v_and_b32 v143, 0xffff0000, v125
  v_lshlrev_b32 v144, 16, v126
  v_and_b32 v145, 0xffff0000, v126
  v_lshlrev_b32 v146, 16, v127
  v_and_b32 v147, 0xffff0000, v127
  v_lshlrev_b32 v148, 16, v128
  v_and_b32 v149, 0xffff0000, v128
  v_lshlrev_b32 v150, 16, v129
  v_and_b32 v151, 0xffff0000, v129
  v_lshlrev_b32 v152, 16, v130
  v_and_b32 v153, 0xffff0000, v130
  v_lshlrev_b32 v154, 16, v131
  v_and_b32 v155, 0xffff0000, v131
  v_lshlrev_b32 v156, 16, v132
  v_and_b32 v157, 0xffff0000, v132
  v_lshlrev_b32 v158, 16, v133
  v_mfma_f32_16x16x32_bf16 v[92:95], a[248:251], a[4:7], v[92:95]
  buffer_load_dwordx4 v197, s[28:31], s51 offen offset:3072 lds
  s_add_u32 m0, s50, 45056
  s_nop 0
  buffer_load_dwordx4 v198, s[28:31], s51 offen offset:0 lds
  v_mfma_f32_16x16x32_bf16 v[112:115], a[248:251], a[8:11], 0
  s_waitcnt vmcnt(11)
  ds_read_b128 a[28:31], v244 offset:8320
  v_mfma_f32_16x16x32_bf16 v[112:115], a[252:255], a[20:23], v[112:115]
  s_waitcnt lgkmcnt(6)
  ds_read_b128 a[32:35], v244 offset:10368
  v_mfma_f32_16x16x32_bf16 v[76:79], v[184:187], a[0:3], 0
  s_barrier
  ds_read_b64_tr_b16 a[248:249], v192 offset:20480
  ds_read_b64_tr_b16 a[250:251], v192 offset:21760
  v_mfma_f32_16x16x32_bf16 v[76:79], v[188:191], a[12:15], v[76:79]
  s_cmp_eq_u32 s67, 1
  s_cbranch_scc1 ARP1
ARPB1:
  ds_read_b128 a[36:39], v245 offset:6272
  v_mfma_f32_16x16x32_bf16 v[96:99], v[188:191], a[16:19], 0
  s_bfe_u32 s49, s60, 0x4000c
  ds_read_b64_tr_b16 a[252:253], v192 offset:25600
  ds_read_b64_tr_b16 a[254:255], v192 offset:26880
  v_mfma_f32_16x16x32_bf16 v[96:99], v[184:187], a[4:7], v[96:99]
  s_add_u32 m0, s48, 128
  ds_read_b128 a[40:43], v245 offset:8320
  s_lshl_b32 s49, s49, 7
  v_mfma_f32_16x16x32_bf16 v[116:119], v[184:187], a[8:11], 0
  buffer_load_dwordx4 v238, s[24:27], s49 offen offset:0 lds
  v_mfma_f32_16x16x32_bf16 v[116:119], v[188:191], a[20:23], v[116:119]
  s_waitcnt lgkmcnt(8)
  ds_read_b128 a[44:47], v245 offset:10368
  v_mfma_f32_16x16x32_bf16 v[80:83], a[240:243], a[0:3], 0
  ds_read_b64_tr_b16 v[184:185], v192 offset:20512
  ds_read_b64_tr_b16 v[186:187], v192 offset:21792
  v_mfma_f32_16x16x32_bf16 v[80:83], a[244:247], a[12:15], v[80:83]
  buffer_load_dwordx4 v239, s[24:27], s49 offen offset:1024 lds
  v_mfma_f32_16x16x32_bf16 v[100:103], a[244:247], a[16:19], 0
  ds_read_b64_tr_b16 v[188:189], v192 offset:25632
  ds_read_b64_tr_b16 v[190:191], v192 offset:26912
  v_and_b32 v159, 0xffff0000, v133
  v_lshlrev_b32 v160, 16, v134
  v_and_b32 v161, 0xffff0000, v134
  v_lshlrev_b32 v162, 16, v135
  v_and_b32 v163, 0xffff0000, v135
  v_pk_add_f32 v[164:165], v[140:141], v[142:143]
  v_pk_add_f32 v[166:167], v[144:145], v[146:147]
  v_pk_add_f32 v[164:165], v[164:165], v[148:149]
  v_pk_add_f32 v[166:167], v[166:167], v[150:151]
  v_pk_add_f32 v[164:165], v[164:165], v[152:153]
  v_pk_add_f32 v[166:167], v[166:167], v[154:155]
  v_pk_add_f32 v[164:165], v[164:165], v[156:157]
  v_pk_add_f32 v[166:167], v[166:167], v[158:159]
  v_pk_add_f32 v[164:165], v[164:165], v[160:161]
  v_pk_add_f32 v[166:167], v[166:167], v[162:163]
  v_pk_add_f32 v[164:165], v[164:165], v[166:167]
  v_add_f32 v164, v164, v165
  s_nop 1
  v_add_f32_dpp v164, v164, v164 quad_perm:[1,0,3,2] row_mask:0xf bank_mask:0xf
  s_nop 1
  v_add_f32_dpp v164, v164, v164 quad_perm:[2,3,0,1] row_mask:0xf bank_mask:0xf
  s_nop 1
  v_add_f32_dpp v164, v164, v164 row_half_mirror row_mask:0xf bank_mask:0xf
  s_nop 1
  v_add_f32_dpp v164, v164, v164 row_mirror row_mask:0xf bank_mask:0xf
  v_mfma_f32_16x16x32_bf16 v[100:103], a[240:243], a[4:7], v[100:103]
  v_mfma_f32_16x16x32_bf16 v[120:123], a[240:243], a[8:11], 0
  v_mfma_f32_16x16x32_bf16 v[120:123], a[244:247], a[20:23], v[120:123]
  s_waitcnt lgkmcnt(4)
  buffer_load_dwordx4 v240, s[24:27], s49 offen offset:2048 lds
  v_mfma_f32_16x16x32_bf16 v[4:7], a[248:251], a[24:27], v[4:7]
  ds_read_b64_tr_b16 a[240:241], v192 offset:20544
  ds_read_b64_tr_b16 a[242:243], v192 offset:21824
  v_mfma_f32_16x16x32_bf16 v[4:7], a[252:255], a[36:39], v[4:7]
  v_mfma_f32_16x16x32_bf16 v[24:27], a[252:255], a[40:43], v[24:27]
  ds_read_b64_tr_b16 a[244:245], v192 offset:25664
  ds_read_b64_tr_b16 a[246:247], v192 offset:26944
  v_mfma_f32_16x16x32_bf16 v[24:27], a[248:251], a[28:31], v[24:27]
  v_mfma_f32_16x16x32_bf16 v[44:47], a[248:251], a[32:35], v[44:47]
  buffer_load_dwordx4 v241, s[24:27], s49 offen offset:3072 lds
  v_mfma_f32_16x16x32_bf16 v[44:47], a[252:255], a[44:47], v[44:47]
  s_waitcnt lgkmcnt(4)
  v_mfma_f32_16x16x32_bf16 v[8:11], v[184:187], a[24:27], v[8:11]
  ds_read_b64_tr_b16 a[248:249], v192 offset:20576
  ds_read_b64_tr_b16 a[250:251], v192 offset:21856
  v_mfma_f32_16x16x32_bf16 v[8:11], v[188:191], a[36:39], v[8:11]
  s_add_u32 m0, s48, 4224
  v_mfma_f32_16x16x32_bf16 v[28:31], v[188:191], a[40:43], v[28:31]
  ds_read_b64_tr_b16 a[252:253], v192 offset:25696
  ds_read_b64_tr_b16 a[254:255], v192 offset:26976
  v_mov_b32 v139, v164
  v_mul_lo_u32 v249, v249, s55
  v_and_b32 v137, 16, v0
  v_permlane16_swap_b32 v164, v139
  v_add_f32 v164, v164, v139
  v_add_u32 v249, 1013904223, v249
  v_cmp_eq_u32 vcc, 0, v137
  v_and_b32 v137, 1, v138
  v_lshrrev_b32 v138, 1, v138
  v_lshl_add_u32 v138, v137, 10, v138
  v_lshlrev_b32 v138, 4, v138
  v_mul_f32 v164, 0xbacccccd, v164
  v_pk_add_f32 v[140:141], v[140:141], v[164:165] op_sel_hi:[1,0]
  v_pk_add_f32 v[142:143], v[142:143], v[164:165] op_sel_hi:[1,0]
  v_pk_add_f32 v[144:145], v[144:145], v[164:165] op_sel_hi:[1,0]
  v_pk_add_f32 v[146:147], v[146:147], v[164:165] op_sel_hi:[1,0]
  v_pk_add_f32 v[148:149], v[148:149], v[164:165] op_sel_hi:[1,0]
  v_pk_add_f32 v[150:151], v[150:151], v[164:165] op_sel_hi:[1,0]
  v_pk_add_f32 v[152:153], v[152:153], v[164:165] op_sel_hi:[1,0]
  v_pk_add_f32 v[154:155], v[154:155], v[164:165] op_sel_hi:[1,0]
  v_cndmask_b32 v165, 0, v164, vcc
  v_mfma_f32_16x16x32_bf16 v[28:31], v[184:187], a[28:31], v[28:31]
  buffer_load_dwordx4 v242, s[24:27], s49 offen offset:0 lds
  v_mfma_f32_16x16x32_bf16 v[48:51], v[184:187], a[32:35], v[48:51]
  v_mfma_f32_16x16x32_bf16 v[48:51], v[188:191], a[44:47], v[48:51]
  s_waitcnt lgkmcnt(4)
  v_mfma_f32_16x16x32_bf16 v[12:15], a[240:243], a[24:27], v[12:15]
  ds_read_b64_tr_b16 v[184:185], v192 offset:20608
  ds_read_b64_tr_b16 v[186:187], v192 offset:21888
  v_mfma_f32_16x16x32_bf16 v[12:15], a[244:247], a[36:39], v[12:15]
  v_mfma_f32_16x16x32_bf16 v[32:35], a[244:247], a[40:43], v[32:35]
  ds_read_b64_tr_b16 v[188:189], v192 offset:25728
  ds_read_b64_tr_b16 v[190:191], v192 offset:27008
  v_mfma_f32_16x16x32_bf16 v[32:35], a[240:243], a[28:31], v[32:35]
  buffer_load_dwordx4 v243, s[24:27], s49 offen offset:1024 lds
  v_mfma_f32_16x16x32_bf16 v[52:55], a[240:243], a[32:35], v[52:55]
  v_mfma_f32_16x16x32_bf16 v[52:55], a[244:247], a[44:47], v[52:55]
  s_waitcnt lgkmcnt(4)
  v_mfma_f32_16x16x32_bf16 v[16:19], a[248:251], a[24:27], v[16:19]
  s_bfe_u32 s51, s60, 0x4000c
  ds_read_b64_tr_b16 a[240:241], v192 offset:30720
  ds_read_b64_tr_b16 a[242:243], v192 offset:32000
  v_mfma_f32_16x16x32_bf16 v[16:19], a[252:255], a[36:39], v[16:19]
  s_mul_i32 s51, s51, 245760
  s_add_u32 m0, s50, 61440
  s_add_u32 s51, s51, s52
  v_mfma_f32_16x16x32_bf16 v[36:39], a[252:255], a[40:43], v[36:39]
  ds_read_b64_tr_b16 a[244:245], v192 offset:35840
  ds_read_b64_tr_b16 a[246:247], v192 offset:37120
  v_pk_add_f32 v[156:157], v[156:157], v[164:165] op_sel:[0,1] op_sel_hi:[1,1]
  v_pk_add_f32 v[158:159], v[158:159], v[164:165] op_sel:[0,1] op_sel_hi:[1,1]
  v_pk_add_f32 v[160:161], v[160:161], v[164:165] op_sel:[0,1] op_sel_hi:[1,1]
  v_pk_add_f32 v[162:163], v[162:163], v[164:165] op_sel:[0,1] op_sel_hi:[1,1]
  v_pk_mul_f32 v[166:167], v[140:141], v[140:141]
  v_pk_fma_f32 v[166:167], v[142:143], v[142:143], v[166:167]
  v_pk_fma_f32 v[166:167], v[144:145], v[144:145], v[166:167]
  v_pk_fma_f32 v[166:167], v[146:147], v[146:147], v[166:167]
  v_pk_fma_f32 v[166:167], v[148:149], v[148:149], v[166:167]
  v_pk_fma_f32 v[166:167], v[150:151], v[150:151], v[166:167]
  v_pk_fma_f32 v[166:167], v[152:153], v[152:153], v[166:167]
  v_pk_fma_f32 v[166:167], v[154:155], v[154:155], v[166:167]
  v_pk_fma_f32 v[166:167], v[156:157], v[156:157], v[166:167]
  v_pk_fma_f32 v[166:167], v[158:159], v[158:159], v[166:167]
  v_pk_fma_f32 v[166:167], v[160:161], v[160:161], v[166:167]
  v_pk_fma_f32 v[166:167], v[162:163], v[162:163], v[166:167]
  v_add_f32 v166, v166, v167
  s_nop 1
  v_add_f32_dpp v166, v166, v166 quad_perm:[1,0,3,2] row_mask:0xf bank_mask:0xf
  s_nop 1
  v_add_f32_dpp v166, v166, v166 quad_perm:[2,3,0,1] row_mask:0xf bank_mask:0xf
  s_nop 1
  v_add_f32_dpp v166, v166, v166 row_half_mirror row_mask:0xf bank_mask:0xf
  s_nop 1
  v_add_f32_dpp v166, v166, v166 row_mirror row_mask:0xf bank_mask:0xf
  v_mfma_f32_16x16x32_bf16 v[36:39], a[248:251], a[28:31], v[36:39]
  buffer_load_dwordx4 v194, s[28:31], s51 offen offset:0 lds
  v_mfma_f32_16x16x32_bf16 v[56:59], a[248:251], a[32:35], v[56:59]
  v_mfma_f32_16x16x32_bf16 v[56:59], a[252:255], a[44:47], v[56:59]
  s_waitcnt lgkmcnt(4)
  v_mfma_f32_16x16x32_bf16 v[20:23], v[184:187], a[24:27], v[20:23]
  ds_read_b64_tr_b16 a[248:249], v192 offset:30752
  ds_read_b64_tr_b16 a[250:251], v192 offset:32032
  v_mfma_f32_16x16x32_bf16 v[20:23], v[188:191], a[36:39], v[20:23]
  buffer_load_dwordx4 v195, s[28:31], s51 offen offset:1024 lds
  v_mfma_f32_16x16x32_bf16 v[40:43], v[188:191], a[40:43], v[40:43]
  ds_read_b64_tr_b16 a[252:253], v192 offset:35872
  ds_read_b64_tr_b16 a[254:255], v192 offset:37152
  v_mfma_f32_16x16x32_bf16 v[40:43], v[184:187], a[28:31], v[40:43]
  v_mfma_f32_16x16x32_bf16 v[60:63], v[184:187], a[32:35], v[60:63]
  v_mfma_f32_16x16x32_bf16 v[60:63], v[188:191], a[44:47], v[60:63]
  s_waitcnt lgkmcnt(4)
  v_mfma_f32_16x16x32_bf16 v[64:67], a[240:243], a[24:27], v[64:67]
  ds_read_b64_tr_b16 v[184:185], v192 offset:30784
  ds_read_b64_tr_b16 v[186:187], v192 offset:32064
  v_mfma_f32_16x16x32_bf16 v[64:67], a[244:247], a[36:39], v[64:67]
  buffer_load_dwordx4 v196, s[28:31], s51 offen offset:2048 lds
  v_mfma_f32_16x16x32_bf16 v[84:87], a[244:247], a[40:43], v[84:87]
  ds_read_b64_tr_b16 v[188:189], v192 offset:35904
  ds_read_b64_tr_b16 v[190:191], v192 offset:37184
  v_mov_b32 v139, v166
  v_cvt_pk_bf16_f32 v164, v164, v164
  v_and_b32 v137, 31, v0
  v_permlane16_swap_b32 v166, v139
  v_add_f32 v166, v166, v139
  v_lshlrev_b32 v124, 16, v164
  v_lshl_add_u32 v138, v137, 25, v138
  v_mov_b32 v125, v249
  v_add_u32 v138, 4096, v138
  v_mul_f32 v166, 0x3acccccd, v166
  v_cvt_pk_bf16_f32 v166, v166, v166
  v_lshlrev_b32 v166, 16, v166
  v_add_f32 v166, 0x3727c5ac, v166
  v_cvt_pk_bf16_f32 v166, v166, v166
  v_lshlrev_b32 v166, 16, v166
  v_sqrt_f32 v166, v166
  v_mov_b32 v127, v249
  v_cvt_pk_bf16_f32 v166, v166, v166
  v_lshlrev_b32 v126, 16, v166
  buffer_store_dwordx4 v[124:127], v138, s[36:39], 0 offen sc1
  s_mul_i32 s70, s70, 20480
  v_mfma_f32_16x16x32_bf16 v[84:87], a[240:243], a[28:31], v[84:87]
  v_mfma_f32_16x16x32_bf16 v[104:107], a[240:243], a[32:35], v[104:107]
  v_mfma_f32_16x16x32_bf16 v[104:107], a[244:247], a[44:47], v[104:107]
  s_waitcnt lgkmcnt(4)
  buffer_load_dwordx4 v197, s[28:31], s51 offen offset:3072 lds
  v_mfma_f32_16x16x32_bf16 v[68:71], a[248:251], a[24:27], v[68:71]
  ds_read_b64_tr_b16 a[240:241], v192 offset:30816
  ds_read_b64_tr_b16 a[242:243], v192 offset:32096
  v_mfma_f32_16x16x32_bf16 v[68:71], a[252:255], a[36:39], v[68:71]
  v_mfma_f32_16x16x32_bf16 v[88:91], a[252:255], a[40:43], v[88:91]
  s_mov_b64 exec, 0
  s_cmp_lt_u32 s44, 1
  s_cbranch_scc1 AHOP0
  s_cmp_lt_u32 s44, 2
  s_cbranch_scc1 AHOP1
  s_cmp_lt_u32 s44, 3
  s_cbranch_scc1 AHOP2
  s_branch AHOP3
AHRET:
  s_mov_b64 exec, -1
  ds_read_b64_tr_b16 a[244:245], v192 offset:35936
  ds_read_b64_tr_b16 a[246:247], v192 offset:37216
  v_mfma_f32_16x16x32_bf16 v[88:91], a[248:251], a[28:31], v[88:91]
  s_add_u32 m0, s50, 65536
  v_mfma_f32_16x16x32_bf16 v[108:111], a[248:251], a[32:35], v[108:111]
  buffer_load_dwordx4 v198, s[28:31], s51 offen offset:0 lds
  v_mfma_f32_16x16x32_bf16 v[108:111], a[252:255], a[44:47], v[108:111]
  s_waitcnt lgkmcnt(4)
  v_mfma_f32_16x16x32_bf16 v[72:75], v[184:187], a[24:27], v[72:75]
  ds_read_b64_tr_b16 a[248:249], v192 offset:30848
  ds_read_b64_tr_b16 a[250:251], v192 offset:32128
  v_mfma_f32_16x16x32_bf16 v[72:75], v[188:191], a[36:39], v[72:75]
  s_waitcnt vmcnt(17)
  ds_read_b128 a[48:51], v244 offset:12544
  v_mfma_f32_16x16x32_bf16 v[92:95], v[188:191], a[40:43], v[92:95]
  s_mul_i32 s55, s46, 4849664
  ds_read_b64_tr_b16 a[252:253], v192 offset:35968
  ds_read_b64_tr_b16 a[254:255], v192 offset:37248
  s_add_u32 s70, s70, s55
  s_add_u32 s70, s70, 0x136000
  s_and_b32 s56, s54, 1
  s_lshl_b32 s57, s56, 9
  s_add_u32 s72, s70, 16384
  s_add_u32 s72, s72, s57
  s_lshl_b32 s56, s56, 13
  s_add_u32 s70, s70, s56
  s_add_u32 s71, s70, 4096
  s_lshl_b32 s55, s54, 6
  s_mul_i32 s56, s46, 24
  s_add_u32 s55, s55, s56
  s_lshl_b32 s56, s53, 2
  s_add_u32 s55, s55, s56
  s_add_u32 s55, s55, s44
  s_lshl_b32 s55, s55, 6
  s_add_u32 s55, s55, 0xa0000
  s_mov_b32 s63, 0
  v_lshrrev_b32 v250, 4, v0
  v_lshlrev_b32 v250, 22, v250
  v_mfma_f32_16x16x32_bf16 v[92:95], v[184:187], a[28:31], v[92:95]
  ds_read_b128 a[52:55], v244 offset:14592
  v_mfma_f32_16x16x32_bf16 v[112:115], v[184:187], a[32:35], v[112:115]
  s_waitcnt vmcnt(12)
  v_mfma_f32_16x16x32_bf16 v[112:115], v[188:191], a[44:47], v[112:115]
  s_waitcnt lgkmcnt(6)
  ds_read_b128 a[56:59], v244 offset:16640
  v_mfma_f32_16x16x32_bf16 v[76:79], a[240:243], a[24:27], v[76:79]
  s_barrier
  ds_read_b64_tr_b16 v[184:185], v193 offset:0
  ds_read_b64_tr_b16 v[186:187], v193 offset:1280
  v_mfma_f32_16x16x32_bf16 v[76:79], a[244:247], a[36:39], v[76:79]
  s_cmp_eq_u32 s67, 2
  s_cbranch_scc1 ARP2
ARPB2:
  ds_read_b128 a[60:63], v245 offset:12544
  v_mfma_f32_16x16x32_bf16 v[96:99], a[244:247], a[40:43], v[96:99]
  s_bfe_u32 s49, s60, 0x40010
  ds_read_b64_tr_b16 v[188:189], v193 offset:5120
  ds_read_b64_tr_b16 v[190:191], v193 offset:6400
  v_mfma_f32_16x16x32_bf16 v[96:99], a[240:243], a[28:31], v[96:99]
  s_add_u32 m0, s48, 6400
  ds_read_b128 a[64:67], v245 offset:14592
  s_lshl_b32 s49, s49, 7
  v_mfma_f32_16x16x32_bf16 v[116:119], a[240:243], a[32:35], v[116:119]
  buffer_load_dwordx4 v238, s[24:27], s49 offen offset:0 lds
  v_mfma_f32_16x16x32_bf16 v[116:119], a[244:247], a[44:47], v[116:119]
  s_waitcnt lgkmcnt(8)
  ds_read_b128 a[68:71], v245 offset:16640
  v_mfma_f32_16x16x32_bf16 v[80:83], a[248:251], a[24:27], v[80:83]
  ds_read_b64_tr_b16 a[240:241], v193 offset:32
  ds_read_b64_tr_b16 a[242:243], v193 offset:1312
  v_mfma_f32_16x16x32_bf16 v[80:83], a[252:255], a[36:39], v[80:83]
  buffer_load_dwordx4 v239, s[24:27], s49 offen offset:1024 lds
  v_mfma_f32_16x16x32_bf16 v[100:103], a[252:255], a[40:43], v[100:103]
  ds_read_b64_tr_b16 a[244:245], v193 offset:5152
  ds_read_b64_tr_b16 a[246:247], v193 offset:6432
  v_add_lshl_u32 v250, v250, v0, 2
  v_add_u32 v250, s55, v250
  s_mov_b32 s82, 0x0
  s_mov_b32 s83, 0xff000f
  s_mov_b32 s84, 0x10000
  s_mov_b32 s85, 0x1f
  s_mov_b32 s86, 0x30000
  s_mov_b32 s87, 0x3f
  s_mov_b32 s88, 0x70000
AHOP0:
  s_cbranch_execz AHOP4
  s_mov_b32 s89, 0x7f
  s_mov_b32 s90, 0x0
  s_mov_b32 s91, 0xf0000
  s_mov_b32 s92, 0x0
  s_mov_b32 s93, 0x1f0001
  s_mov_b32 s94, 0x0
  s_mov_b32 s95, 0x3f0003
  s_mov_b32 s96, 0x0
  s_mov_b32 s97, 0x7f0007
  s_mov_b32 s76, 0xffff
  s_mov_b32 s77, 0x0
  s_mov_b32 s78, 0xffffffff
  v_mfma_f32_16x16x32_bf16 v[100:103], a[248:251], a[28:31], v[100:103]
  v_mfma_f32_16x16x32_bf16 v[120:123], a[248:251], a[32:35], v[120:123]
  v_mfma_f32_16x16x32_bf16 v[120:123], a[252:255], a[44:47], v[120:123]
  s_waitcnt lgkmcnt(4)
  buffer_load_dwordx4 v240, s[24:27], s49 offen offset:2048 lds
  v_mfma_f32_16x16x32_bf16 v[4:7], v[184:187], a[48:51], v[4:7]
  ds_read_b64_tr_b16 a[248:249], v193 offset:64
  ds_read_b64_tr_b16 a[250:251], v193 offset:1344
  v_mfma_f32_16x16x32_bf16 v[4:7], v[188:191], a[60:63], v[4:7]
  v_mfma_f32_16x16x32_bf16 v[24:27], v[188:191], a[64:67], v[24:27]
  ds_read_b64_tr_b16 a[252:253], v193 offset:5184
  ds_read_b64_tr_b16 a[254:255], v193 offset:6464
  v_mfma_f32_16x16x32_bf16 v[24:27], v[184:187], a[52:55], v[24:27]
  v_mfma_f32_16x16x32_bf16 v[44:47], v[184:187], a[56:59], v[44:47]
  buffer_load_dwordx4 v241, s[24:27], s49 offen offset:3072 lds
  v_mfma_f32_16x16x32_bf16 v[44:47], v[188:191], a[68:71], v[44:47]
  s_waitcnt lgkmcnt(4)
  v_mfma_f32_16x16x32_bf16 v[8:11], a[240:243], a[48:51], v[8:11]
  ds_read_b64_tr_b16 v[184:185], v193 offset:96
  ds_read_b64_tr_b16 v[186:187], v193 offset:1376
  v_mfma_f32_16x16x32_bf16 v[8:11], a[244:247], a[60:63], v[8:11]
  s_add_u32 m0, s48, 10496
  v_mfma_f32_16x16x32_bf16 v[28:31], a[244:247], a[64:67], v[28:31]
  s_mov_b32 s79, 0x0
  ds_read_b64_tr_b16 v[188:189], v193 offset:5216
  ds_read_b64_tr_b16 v[190:191], v193 offset:6496
  s_mov_b32 s80, 0xffffffff
  s_mov_b32 s81, 0xffff
  v_mov_b32 v168, 0xffff
  v_mov_b32 v169, 0xffff0000
  v_cndmask_b32 v206, 0, v168, s[82:83]
  v_cndmask_b32 v170, 0, v169, s[84:85]
  v_or_b32 v206, v206, v170
  v_cndmask_b32 v207, 0, v168, s[86:87]
  v_cndmask_b32 v170, 0, v169, s[88:89]
  v_or_b32 v207, v207, v170
  v_cndmask_b32 v208, 0, v168, s[90:91]
  v_cndmask_b32 v170, 0, v169, s[92:93]
  v_or_b32 v208, v208, v170
  v_cndmask_b32 v209, 0, v168, s[94:95]
  v_cndmask_b32 v170, 0, v169, s[96:97]
  v_or_b32 v209, v209, v170
  v_lshlrev_b32 v248, 4, v0
  s_bfe_u32 s55, s2, 0x30003
  s_mul_i32 s56, s55, 378880
  s_add_u32 s56, s56, 0xb00000
  v_mfma_f32_16x16x32_bf16 v[28:31], a[240:243], a[52:55], v[28:31]
  buffer_load_dwordx4 v242, s[24:27], s49 offen offset:0 lds
  v_mfma_f32_16x16x32_bf16 v[48:51], a[240:243], a[56:59], v[48:51]
  v_mfma_f32_16x16x32_bf16 v[48:51], a[244:247], a[68:71], v[48:51]
  s_waitcnt lgkmcnt(4)
  v_mfma_f32_16x16x32_bf16 v[12:15], a[248:251], a[48:51], v[12:15]
  ds_read_b64_tr_b16 a[240:241], v193 offset:128
  ds_read_b64_tr_b16 a[242:243], v193 offset:1408
  v_mfma_f32_16x16x32_bf16 v[12:15], a[252:255], a[60:63], v[12:15]
  v_mfma_f32_16x16x32_bf16 v[32:35], a[252:255], a[64:67], v[32:35]
  ds_read_b64_tr_b16 a[244:245], v193 offset:5248
  ds_read_b64_tr_b16 a[246:247], v193 offset:6528
  v_mfma_f32_16x16x32_bf16 v[32:35], a[248:251], a[52:55], v[32:35]
  buffer_load_dwordx4 v243, s[24:27], s49 offen offset:1024 lds
  v_mfma_f32_16x16x32_bf16 v[52:55], a[248:251], a[56:59], v[52:55]
  v_mfma_f32_16x16x32_bf16 v[52:55], a[252:255], a[68:71], v[52:55]
  s_waitcnt lgkmcnt(4)
  v_mfma_f32_16x16x32_bf16 v[16:19], v[184:187], a[48:51], v[16:19]
  s_bfe_u32 s51, s60, 0x40010
  ds_read_b64_tr_b16 a[248:249], v193 offset:10240
  ds_read_b64_tr_b16 a[250:251], v193 offset:11520
  v_mfma_f32_16x16x32_bf16 v[16:19], v[188:191], a[60:63], v[16:19]
  s_mul_i32 s51, s51, 245760
  s_add_u32 m0, s50, 0
  s_add_u32 s51, s51, s52
  v_mfma_f32_16x16x32_bf16 v[36:39], v[188:191], a[64:67], v[36:39]
  s_mul_i32 s57, s44, 7
  ds_read_b64_tr_b16 a[252:253], v193 offset:15360
  ds_read_b64_tr_b16 a[254:255], v193 offset:16640
  s_mul_i32 s64, s57, 5120
  s_add_u32 s64, s64, s56
  s_mul_i32 s58, s44, 6
  s_mul_i32 s65, s58, 5120
  s_add_u32 s65, s65, s56
  s_add_u32 s65, s65, 143360
  s_mul_i32 s66, s44, 25600
  s_add_u32 s66, s66, s56
  s_add_u32 s66, s66, 276480
  s_mul_i32 s55, s55, 5
  s_lshr_b32 s55, s55, 2
  v_lshrrev_b32 v168, 1, v0
  v_min_u32 v168, 13, v168
  s_and_b32 s56, s44, 1
  s_add_u32 s56, s56, 39
  v_mov_b32 v169, s56
  s_add_u32 s56, s58, 21
  v_mov_b32 v170, s56
  v_cmp_gt_u32 vcc, 13, v168
  s_nop 1
  v_cndmask_b32 v169, v169, v170, vcc
  v_mfma_f32_16x16x32_bf16 v[36:39], v[184:187], a[52:55], v[36:39]
  buffer_load_dwordx4 v194, s[28:31], s51 offen offset:0 lds
  v_mfma_f32_16x16x32_bf16 v[56:59], v[184:187], a[56:59], v[56:59]
  v_mfma_f32_16x16x32_bf16 v[56:59], v[188:191], a[68:71], v[56:59]
  s_waitcnt lgkmcnt(4)
  v_mfma_f32_16x16x32_bf16 v[20:23], a[240:243], a[48:51], v[20:23]
  ds_read_b64_tr_b16 v[184:185], v193 offset:10272
  ds_read_b64_tr_b16 v[186:187], v193 offset:11552
  v_mfma_f32_16x16x32_bf16 v[20:23], a[244:247], a[60:63], v[20:23]
  buffer_load_dwordx4 v195, s[28:31], s51 offen offset:1024 lds
  v_mfma_f32_16x16x32_bf16 v[40:43], a[244:247], a[64:67], v[40:43]
  ds_read_b64_tr_b16 v[188:189], v193 offset:15392
  ds_read_b64_tr_b16 v[190:191], v193 offset:16672
  v_mfma_f32_16x16x32_bf16 v[40:43], a[240:243], a[52:55], v[40:43]
  v_mfma_f32_16x16x32_bf16 v[60:63], a[240:243], a[56:59], v[60:63]
  v_mfma_f32_16x16x32_bf16 v[60:63], a[244:247], a[68:71], v[60:63]
  s_waitcnt lgkmcnt(4)
  v_mfma_f32_16x16x32_bf16 v[64:67], a[248:251], a[48:51], v[64:67]
  ds_read_b64_tr_b16 a[240:241], v193 offset:10304
  ds_read_b64_tr_b16 a[242:243], v193 offset:11584
  v_mfma_f32_16x16x32_bf16 v[64:67], a[252:255], a[60:63], v[64:67]
  buffer_load_dwordx4 v196, s[28:31], s51 offen offset:2048 lds
  v_mfma_f32_16x16x32_bf16 v[84:87], a[252:255], a[64:67], v[84:87]
  ds_read_b64_tr_b16 a[244:245], v193 offset:15424
  ds_read_b64_tr_b16 a[246:247], v193 offset:16704
  v_mov_b32 v170, s57
  v_cmp_gt_u32 vcc, 7, v168
  s_nop 1
  v_cndmask_b32 v169, v169, v170, vcc
  v_add_u32 v168, v168, v169
  v_and_b32 v169, 1, v0
  v_lshl_add_u32 v168, v168, 4, v169
  v_add_u32 v168, s55, v168
  v_lshlrev_b32 v168, 6, v168
  v_add_u32 v251, 0x10000, v168
  s_and_b32 s55, s2, 7
  s_and_b32 s62, s55, 3
  s_lshl_b32 s62, s62, 2
  s_lshr_b32 s62, 0x02103210, s62
  s_and_b32 s62, s62, 0xffff
  s_or_b32 s62, s62, 0x40000
  s_lshl_b32 s56, s55, 2
  s_lshr_b32 s56, 0x40840840, s56
  s_and_b32 s56, s56, 15
  s_lshr_b32 s69, 0x20420, s56
  s_and_b32 s69, s69, 0xfff
  s_bitcmp1_b32 s44, 0
  s_cselect_b32 s56, 0x111, 0
  s_mov_b32 s59, 0x3165316
  s_cselect_b32 s59, 0x4206420, s59
  v_mfma_f32_16x16x32_bf16 v[84:87], a[248:251], a[52:55], v[84:87]
  v_mfma_f32_16x16x32_bf16 v[104:107], a[248:251], a[56:59], v[104:107]
  v_mfma_f32_16x16x32_bf16 v[104:107], a[252:255], a[68:71], v[104:107]
  s_waitcnt lgkmcnt(4)
  buffer_load_dwordx4 v197, s[28:31], s51 offen offset:3072 lds
  v_mfma_f32_16x16x32_bf16 v[68:71], v[184:187], a[48:51], v[68:71]
  ds_read_b64_tr_b16 a[248:249], v193 offset:10336
  ds_read_b64_tr_b16 a[250:251], v193 offset:11616
  v_mfma_f32_16x16x32_bf16 v[68:71], v[188:191], a[60:63], v[68:71]
  v_mfma_f32_16x16x32_bf16 v[88:91], v[188:191], a[64:67], v[88:91]
  s_add_u32 m0, s50, 4096
  ds_read_b64_tr_b16 a[252:253], v193 offset:15456
  ds_read_b64_tr_b16 a[254:255], v193 offset:16736
  v_mfma_f32_16x16x32_bf16 v[88:91], v[184:187], a[52:55], v[88:91]
  v_mfma_f32_16x16x32_bf16 v[108:111], v[184:187], a[56:59], v[108:111]
  buffer_load_dwordx4 v198, s[28:31], s51 offen offset:0 lds
  v_mfma_f32_16x16x32_bf16 v[108:111], v[188:191], a[68:71], v[108:111]
  s_waitcnt lgkmcnt(4)
  v_mfma_f32_16x16x32_bf16 v[72:75], a[240:243], a[48:51], v[72:75]
  ds_read_b64_tr_b16 v[184:185], v193 offset:10368
  ds_read_b64_tr_b16 v[186:187], v193 offset:11648
  v_mfma_f32_16x16x32_bf16 v[72:75], a[244:247], a[60:63], v[72:75]
  s_waitcnt vmcnt(17)
  ds_read_b128 a[72:75], v244 offset:0
  v_mfma_f32_16x16x32_bf16 v[92:95], a[244:247], a[64:67], v[92:95]
  s_add_u32 s69, s69, s56
  ds_read_b64_tr_b16 v[188:189], v193 offset:15488
  ds_read_b64_tr_b16 v[190:191], v193 offset:16768
  s_and_b32 s56, s55, 3
  s_lshl_b32 s56, s56, 2
  s_lshr_b32 s59, s59, s56
  s_lshl_b32 s59, s59, 12
  s_or_b32 s69, s69, s59
  s_cmp_ge_u32 s55, 6
  s_cselect_b32 s56, 6, 0
  s_sub_u32 s55, s55, s56
  s_lshl_b32 s55, s55, 2
  s_lshr_b32 s23, 0x543210, s55
  s_sub_u32 s55, 24, s55
  s_lshl_b32 s55, 0x543210, s55
  s_or_b32 s23, s23, s55
  s_and_b32 s23, s23, 0xffffff
  s_and_b32 s55, s44, 1
  s_add_u32 s55, s55, 24
  s_sub_u32 s55, s55, s58
  s_lshl_b32 s55, s55, 24
  s_or_b32 s23, s23, s55
  s_mul_i32 s22, s44, 5120
  s_and_b32 s55, s2, 3
  v_mfma_f32_16x16x32_bf16 v[92:95], a[240:243], a[52:55], v[92:95]
  ds_read_b128 a[76:79], v244 offset:2048
  v_mfma_f32_16x16x32_bf16 v[112:115], a[240:243], a[56:59], v[112:115]
  s_waitcnt vmcnt(11)
  v_mfma_f32_16x16x32_bf16 v[112:115], a[244:247], a[68:71], v[112:115]
  s_waitcnt lgkmcnt(6)
  ds_read_b128 a[80:83], v244 offset:4096
  v_mfma_f32_16x16x32_bf16 v[76:79], a[248:251], a[48:51], v[76:79]
  s_barrier
  ds_read_b64_tr_b16 a[240:241], v193 offset:20480
  ds_read_b64_tr_b16 a[242:243], v193 offset:21760
  v_mfma_f32_16x16x32_bf16 v[76:79], a[252:255], a[60:63], v[76:79]
  s_cmp_eq_u32 s67, 3
  s_cbranch_scc1 ARP3
ARPB3:
  ds_read_b128 a[84:87], v245 offset:0
  v_mfma_f32_16x16x32_bf16 v[96:99], a[252:255], a[64:67], v[96:99]
  s_bfe_u32 s49, s60, 0x40014
  ds_read_b64_tr_b16 a[244:245], v193 offset:25600
  ds_read_b64_tr_b16 a[246:247], v193 offset:26880
  v_mfma_f32_16x16x32_bf16 v[96:99], a[248:251], a[52:55], v[96:99]
  s_add_u32 m0, s48, 12672
  ds_read_b128 a[88:91], v245 offset:2048
  s_lshl_b32 s49, s49, 7
  v_mfma_f32_16x16x32_bf16 v[116:119], a[248:251], a[56:59], v[116:119]
  buffer_load_dwordx4 v238, s[24:27], s49 offen offset:0 lds
  v_mfma_f32_16x16x32_bf16 v[116:119], a[252:255], a[68:71], v[116:119]
  s_waitcnt lgkmcnt(8)
  ds_read_b128 a[92:95], v245 offset:4096
  v_mfma_f32_16x16x32_bf16 v[80:83], v[184:187], a[48:51], v[80:83]
  ds_read_b64_tr_b16 a[248:249], v193 offset:20512
  ds_read_b64_tr_b16 a[250:251], v193 offset:21792
  v_mfma_f32_16x16x32_bf16 v[80:83], v[188:191], a[60:63], v[80:83]
  buffer_load_dwordx4 v239, s[24:27], s49 offen offset:1024 lds
  v_mfma_f32_16x16x32_bf16 v[100:103], v[188:191], a[64:67], v[100:103]
  s_lshl_b32 s55, s55, 2
  ds_read_b64_tr_b16 a[252:253], v193 offset:25632
  ds_read_b64_tr_b16 a[254:255], v193 offset:26912
  s_lshr_b32 s56, s2, 6
  s_add_u32 s55, s55, s56
  s_lshl_b32 s55, s55, 6
  s_bfe_u32 s59, s2, 0x10002
  s_lshl1_add_u32 s56, s59, s55
  s_mul_i32 s56, s56, 1395
  s_lshr_b32 s56, s56, 16
  v_bfe_u32 v168, v0, 3, 2
  v_add_u32 v169, s56, v168
  s_lshl1_add_u32 s56, s59, s55
  s_add_u32 s56, s56, 63
  s_mul_i32 s56, s56, 1395
  s_lshr_b32 s56, s56, 16
  v_min_u32 v169, s56, v169
  s_mul_i32 s56, s59, 22
  v_add_u32 v169, s56, v169
  v_and_b32 v170, 7, v0
  v_min_u32 v252, 6, v170
  v_add_u32 v252, s57, v252
  v_lshrrev_b32 v252, 1, v252
  v_mfma_f32_16x16x32_bf16 v[100:103], v[184:187], a[52:55], v[100:103]
  v_mfma_f32_16x16x32_bf16 v[120:123], v[184:187], a[56:59], v[120:123]
  v_mfma_f32_16x16x32_bf16 v[120:123], v[188:191], a[68:71], v[120:123]
  s_waitcnt lgkmcnt(4)
  buffer_load_dwordx4 v240, s[24:27], s49 offen offset:2048 lds
  v_mfma_f32_16x16x32_bf16 v[4:7], a[240:243], a[72:75], v[4:7]
  ds_read_b64_tr_b16 v[184:185], v193 offset:20544
  ds_read_b64_tr_b16 v[186:187], v193 offset:21824
  v_mfma_f32_16x16x32_bf16 v[4:7], a[244:247], a[84:87], v[4:7]
  v_mfma_f32_16x16x32_bf16 v[24:27], a[244:247], a[88:91], v[24:27]
  ds_read_b64_tr_b16 v[188:189], v193 offset:25664
  ds_read_b64_tr_b16 v[190:191], v193 offset:26944
  v_mfma_f32_16x16x32_bf16 v[24:27], a[240:243], a[76:79], v[24:27]
  v_mfma_f32_16x16x32_bf16 v[44:47], a[240:243], a[80:83], v[44:47]
  buffer_load_dwordx4 v241, s[24:27], s49 offen offset:3072 lds
  v_mfma_f32_16x16x32_bf16 v[44:47], a[244:247], a[92:95], v[44:47]
  s_waitcnt lgkmcnt(4)
  v_mfma_f32_16x16x32_bf16 v[8:11], a[248:251], a[72:75], v[8:11]
  ds_read_b64_tr_b16 a[240:241], v193 offset:20576
  ds_read_b64_tr_b16 a[242:243], v193 offset:21856
  v_mfma_f32_16x16x32_bf16 v[8:11], a[252:255], a[84:87], v[8:11]
  s_add_u32 m0, s48, 16768
  v_mfma_f32_16x16x32_bf16 v[28:31], a[252:255], a[88:91], v[28:31]
  ds_read_b64_tr_b16 a[244:245], v193 offset:25696
  ds_read_b64_tr_b16 a[246:247], v193 offset:26976
  v_lshl_add_u32 v252, v252, 6, v169
  v_lshlrev_b32 v252, 6, v252
  v_add_u32 v252, 0x40000, v252
  v_add_u32 v253, s58, v170
  v_lshrrev_b32 v253, 1, v253
  v_cmp_gt_u32 vcc, 6, v170
  s_nop 1
  v_cndmask_b32 v253, 12, v253, vcc
  v_lshl_add_u32 v253, v253, 6, v169
  v_lshlrev_b32 v253, 6, v253
  v_add_u32 v253, 0x50000, v253
  s_mul_i32 s56, s55, 3049
  s_lshr_b32 s56, s56, 19
  s_mul_i32 s57, s56, 172
  s_sub_u32 s57, s55, s57
  s_add_u32 s57, s57, 4
  s_mul_i32 s57, s57, 1490
  s_lshr_b32 s57, s57, 16
  s_lshl_b32 s56, s56, 2
  s_add_u32 s56, s56, s57
  v_add_u32 v168, s56, v168
  s_add_u32 s55, s55, 63
  v_mfma_f32_16x16x32_bf16 v[28:31], a[248:251], a[76:79], v[28:31]
  buffer_load_dwordx4 v242, s[24:27], s49 offen offset:0 lds
  v_mfma_f32_16x16x32_bf16 v[48:51], a[248:251], a[80:83], v[48:51]
  v_mfma_f32_16x16x32_bf16 v[48:51], a[252:255], a[92:95], v[48:51]
  s_waitcnt lgkmcnt(4)
  v_mfma_f32_16x16x32_bf16 v[12:15], v[184:187], a[72:75], v[12:15]
  ds_read_b64_tr_b16 a[248:249], v193 offset:20608
  ds_read_b64_tr_b16 a[250:251], v193 offset:21888
  v_mfma_f32_16x16x32_bf16 v[12:15], v[188:191], a[84:87], v[12:15]
  v_mfma_f32_16x16x32_bf16 v[32:35], v[188:191], a[88:91], v[32:35]
  ds_read_b64_tr_b16 a[252:253], v193 offset:25728
  ds_read_b64_tr_b16 a[254:255], v193 offset:27008
  v_mfma_f32_16x16x32_bf16 v[32:35], v[184:187], a[76:79], v[32:35]
  buffer_load_dwordx4 v243, s[24:27], s49 offen offset:1024 lds
  v_mfma_f32_16x16x32_bf16 v[52:55], v[184:187], a[80:83], v[52:55]
  v_mfma_f32_16x16x32_bf16 v[52:55], v[188:191], a[92:95], v[52:55]
  s_waitcnt lgkmcnt(4)
  v_mfma_f32_16x16x32_bf16 v[16:19], a[240:243], a[72:75], v[16:19]
  s_bfe_u32 s51, s60, 0x40014
  ds_read_b64_tr_b16 v[184:185], v193 offset:30720
  ds_read_b64_tr_b16 v[186:187], v193 offset:32000
  v_mfma_f32_16x16x32_bf16 v[16:19], a[244:247], a[84:87], v[16:19]
  s_mul_i32 s51, s51, 245760
  s_add_u32 m0, s50, 20480
  s_add_u32 s51, s51, s52
  v_mfma_f32_16x16x32_bf16 v[36:39], a[244:247], a[88:91], v[36:39]
  s_mul_i32 s56, s55, 3049
  ds_read_b64_tr_b16 v[188:189], v193 offset:35840
  ds_read_b64_tr_b16 v[190:191], v193 offset:37120
  s_lshr_b32 s56, s56, 19
  s_mul_i32 s57, s56, 172
  s_sub_u32 s57, s55, s57
  s_add_u32 s57, s57, 4
  s_mul_i32 s57, s57, 1490
  s_lshr_b32 s57, s57, 16
  s_lshl_b32 s56, s56, 2
  s_add_u32 s56, s56, s57
  v_min_u32 v168, s56, v168
  s_mul_i32 s59, s59, 24
  s_lshl_b32 s56, s44, 7
  s_add_u32 s59, s59, s56
  v_add_u32 v168, s59, v168
  v_and_b32 v169, 1, v0
  v_lshl_add_u32 v168, v169, 6, v168
  v_lshlrev_b32 v168, 6, v168
  v_add_u32 v168, 0xa0000, v168
  v_cmp_gt_u32 vcc, 32, v0
  s_nop 1
  v_cndmask_b32 v253, v168, v253, vcc
  s_mul_i32 s55, s44, 5
  v_mfma_f32_16x16x32_bf16 v[36:39], a[240:243], a[76:79], v[36:39]
  buffer_load_dwordx4 v194, s[28:31], s51 offen offset:0 lds
  v_mfma_f32_16x16x32_bf16 v[56:59], a[240:243], a[80:83], v[56:59]
  v_mfma_f32_16x16x32_bf16 v[56:59], a[244:247], a[92:95], v[56:59]
  s_waitcnt lgkmcnt(4)
  v_mfma_f32_16x16x32_bf16 v[20:23], a[248:251], a[72:75], v[20:23]
  ds_read_b64_tr_b16 a[240:241], v193 offset:30752
  ds_read_b64_tr_b16 a[242:243], v193 offset:32032
  v_mfma_f32_16x16x32_bf16 v[20:23], a[252:255], a[84:87], v[20:23]
  buffer_load_dwordx4 v195, s[28:31], s51 offen offset:1024 lds
  v_mfma_f32_16x16x32_bf16 v[40:43], a[252:255], a[88:91], v[40:43]
  ds_read_b64_tr_b16 a[244:245], v193 offset:35872
  ds_read_b64_tr_b16 a[246:247], v193 offset:37152
  v_mfma_f32_16x16x32_bf16 v[40:43], a[248:251], a[76:79], v[40:43]
  v_mfma_f32_16x16x32_bf16 v[60:63], a[248:251], a[80:83], v[60:63]
  v_mfma_f32_16x16x32_bf16 v[60:63], a[252:255], a[92:95], v[60:63]
  s_waitcnt lgkmcnt(4)
  v_mfma_f32_16x16x32_bf16 v[64:67], v[184:187], a[72:75], v[64:67]
  ds_read_b64_tr_b16 a[248:249], v193 offset:30784
  ds_read_b64_tr_b16 a[250:251], v193 offset:32064
  v_mfma_f32_16x16x32_bf16 v[64:67], v[188:191], a[84:87], v[64:67]
  buffer_load_dwordx4 v196, s[28:31], s51 offen offset:2048 lds
  v_mfma_f32_16x16x32_bf16 v[84:87], v[188:191], a[88:91], v[84:87]
  s_add_u32 s55, s55, 54
  ds_read_b64_tr_b16 a[252:253], v193 offset:35904
  ds_read_b64_tr_b16 a[254:255], v193 offset:37184
  v_min_u32 v168, 3, v170
  v_add_u32 v168, s55, v168
  v_lshlrev_b32 v168, 10, v168
  v_add_u32 v168, 0x10000, v168
  v_cndmask_b32 v251, v168, v251, vcc
  v_add_u32 v169, 131072, v252
  v_cndmask_b32 v252, v169, v252, vcc
  v_add_u32 v168, 1024, v168
  v_cmp_eq_u32 vcc, 7, v0
  s_nop 1
  v_cndmask_b32 v252, v252, v168, vcc
  v_add_u32 v168, s45, v0
  v_subrev_u32 v168, 13, v168
  v_subrev_u32 v169, 4, v168
  v_cmp_gt_u32 vcc, 16, v0
  s_nop 1
  v_cndmask_b32 v168, v169, v168, vcc
  v_cmp_ne_u32 vcc, 16, v0
  s_nop 1
  v_cndmask_b32 v169, -1, v168, vcc
  v_cmp_gt_u32 s[100:101], s47, v169
  v_max_i32 v168, 0, v168
  v_min_u32 v168, 0x3ff, v168
  v_mfma_f32_16x16x32_bf16 v[84:87], v[184:187], a[76:79], v[84:87]
  v_mfma_f32_16x16x32_bf16 v[104:107], v[184:187], a[80:83], v[104:107]
  v_mfma_f32_16x16x32_bf16 v[104:107], v[188:191], a[92:95], v[104:107]
  s_waitcnt lgkmcnt(4)
  buffer_load_dwordx4 v197, s[28:31], s51 offen offset:3072 lds
  v_mfma_f32_16x16x32_bf16 v[68:71], a[240:243], a[72:75], v[68:71]
  ds_read_b64_tr_b16 v[184:185], v193 offset:30816
  ds_read_b64_tr_b16 v[186:187], v193 offset:32096
  v_mfma_f32_16x16x32_bf16 v[68:71], a[244:247], a[84:87], v[68:71]
  v_mfma_f32_16x16x32_bf16 v[88:91], a[244:247], a[88:91], v[88:91]
  s_add_u32 m0, s50, 24576
  ds_read_b64_tr_b16 v[188:189], v193 offset:35936
  ds_read_b64_tr_b16 v[190:191], v193 offset:37216
  v_mfma_f32_16x16x32_bf16 v[88:91], a[240:243], a[76:79], v[88:91]
  v_mfma_f32_16x16x32_bf16 v[108:111], a[240:243], a[80:83], v[108:111]
  buffer_load_dwordx4 v198, s[28:31], s51 offen offset:0 lds
  v_mfma_f32_16x16x32_bf16 v[108:111], a[244:247], a[92:95], v[108:111]
  s_waitcnt lgkmcnt(4)
  v_mfma_f32_16x16x32_bf16 v[72:75], a[248:251], a[72:75], v[72:75]
  ds_read_b64_tr_b16 a[240:241], v193 offset:30848
  ds_read_b64_tr_b16 a[242:243], v193 offset:32128
  v_mfma_f32_16x16x32_bf16 v[72:75], a[252:255], a[84:87], v[72:75]
  s_waitcnt vmcnt(16)
  ds_read_b128 a[96:99], v244 offset:6272
  v_mfma_f32_16x16x32_bf16 v[92:95], a[252:255], a[88:91], v[92:95]
  ds_read_b64_tr_b16 a[244:245], v193 offset:35968
  ds_read_b64_tr_b16 a[246:247], v193 offset:37248
  v_lshlrev_b32 v168, 4, v168
  s_lshl_b32 s56, s44, 9
  s_add_u32 s56, s56, 161792
  v_lshlrev_b32 v169, 2, v0
  v_add_u32 v169, s56, v169
  v_and_b32 v170, 15, v0
  v_lshlrev_b32 v170, 2, v170
  v_add_u32 v170, s56, v170
  v_lshrrev_b32 v210, 4, v0
  v_lshlrev_b32 v210, 4, v210
  v_add_u32 v210, s56, v210
  v_lshlrev_b32 v211, 3, v0
  s_add_u32 s57, s44, 3
  s_and_b32 s57, s57, 3
  s_mul_i32 s57, s57, 2560
  v_add_u32 v211, 147456, v211
  v_add_u32 v212, s57, v211
  s_mul_i32 s57, s44, 2560
  v_add_u32 v211, s57, v211
  s_lshl_b32 s59, s46, 14
  s_add_u32 s59, s59, 4096
  v_mfma_f32_16x16x32_bf16 v[92:95], a[248:251], a[76:79], v[92:95]
  ds_read_b128 a[100:103], v244 offset:8320
  v_mfma_f32_16x16x32_bf16 v[112:115], a[248:251], a[80:83], v[112:115]
  s_waitcnt vmcnt(11)
  v_mfma_f32_16x16x32_bf16 v[112:115], a[252:255], a[92:95], v[112:115]
  s_waitcnt lgkmcnt(6)
  ds_read_b128 a[104:107], v244 offset:10368
  v_mfma_f32_16x16x32_bf16 v[76:79], v[184:187], a[72:75], v[76:79]
  s_barrier
  ds_read_b64_tr_b16 a[248:249], v192 offset:0
  ds_read_b64_tr_b16 a[250:251], v192 offset:1280
  v_mfma_f32_16x16x32_bf16 v[76:79], v[188:191], a[84:87], v[76:79]
  s_cmp_eq_u32 s67, 4
  s_cbranch_scc1 ARP4
ARPB4:
  ds_read_b128 a[108:111], v245 offset:6272
  v_mfma_f32_16x16x32_bf16 v[96:99], v[188:191], a[88:91], v[96:99]
  s_bfe_u32 s49, s60, 0x40018
  ds_read_b64_tr_b16 a[252:253], v192 offset:5120
  ds_read_b64_tr_b16 a[254:255], v192 offset:6400
  v_mfma_f32_16x16x32_bf16 v[96:99], v[184:187], a[76:79], v[96:99]
  s_add_u32 m0, s48, 128
  ds_read_b128 a[112:115], v245 offset:8320
  s_lshl_b32 s49, s49, 7
  v_mfma_f32_16x16x32_bf16 v[116:119], v[184:187], a[80:83], v[116:119]
  buffer_load_dwordx4 v238, s[24:27], s49 offen offset:0 lds
  v_mfma_f32_16x16x32_bf16 v[116:119], v[188:191], a[92:95], v[116:119]
  s_waitcnt lgkmcnt(8)
  ds_read_b128 a[116:119], v245 offset:10368
  v_mfma_f32_16x16x32_bf16 v[80:83], a[240:243], a[72:75], v[80:83]
  ds_read_b64_tr_b16 v[184:185], v192 offset:32
  ds_read_b64_tr_b16 v[186:187], v192 offset:1312
  v_mfma_f32_16x16x32_bf16 v[80:83], a[244:247], a[84:87], v[80:83]
  buffer_load_dwordx4 v239, s[24:27], s49 offen offset:1024 lds
  v_mfma_f32_16x16x32_bf16 v[100:103], a[244:247], a[88:91], v[100:103]
  ds_read_b64_tr_b16 v[188:189], v192 offset:5152
  ds_read_b64_tr_b16 v[190:191], v192 offset:6432
  v_mfma_f32_16x16x32_bf16 v[100:103], a[240:243], a[76:79], v[100:103]
  v_mfma_f32_16x16x32_bf16 v[120:123], a[240:243], a[80:83], v[120:123]
  v_mfma_f32_16x16x32_bf16 v[120:123], a[244:247], a[92:95], v[120:123]
  s_waitcnt lgkmcnt(4)
  buffer_load_dwordx4 v240, s[24:27], s49 offen offset:2048 lds
  v_mfma_f32_16x16x32_bf16 v[4:7], a[248:251], a[96:99], v[4:7]
  ds_read_b64_tr_b16 a[240:241], v192 offset:64
  ds_read_b64_tr_b16 a[242:243], v192 offset:1344
  v_mfma_f32_16x16x32_bf16 v[4:7], a[252:255], a[108:111], v[4:7]
  v_mfma_f32_16x16x32_bf16 v[24:27], a[252:255], a[112:115], v[24:27]
  ds_read_b64_tr_b16 a[244:245], v192 offset:5184
  ds_read_b64_tr_b16 a[246:247], v192 offset:6464
  v_mfma_f32_16x16x32_bf16 v[24:27], a[248:251], a[100:103], v[24:27]
  v_mfma_f32_16x16x32_bf16 v[44:47], a[248:251], a[104:107], v[44:47]
  buffer_load_dwordx4 v241, s[24:27], s49 offen offset:3072 lds
  v_mfma_f32_16x16x32_bf16 v[44:47], a[252:255], a[116:119], v[44:47]
  s_waitcnt lgkmcnt(4)
  v_mfma_f32_16x16x32_bf16 v[8:11], v[184:187], a[96:99], v[8:11]
  ds_read_b64_tr_b16 a[248:249], v192 offset:96
  ds_read_b64_tr_b16 a[250:251], v192 offset:1376
  v_mfma_f32_16x16x32_bf16 v[8:11], v[188:191], a[108:111], v[8:11]
  s_add_u32 m0, s48, 4224
  v_mfma_f32_16x16x32_bf16 v[28:31], v[188:191], a[112:115], v[28:31]
  ds_read_b64_tr_b16 a[252:253], v192 offset:5216
  ds_read_b64_tr_b16 a[254:255], v192 offset:6496
  v_mfma_f32_16x16x32_bf16 v[28:31], v[184:187], a[100:103], v[28:31]
  buffer_load_dwordx4 v242, s[24:27], s49 offen offset:0 lds
  v_mfma_f32_16x16x32_bf16 v[48:51], v[184:187], a[104:107], v[48:51]
  v_mfma_f32_16x16x32_bf16 v[48:51], v[188:191], a[116:119], v[48:51]
  s_waitcnt lgkmcnt(4)
  v_mfma_f32_16x16x32_bf16 v[12:15], a[240:243], a[96:99], v[12:15]
  ds_read_b64_tr_b16 v[184:185], v192 offset:128
  ds_read_b64_tr_b16 v[186:187], v192 offset:1408
  v_mfma_f32_16x16x32_bf16 v[12:15], a[244:247], a[108:111], v[12:15]
  v_mfma_f32_16x16x32_bf16 v[32:35], a[244:247], a[112:115], v[32:35]
  ds_read_b64_tr_b16 v[188:189], v192 offset:5248
  ds_read_b64_tr_b16 v[190:191], v192 offset:6528
  v_mfma_f32_16x16x32_bf16 v[32:35], a[240:243], a[100:103], v[32:35]
  buffer_load_dwordx4 v243, s[24:27], s49 offen offset:1024 lds
  v_mfma_f32_16x16x32_bf16 v[52:55], a[240:243], a[104:107], v[52:55]
  v_mfma_f32_16x16x32_bf16 v[52:55], a[244:247], a[116:119], v[52:55]
  s_waitcnt lgkmcnt(4)
  v_mfma_f32_16x16x32_bf16 v[16:19], a[248:251], a[96:99], v[16:19]
  s_bfe_u32 s51, s60, 0x40018
  ds_read_b64_tr_b16 a[240:241], v192 offset:10240
  ds_read_b64_tr_b16 a[242:243], v192 offset:11520
  v_mfma_f32_16x16x32_bf16 v[16:19], a[252:255], a[108:111], v[16:19]
  s_mul_i32 s51, s51, 245760
  s_add_u32 m0, s50, 40960
  s_add_u32 s51, s51, s52
  v_mfma_f32_16x16x32_bf16 v[36:39], a[252:255], a[112:115], v[36:39]
  ds_read_b64_tr_b16 a[244:245], v192 offset:15360
  ds_read_b64_tr_b16 a[246:247], v192 offset:16640
  v_mfma_f32_16x16x32_bf16 v[36:39], a[248:251], a[100:103], v[36:39]
  buffer_load_dwordx4 v194, s[28:31], s51 offen offset:0 lds
  v_mfma_f32_16x16x32_bf16 v[56:59], a[248:251], a[104:107], v[56:59]
  v_mfma_f32_16x16x32_bf16 v[56:59], a[252:255], a[116:119], v[56:59]
  s_waitcnt lgkmcnt(4)
  v_mfma_f32_16x16x32_bf16 v[20:23], v[184:187], a[96:99], v[20:23]
  ds_read_b64_tr_b16 a[248:249], v192 offset:10272
  ds_read_b64_tr_b16 a[250:251], v192 offset:11552
  v_mfma_f32_16x16x32_bf16 v[20:23], v[188:191], a[108:111], v[20:23]
  buffer_load_dwordx4 v195, s[28:31], s51 offen offset:1024 lds
  v_mfma_f32_16x16x32_bf16 v[40:43], v[188:191], a[112:115], v[40:43]
  ds_read_b64_tr_b16 a[252:253], v192 offset:15392
  ds_read_b64_tr_b16 a[254:255], v192 offset:16672
  v_mfma_f32_16x16x32_bf16 v[40:43], v[184:187], a[100:103], v[40:43]
  v_mfma_f32_16x16x32_bf16 v[60:63], v[184:187], a[104:107], v[60:63]
  v_mfma_f32_16x16x32_bf16 v[60:63], v[188:191], a[116:119], v[60:63]
  s_waitcnt lgkmcnt(4)
  v_mfma_f32_16x16x32_bf16 v[64:67], a[240:243], a[96:99], v[64:67]
  ds_read_b64_tr_b16 v[184:185], v192 offset:10304
  ds_read_b64_tr_b16 v[186:187], v192 offset:11584
  v_mfma_f32_16x16x32_bf16 v[64:67], a[244:247], a[108:111], v[64:67]
  buffer_load_dwordx4 v196, s[28:31], s51 offen offset:2048 lds
  v_mfma_f32_16x16x32_bf16 v[84:87], a[244:247], a[112:115], v[84:87]
  ds_read_b64_tr_b16 v[188:189], v192 offset:15424
  ds_read_b64_tr_b16 v[190:191], v192 offset:16704
  v_mfma_f32_16x16x32_bf16 v[84:87], a[240:243], a[100:103], v[84:87]
  v_mfma_f32_16x16x32_bf16 v[104:107], a[240:243], a[104:107], v[104:107]
  v_mfma_f32_16x16x32_bf16 v[104:107], a[244:247], a[116:119], v[104:107]
  s_waitcnt lgkmcnt(4)
  buffer_load_dwordx4 v197, s[28:31], s51 offen offset:3072 lds
  v_mfma_f32_16x16x32_bf16 v[68:71], a[248:251], a[96:99], v[68:71]
  ds_read_b64_tr_b16 a[240:241], v192 offset:10336
  ds_read_b64_tr_b16 a[242:243], v192 offset:11616
  v_mfma_f32_16x16x32_bf16 v[68:71], a[252:255], a[108:111], v[68:71]
  v_mfma_f32_16x16x32_bf16 v[88:91], a[252:255], a[112:115], v[88:91]
  s_add_u32 m0, s50, 45056
  ds_read_b64_tr_b16 a[244:245], v192 offset:15456
  ds_read_b64_tr_b16 a[246:247], v192 offset:16736
  v_mfma_f32_16x16x32_bf16 v[88:91], a[248:251], a[100:103], v[88:91]
  v_mfma_f32_16x16x32_bf16 v[108:111], a[248:251], a[104:107], v[108:111]
  buffer_load_dwordx4 v198, s[28:31], s51 offen offset:0 lds
  v_mfma_f32_16x16x32_bf16 v[108:111], a[252:255], a[116:119], v[108:111]
  s_waitcnt lgkmcnt(4)
  v_mfma_f32_16x16x32_bf16 v[72:75], v[184:187], a[96:99], v[72:75]
  ds_read_b64_tr_b16 a[248:249], v192 offset:10368
  ds_read_b64_tr_b16 a[250:251], v192 offset:11648
  v_mfma_f32_16x16x32_bf16 v[72:75], v[188:191], a[108:111], v[72:75]
  s_waitcnt vmcnt(16)
  ds_read_b128 a[120:123], v244 offset:12544
  v_mfma_f32_16x16x32_bf16 v[92:95], v[188:191], a[112:115], v[92:95]
  ds_read_b64_tr_b16 a[252:253], v192 offset:15488
  ds_read_b64_tr_b16 a[254:255], v192 offset:16768
  v_mfma_f32_16x16x32_bf16 v[92:95], v[184:187], a[100:103], v[92:95]
  ds_read_b128 a[124:127], v244 offset:14592
  v_mfma_f32_16x16x32_bf16 v[112:115], v[184:187], a[104:107], v[112:115]
  s_waitcnt vmcnt(11)
  v_mfma_f32_16x16x32_bf16 v[112:115], v[188:191], a[116:119], v[112:115]
  s_waitcnt lgkmcnt(6)
  ds_read_b128 a[128:131], v244 offset:16640
  v_mfma_f32_16x16x32_bf16 v[76:79], a[240:243], a[96:99], v[76:79]
  s_barrier
  ds_read_b64_tr_b16 v[184:185], v192 offset:20480
  ds_read_b64_tr_b16 v[186:187], v192 offset:21760
  v_mfma_f32_16x16x32_bf16 v[76:79], a[244:247], a[108:111], v[76:79]
AHOP1:
  s_cbranch_execz AHOP5
  ds_read_b128 a[132:135], v245 offset:12544
  s_bfe_u32 s49, s60, 0x4001c
  v_mfma_f32_16x16x32_bf16 v[96:99], a[244:247], a[112:115], v[96:99]
  s_add_u32 m0, s48, 6400
  ds_read_b64_tr_b16 v[188:189], v192 offset:25600
  ds_read_b64_tr_b16 v[190:191], v192 offset:26880
  v_mfma_f32_16x16x32_bf16 v[96:99], a[240:243], a[100:103], v[96:99]
  s_lshl_b32 s49, s49, 7
  ds_read_b128 a[136:139], v245 offset:14592
  v_mfma_f32_16x16x32_bf16 v[116:119], a[240:243], a[104:107], v[116:119]
  buffer_load_dwordx4 v238, s[24:27], s49 offen offset:0 lds
  v_mfma_f32_16x16x32_bf16 v[116:119], a[244:247], a[116:119], v[116:119]
  s_waitcnt lgkmcnt(8)
  ds_read_b128 a[140:143], v245 offset:16640
  v_mfma_f32_16x16x32_bf16 v[80:83], a[248:251], a[96:99], v[80:83]
  ds_read_b64_tr_b16 a[240:241], v192 offset:20512
  ds_read_b64_tr_b16 a[242:243], v192 offset:21792
  v_mfma_f32_16x16x32_bf16 v[80:83], a[252:255], a[108:111], v[80:83]
  buffer_load_dwordx4 v239, s[24:27], s49 offen offset:1024 lds
  v_mfma_f32_16x16x32_bf16 v[100:103], a[252:255], a[112:115], v[100:103]
  ds_read_b64_tr_b16 a[244:245], v192 offset:25632
  ds_read_b64_tr_b16 a[246:247], v192 offset:26912
  v_mfma_f32_16x16x32_bf16 v[100:103], a[248:251], a[100:103], v[100:103]
  v_mfma_f32_16x16x32_bf16 v[120:123], a[248:251], a[104:107], v[120:123]
  v_mfma_f32_16x16x32_bf16 v[120:123], a[252:255], a[116:119], v[120:123]
  s_waitcnt lgkmcnt(4)
  buffer_load_dwordx4 v240, s[24:27], s49 offen offset:2048 lds
  v_mfma_f32_16x16x32_bf16 v[4:7], v[184:187], a[120:123], v[4:7]
  ds_read_b64_tr_b16 a[248:249], v192 offset:20544
  ds_read_b64_tr_b16 a[250:251], v192 offset:21824
  v_mfma_f32_16x16x32_bf16 v[4:7], v[188:191], a[132:135], v[4:7]
  v_mfma_f32_16x16x32_bf16 v[24:27], v[188:191], a[136:139], v[24:27]
  ds_read_b64_tr_b16 a[252:253], v192 offset:25664
  ds_read_b64_tr_b16 a[254:255], v192 offset:26944
  v_mfma_f32_16x16x32_bf16 v[24:27], v[184:187], a[124:127], v[24:27]
  v_mfma_f32_16x16x32_bf16 v[44:47], v[184:187], a[128:131], v[44:47]
  buffer_load_dwordx4 v241, s[24:27], s49 offen offset:3072 lds
  v_mfma_f32_16x16x32_bf16 v[44:47], v[188:191], a[140:143], v[44:47]
  s_waitcnt lgkmcnt(4)
  v_mfma_f32_16x16x32_bf16 v[8:11], a[240:243], a[120:123], v[8:11]
  ds_read_b64_tr_b16 v[184:185], v192 offset:20576
  ds_read_b64_tr_b16 v[186:187], v192 offset:21856
  v_mfma_f32_16x16x32_bf16 v[8:11], a[244:247], a[132:135], v[8:11]
  s_add_u32 m0, s48, 10496
  v_mfma_f32_16x16x32_bf16 v[28:31], a[244:247], a[136:139], v[28:31]
  ds_read_b64_tr_b16 v[188:189], v192 offset:25696
  ds_read_b64_tr_b16 v[190:191], v192 offset:26976
  v_mfma_f32_16x16x32_bf16 v[28:31], a[240:243], a[124:127], v[28:31]
  buffer_load_dwordx4 v242, s[24:27], s49 offen offset:0 lds
  v_mfma_f32_16x16x32_bf16 v[48:51], a[240:243], a[128:131], v[48:51]
  v_mfma_f32_16x16x32_bf16 v[48:51], a[244:247], a[140:143], v[48:51]
  s_waitcnt lgkmcnt(4)
  v_mfma_f32_16x16x32_bf16 v[12:15], a[248:251], a[120:123], v[12:15]
  ds_read_b64_tr_b16 a[240:241], v192 offset:20608
  ds_read_b64_tr_b16 a[242:243], v192 offset:21888
  v_mfma_f32_16x16x32_bf16 v[12:15], a[252:255], a[132:135], v[12:15]
  v_mfma_f32_16x16x32_bf16 v[32:35], a[252:255], a[136:139], v[32:35]
  ds_read_b64_tr_b16 a[244:245], v192 offset:25728
  ds_read_b64_tr_b16 a[246:247], v192 offset:27008
  v_mfma_f32_16x16x32_bf16 v[32:35], a[248:251], a[124:127], v[32:35]
  buffer_load_dwordx4 v243, s[24:27], s49 offen offset:1024 lds
  v_mfma_f32_16x16x32_bf16 v[52:55], a[248:251], a[128:131], v[52:55]
  v_mfma_f32_16x16x32_bf16 v[52:55], a[252:255], a[140:143], v[52:55]
  s_waitcnt lgkmcnt(4)
  v_mfma_f32_16x16x32_bf16 v[16:19], v[184:187], a[120:123], v[16:19]
  s_bfe_u32 s51, s60, 0x4001c
  ds_read_b64_tr_b16 a[248:249], v192 offset:30720
  ds_read_b64_tr_b16 a[250:251], v192 offset:32000
  v_mfma_f32_16x16x32_bf16 v[16:19], v[188:191], a[132:135], v[16:19]
  s_mul_i32 s51, s51, 245760
  s_add_u32 m0, s50, 61440
  s_add_u32 s51, s51, s52
  v_mfma_f32_16x16x32_bf16 v[36:39], v[188:191], a[136:139], v[36:39]
  ds_read_b64_tr_b16 a[252:253], v192 offset:35840
  ds_read_b64_tr_b16 a[254:255], v192 offset:37120
  v_mfma_f32_16x16x32_bf16 v[36:39], v[184:187], a[124:127], v[36:39]
  buffer_load_dwordx4 v194, s[28:31], s51 offen offset:0 lds
  v_mfma_f32_16x16x32_bf16 v[56:59], v[184:187], a[128:131], v[56:59]
  v_mfma_f32_16x16x32_bf16 v[56:59], v[188:191], a[140:143], v[56:59]
  s_waitcnt lgkmcnt(4)
  v_mfma_f32_16x16x32_bf16 v[20:23], a[240:243], a[120:123], v[20:23]
  ds_read_b64_tr_b16 v[184:185], v192 offset:30752
  ds_read_b64_tr_b16 v[186:187], v192 offset:32032
  v_mfma_f32_16x16x32_bf16 v[20:23], a[244:247], a[132:135], v[20:23]
  buffer_load_dwordx4 v195, s[28:31], s51 offen offset:1024 lds
  v_mfma_f32_16x16x32_bf16 v[40:43], a[244:247], a[136:139], v[40:43]
  ds_read_b64_tr_b16 v[188:189], v192 offset:35872
  ds_read_b64_tr_b16 v[190:191], v192 offset:37152
  v_mfma_f32_16x16x32_bf16 v[40:43], a[240:243], a[124:127], v[40:43]
  v_mfma_f32_16x16x32_bf16 v[60:63], a[240:243], a[128:131], v[60:63]
  v_mfma_f32_16x16x32_bf16 v[60:63], a[244:247], a[140:143], v[60:63]
  s_waitcnt lgkmcnt(4)
  v_mfma_f32_16x16x32_bf16 v[64:67], a[248:251], a[120:123], v[64:67]
  ds_read_b64_tr_b16 a[240:241], v192 offset:30784
  ds_read_b64_tr_b16 a[242:243], v192 offset:32064
  v_mfma_f32_16x16x32_bf16 v[64:67], a[252:255], a[132:135], v[64:67]
  buffer_load_dwordx4 v196, s[28:31], s51 offen offset:2048 lds
  v_mfma_f32_16x16x32_bf16 v[84:87], a[252:255], a[136:139], v[84:87]
  ds_read_b64_tr_b16 a[244:245], v192 offset:35904
  ds_read_b64_tr_b16 a[246:247], v192 offset:37184
  v_mfma_f32_16x16x32_bf16 v[84:87], a[248:251], a[124:127], v[84:87]
  buffer_load_dwordx4 v[172:175], v168, s[36:39], s59 offen sc1
  v_mfma_f32_16x16x32_bf16 v[104:107], a[248:251], a[128:131], v[104:107]
  v_mfma_f32_16x16x32_bf16 v[104:107], a[252:255], a[140:143], v[104:107]
  s_waitcnt lgkmcnt(4)
  buffer_load_dwordx4 v197, s[28:31], s51 offen offset:3072 lds
  v_mfma_f32_16x16x32_bf16 v[68:71], v[184:187], a[120:123], v[68:71]
  ds_read_b64_tr_b16 a[248:249], v192 offset:30816
  ds_read_b64_tr_b16 a[250:251], v192 offset:32096
  v_mfma_f32_16x16x32_bf16 v[68:71], v[188:191], a[132:135], v[68:71]
  v_mfma_f32_16x16x32_bf16 v[88:91], v[188:191], a[136:139], v[88:91]
  s_add_u32 m0, s50, 65536
  ds_read_b64_tr_b16 a[252:253], v192 offset:35936
  ds_read_b64_tr_b16 a[254:255], v192 offset:37216
  v_mfma_f32_16x16x32_bf16 v[88:91], v[184:187], a[124:127], v[88:91]
  v_mfma_f32_16x16x32_bf16 v[108:111], v[184:187], a[128:131], v[108:111]
  buffer_load_dwordx4 v198, s[28:31], s51 offen offset:0 lds
  v_mfma_f32_16x16x32_bf16 v[108:111], v[188:191], a[140:143], v[108:111]
  s_waitcnt lgkmcnt(4)
  v_mfma_f32_16x16x32_bf16 v[72:75], a[240:243], a[120:123], v[72:75]
  ds_read_b64_tr_b16 v[184:185], v192 offset:30848
  ds_read_b64_tr_b16 v[186:187], v192 offset:32128
  v_mfma_f32_16x16x32_bf16 v[72:75], a[244:247], a[132:135], v[72:75]
  s_waitcnt vmcnt(17)
  ds_read_b128 a[144:147], v244 offset:0
  v_mfma_f32_16x16x32_bf16 v[92:95], a[244:247], a[136:139], v[92:95]
  ds_read_b64_tr_b16 v[188:189], v192 offset:35968
  ds_read_b64_tr_b16 v[190:191], v192 offset:37248
  v_mfma_f32_16x16x32_bf16 v[92:95], a[240:243], a[124:127], v[92:95]
  ds_read_b128 a[148:151], v244 offset:2048
  v_mfma_f32_16x16x32_bf16 v[112:115], a[240:243], a[128:131], v[112:115]
  s_waitcnt vmcnt(12)
  v_mfma_f32_16x16x32_bf16 v[112:115], a[244:247], a[140:143], v[112:115]
  s_waitcnt lgkmcnt(6)
  ds_read_b128 a[152:155], v244 offset:4096
  v_mfma_f32_16x16x32_bf16 v[76:79], a[248:251], a[120:123], v[76:79]
  s_barrier
  ds_read_b64_tr_b16 a[240:241], v193 offset:0
  ds_read_b64_tr_b16 a[242:243], v193 offset:1280
  v_mfma_f32_16x16x32_bf16 v[76:79], a[252:255], a[132:135], v[76:79]
  ds_read_b128 a[156:159], v245 offset:0
  s_bfe_u32 s49, s61, 0x40000
  v_mfma_f32_16x16x32_bf16 v[96:99], a[252:255], a[136:139], v[96:99]
  s_add_u32 m0, s48, 12672
  ds_read_b64_tr_b16 a[244:245], v193 offset:5120
  ds_read_b64_tr_b16 a[246:247], v193 offset:6400
  v_mfma_f32_16x16x32_bf16 v[96:99], a[248:251], a[124:127], v[96:99]
  s_lshl_b32 s49, s49, 7
  ds_read_b128 a[160:163], v245 offset:2048
  v_mfma_f32_16x16x32_bf16 v[116:119], a[248:251], a[128:131], v[116:119]
  buffer_load_dwordx4 v238, s[24:27], s49 offen offset:0 lds
  v_mfma_f32_16x16x32_bf16 v[116:119], a[252:255], a[140:143], v[116:119]
  s_waitcnt lgkmcnt(8)
  ds_read_b128 a[164:167], v245 offset:4096
  v_mfma_f32_16x16x32_bf16 v[80:83], v[184:187], a[120:123], v[80:83]
  ds_read_b64_tr_b16 a[248:249], v193 offset:32
  ds_read_b64_tr_b16 a[250:251], v193 offset:1312
  v_mfma_f32_16x16x32_bf16 v[80:83], v[188:191], a[132:135], v[80:83]
  buffer_load_dwordx4 v239, s[24:27], s49 offen offset:1024 lds
  v_mfma_f32_16x16x32_bf16 v[100:103], v[188:191], a[136:139], v[100:103]
  ds_read_b64_tr_b16 a[252:253], v193 offset:5152
  ds_read_b64_tr_b16 a[254:255], v193 offset:6432
  v_mfma_f32_16x16x32_bf16 v[100:103], v[184:187], a[124:127], v[100:103]
  v_mfma_f32_16x16x32_bf16 v[120:123], v[184:187], a[128:131], v[120:123]
  v_mfma_f32_16x16x32_bf16 v[120:123], v[188:191], a[140:143], v[120:123]
  s_waitcnt lgkmcnt(4)
  buffer_load_dwordx4 v240, s[24:27], s49 offen offset:2048 lds
  v_mfma_f32_16x16x32_bf16 v[4:7], a[240:243], a[144:147], v[4:7]
  ds_read_b64_tr_b16 v[184:185], v193 offset:64
  ds_read_b64_tr_b16 v[186:187], v193 offset:1344
  v_mfma_f32_16x16x32_bf16 v[4:7], a[244:247], a[156:159], v[4:7]
  v_mfma_f32_16x16x32_bf16 v[24:27], a[244:247], a[160:163], v[24:27]
  ds_read_b64_tr_b16 v[188:189], v193 offset:5184
  ds_read_b64_tr_b16 v[190:191], v193 offset:6464
  v_mfma_f32_16x16x32_bf16 v[24:27], a[240:243], a[148:151], v[24:27]
  v_mfma_f32_16x16x32_bf16 v[44:47], a[240:243], a[152:155], v[44:47]
  buffer_load_dwordx4 v241, s[24:27], s49 offen offset:3072 lds
  v_mfma_f32_16x16x32_bf16 v[44:47], a[244:247], a[164:167], v[44:47]
  s_waitcnt lgkmcnt(4)
  v_mfma_f32_16x16x32_bf16 v[8:11], a[248:251], a[144:147], v[8:11]
  ds_read_b64_tr_b16 a[240:241], v193 offset:96
  ds_read_b64_tr_b16 a[242:243], v193 offset:1376
  v_mfma_f32_16x16x32_bf16 v[8:11], a[252:255], a[156:159], v[8:11]
  s_add_u32 m0, s48, 16768
  v_mfma_f32_16x16x32_bf16 v[28:31], a[252:255], a[160:163], v[28:31]
  ds_read_b64_tr_b16 a[244:245], v193 offset:5216
  ds_read_b64_tr_b16 a[246:247], v193 offset:6496
  v_mfma_f32_16x16x32_bf16 v[28:31], a[248:251], a[148:151], v[28:31]
  buffer_load_dwordx4 v242, s[24:27], s49 offen offset:0 lds
  v_mfma_f32_16x16x32_bf16 v[48:51], a[248:251], a[152:155], v[48:51]
  v_mfma_f32_16x16x32_bf16 v[48:51], a[252:255], a[164:167], v[48:51]
  s_waitcnt lgkmcnt(4)
  v_mfma_f32_16x16x32_bf16 v[12:15], v[184:187], a[144:147], v[12:15]
  ds_read_b64_tr_b16 a[248:249], v193 offset:128
  ds_read_b64_tr_b16 a[250:251], v193 offset:1408
  v_mfma_f32_16x16x32_bf16 v[12:15], v[188:191], a[156:159], v[12:15]
  v_mfma_f32_16x16x32_bf16 v[32:35], v[188:191], a[160:163], v[32:35]
  ds_read_b64_tr_b16 a[252:253], v193 offset:5248
  ds_read_b64_tr_b16 a[254:255], v193 offset:6528
  v_mfma_f32_16x16x32_bf16 v[32:35], v[184:187], a[148:151], v[32:35]
  buffer_load_dwordx4 v243, s[24:27], s49 offen offset:1024 lds
  v_mfma_f32_16x16x32_bf16 v[52:55], v[184:187], a[152:155], v[52:55]
  v_mfma_f32_16x16x32_bf16 v[52:55], v[188:191], a[164:167], v[52:55]
  s_waitcnt lgkmcnt(4)
  v_mfma_f32_16x16x32_bf16 v[16:19], a[240:243], a[144:147], v[16:19]
  s_bfe_u32 s51, s61, 0x40000
  ds_read_b64_tr_b16 v[184:185], v193 offset:10240
  ds_read_b64_tr_b16 v[186:187], v193 offset:11520
  v_mfma_f32_16x16x32_bf16 v[16:19], a[244:247], a[156:159], v[16:19]
  s_mul_i32 s51, s51, 245760
  s_add_u32 m0, s50, 0
  s_add_u32 s51, s51, s52
  v_mfma_f32_16x16x32_bf16 v[36:39], a[244:247], a[160:163], v[36:39]
  ds_read_b64_tr_b16 v[188:189], v193 offset:15360
  ds_read_b64_tr_b16 v[190:191], v193 offset:16640
  v_mfma_f32_16x16x32_bf16 v[36:39], a[240:243], a[148:151], v[36:39]
  buffer_load_dwordx4 v194, s[28:31], s51 offen offset:0 lds
  v_mfma_f32_16x16x32_bf16 v[56:59], a[240:243], a[152:155], v[56:59]
  v_mfma_f32_16x16x32_bf16 v[56:59], a[244:247], a[164:167], v[56:59]
  s_waitcnt lgkmcnt(4)
  v_mfma_f32_16x16x32_bf16 v[20:23], a[248:251], a[144:147], v[20:23]
  ds_read_b64_tr_b16 a[240:241], v193 offset:10272
  ds_read_b64_tr_b16 a[242:243], v193 offset:11552
  v_mfma_f32_16x16x32_bf16 v[20:23], a[252:255], a[156:159], v[20:23]
  buffer_load_dwordx4 v195, s[28:31], s51 offen offset:1024 lds
  v_mfma_f32_16x16x32_bf16 v[40:43], a[252:255], a[160:163], v[40:43]
  s_waitcnt vmcnt(10)
  ds_read_b64_tr_b16 a[244:245], v193 offset:15392
  ds_read_b64_tr_b16 a[246:247], v193 offset:16672
  v_mfma_f32_16x16x32_bf16 v[40:43], a[248:251], a[148:151], v[40:43]
  v_xor_b32 v173, v173, v249
  v_xor_b32 v175, v175, v249
  v_mfma_f32_16x16x32_bf16 v[60:63], a[248:251], a[152:155], v[60:63]
  v_or_b32 v173, v173, v175
  v_mfma_f32_16x16x32_bf16 v[60:63], a[252:255], a[164:167], v[60:63]
  s_waitcnt lgkmcnt(4)
  v_cmp_ne_u32 vcc, 0, v173
  v_mfma_f32_16x16x32_bf16 v[64:67], v[184:187], a[144:147], v[64:67]
  s_cbranch_vccnz SAs
BAs:
  ds_read_b64_tr_b16 a[248:249], v193 offset:10304
  ds_read_b64_tr_b16 a[250:251], v193 offset:11584
  v_mfma_f32_16x16x32_bf16 v[64:67], v[188:191], a[156:159], v[64:67]
  buffer_load_dwordx4 v196, s[28:31], s51 offen offset:2048 lds
  v_mfma_f32_16x16x32_bf16 v[84:87], v[188:191], a[160:163], v[84:87]
  ds_read_b64_tr_b16 a[252:253], v193 offset:15424
  ds_read_b64_tr_b16 a[254:255], v193 offset:16704
  v_mfma_f32_16x16x32_bf16 v[84:87], v[184:187], a[148:151], v[84:87]
  v_rcp_f32 v173, v174
  v_mfma_f32_16x16x32_bf16 v[104:107], v[184:187], a[152:155], v[104:107]
  v_cndmask_b32 v172, 0, v172, s[100:101]
  v_cndmask_b32 v173, 0, v173, s[100:101]
  v_mfma_f32_16x16x32_bf16 v[104:107], v[188:191], a[164:167], v[104:107]
  s_waitcnt lgkmcnt(4)
  buffer_load_dwordx4 v197, s[28:31], s51 offen offset:3072 lds
  v_mfma_f32_16x16x32_bf16 v[68:71], a[240:243], a[144:147], v[68:71]
  ds_read_b64_tr_b16 v[184:185], v193 offset:10336
  ds_read_b64_tr_b16 v[186:187], v193 offset:11616
  v_mfma_f32_16x16x32_bf16 v[68:71], a[244:247], a[156:159], v[68:71]
  ds_write_b32 v169, v172
  v_mfma_f32_16x16x32_bf16 v[88:91], a[244:247], a[160:163], v[88:91]
  s_add_u32 m0, s50, 4096
  ds_read_b64_tr_b16 v[188:189], v193 offset:15456
  ds_read_b64_tr_b16 v[190:191], v193 offset:16736
  ds_write_b32 v169, v173 offset:256
  v_mfma_f32_16x16x32_bf16 v[88:91], a[240:243], a[148:151], v[88:91]
  v_mfma_f32_16x16x32_bf16 v[108:111], a[240:243], a[152:155], v[108:111]
  buffer_load_dwordx4 v198, s[28:31], s51 offen offset:0 lds
  v_mfma_f32_16x16x32_bf16 v[108:111], a[244:247], a[164:167], v[108:111]
  s_waitcnt lgkmcnt(6)
  v_mfma_f32_16x16x32_bf16 v[72:75], a[248:251], a[144:147], v[72:75]
  ds_read_b64_tr_b16 a[240:241], v193 offset:10368
  ds_read_b64_tr_b16 a[242:243], v193 offset:11648
  v_mfma_f32_16x16x32_bf16 v[72:75], a[252:255], a[156:159], v[72:75]
  ds_read_b128 a[168:171], v244 offset:6272
  v_mfma_f32_16x16x32_bf16 v[92:95], a[252:255], a[160:163], v[92:95]
  s_waitcnt lgkmcnt(3)
  ds_read_b64_tr_b16 a[244:245], v193 offset:15488
  ds_read_b64_tr_b16 a[246:247], v193 offset:16768
  v_mfma_f32_16x16x32_bf16 v[92:95], a[248:251], a[148:151], v[92:95]
  ds_read_b128 a[172:175], v244 offset:8320
  ds_read2_b32 v[200:201], v170 offset0:16 offset1:80
  v_mfma_f32_16x16x32_bf16 v[112:115], a[248:251], a[152:155], v[112:115]
  s_waitcnt vmcnt(11)
  ds_read2_b32 v[202:203], v170 offset0:32 offset1:96
  v_mfma_f32_16x16x32_bf16 v[112:115], a[252:255], a[164:167], v[112:115]
  ds_read_b128 a[176:179], v244 offset:10368
  ds_read2_b32 v[204:205], v170 offset0:48 offset1:112
  v_mfma_f32_16x16x32_bf16 v[76:79], v[184:187], a[144:147], v[76:79]
  s_barrier
  ds_read_b64_tr_b16 a[248:249], v193 offset:20480
  ds_read_b64_tr_b16 a[250:251], v193 offset:21760
  v_mfma_f32_16x16x32_bf16 v[76:79], v[188:191], a[156:159], v[76:79]
  ds_read_b128 a[180:183], v245 offset:6272
  ds_read_b128 v[124:127], v210 offset:256
  v_mfma_f32_16x16x32_bf16 v[96:99], v[188:191], a[160:163], v[96:99]
  s_bfe_u32 s49, s61, 0x40004
  ds_read_b64_tr_b16 a[252:253], v193 offset:25600
  ds_read_b64_tr_b16 a[254:255], v193 offset:26880
  v_mfma_f32_16x16x32_bf16 v[96:99], v[184:187], a[148:151], v[96:99]
  s_add_u32 m0, s48, 128
  ds_read_b128 a[184:187], v245 offset:8320
  ds_read_b128 v[128:131], v210 offset:320
  v_mfma_f32_16x16x32_bf16 v[116:119], v[184:187], a[152:155], v[116:119]
  s_lshl_b32 s49, s49, 7
  buffer_load_dwordx4 v238, s[24:27], s49 offen offset:0 lds
  v_mfma_f32_16x16x32_bf16 v[116:119], v[188:191], a[164:167], v[116:119]
  s_waitcnt lgkmcnt(13)
  ds_read_b128 v[132:135], v210 offset:384
  ds_read_b128 v[136:139], v210 offset:448
  v_mfma_f32_16x16x32_bf16 v[80:83], a[240:243], a[144:147], v[80:83]
  ds_read_b64_tr_b16 v[184:185], v193 offset:20512
  ds_read_b64_tr_b16 v[186:187], v193 offset:21792
  v_mfma_f32_16x16x32_bf16 v[80:83], a[244:247], a[156:159], v[80:83]
  ds_read_b128 a[188:191], v245 offset:10368
  v_mfma_f32_16x16x32_bf16 v[100:103], a[244:247], a[160:163], v[100:103]
  ds_read_b64_tr_b16 v[188:189], v193 offset:25632
  ds_read_b64_tr_b16 v[190:191], v193 offset:26912
  v_mfma_f32_16x16x32_bf16 v[100:103], a[240:243], a[148:151], v[100:103]
  buffer_load_dwordx4 v239, s[24:27], s49 offen offset:1024 lds
  v_mfma_f32_16x16x32_bf16 v[120:123], a[240:243], a[152:155], v[120:123]
  v_mfma_f32_16x16x32_bf16 v[120:123], a[244:247], a[164:167], v[120:123]
  s_waitcnt lgkmcnt(2)
  buffer_load_dwordx4 v240, s[24:27], s49 offen offset:2048 lds
  v_mfma_f32_16x16x32_bf16 v[4:7], a[248:251], a[168:171], v[4:7]
  ds_read_b64_tr_b16 a[240:241], v193 offset:20544
  ds_read_b64_tr_b16 a[242:243], v193 offset:21824
  v_mfma_f32_16x16x32_bf16 v[4:7], a[252:255], a[180:183], v[4:7]
  v_mov_b32 v171, 0xf149f2ca
  v_mfma_f32_16x16x32_bf16 v[24:27], a[252:255], a[184:187], v[24:27]
  ds_read_b64_tr_b16 a[244:245], v193 offset:25664
  ds_read_b64_tr_b16 a[246:247], v193 offset:26944
  v_mfma_f32_16x16x32_bf16 v[24:27], a[248:251], a[172:175], v[24:27]
  v_mul_f32 v201, 0x3ea52b5c, v201
  s_mov_b32 s98, 0xff00000
  v_mfma_f32_16x16x32_bf16 v[44:47], a[248:251], a[176:179], v[44:47]
  s_mov_b32 s99, 0xf0ffff0f
  buffer_load_dwordx4 v241, s[24:27], s49 offen offset:3072 lds
  v_mfma_f32_16x16x32_bf16 v[44:47], a[252:255], a[188:191], v[44:47]
  s_waitcnt lgkmcnt(4)
  v_cndmask_b32 v214, v128, v124, s[82:83]
  v_mfma_f32_16x16x32_bf16 v[8:11], v[184:187], a[168:171], v[8:11]
  ds_read_b64_tr_b16 a[248:249], v193 offset:20576
  ds_read_b64_tr_b16 a[250:251], v193 offset:21856
  v_mfma_f32_16x16x32_bf16 v[8:11], v[188:191], a[180:183], v[8:11]
  s_add_u32 m0, s48, 4224
  v_mul_f32 v214, v214, v201
  v_mfma_f32_16x16x32_bf16 v[28:31], v[188:191], a[184:187], v[28:31]
  ds_read_b64_tr_b16 a[252:253], v193 offset:25696
  ds_read_b64_tr_b16 a[254:255], v193 offset:26976
  v_mfma_f32_16x16x32_bf16 v[28:31], v[184:187], a[172:175], v[28:31]
  buffer_load_dwordx4 v242, s[24:27], s49 offen offset:0 lds
  v_mfma_f32_16x16x32_bf16 v[48:51], v[184:187], a[176:179], v[48:51]
  v_cndmask_b32 v214, 0, v214, s[98:99]
  v_mfma_f32_16x16x32_bf16 v[48:51], v[188:191], a[188:191], v[48:51]
  s_waitcnt lgkmcnt(4)
  v_cmp_ge_f32 vcc, 0, v214
  v_mfma_f32_16x16x32_bf16 v[12:15], a[240:243], a[168:171], v[12:15]
  ds_read_b64_tr_b16 v[184:185], v193 offset:20608
  ds_read_b64_tr_b16 v[186:187], v193 offset:21888
  v_mfma_f32_16x16x32_bf16 v[12:15], a[244:247], a[180:183], v[12:15]
  v_mfma_f32_16x16x32_bf16 v[32:35], a[244:247], a[184:187], v[32:35]
  ds_read_b64_tr_b16 v[188:189], v193 offset:25728
  ds_read_b64_tr_b16 v[190:191], v193 offset:27008
  v_mfma_f32_16x16x32_bf16 v[32:35], a[240:243], a[172:175], v[32:35]
  buffer_load_dwordx4 v243, s[24:27], s49 offen offset:1024 lds
  v_mfma_f32_16x16x32_bf16 v[52:55], a[240:243], a[176:179], v[52:55]
  v_cndmask_b32 v218, 0, v171, vcc
  s_mov_b32 s98, 0x1fe101fe
  v_mfma_f32_16x16x32_bf16 v[52:55], a[244:247], a[188:191], v[52:55]
  s_waitcnt lgkmcnt(4)
  s_mov_b32 s99, 0xe000fe1f
  v_cndmask_b32 v215, v129, v125, s[84:85]
  v_mfma_f32_16x16x32_bf16 v[16:19], a[248:251], a[168:171], v[16:19]
  s_bfe_u32 s51, s61, 0x40004
  ds_read_b64_tr_b16 a[240:241], v193 offset:30720
  ds_read_b64_tr_b16 a[242:243], v193 offset:32000
  v_mfma_f32_16x16x32_bf16 v[16:19], a[252:255], a[180:183], v[16:19]
  s_mul_i32 s51, s51, 245760
  v_mul_f32 v215, v215, v201
  s_add_u32 m0, s50, 20480
  v_mfma_f32_16x16x32_bf16 v[36:39], a[252:255], a[184:187], v[36:39]
  s_add_u32 s51, s51, s52
  ds_read_b64_tr_b16 a[244:245], v193 offset:35840
  ds_read_b64_tr_b16 a[246:247], v193 offset:37120
  v_mfma_f32_16x16x32_bf16 v[36:39], a[248:251], a[172:175], v[36:39]
  buffer_load_dwordx4 v194, s[28:31], s51 offen offset:0 lds
  v_mfma_f32_16x16x32_bf16 v[56:59], a[248:251], a[176:179], v[56:59]
  v_cndmask_b32 v215, 0, v215, s[98:99]
  v_mfma_f32_16x16x32_bf16 v[56:59], a[252:255], a[188:191], v[56:59]
  s_waitcnt lgkmcnt(4)
  v_cmp_ge_f32 vcc, 0, v215
  v_mfma_f32_16x16x32_bf16 v[20:23], v[184:187], a[168:171], v[20:23]
  ds_read_b64_tr_b16 a[248:249], v193 offset:30752
  ds_read_b64_tr_b16 a[250:251], v193 offset:32032
  v_mfma_f32_16x16x32_bf16 v[20:23], v[188:191], a[180:183], v[20:23]
  buffer_load_dwordx4 v195, s[28:31], s51 offen offset:1024 lds
  v_mfma_f32_16x16x32_bf16 v[40:43], v[188:191], a[184:187], v[40:43]
  ds_read_b64_tr_b16 a[252:253], v193 offset:35872
  ds_read_b64_tr_b16 a[254:255], v193 offset:37152
  v_mfma_f32_16x16x32_bf16 v[40:43], v[184:187], a[172:175], v[40:43]
  v_cndmask_b32 v219, 0, v171, vcc
  s_mov_b32 s98, 0x3fc303fc
  v_mfma_f32_16x16x32_bf16 v[60:63], v[184:187], a[176:179], v[60:63]
  s_mov_b32 s99, 0xc000fc3f
  v_cndmask_b32 v216, v130, v126, s[86:87]
  v_mfma_f32_16x16x32_bf16 v[60:63], v[188:191], a[188:191], v[60:63]
  s_waitcnt lgkmcnt(4)
  v_mfma_f32_16x16x32_bf16 v[64:67], a[240:243], a[168:171], v[64:67]
  ds_read_b64_tr_b16 v[184:185], v193 offset:30784
  ds_read_b64_tr_b16 v[186:187], v193 offset:32064
  v_mfma_f32_16x16x32_bf16 v[64:67], a[244:247], a[180:183], v[64:67]
  buffer_load_dwordx4 v196, s[28:31], s51 offen offset:2048 lds
  v_mfma_f32_16x16x32_bf16 v[84:87], a[244:247], a[184:187], v[84:87]
  ds_read_b64_tr_b16 v[188:189], v193 offset:35904
  ds_read_b64_tr_b16 v[190:191], v193 offset:37184
  v_mfma_f32_16x16x32_bf16 v[84:87], a[240:243], a[172:175], v[84:87]
  v_mul_f32 v216, v216, v201
  v_cndmask_b32 v216, 0, v216, s[98:99]
  v_mfma_f32_16x16x32_bf16 v[104:107], a[240:243], a[176:179], v[104:107]
  v_mfma_f32_16x16x32_bf16 v[104:107], a[244:247], a[188:191], v[104:107]
  s_waitcnt lgkmcnt(4)
  buffer_load_dwordx4 v197, s[28:31], s51 offen offset:3072 lds
  v_mfma_f32_16x16x32_bf16 v[68:71], a[248:251], a[168:171], v[68:71]
  ds_read_b64_tr_b16 a[240:241], v193 offset:30816
  ds_read_b64_tr_b16 a[242:243], v193 offset:32096
  v_mfma_f32_16x16x32_bf16 v[68:71], a[252:255], a[180:183], v[68:71]
  v_cmp_ge_f32 vcc, 0, v216
  v_mfma_f32_16x16x32_bf16 v[88:91], a[252:255], a[184:187], v[88:91]
  s_add_u32 m0, s50, 24576
  ds_read_b64_tr_b16 a[244:245], v193 offset:35936
  ds_read_b64_tr_b16 a[246:247], v193 offset:37216
  v_mfma_f32_16x16x32_bf16 v[88:91], a[248:251], a[172:175], v[88:91]
  v_cndmask_b32 v220, 0, v171, vcc
  s_mov_b32 s98, 0x7f8707f8
  v_mfma_f32_16x16x32_bf16 v[108:111], a[248:251], a[176:179], v[108:111]
  s_mov_b32 s99, 0x8000f87f
  buffer_load_dwordx4 v198, s[28:31], s51 offen offset:0 lds
  v_mfma_f32_16x16x32_bf16 v[108:111], a[252:255], a[188:191], v[108:111]
  s_waitcnt lgkmcnt(4)
  v_cndmask_b32 v217, v131, v127, s[88:89]
  v_mfma_f32_16x16x32_bf16 v[72:75], v[184:187], a[168:171], v[72:75]
  ds_read_b64_tr_b16 a[248:249], v193 offset:30848
  ds_read_b64_tr_b16 a[250:251], v193 offset:32128
  v_mfma_f32_16x16x32_bf16 v[72:75], v[188:191], a[180:183], v[72:75]
  s_waitcnt vmcnt(16)
  ds_read_b128 a[192:195], v244 offset:12544
  v_mul_f32 v217, v217, v201
  v_mfma_f32_16x16x32_bf16 v[92:95], v[188:191], a[184:187], v[92:95]
  ds_read_b64_tr_b16 a[252:253], v193 offset:35968
  ds_read_b64_tr_b16 a[254:255], v193 offset:37248
  v_mfma_f32_16x16x32_bf16 v[92:95], v[184:187], a[172:175], v[92:95]
  ds_read_b128 a[196:199], v244 offset:14592
  v_cndmask_b32 v217, 0, v217, s[98:99]
  v_mfma_f32_16x16x32_bf16 v[112:115], v[184:187], a[176:179], v[112:115]
  s_waitcnt vmcnt(11)
  v_mfma_f32_16x16x32_bf16 v[112:115], v[188:191], a[188:191], v[112:115]
  s_waitcnt lgkmcnt(6)
  ds_read_b128 a[200:203], v244 offset:16640
  v_cmp_ge_f32 vcc, 0, v217
  v_mfma_f32_16x16x32_bf16 v[76:79], a[240:243], a[168:171], v[76:79]
  s_barrier
  ds_read_b64_tr_b16 v[184:185], v192 offset:0
  ds_read_b64_tr_b16 v[186:187], v192 offset:1280
  v_mfma_f32_16x16x32_bf16 v[76:79], a[244:247], a[180:183], v[76:79]
  s_bfe_u32 s51, s74, 0x40000
  ds_read_b128 a[204:207], v245 offset:12544
  v_cndmask_b32 v221, 0, v171, vcc
  v_mfma_f32_16x16x32_bf16 v[96:99], a[244:247], a[184:187], v[96:99]
  s_mul_i32 s51, s51, 245760
  ds_read_b64_tr_b16 v[188:189], v192 offset:5120
  ds_read_b64_tr_b16 v[190:191], v192 offset:6400
  v_mfma_f32_16x16x32_bf16 v[96:99], a[240:243], a[172:175], v[96:99]
  s_add_u32 m0, s50, 40960
  ds_read_b128 a[208:211], v245 offset:14592
  v_mul_f32 v203, 0x3ea52b5c, v203
  v_mfma_f32_16x16x32_bf16 v[116:119], a[240:243], a[176:179], v[116:119]
  s_add_u32 s51, s51, s73
  buffer_load_dwordx4 v194, s[28:31], s51 offen offset:0 lds
  v_mfma_f32_16x16x32_bf16 v[116:119], a[244:247], a[188:191], v[116:119]
  s_waitcnt lgkmcnt(8)
  ds_read_b128 a[212:215], v245 offset:16640
  s_mov_b32 s98, 0xff000ff
  v_mfma_f32_16x16x32_bf16 v[80:83], a[248:251], a[168:171], v[80:83]
  s_mov_b32 s99, 0xf00fff00
  ds_read_b64_tr_b16 a[240:241], v192 offset:32
  ds_read_b64_tr_b16 a[242:243], v192 offset:1312
  v_mfma_f32_16x16x32_bf16 v[80:83], a[252:255], a[180:183], v[80:83]
  buffer_load_dwordx4 v195, s[28:31], s51 offen offset:1024 lds
  v_mfma_f32_16x16x32_bf16 v[100:103], a[252:255], a[184:187], v[100:103]
  ds_read_b64_tr_b16 a[244:245], v192 offset:5152
  ds_read_b64_tr_b16 a[246:247], v192 offset:6432
  v_mfma_f32_16x16x32_bf16 v[100:103], a[248:251], a[172:175], v[100:103]
  v_cndmask_b32 v222, v132, v128, s[90:91]
  v_mul_f32 v222, v222, v203
  v_mfma_f32_16x16x32_bf16 v[120:123], a[248:251], a[176:179], v[120:123]
  v_cndmask_b32 v222, 0, v222, s[98:99]
  v_mfma_f32_16x16x32_bf16 v[120:123], a[252:255], a[188:191], v[120:123]
  s_waitcnt lgkmcnt(4)
  v_mfma_f32_16x16x32_bf16 v[4:7], v[184:187], a[192:195], v[4:7]
  ds_read_b64_tr_b16 a[248:249], v192 offset:64
  ds_read_b64_tr_b16 a[250:251], v192 offset:1344
  v_mfma_f32_16x16x32_bf16 v[4:7], v[188:191], a[204:207], v[4:7]
  v_cmp_ge_f32 vcc, 0, v222
  v_mfma_f32_16x16x32_bf16 v[24:27], v[188:191], a[208:211], v[24:27]
  ds_read_b64_tr_b16 a[252:253], v192 offset:5184
  ds_read_b64_tr_b16 a[254:255], v192 offset:6464
  v_mfma_f32_16x16x32_bf16 v[24:27], v[184:187], a[196:199], v[24:27]
  buffer_load_dwordx4 v196, s[28:31], s51 offen offset:2048 lds
  v_mfma_f32_16x16x32_bf16 v[44:47], v[184:187], a[200:203], v[44:47]
  v_cndmask_b32 v226, 0, v171, vcc
  s_mov_b32 s98, 0x1fe001fe
  v_mfma_f32_16x16x32_bf16 v[44:47], v[188:191], a[212:215], v[44:47]
  s_waitcnt lgkmcnt(4)
  s_mov_b32 s99, 0xe01ffe01
  v_mfma_f32_16x16x32_bf16 v[8:11], a[240:243], a[192:195], v[8:11]
  ds_read_b64_tr_b16 v[184:185], v192 offset:96
  ds_read_b64_tr_b16 v[186:187], v192 offset:1376
  v_mfma_f32_16x16x32_bf16 v[8:11], a[244:247], a[204:207], v[8:11]
  v_cndmask_b32 v223, v133, v129, s[92:93]
  v_mfma_f32_16x16x32_bf16 v[28:31], a[244:247], a[208:211], v[28:31]
  ds_read_b64_tr_b16 v[188:189], v192 offset:5216
  ds_read_b64_tr_b16 v[190:191], v192 offset:6496
  v_mfma_f32_16x16x32_bf16 v[28:31], a[240:243], a[196:199], v[28:31]
  buffer_load_dwordx4 v197, s[28:31], s51 offen offset:3072 lds
  v_mfma_f32_16x16x32_bf16 v[48:51], a[240:243], a[200:203], v[48:51]
  global_load_dword v176, v[176:177], off
  v_mfma_f32_16x16x32_bf16 v[48:51], a[244:247], a[212:215], v[48:51]
  s_waitcnt lgkmcnt(4)
  v_mul_f32 v223, v223, v203
  v_cndmask_b32 v223, 0, v223, s[98:99]
  v_mfma_f32_16x16x32_bf16 v[12:15], a[248:251], a[192:195], v[12:15]
  ds_read_b64_tr_b16 a[240:241], v192 offset:128
  ds_read_b64_tr_b16 a[242:243], v192 offset:1408
  v_mfma_f32_16x16x32_bf16 v[12:15], a[252:255], a[204:207], v[12:15]
  v_cmp_ge_f32 vcc, 0, v223
  v_mfma_f32_16x16x32_bf16 v[32:35], a[252:255], a[208:211], v[32:35]
  s_add_u32 m0, s50, 45056
  ds_read_b64_tr_b16 a[244:245], v192 offset:5248
  ds_read_b64_tr_b16 a[246:247], v192 offset:6528
  v_mfma_f32_16x16x32_bf16 v[32:35], a[248:251], a[196:199], v[32:35]
  v_cndmask_b32 v227, 0, v171, vcc
  s_mov_b32 s98, 0x3fc003fc
  v_mfma_f32_16x16x32_bf16 v[52:55], a[248:251], a[200:203], v[52:55]
  s_mov_b32 s99, 0xc03ffc03
  buffer_load_dwordx4 v198, s[28:31], s51 offen offset:0 lds
  v_mfma_f32_16x16x32_bf16 v[52:55], a[252:255], a[212:215], v[52:55]
  s_waitcnt lgkmcnt(4)
  v_cndmask_b32 v224, v134, v130, s[94:95]
  v_mfma_f32_16x16x32_bf16 v[16:19], v[184:187], a[192:195], v[16:19]
AHOP2:
  s_cbranch_execz AHOP6
  ds_read_b64_tr_b16 a[248:249], v192 offset:10240
  ds_read_b64_tr_b16 a[250:251], v192 offset:11520
  v_mfma_f32_16x16x32_bf16 v[16:19], v[188:191], a[204:207], v[16:19]
  v_mfma_f32_16x16x32_bf16 v[36:39], v[188:191], a[208:211], v[36:39]
  ds_read_b64_tr_b16 a[252:253], v192 offset:15360
  ds_read_b64_tr_b16 a[254:255], v192 offset:16640
  v_mfma_f32_16x16x32_bf16 v[36:39], v[184:187], a[196:199], v[36:39]
  v_mul_f32 v224, v224, v203
  v_mfma_f32_16x16x32_bf16 v[56:59], v[184:187], a[200:203], v[56:59]
  v_cndmask_b32 v224, 0, v224, s[98:99]
  v_mfma_f32_16x16x32_bf16 v[56:59], v[188:191], a[212:215], v[56:59]
  s_waitcnt lgkmcnt(4)
  v_mfma_f32_16x16x32_bf16 v[20:23], a[240:243], a[192:195], v[20:23]
  ds_read_b64_tr_b16 v[184:185], v192 offset:10272
  ds_read_b64_tr_b16 v[186:187], v192 offset:11552
  v_mfma_f32_16x16x32_bf16 v[20:23], a[244:247], a[204:207], v[20:23]
  v_cmp_ge_f32 vcc, 0, v224
  v_mfma_f32_16x16x32_bf16 v[40:43], a[244:247], a[208:211], v[40:43]
  ds_read_b64_tr_b16 v[188:189], v192 offset:15392
  ds_read_b64_tr_b16 v[190:191], v192 offset:16672
  v_mfma_f32_16x16x32_bf16 v[40:43], a[240:243], a[196:199], v[40:43]
  v_cndmask_b32 v228, 0, v171, vcc
  s_mov_b32 s98, 0x7f8007f8
  v_mfma_f32_16x16x32_bf16 v[60:63], a[240:243], a[200:203], v[60:63]
  s_mov_b32 s99, 0x807ff807
  v_mfma_f32_16x16x32_bf16 v[60:63], a[244:247], a[212:215], v[60:63]
  s_waitcnt lgkmcnt(4)
  v_cndmask_b32 v225, v135, v131, s[96:97]
  v_mfma_f32_16x16x32_bf16 v[64:67], a[248:251], a[192:195], v[64:67]
  ds_read_b64_tr_b16 a[240:241], v192 offset:10304
  ds_read_b64_tr_b16 a[242:243], v192 offset:11584
  v_mfma_f32_16x16x32_bf16 v[64:67], a[252:255], a[204:207], v[64:67]
  v_mfma_f32_16x16x32_bf16 v[84:87], a[252:255], a[208:211], v[84:87]
  ds_read_b64_tr_b16 a[244:245], v192 offset:15424
  ds_read_b64_tr_b16 a[246:247], v192 offset:16704
  v_mfma_f32_16x16x32_bf16 v[84:87], a[248:251], a[196:199], v[84:87]
  v_mul_f32 v225, v225, v203
  v_mfma_f32_16x16x32_bf16 v[104:107], a[248:251], a[200:203], v[104:107]
  v_cndmask_b32 v225, 0, v225, s[98:99]
  v_mfma_f32_16x16x32_bf16 v[104:107], a[252:255], a[212:215], v[104:107]
  s_waitcnt lgkmcnt(4)
  v_mfma_f32_16x16x32_bf16 v[68:71], v[184:187], a[192:195], v[68:71]
  ds_read_b64_tr_b16 a[248:249], v192 offset:10336
  ds_read_b64_tr_b16 a[250:251], v192 offset:11616
  v_mfma_f32_16x16x32_bf16 v[68:71], v[188:191], a[204:207], v[68:71]
  v_cmp_ge_f32 vcc, 0, v225
  v_mfma_f32_16x16x32_bf16 v[88:91], v[188:191], a[208:211], v[88:91]
  ds_read_b64_tr_b16 a[252:253], v192 offset:15456
  ds_read_b64_tr_b16 a[254:255], v192 offset:16736
  v_mfma_f32_16x16x32_bf16 v[88:91], v[184:187], a[196:199], v[88:91]
  v_cndmask_b32 v229, 0, v171, vcc
  v_mfma_f32_16x16x32_bf16 v[108:111], v[184:187], a[200:203], v[108:111]
  v_mfma_f32_16x16x32_bf16 v[108:111], v[188:191], a[212:215], v[108:111]
  s_waitcnt lgkmcnt(4)
  v_mul_f32 v205, 0x3ea52b5c, v205
  s_mov_b32 s98, 0xff000ff
  v_mfma_f32_16x16x32_bf16 v[72:75], a[240:243], a[192:195], v[72:75]
  s_mov_b32 s99, 0xf00fff00
  ds_read_b64_tr_b16 v[184:185], v192 offset:10368
  ds_read_b64_tr_b16 v[186:187], v192 offset:11648
  v_mfma_f32_16x16x32_bf16 v[72:75], a[244:247], a[204:207], v[72:75]
  s_waitcnt vmcnt(11)
  ds_read_b128 a[216:219], v244 offset:0
  v_cndmask_b32 v230, v136, v132, s[90:91]
  v_mfma_f32_16x16x32_bf16 v[92:95], a[244:247], a[208:211], v[92:95]
  ds_read_b64_tr_b16 v[188:189], v192 offset:15488
  ds_read_b64_tr_b16 v[190:191], v192 offset:16768
  v_mfma_f32_16x16x32_bf16 v[92:95], a[240:243], a[196:199], v[92:95]
  ds_read_b128 a[220:223], v244 offset:2048
  v_mfma_f32_16x16x32_bf16 v[112:115], a[240:243], a[200:203], v[112:115]
  s_waitcnt vmcnt(6)
  v_mul_f32 v230, v230, v205
  v_mfma_f32_16x16x32_bf16 v[112:115], a[244:247], a[212:215], v[112:115]
  s_waitcnt lgkmcnt(6)
  ds_read_b128 a[224:227], v244 offset:4096
  v_mfma_f32_16x16x32_bf16 v[76:79], a[248:251], a[192:195], v[76:79]
  s_barrier
  ds_read_b64_tr_b16 a[240:241], v192 offset:20480
  ds_read_b64_tr_b16 a[242:243], v192 offset:21760
  v_mfma_f32_16x16x32_bf16 v[76:79], a[252:255], a[204:207], v[76:79]
  s_bfe_u32 s51, s74, 0x40008
  ds_read_b128 a[228:231], v245 offset:0
  v_cndmask_b32 v230, 0, v230, s[98:99]
  v_mfma_f32_16x16x32_bf16 v[96:99], a[252:255], a[208:211], v[96:99]
  s_mul_i32 s51, s51, 245760
  ds_read_b64_tr_b16 a[244:245], v192 offset:25600
  ds_read_b64_tr_b16 a[246:247], v192 offset:26880
  v_mfma_f32_16x16x32_bf16 v[96:99], a[248:251], a[196:199], v[96:99]
  s_add_u32 m0, s50, 61440
  ds_read_b128 a[232:235], v245 offset:2048
  v_cmp_ge_f32 vcc, 0, v230
  v_mfma_f32_16x16x32_bf16 v[116:119], a[248:251], a[200:203], v[116:119]
  s_add_u32 s51, s51, s73
  buffer_load_dwordx4 v194, s[28:31], s51 offen offset:0 lds
  v_mfma_f32_16x16x32_bf16 v[116:119], a[252:255], a[212:215], v[116:119]
  s_waitcnt lgkmcnt(8)
  ds_read_b128 a[236:239], v245 offset:4096
  v_cndmask_b32 v234, 0, v171, vcc
  v_mfma_f32_16x16x32_bf16 v[80:83], v[184:187], a[192:195], v[80:83]
  s_mov_b32 s98, 0x1fe001fe
  ds_read_b64_tr_b16 a[248:249], v192 offset:20512
  ds_read_b64_tr_b16 a[250:251], v192 offset:21792
  v_mfma_f32_16x16x32_bf16 v[80:83], v[188:191], a[204:207], v[80:83]
  s_mov_b32 s99, 0xe01ffe01
  buffer_load_dwordx4 v195, s[28:31], s51 offen offset:1024 lds
  v_mfma_f32_16x16x32_bf16 v[100:103], v[188:191], a[208:211], v[100:103]
  ds_read_b64_tr_b16 a[252:253], v192 offset:25632
  ds_read_b64_tr_b16 a[254:255], v192 offset:26912
  v_mfma_f32_16x16x32_bf16 v[100:103], v[184:187], a[196:199], v[100:103]
  v_cndmask_b32 v231, v137, v133, s[92:93]
  v_mul_f32 v231, v231, v205
  v_mfma_f32_16x16x32_bf16 v[120:123], v[184:187], a[200:203], v[120:123]
  v_mfma_f32_16x16x32_bf16 v[120:123], v[188:191], a[212:215], v[120:123]
  s_waitcnt lgkmcnt(4)
  v_mfma_f32_16x16x32_bf16 v[4:7], a[240:243], a[216:219], v[4:7]
  ds_read_b64_tr_b16 v[184:185], v192 offset:20544
  ds_read_b64_tr_b16 v[186:187], v192 offset:21824
  v_mfma_f32_16x16x32_bf16 v[4:7], a[244:247], a[228:231], v[4:7]
  buffer_load_dwordx4 v196, s[28:31], s51 offen offset:2048 lds
  v_mfma_f32_16x16x32_bf16 v[24:27], a[244:247], a[232:235], v[24:27]
  ds_read_b64_tr_b16 v[188:189], v192 offset:25664
  ds_read_b64_tr_b16 v[190:191], v192 offset:26944
  v_mfma_f32_16x16x32_bf16 v[24:27], a[240:243], a[220:223], v[24:27]
  v_cndmask_b32 v231, 0, v231, s[98:99]
  v_cmp_ge_f32 vcc, 0, v231
  v_mfma_f32_16x16x32_bf16 v[44:47], a[240:243], a[224:227], v[44:47]
  v_mfma_f32_16x16x32_bf16 v[44:47], a[244:247], a[236:239], v[44:47]
  s_waitcnt lgkmcnt(4)
  v_cndmask_b32 v235, 0, v171, vcc
  s_mov_b32 s98, 0x3fc003fc
  v_mfma_f32_16x16x32_bf16 v[8:11], a[248:251], a[216:219], v[8:11]
  s_mov_b32 s99, 0xc03ffc03
  ds_read_b64_tr_b16 a[240:241], v192 offset:20576
  ds_read_b64_tr_b16 a[242:243], v192 offset:21856
  v_mfma_f32_16x16x32_bf16 v[8:11], a[252:255], a[228:231], v[8:11]
  buffer_load_dwordx4 v197, s[28:31], s51 offen offset:3072 lds
  v_mfma_f32_16x16x32_bf16 v[28:31], a[252:255], a[232:235], v[28:31]
  ds_read_b64_tr_b16 a[244:245], v192 offset:25696
  ds_read_b64_tr_b16 a[246:247], v192 offset:26976
  v_mfma_f32_16x16x32_bf16 v[28:31], a[248:251], a[220:223], v[28:31]
  s_add_u32 m0, s50, 65536
  v_cndmask_b32 v232, v138, v134, s[94:95]
  v_mul_f32 v232, v232, v205
  v_mfma_f32_16x16x32_bf16 v[48:51], a[248:251], a[224:227], v[48:51]
  v_mfma_f32_16x16x32_bf16 v[48:51], a[252:255], a[236:239], v[48:51]
  s_waitcnt lgkmcnt(4)
  buffer_load_dwordx4 v198, s[28:31], s51 offen offset:0 lds
  v_mfma_f32_16x16x32_bf16 v[12:15], v[184:187], a[216:219], v[12:15]
  ds_read_b64_tr_b16 a[248:249], v192 offset:20608
  ds_read_b64_tr_b16 a[250:251], v192 offset:21888
  v_mfma_f32_16x16x32_bf16 v[12:15], v[188:191], a[228:231], v[12:15]
  v_cndmask_b32 v232, 0, v232, s[98:99]
  v_mfma_f32_16x16x32_bf16 v[32:35], v[188:191], a[232:235], v[32:35]
  ds_read_b64_tr_b16 a[252:253], v192 offset:25728
  ds_read_b64_tr_b16 a[254:255], v192 offset:27008
  v_mfma_f32_16x16x32_bf16 v[32:35], v[184:187], a[220:223], v[32:35]
  v_cmp_ge_f32 vcc, 0, v232
  v_mfma_f32_16x16x32_bf16 v[52:55], v[184:187], a[224:227], v[52:55]
  v_mfma_f32_16x16x32_bf16 v[52:55], v[188:191], a[236:239], v[52:55]
  s_waitcnt lgkmcnt(4)
  s_bfm_b64 exec, 32, 32
  buffer_load_dword v254, v251, s[36:39], 0 offen sc1
  s_mov_b64 exec, -1
  v_mfma_f32_16x16x32_bf16 v[16:19], a[240:243], a[216:219], v[16:19]
  ds_read_b64_tr_b16 v[184:185], v192 offset:30720
  ds_read_b64_tr_b16 v[186:187], v192 offset:32000
  v_mfma_f32_16x16x32_bf16 v[16:19], a[244:247], a[228:231], v[16:19]
  v_cndmask_b32 v236, 0, v171, vcc
  s_mov_b32 s98, 0x7f8007f8
  v_mfma_f32_16x16x32_bf16 v[36:39], a[244:247], a[232:235], v[36:39]
  s_mov_b32 s99, 0x807ff807
  ds_read_b64_tr_b16 v[188:189], v192 offset:35840
  ds_read_b64_tr_b16 v[190:191], v192 offset:37120
  v_mfma_f32_16x16x32_bf16 v[36:39], a[240:243], a[220:223], v[36:39]
  v_cndmask_b32 v233, v139, v135, s[96:97]
  v_mul_f32 v233, v233, v205
  v_mfma_f32_16x16x32_bf16 v[56:59], a[240:243], a[224:227], v[56:59]
  v_mfma_f32_16x16x32_bf16 v[56:59], a[244:247], a[236:239], v[56:59]
  s_waitcnt lgkmcnt(4)
  v_cndmask_b32 v233, 0, v233, s[98:99]
  v_mfma_f32_16x16x32_bf16 v[20:23], a[248:251], a[216:219], v[20:23]
  ds_read_b64_tr_b16 a[240:241], v192 offset:30752
  ds_read_b64_tr_b16 a[242:243], v192 offset:32032
  v_mfma_f32_16x16x32_bf16 v[20:23], a[252:255], a[228:231], v[20:23]
  v_mfma_f32_16x16x32_bf16 v[40:43], a[252:255], a[232:235], v[40:43]
  ds_read_b64_tr_b16 a[244:245], v192 offset:35872
  ds_read_b64_tr_b16 a[246:247], v192 offset:37152
  v_mfma_f32_16x16x32_bf16 v[40:43], a[248:251], a[220:223], v[40:43]
  v_cmp_ge_f32 vcc, 0, v233
  v_mfma_f32_16x16x32_bf16 v[60:63], a[248:251], a[224:227], v[60:63]
  v_mfma_f32_16x16x32_bf16 v[60:63], a[252:255], a[236:239], v[60:63]
  s_waitcnt lgkmcnt(4)
  v_cndmask_b32 v237, 0, v171, vcc
AC1:
  v_mfma_f32_16x16x32_bf16 v[64:67], v[184:187], a[216:219], v[64:67]
  ds_read_b64_tr_b16 a[248:249], v192 offset:30784
  ds_read_b64_tr_b16 a[250:251], v192 offset:32064
  v_mfma_f32_16x16x32_bf16 v[64:67], v[188:191], a[228:231], v[64:67]
  v_mfma_f32_16x16x32_bf16 v[84:87], v[188:191], a[232:235], v[84:87]
  ds_read_b64_tr_b16 a[252:253], v192 offset:35904
  ds_read_b64_tr_b16 a[254:255], v192 offset:37184
  v_mfma_f32_16x16x32_bf16 v[84:87], v[184:187], a[220:223], v[84:87]
  v_fmac_f32_dpp v44, v4, v204 row_newbcast:0 row_mask:0xf bank_mask:0xf
  v_fmac_f32_dpp v45, v5, v204 row_newbcast:0 row_mask:0xf bank_mask:0xf
  v_mfma_f32_16x16x32_bf16 v[104:107], v[184:187], a[224:227], v[104:107]
  v_fmac_f32_dpp v46, v6, v204 row_newbcast:0 row_mask:0xf bank_mask:0xf
  v_fmac_f32_dpp v47, v7, v204 row_newbcast:0 row_mask:0xf bank_mask:0xf
  v_mfma_f32_16x16x32_bf16 v[104:107], v[188:191], a[236:239], v[104:107]
  s_waitcnt lgkmcnt(4)
  v_fmac_f32_dpp v48, v8, v204 row_newbcast:0 row_mask:0xf bank_mask:0xf
  v_fmac_f32_dpp v49, v9, v204 row_newbcast:0 row_mask:0xf bank_mask:0xf
  v_mfma_f32_16x16x32_bf16 v[68:71], a[240:243], a[216:219], v[68:71]
  ds_read_b64_tr_b16 v[184:185], v192 offset:30816
  ds_read_b64_tr_b16 v[186:187], v192 offset:32096
  v_mfma_f32_16x16x32_bf16 v[68:71], a[244:247], a[228:231], v[68:71]
  v_fmac_f32_dpp v50, v10, v204 row_newbcast:0 row_mask:0xf bank_mask:0xf
  v_fmac_f32_dpp v51, v11, v204 row_newbcast:0 row_mask:0xf bank_mask:0xf
  v_mfma_f32_16x16x32_bf16 v[88:91], a[244:247], a[232:235], v[88:91]
  ds_read_b64_tr_b16 v[188:189], v192 offset:35936
  ds_read_b64_tr_b16 v[190:191], v192 offset:37216
  v_mfma_f32_16x16x32_bf16 v[88:91], a[240:243], a[220:223], v[88:91]
  v_fmac_f32_dpp v52, v12, v204 row_newbcast:0 row_mask:0xf bank_mask:0xf
  v_fmac_f32_dpp v53, v13, v204 row_newbcast:0 row_mask:0xf bank_mask:0xf
  v_mfma_f32_16x16x32_bf16 v[108:111], a[240:243], a[224:227], v[108:111]
  v_fmac_f32_dpp v54, v14, v204 row_newbcast:0 row_mask:0xf bank_mask:0xf
  v_fmac_f32_dpp v55, v15, v204 row_newbcast:0 row_mask:0xf bank_mask:0xf
  v_mfma_f32_16x16x32_bf16 v[108:111], a[244:247], a[236:239], v[108:111]
  s_waitcnt lgkmcnt(4)
  v_fmac_f32_dpp v56, v16, v204 row_newbcast:0 row_mask:0xf bank_mask:0xf
  v_fmac_f32_dpp v57, v17, v204 row_newbcast:0 row_mask:0xf bank_mask:0xf
  v_mfma_f32_16x16x32_bf16 v[72:75], a[248:251], a[216:219], v[72:75]
  ds_read_b64_tr_b16 a[240:241], v192 offset:30848
  ds_read_b64_tr_b16 a[242:243], v192 offset:32128
  v_mfma_f32_16x16x32_bf16 v[72:75], a[252:255], a[228:231], v[72:75]
  v_fmac_f32_dpp v58, v18, v204 row_newbcast:0 row_mask:0xf bank_mask:0xf
  v_fmac_f32_dpp v59, v19, v204 row_newbcast:0 row_mask:0xf bank_mask:0xf
  v_mfma_f32_16x16x32_bf16 v[92:95], a[252:255], a[232:235], v[92:95]
  ds_read_b64_tr_b16 a[244:245], v192 offset:35968
  ds_read_b64_tr_b16 a[246:247], v192 offset:37248
  v_mfma_f32_16x16x32_bf16 v[92:95], a[248:251], a[220:223], v[92:95]
  v_fmac_f32_dpp v60, v20, v204 row_newbcast:0 row_mask:0xf bank_mask:0xf
  v_fmac_f32_dpp v61, v21, v204 row_newbcast:0 row_mask:0xf bank_mask:0xf
  v_mfma_f32_16x16x32_bf16 v[112:115], a[248:251], a[224:227], v[112:115]
  s_waitcnt vmcnt(6)
  v_fmac_f32_dpp v62, v22, v204 row_newbcast:0 row_mask:0xf bank_mask:0xf
  v_fmac_f32_dpp v63, v23, v204 row_newbcast:0 row_mask:0xf bank_mask:0xf
  v_mfma_f32_16x16x32_bf16 v[112:115], a[252:255], a[236:239], v[112:115]
  s_waitcnt lgkmcnt(4)
  v_cvt_pk_bf16_f32 v44, v44, v45
  v_cvt_pk_bf16_f32 v45, v46, v47
  v_mfma_f32_16x16x32_bf16 v[76:79], v[184:187], a[216:219], v[76:79]
  s_barrier
  ds_read_b64_tr_b16 a[248:249], v193 offset:0
  ds_read_b64_tr_b16 a[250:251], v193 offset:1280
  v_mfma_f32_16x16x32_bf16 v[76:79], v[188:191], a[228:231], v[76:79]
  s_bfe_u32 s51, s74, 0x40010
  v_cvt_pk_bf16_f32 v46, v48, v49
  v_cvt_pk_bf16_f32 v47, v50, v51
  v_mfma_f32_16x16x32_bf16 v[96:99], v[188:191], a[232:235], v[96:99]
  s_mul_i32 s51, s51, 245760
  ds_read_b64_tr_b16 a[252:253], v193 offset:5120
  ds_read_b64_tr_b16 a[254:255], v193 offset:6400
  v_mfma_f32_16x16x32_bf16 v[96:99], v[184:187], a[220:223], v[96:99]
  s_add_u32 m0, s50, 0
  v_cvt_pk_bf16_f32 v48, v52, v53
  v_cvt_pk_bf16_f32 v49, v54, v55
  v_mfma_f32_16x16x32_bf16 v[116:119], v[184:187], a[224:227], v[116:119]
  s_add_u32 s51, s51, s73
  buffer_load_dwordx4 v194, s[28:31], s51 offen offset:0 lds
  v_mfma_f32_16x16x32_bf16 v[116:119], v[188:191], a[236:239], v[116:119]
  s_waitcnt lgkmcnt(4)
  buffer_load_dwordx4 v195, s[28:31], s51 offen offset:1024 lds
  v_mfma_f32_16x16x32_bf16 v[80:83], a[240:243], a[216:219], v[80:83]
  ds_read_b64_tr_b16 v[184:185], v193 offset:32
  ds_read_b64_tr_b16 v[186:187], v193 offset:1312
  v_mfma_f32_16x16x32_bf16 v[80:83], a[244:247], a[228:231], v[80:83]
  v_cvt_pk_bf16_f32 v50, v56, v57
  v_cvt_pk_bf16_f32 v51, v58, v59
  v_mfma_f32_16x16x32_bf16 v[100:103], a[244:247], a[232:235], v[100:103]
  ds_read_b64_tr_b16 v[188:189], v193 offset:5152
  ds_read_b64_tr_b16 v[190:191], v193 offset:6432
  v_mfma_f32_16x16x32_bf16 v[100:103], a[240:243], a[220:223], v[100:103]
  buffer_load_dwordx4 v196, s[28:31], s51 offen offset:2048 lds
  v_mfma_f32_16x16x32_bf16 v[120:123], a[240:243], a[224:227], v[120:123]
  v_cvt_pk_bf16_f32 v52, v60, v61
  v_cvt_pk_bf16_f32 v53, v62, v63
  v_mfma_f32_16x16x32_bf16 v[120:123], a[244:247], a[236:239], v[120:123]
  s_waitcnt lgkmcnt(4)
  ds_write_b64 v211, v[44:45] offset:0
  v_mfma_f32_16x16x32_bf16 v[124:127], a[0:3], a[248:251], 0
  ds_read_b64_tr_b16 a[240:241], v193 offset:64
  ds_read_b64_tr_b16 a[242:243], v193 offset:1344
  v_mfma_f32_16x16x32_bf16 v[124:127], a[12:15], a[252:255], v[124:127]
  buffer_load_dwordx4 v197, s[28:31], s51 offen offset:3072 lds
  v_mfma_f32_16x16x32_bf16 v[128:131], a[16:19], a[252:255], 0
  s_add_u32 m0, s50, 4096
  ds_read_b64_tr_b16 a[244:245], v193 offset:5184
  ds_read_b64_tr_b16 a[246:247], v193 offset:6464
  v_mfma_f32_16x16x32_bf16 v[128:131], a[4:7], a[248:251], v[128:131]
  buffer_load_dwordx4 v198, s[28:31], s51 offen offset:0 lds
  v_mfma_f32_16x16x32_bf16 v[132:135], a[8:11], a[248:251], 0
  ds_write_b64 v211, v[46:47] offset:512
  v_mfma_f32_16x16x32_bf16 v[132:135], a[20:23], a[252:255], v[132:135]
  s_waitcnt lgkmcnt(6)
  ds_write_b64 v211, v[48:49] offset:1024
  v_mfma_f32_16x16x32_bf16 v[136:139], a[0:3], v[184:187], 0
  ds_read_b64_tr_b16 a[248:249], v193 offset:96
  ds_read_b64_tr_b16 a[250:251], v193 offset:1376
  v_mfma_f32_16x16x32_bf16 v[136:139], a[12:15], v[188:191], v[136:139]
  s_waitcnt vmcnt(5)
  v_cmp_ne_u32 vcc, v254, v249
  v_fmac_f32_dpp v24, v4, v202 row_newbcast:0 row_mask:0xf bank_mask:0xf
  v_mfma_f32_16x16x32_bf16 v[140:143], a[16:19], v[188:191], 0
  ds_read_b64_tr_b16 a[252:253], v193 offset:5216
  ds_read_b64_tr_b16 a[254:255], v193 offset:6496
  v_mfma_f32_16x16x32_bf16 v[140:143], a[4:7], v[184:187], v[140:143]
  s_cmp_lg_u32 vcc_hi, 0
  s_cbranch_scc1 SAo
BAo:
  ds_write_b64 v211, v[50:51] offset:1536
  v_mfma_f32_16x16x32_bf16 v[144:147], a[8:11], v[184:187], 0
  s_bfe_u32 s49, s62, 0x40000
  s_mul_i32 s49, s49, 5120
  s_add_u32 s49, s49, s66
  s_add_u32 m0, s22, 126976
  v_mfma_f32_16x16x32_bf16 v[144:147], a[20:23], v[188:191], v[144:147]
  s_waitcnt lgkmcnt(7)
  buffer_load_dwordx4 v248, s[36:39], s49 offen offset:0 sc1 lds
  v_mfma_f32_16x16x32_bf16 v[148:151], a[0:3], a[240:243], 0
  ds_read_b64_tr_b16 v[184:185], v193 offset:128
  ds_read_b64_tr_b16 v[186:187], v193 offset:1408
  v_mfma_f32_16x16x32_bf16 v[148:151], a[12:15], a[244:247], v[148:151]
  buffer_load_dwordx4 v248, s[36:39], s49 offen offset:1024 sc1 lds
  v_mfma_f32_16x16x32_bf16 v[152:155], a[16:19], a[244:247], 0
  ds_read_b64_tr_b16 v[188:189], v193 offset:5248
  ds_read_b64_tr_b16 v[190:191], v193 offset:6528
  v_mfma_f32_16x16x32_bf16 v[152:155], a[4:7], a[240:243], v[152:155]
  ds_write_b64 v211, v[52:53] offset:2048
  v_mfma_f32_16x16x32_bf16 v[156:159], a[8:11], a[240:243], 0
  v_fmac_f32_dpp v25, v5, v202 row_newbcast:0 row_mask:0xf bank_mask:0xf
  v_fmac_f32_dpp v26, v6, v202 row_newbcast:0 row_mask:0xf bank_mask:0xf
  v_mfma_f32_16x16x32_bf16 v[156:159], a[20:23], a[244:247], v[156:159]
  s_waitcnt lgkmcnt(6)
  buffer_load_dwordx4 v248, s[36:39], s49 offen offset:2048 sc1 lds
  v_mfma_f32_16x16x32_bf16 v[160:163], a[0:3], a[248:251], 0
  ds_read_b64_tr_b16 a[240:241], v193 offset:10240
  ds_read_b64_tr_b16 a[242:243], v193 offset:11520
  v_mfma_f32_16x16x32_bf16 v[160:163], a[12:15], a[252:255], v[160:163]
  v_fmac_f32_dpp v27, v7, v202 row_newbcast:0 row_mask:0xf bank_mask:0xf
  v_fmac_f32_dpp v28, v8, v202 row_newbcast:0 row_mask:0xf bank_mask:0xf
  v_mfma_f32_16x16x32_bf16 v[164:167], a[16:19], a[252:255], 0
  ds_read_b64_tr_b16 a[244:245], v193 offset:15360
  ds_read_b64_tr_b16 a[246:247], v193 offset:16640
  v_mfma_f32_16x16x32_bf16 v[164:167], a[4:7], a[248:251], v[164:167]
  v_fmac_f32_dpp v29, v9, v202 row_newbcast:0 row_mask:0xf bank_mask:0xf
  v_fmac_f32_dpp v30, v10, v202 row_newbcast:0 row_mask:0xf bank_mask:0xf
  v_mfma_f32_16x16x32_bf16 v[168:171], a[8:11], a[248:251], 0
  v_fmac_f32_dpp v31, v11, v202 row_newbcast:0 row_mask:0xf bank_mask:0xf
  v_fmac_f32_dpp v32, v12, v202 row_newbcast:0 row_mask:0xf bank_mask:0xf
  v_mfma_f32_16x16x32_bf16 v[168:171], a[20:23], a[252:255], v[168:171]
  s_waitcnt lgkmcnt(5)
  buffer_load_dwordx4 v248, s[36:39], s49 offen offset:3072 sc1 lds
  v_mfma_f32_16x16x32_bf16 v[172:175], a[0:3], v[184:187], 0
  s_add_u32 s49, s49, 4096
  ds_read_b64_tr_b16 a[248:249], v193 offset:10272
  ds_read_b64_tr_b16 a[250:251], v193 offset:11552
  s_add_u32 m0, s22, 131072
  v_fmac_f32_dpp v33, v13, v202 row_newbcast:0 row_mask:0xf bank_mask:0xf
  v_fmac_f32_dpp v34, v14, v202 row_newbcast:0 row_mask:0xf bank_mask:0xf
  v_mfma_f32_16x16x32_bf16 v[172:175], a[12:15], v[188:191], v[172:175]
  v_fmac_f32_dpp v35, v15, v202 row_newbcast:0 row_mask:0xf bank_mask:0xf
  v_fmac_f32_dpp v36, v16, v202 row_newbcast:0 row_mask:0xf bank_mask:0xf
  v_mfma_f32_16x16x32_bf16 v[176:179], a[16:19], v[188:191], 0
  ds_read_b64_tr_b16 a[252:253], v193 offset:15392
  ds_read_b64_tr_b16 a[254:255], v193 offset:16672
  buffer_load_dwordx4 v248, s[36:39], s49 offen offset:0 sc1 lds
  v_mfma_f32_16x16x32_bf16 v[176:179], a[4:7], v[184:187], v[176:179]
  s_bfe_u32 s49, s62, 0x40004
  v_fmac_f32_dpp v37, v17, v202 row_newbcast:0 row_mask:0xf bank_mask:0xf
  v_fmac_f32_dpp v38, v18, v202 row_newbcast:0 row_mask:0xf bank_mask:0xf
  v_mfma_f32_16x16x32_bf16 v[180:183], a[8:11], v[184:187], 0
  s_mul_i32 s49, s49, 5120
  s_add_u32 s49, s49, s66
  s_add_u32 m0, s22, 106496
  v_fmac_f32_dpp v39, v19, v202 row_newbcast:0 row_mask:0xf bank_mask:0xf
  v_mfma_f32_16x16x32_bf16 v[180:183], a[20:23], v[188:191], v[180:183]
  s_waitcnt lgkmcnt(4)
  v_fmac_f32_dpp v40, v20, v202 row_newbcast:0 row_mask:0xf bank_mask:0xf
  v_fmac_f32_dpp v41, v21, v202 row_newbcast:0 row_mask:0xf bank_mask:0xf
  v_mfma_f32_16x16x32_bf16 v[124:127], a[24:27], a[240:243], v[124:127]
  ds_read_b64_tr_b16 v[184:185], v193 offset:10304
  ds_read_b64_tr_b16 v[186:187], v193 offset:11584
  buffer_load_dwordx4 v248, s[36:39], s49 offen offset:0 sc1 lds
  v_fmac_f32_dpp v42, v22, v202 row_newbcast:0 row_mask:0xf bank_mask:0xf
  v_mfma_f32_16x16x32_bf16 v[124:127], a[36:39], a[244:247], v[124:127]
  v_fmac_f32_dpp v43, v23, v202 row_newbcast:0 row_mask:0xf bank_mask:0xf
  v_cvt_pk_bf16_f32 v24, v24, v25
  v_mfma_f32_16x16x32_bf16 v[128:131], a[40:43], a[244:247], v[128:131]
  ds_read_b64_tr_b16 v[188:189], v193 offset:15424
  ds_read_b64_tr_b16 v[190:191], v193 offset:16704
  v_mfma_f32_16x16x32_bf16 v[128:131], a[28:31], a[240:243], v[128:131]
  v_cvt_pk_bf16_f32 v25, v26, v27
  v_cvt_pk_bf16_f32 v26, v28, v29
  v_mfma_f32_16x16x32_bf16 v[132:135], a[32:35], a[240:243], v[132:135]
  buffer_load_dwordx4 v248, s[36:39], s49 offen offset:1024 sc1 lds
  s_bfm_b64 exec, 32, 0
  buffer_load_dword v254, v251, s[36:39], 0 offen sc1
  s_mov_b64 exec, -1
  v_cvt_pk_bf16_f32 v27, v30, v31
  v_mfma_f32_16x16x32_bf16 v[132:135], a[44:47], a[244:247], v[132:135]
  s_waitcnt lgkmcnt(4)
  v_cvt_pk_bf16_f32 v28, v32, v33
  v_cvt_pk_bf16_f32 v29, v34, v35
  v_mfma_f32_16x16x32_bf16 v[136:139], a[24:27], a[248:251], v[136:139]
  ds_read_b64_tr_b16 a[240:241], v193 offset:10336
  ds_read_b64_tr_b16 a[242:243], v193 offset:11616
  v_cvt_pk_bf16_f32 v30, v36, v37
  v_mfma_f32_16x16x32_bf16 v[136:139], a[36:39], a[252:255], v[136:139]
  buffer_load_dwordx4 v248, s[36:39], s49 offen offset:2048 sc1 lds
  v_cvt_pk_bf16_f32 v31, v38, v39
  v_mfma_f32_16x16x32_bf16 v[140:143], a[40:43], a[252:255], v[140:143]
  ds_read_b64_tr_b16 a[244:245], v193 offset:15456
  ds_read_b64_tr_b16 a[246:247], v193 offset:16736
  v_cvt_pk_bf16_f32 v32, v40, v41
  v_cvt_pk_bf16_f32 v33, v42, v43
  v_mfma_f32_16x16x32_bf16 v[140:143], a[28:31], a[248:251], v[140:143]
  v_fmac_f32_dpp v4, v4, v200 row_newbcast:0 row_mask:0xf bank_mask:0xf
  v_fmac_f32_dpp v5, v5, v200 row_newbcast:0 row_mask:0xf bank_mask:0xf
  v_mfma_f32_16x16x32_bf16 v[144:147], a[32:35], a[248:251], v[144:147]
  buffer_load_dwordx4 v248, s[36:39], s49 offen offset:3072 sc1 lds
  v_mfma_f32_16x16x32_bf16 v[144:147], a[44:47], a[252:255], v[144:147]
  s_waitcnt lgkmcnt(4)
  v_fmac_f32_dpp v6, v6, v200 row_newbcast:0 row_mask:0xf bank_mask:0xf
  v_fmac_f32_dpp v7, v7, v200 row_newbcast:0 row_mask:0xf bank_mask:0xf
  v_mfma_f32_16x16x32_bf16 v[148:151], a[24:27], v[184:187], v[148:151]
  s_add_u32 s49, s49, 4096
  ds_read_b64_tr_b16 a[248:249], v193 offset:10368
  ds_read_b64_tr_b16 a[250:251], v193 offset:11648
  v_fmac_f32_dpp v8, v8, v200 row_newbcast:0 row_mask:0xf bank_mask:0xf
  v_mfma_f32_16x16x32_bf16 v[148:151], a[36:39], v[188:191], v[148:151]
  s_add_u32 m0, s22, 110592
  v_fmac_f32_dpp v9, v9, v200 row_newbcast:0 row_mask:0xf bank_mask:0xf
  v_fmac_f32_dpp v10, v10, v200 row_newbcast:0 row_mask:0xf bank_mask:0xf
  v_mfma_f32_16x16x32_bf16 v[152:155], a[40:43], v[188:191], v[152:155]
  ds_read_b64_tr_b16 a[252:253], v193 offset:15488
  ds_read_b64_tr_b16 a[254:255], v193 offset:16768
  v_fmac_f32_dpp v11, v11, v200 row_newbcast:0 row_mask:0xf bank_mask:0xf
  v_mfma_f32_16x16x32_bf16 v[152:155], a[28:31], v[184:187], v[152:155]
  buffer_load_dwordx4 v248, s[36:39], s49 offen offset:0 sc1 lds
  v_fmac_f32_dpp v12, v12, v200 row_newbcast:0 row_mask:0xf bank_mask:0xf
  v_mfma_f32_16x16x32_bf16 v[156:159], a[32:35], v[184:187], v[156:159]
  v_fmac_f32_dpp v13, v13, v200 row_newbcast:0 row_mask:0xf bank_mask:0xf
  v_fmac_f32_dpp v14, v14, v200 row_newbcast:0 row_mask:0xf bank_mask:0xf
  v_mfma_f32_16x16x32_bf16 v[156:159], a[44:47], v[188:191], v[156:159]
  s_waitcnt lgkmcnt(4)
  v_fmac_f32_dpp v15, v15, v200 row_newbcast:0 row_mask:0xf bank_mask:0xf
  v_fmac_f32_dpp v16, v16, v200 row_newbcast:0 row_mask:0xf bank_mask:0xf
  v_mfma_f32_16x16x32_bf16 v[160:163], a[24:27], a[240:243], v[160:163]
  s_barrier
  ds_read_b64_tr_b16 v[184:185], v193 offset:20480
  ds_read_b64_tr_b16 v[186:187], v193 offset:21760
  v_mfma_f32_16x16x32_bf16 v[160:163], a[36:39], a[244:247], v[160:163]
  s_bfe_u32 s51, s74, 0x40018
  v_fmac_f32_dpp v17, v17, v200 row_newbcast:0 row_mask:0xf bank_mask:0xf
  v_fmac_f32_dpp v18, v18, v200 row_newbcast:0 row_mask:0xf bank_mask:0xf
  v_mfma_f32_16x16x32_bf16 v[164:167], a[40:43], a[244:247], v[164:167]
  s_mul_i32 s51, s51, 245760
  ds_read_b64_tr_b16 v[188:189], v193 offset:25600
  ds_read_b64_tr_b16 v[190:191], v193 offset:26880
  v_fmac_f32_dpp v19, v19, v200 row_newbcast:0 row_mask:0xf bank_mask:0xf
  v_mfma_f32_16x16x32_bf16 v[164:167], a[28:31], a[240:243], v[164:167]
  s_add_u32 m0, s50, 20480
  v_fmac_f32_dpp v20, v20, v200 row_newbcast:0 row_mask:0xf bank_mask:0xf
  v_fmac_f32_dpp v21, v21, v200 row_newbcast:0 row_mask:0xf bank_mask:0xf
  v_mfma_f32_16x16x32_bf16 v[168:171], a[32:35], a[240:243], v[168:171]
  s_add_u32 s51, s51, s73
  buffer_load_dwordx4 v194, s[28:31], s51 offen offset:0 lds
  v_mfma_f32_16x16x32_bf16 v[168:171], a[44:47], a[244:247], v[168:171]
  s_waitcnt lgkmcnt(4)
  v_fmac_f32_dpp v22, v22, v200 row_newbcast:0 row_mask:0xf bank_mask:0xf
  v_fmac_f32_dpp v23, v23, v200 row_newbcast:0 row_mask:0xf bank_mask:0xf
  v_mfma_f32_16x16x32_bf16 v[172:175], a[24:27], a[248:251], v[172:175]
  ds_read_b64_tr_b16 a[240:241], v193 offset:20512
  ds_read_b64_tr_b16 a[242:243], v193 offset:21792
  v_cvt_pk_bf16_f32 v4, v4, v5
  v_mfma_f32_16x16x32_bf16 v[172:175], a[36:39], a[252:255], v[172:175]
  v_cvt_pk_bf16_f32 v5, v6, v7
  v_cvt_pk_bf16_f32 v6, v8, v9
  v_mfma_f32_16x16x32_bf16 v[176:179], a[40:43], a[252:255], v[176:179]
  ds_read_b64_tr_b16 a[244:245], v193 offset:25632
  ds_read_b64_tr_b16 a[246:247], v193 offset:26912
  v_cvt_pk_bf16_f32 v7, v10, v11
  v_mfma_f32_16x16x32_bf16 v[176:179], a[28:31], a[248:251], v[176:179]
  buffer_load_dwordx4 v195, s[28:31], s51 offen offset:1024 lds
  v_cvt_pk_bf16_f32 v8, v12, v13
  v_mfma_f32_16x16x32_bf16 v[180:183], a[32:35], a[248:251], v[180:183]
  v_cvt_pk_bf16_f32 v9, v14, v15
  v_cvt_pk_bf16_f32 v10, v16, v17
  v_mfma_f32_16x16x32_bf16 v[180:183], a[44:47], a[252:255], v[180:183]
  s_waitcnt lgkmcnt(4)
  v_cvt_pk_bf16_f32 v11, v18, v19
  v_cvt_pk_bf16_f32 v12, v20, v21
  v_mfma_f32_16x16x32_bf16 v[124:127], a[48:51], v[184:187], v[124:127]
  ds_read_b64_tr_b16 a[248:249], v193 offset:20544
  ds_read_b64_tr_b16 a[250:251], v193 offset:21824
  v_mfma_f32_16x16x32_bf16 v[124:127], a[60:63], v[188:191], v[124:127]
  v_cvt_pk_bf16_f32 v13, v22, v23
  v_fmac_f32_dpp v104, v64, v204 row_newbcast:0 row_mask:0xf bank_mask:0xf
  v_mfma_f32_16x16x32_bf16 v[128:131], a[64:67], v[188:191], v[128:131]
  ds_read_b64_tr_b16 a[252:253], v193 offset:25664
  ds_read_b64_tr_b16 a[254:255], v193 offset:26944
  v_fmac_f32_dpp v105, v65, v204 row_newbcast:0 row_mask:0xf bank_mask:0xf
  v_mfma_f32_16x16x32_bf16 v[128:131], a[52:55], v[184:187], v[128:131]
  buffer_load_dwordx4 v196, s[28:31], s51 offen offset:2048 lds
  v_fmac_f32_dpp v106, v66, v204 row_newbcast:0 row_mask:0xf bank_mask:0xf
  v_mfma_f32_16x16x32_bf16 v[132:135], a[56:59], v[184:187], v[132:135]
  v_fmac_f32_dpp v107, v67, v204 row_newbcast:0 row_mask:0xf bank_mask:0xf
  v_fmac_f32_dpp v108, v68, v204 row_newbcast:0 row_mask:0xf bank_mask:0xf
  v_mfma_f32_16x16x32_bf16 v[132:135], a[68:71], v[188:191], v[132:135]
  s_waitcnt lgkmcnt(4)
  v_fmac_f32_dpp v109, v69, v204 row_newbcast:0 row_mask:0xf bank_mask:0xf
  v_fmac_f32_dpp v110, v70, v204 row_newbcast:0 row_mask:0xf bank_mask:0xf
  v_mfma_f32_16x16x32_bf16 v[136:139], a[48:51], a[240:243], v[136:139]
  ds_read_b64_tr_b16 v[184:185], v193 offset:20576
  ds_read_b64_tr_b16 v[186:187], v193 offset:21856
  v_mfma_f32_16x16x32_bf16 v[136:139], a[60:63], a[244:247], v[136:139]
  v_fmac_f32_dpp v111, v71, v204 row_newbcast:0 row_mask:0xf bank_mask:0xf
  v_fmac_f32_dpp v112, v72, v204 row_newbcast:0 row_mask:0xf bank_mask:0xf
  v_mfma_f32_16x16x32_bf16 v[140:143], a[64:67], a[244:247], v[140:143]
  ds_read_b64_tr_b16 v[188:189], v193 offset:25696
  ds_read_b64_tr_b16 v[190:191], v193 offset:26976
  v_fmac_f32_dpp v113, v73, v204 row_newbcast:0 row_mask:0xf bank_mask:0xf
  v_mfma_f32_16x16x32_bf16 v[140:143], a[52:55], a[240:243], v[140:143]
  buffer_load_dwordx4 v197, s[28:31], s51 offen offset:3072 lds
  v_fmac_f32_dpp v114, v74, v204 row_newbcast:0 row_mask:0xf bank_mask:0xf
  v_mfma_f32_16x16x32_bf16 v[144:147], a[56:59], a[240:243], v[144:147]
  s_add_u32 m0, s50, 24576
  v_fmac_f32_dpp v115, v75, v204 row_newbcast:0 row_mask:0xf bank_mask:0xf
  v_fmac_f32_dpp v116, v76, v204 row_newbcast:0 row_mask:0xf bank_mask:0xf
  v_mfma_f32_16x16x32_bf16 v[144:147], a[68:71], a[244:247], v[144:147]
  s_waitcnt lgkmcnt(4)
  v_fmac_f32_dpp v117, v77, v204 row_newbcast:0 row_mask:0xf bank_mask:0xf
  v_fmac_f32_dpp v118, v78, v204 row_newbcast:0 row_mask:0xf bank_mask:0xf
  v_mfma_f32_16x16x32_bf16 v[148:151], a[48:51], a[248:251], v[148:151]
  s_waitcnt vmcnt(7)
  ds_read_b64_tr_b16 a[240:241], v193 offset:20608
  ds_read_b64_tr_b16 a[242:243], v193 offset:21888
  v_mfma_f32_16x16x32_bf16 v[148:151], a[60:63], a[252:255], v[148:151]
AHOP3:
  s_cbranch_execz AHOP7
  v_fmac_f32_dpp v119, v79, v204 row_newbcast:0 row_mask:0xf bank_mask:0xf
  v_fmac_f32_dpp v120, v80, v204 row_newbcast:0 row_mask:0xf bank_mask:0xf
  v_mfma_f32_16x16x32_bf16 v[152:155], a[64:67], a[252:255], v[152:155]
  ds_read_b64_tr_b16 a[244:245], v193 offset:25728
  ds_read_b64_tr_b16 a[246:247], v193 offset:27008
  buffer_load_dwordx4 v198, s[28:31], s51 offen offset:0 lds
  v_cmp_ne_u32 vcc, v254, v249
  s_cmp_lg_u32 vcc_lo, 0
  s_cbranch_scc1 SAb
BAb:
  v_fmac_f32_dpp v121, v81, v204 row_newbcast:0 row_mask:0xf bank_mask:0xf
  v_mfma_f32_16x16x32_bf16 v[152:155], a[52:55], a[248:251], v[152:155]
  s_bfe_u32 s49, s62, 0x40008
  v_fmac_f32_dpp v122, v82, v204 row_newbcast:0 row_mask:0xf bank_mask:0xf
  v_fmac_f32_dpp v123, v83, v204 row_newbcast:0 row_mask:0xf bank_mask:0xf
  v_mfma_f32_16x16x32_bf16 v[156:159], a[56:59], a[248:251], v[156:159]
  s_mul_i32 s49, s49, 5120
  v_cvt_pk_bf16_f32 v14, v104, v105
  v_cvt_pk_bf16_f32 v40, v120, v121
  v_mfma_f32_16x16x32_bf16 v[156:159], a[68:71], a[252:255], v[156:159]
  s_waitcnt lgkmcnt(4)
  v_cvt_pk_bf16_f32 v15, v106, v107
  v_cvt_pk_bf16_f32 v41, v122, v123
  v_mfma_f32_16x16x32_bf16 v[160:163], a[48:51], v[184:187], v[160:163]
  s_add_u32 s49, s49, s66
  ds_read_b64_tr_b16 a[248:249], v193 offset:30720
  ds_read_b64_tr_b16 a[250:251], v193 offset:32000
  s_add_u32 m0, s22, 86016
  v_mfma_f32_16x16x32_bf16 v[160:163], a[60:63], v[188:191], v[160:163]
  s_bfe_u32 s67, s69, 0x40000
  s_mul_i32 s67, s67, 5120
  s_add_u32 s67, s67, s64
  buffer_load_dwordx4 a[0:3], v248, s[36:39], s67 offen offset:0 sc1
  v_cvt_pk_bf16_f32 v16, v108, v109
  v_mfma_f32_16x16x32_bf16 v[164:167], a[64:67], v[188:191], v[164:167]
  ds_read_b64_tr_b16 a[252:253], v193 offset:35840
  ds_read_b64_tr_b16 a[254:255], v193 offset:37120
  buffer_load_dwordx4 v248, s[36:39], s49 offen offset:0 sc1 lds
  v_cndmask_b32 v18, v16, 0, s[76:77]
  v_mfma_f32_16x16x32_bf16 v[164:167], a[52:55], v[184:187], v[164:167]
  v_cndmask_b32 v16, 0, v16, s[76:77]
  v_cvt_pk_bf16_f32 v17, v110, v111
  v_mfma_f32_16x16x32_bf16 v[168:171], a[56:59], v[184:187], v[168:171]
  v_cndmask_b32 v19, v17, 0, s[76:77]
  v_cndmask_b32 v17, 0, v17, s[76:77]
  v_mfma_f32_16x16x32_bf16 v[168:171], a[68:71], v[188:191], v[168:171]
  s_waitcnt lgkmcnt(4)
  buffer_load_dwordx4 a[4:7], v248, s[36:39], s67 offen offset:1024 sc1
  v_mfma_f32_16x16x32_bf16 v[172:175], a[48:51], a[240:243], v[172:175]
  ds_read_b64_tr_b16 v[184:185], v193 offset:30752
  ds_read_b64_tr_b16 v[186:187], v193 offset:32032
  v_cvt_pk_bf16_f32 v20, v112, v113
  v_mfma_f32_16x16x32_bf16 v[172:175], a[60:63], a[244:247], v[172:175]
  v_cndmask_b32 v34, v20, 0, s[78:79]
  v_cndmask_b32 v20, 0, v20, s[78:79]
  v_mfma_f32_16x16x32_bf16 v[176:179], a[64:67], a[244:247], v[176:179]
  ds_read_b64_tr_b16 v[188:189], v193 offset:35872
  ds_read_b64_tr_b16 v[190:191], v193 offset:37152
  buffer_load_dwordx4 v248, s[36:39], s49 offen offset:1024 sc1 lds
  v_cvt_pk_bf16_f32 v21, v114, v115
  v_mfma_f32_16x16x32_bf16 v[176:179], a[52:55], a[240:243], v[176:179]
  buffer_load_dwordx4 a[8:11], v248, s[36:39], s67 offen offset:2048 sc1
  v_cndmask_b32 v35, v21, 0, s[78:79]
  v_mfma_f32_16x16x32_bf16 v[180:183], a[56:59], a[240:243], v[180:183]
  v_cndmask_b32 v21, 0, v21, s[78:79]
  v_cvt_pk_bf16_f32 v36, v116, v117
  v_mfma_f32_16x16x32_bf16 v[180:183], a[68:71], a[244:247], v[180:183]
  s_waitcnt lgkmcnt(4)
  v_cndmask_b32 v38, v36, 0, s[80:81]
  v_cndmask_b32 v36, 0, v36, s[80:81]
  v_mfma_f32_16x16x32_bf16 v[124:127], a[72:75], a[248:251], v[124:127]
  ds_read_b64_tr_b16 a[240:241], v193 offset:30784
  ds_read_b64_tr_b16 a[242:243], v193 offset:32064
  v_mfma_f32_16x16x32_bf16 v[124:127], a[84:87], a[252:255], v[124:127]
  buffer_load_dwordx4 v248, s[36:39], s49 offen offset:2048 sc1 lds
  buffer_load_dwordx4 a[12:15], v248, s[36:39], s67 offen offset:3072 sc1
  v_cvt_pk_bf16_f32 v37, v118, v119
  v_cndmask_b32 v39, v37, 0, s[80:81]
  v_mfma_f32_16x16x32_bf16 v[128:131], a[88:91], a[252:255], v[128:131]
  s_add_u32 s67, s67, 4096
  ds_read_b64_tr_b16 a[244:245], v193 offset:35904
  ds_read_b64_tr_b16 a[246:247], v193 offset:37184
  v_cndmask_b32 v37, 0, v37, s[80:81]
  v_mfma_f32_16x16x32_bf16 v[54:57], v[24:27], v[14:17], 0
  v_fmac_f32_dpp v84, v64, v202 row_newbcast:0 row_mask:0xf bank_mask:0xf
  v_fmac_f32_dpp v85, v65, v202 row_newbcast:0 row_mask:0xf bank_mask:0xf
  v_mfma_f32_16x16x32_bf16 v[112:115], v[44:47], v[14:17], 0
  buffer_load_dwordx4 a[16:19], v248, s[36:39], s67 offen offset:0 sc1
  v_mfma_f32_16x16x32_bf16 v[128:131], a[76:79], a[248:251], v[128:131]
  v_fmac_f32_dpp v86, v66, v202 row_newbcast:0 row_mask:0xf bank_mask:0xf
  v_fmac_f32_dpp v87, v67, v202 row_newbcast:0 row_mask:0xf bank_mask:0xf
  v_mfma_f32_16x16x32_bf16 v[58:61], v[26:29], v[18:21], 0
  v_fmac_f32_dpp v88, v68, v202 row_newbcast:0 row_mask:0xf bank_mask:0xf
  v_fmac_f32_dpp v89, v69, v202 row_newbcast:0 row_mask:0xf bank_mask:0xf
  v_mfma_f32_16x16x32_bf16 v[116:119], v[46:49], v[18:21], 0
  v_fmac_f32_dpp v90, v70, v202 row_newbcast:0 row_mask:0xf bank_mask:0xf
  v_fmac_f32_dpp v91, v71, v202 row_newbcast:0 row_mask:0xf bank_mask:0xf
  v_mfma_f32_16x16x32_bf16 v[104:107], v[28:31], v[34:37], 0
  v_fmac_f32_dpp v92, v72, v202 row_newbcast:0 row_mask:0xf bank_mask:0xf
  v_fmac_f32_dpp v93, v73, v202 row_newbcast:0 row_mask:0xf bank_mask:0xf
  v_mfma_f32_16x16x32_bf16 v[120:123], v[48:51], v[34:37], 0
  v_fmac_f32_dpp v94, v74, v202 row_newbcast:0 row_mask:0xf bank_mask:0xf
  v_fmac_f32_dpp v95, v75, v202 row_newbcast:0 row_mask:0xf bank_mask:0xf
  v_mfma_f32_16x16x32_bf16 v[108:111], v[30:33], v[38:41], 0
  v_fmac_f32_dpp v96, v76, v202 row_newbcast:0 row_mask:0xf bank_mask:0xf
  v_fmac_f32_dpp v97, v77, v202 row_newbcast:0 row_mask:0xf bank_mask:0xf
  v_mfma_f32_16x16x32_bf16 v[238:241], v[50:53], v[38:41], 0
  v_fmac_f32_dpp v98, v78, v202 row_newbcast:0 row_mask:0xf bank_mask:0xf
  v_fmac_f32_dpp v99, v79, v202 row_newbcast:0 row_mask:0xf bank_mask:0xf
  v_mfma_f32_16x16x32_bf16 v[132:135], a[80:83], a[248:251], v[132:135]
  s_bfe_u32 s67, s69, 0x40004
  buffer_load_dwordx4 v248, s[36:39], s49 offen offset:3072 sc1 lds
  v_mfma_f32_16x16x32_bf16 v[132:135], a[92:95], a[252:255], v[132:135]
  s_waitcnt lgkmcnt(4)
  v_fmac_f32_dpp v100, v80, v202 row_newbcast:0 row_mask:0xf bank_mask:0xf
  v_fmac_f32_dpp v101, v81, v202 row_newbcast:0 row_mask:0xf bank_mask:0xf
  v_mfma_f32_16x16x32_bf16 v[136:139], a[72:75], v[184:187], v[136:139]
  s_mul_i32 s67, s67, 5120
  ds_read_b64_tr_b16 a[248:249], v193 offset:30816
  ds_read_b64_tr_b16 a[250:251], v193 offset:32096
  v_mfma_f32_16x16x32_bf16 v[136:139], a[84:87], v[188:191], v[136:139]
  s_add_u32 s67, s67, s64
  v_fmac_f32_dpp v102, v82, v202 row_newbcast:0 row_mask:0xf bank_mask:0xf
  v_fmac_f32_dpp v103, v83, v202 row_newbcast:0 row_mask:0xf bank_mask:0xf
  v_mfma_f32_16x16x32_bf16 v[140:143], a[88:91], v[188:191], v[140:143]
  s_add_u32 s49, s49, 4096
  ds_read_b64_tr_b16 a[252:253], v193 offset:35936
  ds_read_b64_tr_b16 a[254:255], v193 offset:37216
  v_mfma_f32_16x16x32_bf16 v[140:143], a[76:79], v[184:187], v[140:143]
  s_add_u32 m0, s22, 90112
  buffer_load_dwordx4 a[20:23], v248, s[36:39], s67 offen offset:0 sc1
  v_mfma_f32_16x16x32_bf16 v[144:147], a[80:83], v[184:187], v[144:147]
  s_and_b32 s58, s2, 7
  buffer_load_dwordx4 v248, s[36:39], s49 offen offset:0 sc1 lds
  v_mfma_f32_16x16x32_bf16 v[144:147], a[92:95], v[188:191], v[144:147]
  s_waitcnt lgkmcnt(4)
  buffer_load_dwordx4 a[24:27], v248, s[36:39], s67 offen offset:1024 sc1
  v_mfma_f32_16x16x32_bf16 v[148:151], a[72:75], a[240:243], v[148:151]
  s_lshr_b32 s13, s2, 6
  ds_read_b64_tr_b16 v[184:185], v193 offset:30848
  ds_read_b64_tr_b16 v[186:187], v193 offset:32128
  v_mfma_f32_16x16x32_bf16 v[148:151], a[84:87], a[244:247], v[148:151]
  s_lshl2_add_u32 s58, s58, s13
  v_cndmask_b32 v112, v112, v54, s[90:91]
  v_cndmask_b32 v113, v113, v55, s[92:93]
  v_mfma_f32_16x16x32_bf16 v[152:155], a[88:91], a[244:247], v[152:155]
  s_mul_i32 s12, s58, 303104
  ds_read_b64_tr_b16 v[188:189], v193 offset:35968
  ds_read_b64_tr_b16 v[190:191], v193 offset:37248
  v_mfma_f32_16x16x32_bf16 v[152:155], a[76:79], a[240:243], v[152:155]
  s_add_u32 s12, s12, 0x100000
  buffer_load_dwordx4 a[28:31], v248, s[36:39], s67 offen offset:2048 sc1
  v_mfma_f32_16x16x32_bf16 v[156:159], a[80:83], a[240:243], v[156:159]
  v_cndmask_b32 v114, v114, v56, s[94:95]
  v_cndmask_b32 v115, v115, v57, s[96:97]
  v_mfma_f32_16x16x32_bf16 v[156:159], a[92:95], a[244:247], v[156:159]
  s_waitcnt lgkmcnt(4)
  s_mul_i32 s14, s44, 28672
  s_mul_i32 s16, s44, 24576
  v_mfma_f32_16x16x32_bf16 v[160:163], a[72:75], a[248:251], v[160:163]
  s_barrier
  ds_read_b64_tr_b16 a[240:241], v192 offset:0
  ds_read_b64_tr_b16 a[242:243], v192 offset:1280
  v_mfma_f32_16x16x32_bf16 v[160:163], a[84:87], a[252:255], v[160:163]
  s_bfe_u32 s51, s75, 0x40000
  buffer_load_dwordx4 a[32:35], v248, s[36:39], s67 offen offset:3072 sc1
  v_mfma_f32_16x16x32_bf16 v[164:167], a[88:91], a[252:255], v[164:167]
  s_mul_i32 s51, s51, 245760
  ds_read_b64_tr_b16 a[244:245], v192 offset:5120
  ds_read_b64_tr_b16 a[246:247], v192 offset:6400
  v_mfma_f32_16x16x32_bf16 v[164:167], a[76:79], a[248:251], v[164:167]
  s_add_u32 m0, s50, 40960
  s_add_u32 s51, s51, s73
  s_add_u32 s67, s67, 4096
  v_mfma_f32_16x16x32_bf16 v[168:171], a[80:83], a[248:251], v[168:171]
  s_add_u32 s16, s16, 114688
  buffer_load_dwordx4 v194, s[28:31], s51 offen offset:0 lds
  v_mfma_f32_16x16x32_bf16 v[168:171], a[92:95], a[252:255], v[168:171]
  s_waitcnt lgkmcnt(4)
  buffer_load_dwordx4 a[36:39], v248, s[36:39], s67 offen offset:0 sc1
  v_mfma_f32_16x16x32_bf16 v[172:175], a[72:75], v[184:187], v[172:175]
  s_mul_i32 s17, s44, 20480
  ds_read_b64_tr_b16 a[248:249], v192 offset:32
  ds_read_b64_tr_b16 a[250:251], v192 offset:1312
  v_mfma_f32_16x16x32_bf16 v[172:175], a[84:87], v[188:191], v[172:175]
  s_bfe_u32 s67, s69, 0x40008
  buffer_load_dwordx4 v195, s[28:31], s51 offen offset:1024 lds
  v_mfma_f32_16x16x32_bf16 v[176:179], a[88:91], v[188:191], v[176:179]
  ds_read_b64_tr_b16 a[252:253], v192 offset:5152
  ds_read_b64_tr_b16 a[254:255], v192 offset:6432
  v_pk_fma_f32 v[112:113], v[112:113], v[230:231], v[234:235]
  v_pk_fma_f32 v[114:115], v[114:115], v[232:233], v[236:237]
  v_max3_f32 v20, v112, v113, v114
  v_max_f32 v20, v20, v115
  v_cndmask_b32 v116, v116, v58, s[90:91]
  v_cndmask_b32 v117, v117, v59, s[92:93]
  v_cndmask_b32 v118, v118, v60, s[94:95]
  v_cndmask_b32 v119, v119, v61, s[96:97]
  v_pk_fma_f32 v[116:117], v[116:117], v[230:231], v[234:235]
  v_pk_fma_f32 v[118:119], v[118:119], v[232:233], v[236:237]
  v_max3_f32 v21, v116, v117, v118
  v_max_f32 v21, v21, v119
  v_cndmask_b32 v120, v120, v104, s[90:91]
  v_cndmask_b32 v121, v121, v105, s[92:93]
  v_cndmask_b32 v122, v122, v106, s[94:95]
  v_cndmask_b32 v123, v123, v107, s[96:97]
  v_pk_fma_f32 v[120:121], v[120:121], v[230:231], v[234:235]
  v_pk_fma_f32 v[122:123], v[122:123], v[232:233], v[236:237]
  v_max3_f32 v22, v120, v121, v122
  v_max_f32 v22, v22, v123
  v_cndmask_b32 v238, v238, v108, s[90:91]
  v_cndmask_b32 v239, v239, v109, s[92:93]
  v_cndmask_b32 v240, v240, v110, s[94:95]
  v_cndmask_b32 v241, v241, v111, s[96:97]
  v_pk_fma_f32 v[238:239], v[238:239], v[230:231], v[234:235]
  v_pk_fma_f32 v[240:241], v[240:241], v[232:233], v[236:237]
  v_mfma_f32_16x16x32_bf16 v[176:179], a[76:79], v[184:187], v[176:179]
  s_mul_i32 s67, s67, 5120
  v_max3_f32 v23, v238, v239, v240
  v_max_f32 v23, v23, v241
  v_mfma_f32_16x16x32_bf16 v[180:183], a[80:83], v[184:187], v[180:183]
  s_add_u32 s67, s67, s64
  v_permlane32_swap_b32 v20, v21
  v_mfma_f32_16x16x32_bf16 v[180:183], a[92:95], v[188:191], v[180:183]
  s_waitcnt lgkmcnt(4)
  v_permlane32_swap_b32 v22, v23
  v_mfma_f32_16x16x32_bf16 v[124:127], a[96:99], a[240:243], v[124:127]
  s_add_u32 s17, s17, 221184
  ds_read_b64_tr_b16 v[184:185], v192 offset:64
  ds_read_b64_tr_b16 v[186:187], v192 offset:1344
  buffer_load_dwordx4 a[40:43], v248, s[36:39], s67 offen offset:0 sc1
  v_mfma_f32_16x16x32_bf16 v[124:127], a[108:111], a[244:247], v[124:127]
  s_sub_u32 s17, s17, s14
  v_max_f32 v20, v20, v21
  v_max_f32 v22, v22, v23
  v_mfma_f32_16x16x32_bf16 v[128:131], a[112:115], a[244:247], v[128:131]
  s_sub_u32 s16, s16, s14
  ds_read_b64_tr_b16 v[188:189], v192 offset:5184
  ds_read_b64_tr_b16 v[190:191], v192 offset:6464
  v_permlane16_swap_b32 v20, v22
  v_mfma_f32_16x16x32_bf16 v[128:131], a[100:103], a[240:243], v[128:131]
  s_add_u32 s12, s12, s14
  buffer_load_dwordx4 a[44:47], v248, s[36:39], s67 offen offset:1024 sc1
  v_mfma_f32_16x16x32_bf16 v[132:135], a[104:107], a[240:243], v[132:135]
  s_mov_b32 s14, 0xbfb8aa3b
  v_max_f32 v20, v20, v22
  v_mov_b32 v22, v20
  v_mfma_f32_16x16x32_bf16 v[132:135], a[116:119], a[244:247], v[132:135]
  s_waitcnt lgkmcnt(4)
  buffer_load_dwordx4 v196, s[28:31], s51 offen offset:2048 lds
  v_permlane16_swap_b32 v20, v22
  v_mfma_f32_16x16x32_bf16 v[136:139], a[96:99], a[248:251], v[136:139]
  s_add_u32 s13, s44, 0
  ds_read_b64_tr_b16 a[240:241], v192 offset:96
  ds_read_b64_tr_b16 a[242:243], v192 offset:1376
  v_mfma_f32_16x16x32_bf16 v[136:139], a[108:111], a[252:255], v[136:139]
  s_and_b32 s13, s13, 3
  v_mov_b32 v21, v20
  v_mov_b32 v23, v22
  v_mfma_f32_16x16x32_bf16 v[140:143], a[112:115], a[252:255], v[140:143]
  s_lshl_b32 s13, s13, 10
  ds_read_b64_tr_b16 a[244:245], v192 offset:5216
  ds_read_b64_tr_b16 a[246:247], v192 offset:6496
  buffer_load_dwordx4 a[48:51], v248, s[36:39], s67 offen offset:2048 sc1
  v_permlane32_swap_b32 v20, v21
  v_mfma_f32_16x16x32_bf16 v[140:143], a[100:103], a[248:251], v[140:143]
  s_add_u32 s4, s12, s13
  v_permlane32_swap_b32 v22, v23
  v_mfma_f32_16x16x32_bf16 v[144:147], a[104:107], a[248:251], v[144:147]
  v_pk_add_f32 v[112:113], v[112:113], v[20:21] op_sel:[0,0] op_sel_hi:[1,0] neg_lo:[0,1] neg_hi:[0,1]
  v_pk_add_f32 v[114:115], v[114:115], v[20:21] op_sel:[0,0] op_sel_hi:[1,0] neg_lo:[0,1] neg_hi:[0,1]
  v_pk_add_f32 v[116:117], v[116:117], v[20:21] op_sel:[0,1] op_sel_hi:[1,1] neg_lo:[0,1] neg_hi:[0,1]
  v_pk_add_f32 v[118:119], v[118:119], v[20:21] op_sel:[0,1] op_sel_hi:[1,1] neg_lo:[0,1] neg_hi:[0,1]
  v_pk_add_f32 v[120:121], v[120:121], v[22:23] op_sel:[0,0] op_sel_hi:[1,0] neg_lo:[0,1] neg_hi:[0,1]
  v_pk_add_f32 v[122:123], v[122:123], v[22:23] op_sel:[0,0] op_sel_hi:[1,0] neg_lo:[0,1] neg_hi:[0,1]
  v_pk_add_f32 v[238:239], v[238:239], v[22:23] op_sel:[0,1] op_sel_hi:[1,1] neg_lo:[0,1] neg_hi:[0,1]
  v_pk_add_f32 v[240:241], v[240:241], v[22:23] op_sel:[0,1] op_sel_hi:[1,1] neg_lo:[0,1] neg_hi:[0,1]
  v_mfma_f32_16x16x32_bf16 v[144:147], a[116:119], a[252:255], v[144:147]
  s_waitcnt lgkmcnt(4)
  v_exp_f32 v112, v112
  v_mfma_f32_16x16x32_bf16 v[148:151], a[96:99], v[184:187], v[148:151]
  s_add_u32 s13, s44, 1
  ds_read_b64_tr_b16 a[248:249], v192 offset:128
  ds_read_b64_tr_b16 a[250:251], v192 offset:1408
  buffer_load_dwordx4 v197, s[28:31], s51 offen offset:3072 lds
  buffer_load_dwordx4 a[52:55], v248, s[36:39], s67 offen offset:3072 sc1
  v_mfma_f32_16x16x32_bf16 v[148:151], a[108:111], v[188:191], v[148:151]
  s_add_u32 s67, s67, 4096
  v_exp_f32 v113, v113
  v_mfma_f32_16x16x32_bf16 v[152:155], a[112:115], v[188:191], v[152:155]
  s_add_u32 m0, s50, 45056
  ds_read_b64_tr_b16 a[252:253], v192 offset:5248
  ds_read_b64_tr_b16 a[254:255], v192 offset:6528
  v_exp_f32 v114, v114
  v_mfma_f32_16x16x32_bf16 v[152:155], a[100:103], v[184:187], v[152:155]
  s_and_b32 s13, s13, 3
  buffer_load_dwordx4 a[56:59], v248, s[36:39], s67 offen offset:0 sc1
  v_mfma_f32_16x16x32_bf16 v[156:159], a[104:107], v[184:187], v[156:159]
  s_bfe_u32 s67, s69, 0x4000c
  v_exp_f32 v115, v115
  v_mfma_f32_16x16x32_bf16 v[156:159], a[116:119], v[188:191], v[156:159]
  s_waitcnt lgkmcnt(4)
  v_exp_f32 v116, v116
  v_mfma_f32_16x16x32_bf16 v[160:163], a[96:99], a[240:243], v[160:163]
  s_mul_i32 s67, s67, 5120
  ds_read_b64_tr_b16 v[184:185], v192 offset:10240
  ds_read_b64_tr_b16 v[186:187], v192 offset:11520
  s_add_u32 s67, s67, s64
  v_mfma_f32_16x16x32_bf16 v[160:163], a[108:111], a[244:247], v[160:163]
  s_lshl_b32 s13, s13, 10
  buffer_load_dwordx4 v198, s[28:31], s51 offen offset:0 lds
  v_exp_f32 v117, v117
  v_mfma_f32_16x16x32_bf16 v[164:167], a[112:115], a[244:247], v[164:167]
  s_add_u32 s5, s12, s13
  ds_read_b64_tr_b16 v[188:189], v192 offset:15360
  ds_read_b64_tr_b16 v[190:191], v192 offset:16640
  buffer_load_dwordx4 a[60:63], v248, s[36:39], s67 offen offset:0 sc1
  v_exp_f32 v118, v118
  v_mfma_f32_16x16x32_bf16 v[164:167], a[100:103], a[240:243], v[164:167]
  s_add_u32 s13, s44, 2
  v_exp_f32 v119, v119
  v_mfma_f32_16x16x32_bf16 v[168:171], a[104:107], a[240:243], v[168:171]
  s_and_b32 s13, s13, 3
  v_exp_f32 v120, v120
  v_mfma_f32_16x16x32_bf16 v[168:171], a[116:119], a[244:247], v[168:171]
  s_waitcnt lgkmcnt(4)
  buffer_load_dwordx4 a[64:67], v248, s[36:39], s67 offen offset:1024 sc1
  v_mfma_f32_16x16x32_bf16 v[172:175], a[96:99], a[248:251], v[172:175]
  s_lshl_b32 s13, s13, 10
  ds_read_b64_tr_b16 a[240:241], v192 offset:10272
  ds_read_b64_tr_b16 a[242:243], v192 offset:11552
  v_mfma_f32_16x16x32_bf16 v[172:175], a[108:111], a[252:255], v[172:175]
  s_add_u32 s6, s12, s13
  v_exp_f32 v121, v121
  v_mfma_f32_16x16x32_bf16 v[176:179], a[112:115], a[252:255], v[176:179]
  s_add_u32 s13, s44, 3
  ds_read_b64_tr_b16 a[244:245], v192 offset:15392
  ds_read_b64_tr_b16 a[246:247], v192 offset:16672
  v_exp_f32 v122, v122
  v_mfma_f32_16x16x32_bf16 v[176:179], a[100:103], a[248:251], v[176:179]
  s_and_b32 s13, s13, 3
  v_exp_f32 v123, v123
  v_mfma_f32_16x16x32_bf16 v[180:183], a[104:107], a[248:251], v[180:183]
  s_lshl_b32 s13, s13, 10
  buffer_load_dwordx4 a[68:71], v248, s[36:39], s67 offen offset:2048 sc1
  v_mfma_f32_16x16x32_bf16 v[180:183], a[116:119], a[252:255], v[180:183]
  s_waitcnt lgkmcnt(4)
  v_exp_f32 v238, v238
  v_mfma_f32_16x16x32_bf16 v[124:127], a[120:123], v[184:187], v[124:127]
  s_add_u32 s7, s12, s13
  ds_read_b64_tr_b16 a[248:249], v192 offset:10304
  ds_read_b64_tr_b16 a[250:251], v192 offset:11584
  v_mfma_f32_16x16x32_bf16 v[124:127], a[132:135], v[188:191], v[124:127]
  s_bfe_u32 s56, s69, 0x40000
  v_exp_f32 v239, v239
  v_mfma_f32_16x16x32_bf16 v[128:131], a[136:139], v[188:191], v[128:131]
  s_lshl_b32 s56, s56, 12
  ds_read_b64_tr_b16 a[252:253], v192 offset:15424
  ds_read_b64_tr_b16 a[254:255], v192 offset:16704
  v_exp_f32 v240, v240
  v_mfma_f32_16x16x32_bf16 v[128:131], a[124:127], v[184:187], v[128:131]
  s_bfe_u32 s57, s69, 0x40004
  buffer_load_dwordx4 a[72:75], v248, s[36:39], s67 offen offset:3072 sc1
  v_mfma_f32_16x16x32_bf16 v[132:135], a[128:131], v[184:187], v[132:135]
  s_add_u32 s67, s67, 4096
  v_exp_f32 v241, v241
  v_pk_add_f32 v[54:55], v[112:113], v[114:115]
  v_pk_add_f32 v[58:59], v[116:117], v[118:119]
  v_pk_add_f32 v[104:105], v[120:121], v[122:123]
  v_pk_add_f32 v[108:109], v[238:239], v[240:241]
  v_mfma_f32_16x16x32_bf16 v[132:135], a[140:143], v[188:191], v[132:135]
  s_waitcnt lgkmcnt(4)
  v_add_f32 v20, v54, v55
  v_add_f32 v21, v58, v59
  v_mfma_f32_16x16x32_bf16 v[136:139], a[120:123], a[240:243], v[136:139]
  s_lshl_b32 s57, s57, 12
  ds_read_b64_tr_b16 v[184:185], v192 offset:10336
  ds_read_b64_tr_b16 v[186:187], v192 offset:11616
  v_mfma_f32_16x16x32_bf16 v[136:139], a[132:135], a[244:247], v[136:139]
  s_bfe_u32 s59, s69, 0x40008
  buffer_load_dwordx4 a[76:79], v248, s[36:39], s67 offen offset:0 sc1
  v_add_f32 v22, v104, v105
  v_add_f32 v23, v108, v109
  v_mfma_f32_16x16x32_bf16 v[140:143], a[136:139], a[244:247], v[140:143]
  s_bfe_u32 s67, s69, 0x40010
  ds_read_b64_tr_b16 v[188:189], v192 offset:15456
  ds_read_b64_tr_b16 v[190:191], v192 offset:16736
  v_permlane32_swap_b32 v20, v21
  v_mfma_f32_16x16x32_bf16 v[140:143], a[124:127], a[240:243], v[140:143]
  s_mul_i32 s67, s67, 5120
  s_add_u32 s67, s67, s64
  v_add_f32 v20, v20, v21
  v_mfma_f32_16x16x32_bf16 v[144:147], a[128:131], a[240:243], v[144:147]
  s_lshl_b32 s59, s59, 12
  v_permlane32_swap_b32 v22, v23
  v_mfma_f32_16x16x32_bf16 v[144:147], a[140:143], a[244:247], v[144:147]
  s_waitcnt lgkmcnt(4)
  buffer_load_dwordx4 a[80:83], v248, s[36:39], s67 offen offset:0 sc1
  v_mfma_f32_16x16x32_bf16 v[148:151], a[120:123], a[248:251], v[148:151]
  s_bfe_u32 s20, s69, 0x4000c
  ds_read_b64_tr_b16 a[240:241], v192 offset:10368
  ds_read_b64_tr_b16 a[242:243], v192 offset:11648
  v_add_f32 v22, v22, v23
  v_mfma_f32_16x16x32_bf16 v[148:151], a[132:135], a[252:255], v[148:151]
  s_lshl_b32 s20, s20, 12
  v_permlane16_swap_b32 v20, v22
  v_mfma_f32_16x16x32_bf16 v[152:155], a[136:139], a[252:255], v[152:155]
  s_bfe_u32 s21, s69, 0x40010
  ds_read_b64_tr_b16 a[244:245], v192 offset:15488
  ds_read_b64_tr_b16 a[246:247], v192 offset:16768
  v_add_f32 v20, v20, v22
  v_mfma_f32_16x16x32_bf16 v[152:155], a[124:127], a[248:251], v[152:155]
  s_lshl_b32 s21, s21, 12
  buffer_load_dwordx4 a[84:87], v248, s[36:39], s67 offen offset:1024 sc1
  v_rcp_f32 v20, v20
  v_mfma_f32_16x16x32_bf16 v[156:159], a[128:131], a[248:251], v[156:159]
  s_waitcnt vmcnt(32)
  v_mov_b32 v22, v20
  s_bfe_u32 s45, s69, 0x40014
  v_mfma_f32_16x16x32_bf16 v[156:159], a[140:143], a[252:255], v[156:159]
  s_waitcnt lgkmcnt(4)
  v_permlane16_swap_b32 v20, v22
  v_mfma_f32_16x16x32_bf16 v[160:163], a[120:123], v[184:187], v[160:163]
  s_barrier
  ds_read_b64_tr_b16 a[248:249], v192 offset:20480
  ds_read_b64_tr_b16 a[250:251], v192 offset:21760
  v_mfma_f32_16x16x32_bf16 v[160:163], a[132:135], v[188:191], v[160:163]
  s_bfe_u32 s49, s62, 0x4000c
  buffer_load_dwordx4 a[88:91], v248, s[36:39], s67 offen offset:2048 sc1
  v_mov_b32 v21, v20
  v_mov_b32 v23, v22
  v_mfma_f32_16x16x32_bf16 v[164:167], a[136:139], v[188:191], v[164:167]
  s_mul_i32 s49, s49, 5120
  ds_read_b64_tr_b16 a[252:253], v192 offset:25600
  ds_read_b64_tr_b16 a[254:255], v192 offset:26880
  v_permlane32_swap_b32 v20, v21
  v_mfma_f32_16x16x32_bf16 v[164:167], a[124:127], v[184:187], v[164:167]
  s_add_u32 s49, s49, s66
  v_permlane32_swap_b32 v22, v23
  v_pk_mul_f32 v[112:113], v[112:113], v[20:21] op_sel:[0,0] op_sel_hi:[1,0]
  v_pk_mul_f32 v[114:115], v[114:115], v[20:21] op_sel:[0,0] op_sel_hi:[1,0]
  v_cvt_pk_bf16_f32 v56, v112, v113
  v_cvt_pk_bf16_f32 v57, v114, v115
  v_and_b32 v54, v56, v208
  v_and_b32 v55, v57, v209
  v_xor_b32 v56, v56, v54
  v_xor_b32 v57, v57, v55
  v_pk_mul_f32 v[116:117], v[116:117], v[20:21] op_sel:[0,1] op_sel_hi:[1,1]
  v_pk_mul_f32 v[118:119], v[118:119], v[20:21] op_sel:[0,1] op_sel_hi:[1,1]
  v_cvt_pk_bf16_f32 v60, v116, v117
  v_cvt_pk_bf16_f32 v61, v118, v119
  v_and_b32 v58, v60, v208
  v_and_b32 v59, v61, v209
  v_xor_b32 v60, v60, v58
  v_xor_b32 v61, v61, v59
  v_pk_mul_f32 v[120:121], v[120:121], v[22:23] op_sel:[0,0] op_sel_hi:[1,0]
  v_pk_mul_f32 v[122:123], v[122:123], v[22:23] op_sel:[0,0] op_sel_hi:[1,0]
  v_cvt_pk_bf16_f32 v106, v120, v121
  v_cvt_pk_bf16_f32 v107, v122, v123
  v_and_b32 v104, v106, v208
  v_and_b32 v105, v107, v209
  v_xor_b32 v106, v106, v104
  v_xor_b32 v107, v107, v105
  v_pk_mul_f32 v[238:239], v[238:239], v[22:23] op_sel:[0,1] op_sel_hi:[1,1]
  v_pk_mul_f32 v[240:241], v[240:241], v[22:23] op_sel:[0,1] op_sel_hi:[1,1]
  v_mfma_f32_16x16x32_bf16 v[168:171], a[128:131], v[184:187], v[168:171]
  s_add_u32 m0, s22, 65536
  s_nop 0
  buffer_load_dwordx4 v248, s[36:39], s49 offen offset:0 sc1 lds
  v_mfma_f32_16x16x32_bf16 v[168:171], a[140:143], v[188:191], v[168:171]
  s_waitcnt lgkmcnt(4)
  buffer_load_dwordx4 a[92:95], v248, s[36:39], s67 offen offset:3072 sc1
  v_cvt_pk_bf16_f32 v110, v238, v239
  v_mfma_f32_16x16x32_bf16 v[172:175], a[120:123], a[240:243], v[172:175]
  s_add_u32 s67, s67, 4096
  ds_read_b64_tr_b16 v[184:185], v192 offset:20512
  ds_read_b64_tr_b16 v[186:187], v192 offset:21792
  v_cvt_pk_bf16_f32 v111, v240, v241
  v_and_b32 v108, v110, v208
  v_mfma_f32_16x16x32_bf16 v[172:175], a[132:135], a[244:247], v[172:175]
  s_lshl_b32 s45, s45, 12
  v_and_b32 v109, v111, v209
  v_xor_b32 v110, v110, v108
  v_mfma_f32_16x16x32_bf16 v[176:179], a[136:139], a[244:247], v[176:179]
  s_bfe_u32 s46, s69, 0x40018
  ds_read_b64_tr_b16 v[188:189], v192 offset:25632
  ds_read_b64_tr_b16 v[190:191], v192 offset:26912
  v_mfma_f32_16x16x32_bf16 v[176:179], a[124:127], a[240:243], v[176:179]
  s_lshl_b32 s46, s46, 12
  v_xor_b32 v111, v111, v109
  v_cvt_pk_bf16_f32 v14, v84, v85
  v_mfma_f32_16x16x32_bf16 v[180:183], a[128:131], a[240:243], v[180:183]
  buffer_load_dwordx4 a[96:99], v248, s[36:39], s67 offen offset:0 sc1
  v_cvt_pk_bf16_f32 v40, v100, v101
  v_mfma_f32_16x16x32_bf16 v[180:183], a[140:143], a[244:247], v[180:183]
  s_waitcnt lgkmcnt(4)
  v_cvt_pk_bf16_f32 v15, v86, v87
  v_cvt_pk_bf16_f32 v41, v102, v103
  v_mfma_f32_16x16x32_bf16 v[124:127], a[144:147], a[248:251], v[124:127]
  s_bfe_u32 s67, s69, 0x40014
  ds_read_b64_tr_b16 a[240:241], v192 offset:20544
  ds_read_b64_tr_b16 a[242:243], v192 offset:21824
  s_mul_i32 s67, s67, 5120
  s_add_u32 s67, s67, s64
  v_cvt_pk_bf16_f32 v16, v88, v89
  v_mfma_f32_16x16x32_bf16 v[124:127], a[156:159], a[252:255], v[124:127]
  v_cndmask_b32 v18, v16, 0, s[76:77]
  v_cndmask_b32 v16, 0, v16, s[76:77]
  v_mfma_f32_16x16x32_bf16 v[128:131], a[160:163], a[252:255], v[128:131]
  ds_read_b64_tr_b16 a[244:245], v192 offset:25664
  ds_read_b64_tr_b16 a[246:247], v192 offset:26944
  buffer_load_dwordx4 a[100:103], v248, s[36:39], s67 offen offset:0 sc1
  v_mfma_f32_16x16x32_bf16 v[128:131], a[148:151], a[248:251], v[128:131]
  buffer_load_dwordx4 v248, s[36:39], s49 offen offset:1024 sc1 lds
  v_cvt_pk_bf16_f32 v17, v90, v91
  v_cndmask_b32 v19, v17, 0, s[76:77]
  v_mfma_f32_16x16x32_bf16 v[132:135], a[152:155], a[248:251], v[132:135]
  v_cndmask_b32 v17, 0, v17, s[76:77]
  v_cvt_pk_bf16_f32 v20, v92, v93
  v_mfma_f32_16x16x32_bf16 v[132:135], a[164:167], a[252:255], v[132:135]
  s_waitcnt lgkmcnt(4)
  buffer_load_dwordx4 a[104:107], v248, s[36:39], s67 offen offset:1024 sc1
  v_mfma_f32_16x16x32_bf16 v[136:139], a[144:147], v[184:187], v[136:139]
  ds_read_b64_tr_b16 a[248:249], v192 offset:20576
  ds_read_b64_tr_b16 a[250:251], v192 offset:21856
  v_cndmask_b32 v34, v20, 0, s[78:79]
  v_cndmask_b32 v20, 0, v20, s[78:79]
  v_mfma_f32_16x16x32_bf16 v[136:139], a[156:159], v[188:191], v[136:139]
  v_cvt_pk_bf16_f32 v21, v94, v95
  v_cndmask_b32 v35, v21, 0, s[78:79]
  v_mfma_f32_16x16x32_bf16 v[140:143], a[160:163], v[188:191], v[140:143]
  ds_read_b64_tr_b16 a[252:253], v192 offset:25696
  ds_read_b64_tr_b16 a[254:255], v192 offset:26976
  v_mfma_f32_16x16x32_bf16 v[140:143], a[148:151], v[184:187], v[140:143]
  v_cndmask_b32 v21, 0, v21, s[78:79]
  v_cvt_pk_bf16_f32 v36, v96, v97
  v_mfma_f32_16x16x32_bf16 v[144:147], a[152:155], v[184:187], v[144:147]
  buffer_load_dwordx4 a[108:111], v248, s[36:39], s67 offen offset:2048 sc1
  v_cndmask_b32 v38, v36, 0, s[80:81]
  v_mfma_f32_16x16x32_bf16 v[144:147], a[164:167], v[188:191], v[144:147]
  s_waitcnt lgkmcnt(4)
  v_cndmask_b32 v36, 0, v36, s[80:81]
  v_cvt_pk_bf16_f32 v37, v98, v99
  v_mfma_f32_16x16x32_bf16 v[148:151], a[144:147], a[240:243], v[148:151]
  ds_read_b64_tr_b16 v[184:185], v192 offset:20608
  ds_read_b64_tr_b16 v[186:187], v192 offset:21888
  v_cndmask_b32 v39, v37, 0, s[80:81]
  v_mfma_f32_16x16x32_bf16 v[148:151], a[156:159], a[244:247], v[148:151]
  v_cndmask_b32 v37, 0, v37, s[80:81]
  v_fmac_f32_dpp v64, v64, v200 row_newbcast:0 row_mask:0xf bank_mask:0xf
  v_mfma_f32_16x16x32_bf16 v[42:45], v[4:7], v[14:17], 0
  buffer_load_dwordx4 v248, s[36:39], s49 offen offset:2048 sc1 lds
  v_mfma_f32_16x16x32_bf16 v[152:155], a[160:163], a[244:247], v[152:155]
  ds_read_b64_tr_b16 v[188:189], v192 offset:25728
  ds_read_b64_tr_b16 v[190:191], v192 offset:27008
  buffer_load_dwordx4 a[112:115], v248, s[36:39], s67 offen offset:3072 sc1
  v_mfma_f32_16x16x32_bf16 v[152:155], a[148:151], a[240:243], v[152:155]
  s_add_u32 s67, s67, 4096
  v_fmac_f32_dpp v65, v65, v200 row_newbcast:0 row_mask:0xf bank_mask:0xf
  v_fmac_f32_dpp v66, v66, v200 row_newbcast:0 row_mask:0xf bank_mask:0xf
  v_mfma_f32_16x16x32_bf16 v[84:87], v[24:27], v[14:17], 0
  buffer_load_dwordx4 a[116:119], v248, s[36:39], s67 offen offset:0 sc1
  v_mfma_f32_16x16x32_bf16 v[156:159], a[152:155], a[240:243], v[156:159]
  v_fmac_f32_dpp v67, v67, v200 row_newbcast:0 row_mask:0xf bank_mask:0xf
  v_fmac_f32_dpp v68, v68, v200 row_newbcast:0 row_mask:0xf bank_mask:0xf
  v_mfma_f32_16x16x32_bf16 v[46:49], v[6:9], v[18:21], 0
  v_fmac_f32_dpp v69, v69, v200 row_newbcast:0 row_mask:0xf bank_mask:0xf
  v_fmac_f32_dpp v70, v70, v200 row_newbcast:0 row_mask:0xf bank_mask:0xf
  v_mfma_f32_16x16x32_bf16 v[88:91], v[26:29], v[18:21], 0
  v_fmac_f32_dpp v71, v71, v200 row_newbcast:0 row_mask:0xf bank_mask:0xf
  v_fmac_f32_dpp v72, v72, v200 row_newbcast:0 row_mask:0xf bank_mask:0xf
  v_mfma_f32_16x16x32_bf16 v[50:53], v[8:11], v[34:37], 0
  v_fmac_f32_dpp v73, v73, v200 row_newbcast:0 row_mask:0xf bank_mask:0xf
  v_fmac_f32_dpp v74, v74, v200 row_newbcast:0 row_mask:0xf bank_mask:0xf
  v_mfma_f32_16x16x32_bf16 v[92:95], v[28:31], v[34:37], 0
AHOP4:
  s_cbranch_execz AHOP8
  v_fmac_f32_dpp v75, v75, v200 row_newbcast:0 row_mask:0xf bank_mask:0xf
  v_fmac_f32_dpp v76, v76, v200 row_newbcast:0 row_mask:0xf bank_mask:0xf
  v_mfma_f32_16x16x32_bf16 v[100:103], v[10:13], v[38:41], 0
  v_fmac_f32_dpp v77, v77, v200 row_newbcast:0 row_mask:0xf bank_mask:0xf
  v_fmac_f32_dpp v78, v78, v200 row_newbcast:0 row_mask:0xf bank_mask:0xf
  v_mfma_f32_16x16x32_bf16 v[96:99], v[30:33], v[38:41], 0
  v_fmac_f32_dpp v79, v79, v200 row_newbcast:0 row_mask:0xf bank_mask:0xf
  v_fmac_f32_dpp v80, v80, v200 row_newbcast:0 row_mask:0xf bank_mask:0xf
  v_mfma_f32_16x16x32_bf16 v[156:159], a[164:167], a[244:247], v[156:159]
  s_waitcnt lgkmcnt(4)
  v_fmac_f32_dpp v81, v81, v200 row_newbcast:0 row_mask:0xf bank_mask:0xf
  v_fmac_f32_dpp v82, v82, v200 row_newbcast:0 row_mask:0xf bank_mask:0xf
  v_mfma_f32_16x16x32_bf16 v[160:163], a[144:147], a[248:251], v[160:163]
  s_bfe_u32 s67, s69, 0x40018
  ds_read_b64_tr_b16 a[240:241], v192 offset:30720
  ds_read_b64_tr_b16 a[242:243], v192 offset:32000
  v_mfma_f32_16x16x32_bf16 v[160:163], a[156:159], a[252:255], v[160:163]
  s_mul_i32 s67, s67, 5120
  v_fmac_f32_dpp v83, v83, v200 row_newbcast:0 row_mask:0xf bank_mask:0xf
  v_cndmask_b32 v84, v84, v42, s[90:91]
  v_mfma_f32_16x16x32_bf16 v[164:167], a[160:163], a[252:255], v[164:167]
  s_add_u32 s67, s67, s64
  ds_read_b64_tr_b16 a[244:245], v192 offset:35840
  ds_read_b64_tr_b16 a[246:247], v192 offset:37120
  v_mfma_f32_16x16x32_bf16 v[164:167], a[148:151], a[248:251], v[164:167]
  buffer_load_dwordx4 a[120:123], v248, s[36:39], s67 offen offset:0 sc1
  v_mfma_f32_16x16x32_bf16 v[168:171], a[152:155], a[248:251], v[168:171]
  v_cndmask_b32 v85, v85, v43, s[92:93]
  v_cndmask_b32 v86, v86, v44, s[94:95]
  v_mfma_f32_16x16x32_bf16 v[168:171], a[164:167], a[252:255], v[168:171]
  s_waitcnt lgkmcnt(4)
  buffer_load_dwordx4 v248, s[36:39], s49 offen offset:3072 sc1 lds
  v_mfma_f32_16x16x32_bf16 v[172:175], a[144:147], v[184:187], v[172:175]
  ds_read_b64_tr_b16 a[248:249], v192 offset:30752
  ds_read_b64_tr_b16 a[250:251], v192 offset:32032
  v_mfma_f32_16x16x32_bf16 v[172:175], a[156:159], v[188:191], v[172:175]
  buffer_load_dwordx4 a[124:127], v248, s[36:39], s67 offen offset:1024 sc1
  v_mfma_f32_16x16x32_bf16 v[176:179], a[160:163], v[188:191], v[176:179]
  ds_read_b64_tr_b16 a[252:253], v192 offset:35872
  ds_read_b64_tr_b16 a[254:255], v192 offset:37152
  v_mfma_f32_16x16x32_bf16 v[176:179], a[148:151], v[184:187], v[176:179]
  v_cndmask_b32 v87, v87, v45, s[96:97]
  v_mfma_f32_16x16x32_bf16 v[180:183], a[152:155], v[184:187], v[180:183]
  buffer_load_dwordx4 a[128:131], v248, s[36:39], s67 offen offset:2048 sc1
  v_mfma_f32_16x16x32_bf16 v[180:183], a[164:167], v[188:191], v[180:183]
  s_waitcnt lgkmcnt(4)
  v_mfma_f32_16x16x32_bf16 v[124:127], a[168:171], a[240:243], v[124:127]
  ds_read_b64_tr_b16 v[184:185], v192 offset:30784
  ds_read_b64_tr_b16 v[186:187], v192 offset:32064
  v_mfma_f32_16x16x32_bf16 v[124:127], a[180:183], a[244:247], v[124:127]
  v_mfma_f32_16x16x32_bf16 v[128:131], a[184:187], a[244:247], v[128:131]
  s_add_u32 s49, s49, 4096
  ds_read_b64_tr_b16 v[188:189], v192 offset:35904
  ds_read_b64_tr_b16 v[190:191], v192 offset:37184
  v_mfma_f32_16x16x32_bf16 v[128:131], a[172:175], a[240:243], v[128:131]
  s_add_u32 m0, s22, 69632
  buffer_load_dwordx4 a[132:135], v248, s[36:39], s67 offen offset:3072 sc1
  v_mfma_f32_16x16x32_bf16 v[132:135], a[176:179], a[240:243], v[132:135]
  s_add_u32 s67, s67, 4096
  buffer_load_dwordx4 v248, s[36:39], s49 offen offset:0 sc1 lds
  v_mfma_f32_16x16x32_bf16 v[132:135], a[188:191], a[244:247], v[132:135]
  s_waitcnt lgkmcnt(4)
  v_mfma_f32_16x16x32_bf16 v[136:139], a[168:171], a[248:251], v[136:139]
  ds_read_b64_tr_b16 a[240:241], v192 offset:30816
  ds_read_b64_tr_b16 a[242:243], v192 offset:32096
  v_mfma_f32_16x16x32_bf16 v[136:139], a[180:183], a[252:255], v[136:139]
  v_pk_fma_f32 v[84:85], v[84:85], v[222:223], v[226:227]
  v_pk_fma_f32 v[86:87], v[86:87], v[224:225], v[228:229]
  v_max3_f32 v20, v84, v85, v86
  v_max_f32 v20, v20, v87
  v_cndmask_b32 v88, v88, v46, s[90:91]
  v_cndmask_b32 v89, v89, v47, s[92:93]
  v_cndmask_b32 v90, v90, v48, s[94:95]
  v_cndmask_b32 v91, v91, v49, s[96:97]
  v_pk_fma_f32 v[88:89], v[88:89], v[222:223], v[226:227]
  v_pk_fma_f32 v[90:91], v[90:91], v[224:225], v[228:229]
  v_max3_f32 v21, v88, v89, v90
  v_max_f32 v21, v21, v91
  v_cndmask_b32 v92, v92, v50, s[90:91]
  v_cndmask_b32 v93, v93, v51, s[92:93]
  v_cndmask_b32 v94, v94, v52, s[94:95]
  v_cndmask_b32 v95, v95, v53, s[96:97]
  v_pk_fma_f32 v[92:93], v[92:93], v[222:223], v[226:227]
  v_pk_fma_f32 v[94:95], v[94:95], v[224:225], v[228:229]
  v_max3_f32 v22, v92, v93, v94
  v_max_f32 v22, v22, v95
  v_cndmask_b32 v96, v96, v100, s[90:91]
  v_cndmask_b32 v97, v97, v101, s[92:93]
  v_cndmask_b32 v98, v98, v102, s[94:95]
  v_cndmask_b32 v99, v99, v103, s[96:97]
  v_pk_fma_f32 v[96:97], v[96:97], v[222:223], v[226:227]
  v_pk_fma_f32 v[98:99], v[98:99], v[224:225], v[228:229]
  v_mfma_f32_16x16x32_bf16 v[140:143], a[184:187], a[252:255], v[140:143]
  ds_read_b64_tr_b16 a[244:245], v192 offset:35936
  ds_read_b64_tr_b16 a[246:247], v192 offset:37216
  v_max3_f32 v23, v96, v97, v98
  v_max_f32 v23, v23, v99
  v_mfma_f32_16x16x32_bf16 v[140:143], a[172:175], a[248:251], v[140:143]
  buffer_load_dwordx4 a[136:139], v248, s[36:39], s67 offen offset:0 sc1
  v_permlane32_swap_b32 v20, v21
  v_mfma_f32_16x16x32_bf16 v[144:147], a[176:179], a[248:251], v[144:147]
  s_bfe_u32 s67, s23, 0x40000
  v_permlane32_swap_b32 v22, v23
  v_mfma_f32_16x16x32_bf16 v[144:147], a[188:191], a[252:255], v[144:147]
  s_waitcnt lgkmcnt(4)
  s_mul_i32 s67, s67, 5120
  s_add_u32 s67, s67, s65
  v_mfma_f32_16x16x32_bf16 v[148:151], a[168:171], v[184:187], v[148:151]
  ds_read_b64_tr_b16 a[248:249], v192 offset:30848
  ds_read_b64_tr_b16 a[250:251], v192 offset:32128
  v_max_f32 v20, v20, v21
  v_mfma_f32_16x16x32_bf16 v[148:151], a[180:183], v[188:191], v[148:151]
  buffer_load_dwordx4 a[140:143], v248, s[36:39], s67 offen offset:0 sc1
  v_max_f32 v22, v22, v23
  v_mfma_f32_16x16x32_bf16 v[152:155], a[184:187], v[188:191], v[152:155]
  ds_read_b64_tr_b16 a[252:253], v192 offset:35968
  ds_read_b64_tr_b16 a[254:255], v192 offset:37248
  v_permlane16_swap_b32 v20, v22
  v_mfma_f32_16x16x32_bf16 v[152:155], a[172:175], v[184:187], v[152:155]
  v_max_f32 v20, v20, v22
  v_mov_b32 v22, v20
  v_mfma_f32_16x16x32_bf16 v[156:159], a[176:179], v[184:187], v[156:159]
  s_waitcnt vmcnt(26)
  v_permlane16_swap_b32 v20, v22
  v_mfma_f32_16x16x32_bf16 v[156:159], a[188:191], v[188:191], v[156:159]
  s_waitcnt lgkmcnt(4)
  buffer_load_dwordx4 a[144:147], v248, s[36:39], s67 offen offset:1024 sc1
  v_mfma_f32_16x16x32_bf16 v[160:163], a[168:171], a[240:243], v[160:163]
  s_barrier
  ds_read_b64_tr_b16 v[184:185], v193 offset:0
  ds_read_b64_tr_b16 v[186:187], v193 offset:1280
  v_mov_b32 v21, v20
  v_mfma_f32_16x16x32_bf16 v[160:163], a[180:183], a[244:247], v[160:163]
  v_mov_b32 v23, v22
  v_permlane32_swap_b32 v20, v21
  v_mfma_f32_16x16x32_bf16 v[164:167], a[184:187], a[244:247], v[164:167]
  ds_read_b64_tr_b16 v[188:189], v193 offset:5120
  ds_read_b64_tr_b16 v[190:191], v193 offset:6400
  v_mfma_f32_16x16x32_bf16 v[164:167], a[172:175], a[240:243], v[164:167]
  buffer_load_dwordx4 a[148:151], v248, s[36:39], s67 offen offset:2048 sc1
  v_permlane32_swap_b32 v22, v23
  v_pk_add_f32 v[84:85], v[84:85], v[20:21] op_sel:[0,0] op_sel_hi:[1,0] neg_lo:[0,1] neg_hi:[0,1]
  v_pk_add_f32 v[86:87], v[86:87], v[20:21] op_sel:[0,0] op_sel_hi:[1,0] neg_lo:[0,1] neg_hi:[0,1]
  v_pk_add_f32 v[88:89], v[88:89], v[20:21] op_sel:[0,1] op_sel_hi:[1,1] neg_lo:[0,1] neg_hi:[0,1]
  v_pk_add_f32 v[90:91], v[90:91], v[20:21] op_sel:[0,1] op_sel_hi:[1,1] neg_lo:[0,1] neg_hi:[0,1]
  v_pk_add_f32 v[92:93], v[92:93], v[22:23] op_sel:[0,0] op_sel_hi:[1,0] neg_lo:[0,1] neg_hi:[0,1]
  v_pk_add_f32 v[94:95], v[94:95], v[22:23] op_sel:[0,0] op_sel_hi:[1,0] neg_lo:[0,1] neg_hi:[0,1]
  v_pk_add_f32 v[96:97], v[96:97], v[22:23] op_sel:[0,1] op_sel_hi:[1,1] neg_lo:[0,1] neg_hi:[0,1]
  v_pk_add_f32 v[98:99], v[98:99], v[22:23] op_sel:[0,1] op_sel_hi:[1,1] neg_lo:[0,1] neg_hi:[0,1]
  v_mfma_f32_16x16x32_bf16 v[168:171], a[176:179], a[240:243], v[168:171]
  v_exp_f32 v84, v84
  v_mfma_f32_16x16x32_bf16 v[168:171], a[188:191], a[244:247], v[168:171]
  s_waitcnt lgkmcnt(4)
  v_exp_f32 v85, v85
  v_mfma_f32_16x16x32_bf16 v[172:175], a[168:171], a[248:251], v[172:175]
  ds_read_b64_tr_b16 a[240:241], v193 offset:32
  ds_read_b64_tr_b16 a[242:243], v193 offset:1312
  v_mfma_f32_16x16x32_bf16 v[172:175], a[180:183], a[252:255], v[172:175]
  buffer_load_dwordx4 a[152:155], v248, s[36:39], s67 offen offset:3072 sc1
  v_exp_f32 v86, v86
  v_mfma_f32_16x16x32_bf16 v[176:179], a[184:187], a[252:255], v[176:179]
  s_add_u32 s67, s67, 4096
  ds_read_b64_tr_b16 a[244:245], v193 offset:5152
  ds_read_b64_tr_b16 a[246:247], v193 offset:6432
  v_mfma_f32_16x16x32_bf16 v[176:179], a[172:175], a[248:251], v[176:179]
  v_exp_f32 v87, v87
  v_mfma_f32_16x16x32_bf16 v[180:183], a[176:179], a[248:251], v[180:183]
  v_exp_f32 v88, v88
  v_mfma_f32_16x16x32_bf16 v[180:183], a[188:191], a[252:255], v[180:183]
  s_waitcnt lgkmcnt(4)
  buffer_load_dwordx4 a[156:159], v248, s[36:39], s67 offen offset:0 sc1
  v_mfma_f32_16x16x32_bf16 v[124:127], a[192:195], v[184:187], v[124:127]
  s_bfe_u32 s67, s23, 0x40004
  ds_read_b64_tr_b16 a[248:249], v193 offset:64
  ds_read_b64_tr_b16 a[250:251], v193 offset:1344
  v_exp_f32 v89, v89
  v_mfma_f32_16x16x32_bf16 v[124:127], a[204:207], v[188:191], v[124:127]
  s_mul_i32 s67, s67, 5120
  v_exp_f32 v90, v90
  v_mfma_f32_16x16x32_bf16 v[128:131], a[208:211], v[188:191], v[128:131]
  s_add_u32 s67, s67, s65
  ds_read_b64_tr_b16 a[252:253], v193 offset:5184
  ds_read_b64_tr_b16 a[254:255], v193 offset:6464
  v_mfma_f32_16x16x32_bf16 v[128:131], a[196:199], v[184:187], v[128:131]
  v_exp_f32 v91, v91
  v_mfma_f32_16x16x32_bf16 v[132:135], a[200:203], v[184:187], v[132:135]
  buffer_load_dwordx4 a[160:163], v248, s[36:39], s67 offen offset:0 sc1
  v_exp_f32 v92, v92
  v_mfma_f32_16x16x32_bf16 v[132:135], a[212:215], v[188:191], v[132:135]
  s_waitcnt lgkmcnt(4)
  v_exp_f32 v93, v93
  v_mfma_f32_16x16x32_bf16 v[136:139], a[192:195], a[240:243], v[136:139]
  ds_read_b64_tr_b16 v[184:185], v193 offset:96
  ds_read_b64_tr_b16 v[186:187], v193 offset:1376
  v_mfma_f32_16x16x32_bf16 v[136:139], a[204:207], a[244:247], v[136:139]
  v_exp_f32 v94, v94
  v_mfma_f32_16x16x32_bf16 v[140:143], a[208:211], a[244:247], v[140:143]
  ds_read_b64_tr_b16 v[188:189], v193 offset:5216
  ds_read_b64_tr_b16 v[190:191], v193 offset:6496
  buffer_load_dwordx4 a[164:167], v248, s[36:39], s67 offen offset:1024 sc1
  v_mfma_f32_16x16x32_bf16 v[140:143], a[196:199], a[240:243], v[140:143]
  v_exp_f32 v95, v95
  v_mfma_f32_16x16x32_bf16 v[144:147], a[200:203], a[240:243], v[144:147]
  v_exp_f32 v96, v96
  v_mfma_f32_16x16x32_bf16 v[144:147], a[212:215], a[244:247], v[144:147]
  s_waitcnt lgkmcnt(4)
  buffer_load_dwordx4 a[168:171], v248, s[36:39], s67 offen offset:2048 sc1
  v_mfma_f32_16x16x32_bf16 v[148:151], a[192:195], a[248:251], v[148:151]
  ds_read_b64_tr_b16 a[240:241], v193 offset:128
  ds_read_b64_tr_b16 a[242:243], v193 offset:1408
  v_exp_f32 v97, v97
  v_mfma_f32_16x16x32_bf16 v[148:151], a[204:207], a[252:255], v[148:151]
  s_bfm_b64 exec, 32, 32
  buffer_load_dword v254, v252, s[36:39], 0 offen sc1
  s_mov_b64 exec, -1
  v_exp_f32 v98, v98
  v_mfma_f32_16x16x32_bf16 v[152:155], a[208:211], a[252:255], v[152:155]
  ds_read_b64_tr_b16 a[244:245], v193 offset:5248
  ds_read_b64_tr_b16 a[246:247], v193 offset:6528
  v_mfma_f32_16x16x32_bf16 v[152:155], a[196:199], a[248:251], v[152:155]
  v_exp_f32 v99, v99
  v_pk_add_f32 v[42:43], v[84:85], v[86:87]
  v_pk_add_f32 v[46:47], v[88:89], v[90:91]
  v_pk_add_f32 v[50:51], v[92:93], v[94:95]
  v_pk_add_f32 v[100:101], v[96:97], v[98:99]
  v_mfma_f32_16x16x32_bf16 v[156:159], a[200:203], a[248:251], v[156:159]
  buffer_load_dwordx4 a[172:175], v248, s[36:39], s67 offen offset:3072 sc1
  v_add_f32 v20, v42, v43
  v_mfma_f32_16x16x32_bf16 v[156:159], a[212:215], a[252:255], v[156:159]
  s_waitcnt lgkmcnt(4)
  v_add_f32 v21, v46, v47
  v_add_f32 v22, v50, v51
  v_mfma_f32_16x16x32_bf16 v[160:163], a[192:195], v[184:187], v[160:163]
  s_add_u32 s67, s67, 4096
  ds_read_b64_tr_b16 a[248:249], v193 offset:10240
  ds_read_b64_tr_b16 a[250:251], v193 offset:11520
  v_add_f32 v23, v100, v101
  v_mfma_f32_16x16x32_bf16 v[160:163], a[204:207], v[188:191], v[160:163]
  v_permlane32_swap_b32 v20, v21
  v_mfma_f32_16x16x32_bf16 v[164:167], a[208:211], v[188:191], v[164:167]
  ds_read_b64_tr_b16 a[252:253], v193 offset:15360
  ds_read_b64_tr_b16 a[254:255], v193 offset:16640
  buffer_load_dwordx4 a[176:179], v248, s[36:39], s67 offen offset:0 sc1
  v_mfma_f32_16x16x32_bf16 v[164:167], a[196:199], v[184:187], v[164:167]
  s_bfe_u32 s67, s23, 0x40008
  v_permlane32_swap_b32 v22, v23
  v_mfma_f32_16x16x32_bf16 v[168:171], a[200:203], v[184:187], v[168:171]
  s_mul_i32 s67, s67, 5120
  s_add_u32 s67, s67, s65
  v_add_f32 v20, v20, v21
  v_mfma_f32_16x16x32_bf16 v[168:171], a[212:215], v[188:191], v[168:171]
  s_waitcnt lgkmcnt(4)
  v_add_f32 v22, v22, v23
  v_mfma_f32_16x16x32_bf16 v[172:175], a[192:195], a[240:243], v[172:175]
  ds_read_b64_tr_b16 v[184:185], v193 offset:10272
  ds_read_b64_tr_b16 v[186:187], v193 offset:11552
  buffer_load_dwordx4 a[180:183], v248, s[36:39], s67 offen offset:0 sc1
  v_permlane16_swap_b32 v20, v22
  v_mfma_f32_16x16x32_bf16 v[172:175], a[204:207], a[244:247], v[172:175]
  v_add_f32 v20, v20, v22
  v_mfma_f32_16x16x32_bf16 v[176:179], a[208:211], a[244:247], v[176:179]
  ds_read_b64_tr_b16 v[188:189], v193 offset:15392
  ds_read_b64_tr_b16 v[190:191], v193 offset:16672
  v_rcp_f32 v20, v20
  v_mfma_f32_16x16x32_bf16 v[176:179], a[196:199], a[240:243], v[176:179]
  v_mov_b32 v22, v20
  v_mfma_f32_16x16x32_bf16 v[180:183], a[200:203], a[240:243], v[180:183]
  buffer_load_dwordx4 a[184:187], v248, s[36:39], s67 offen offset:1024 sc1
  v_permlane16_swap_b32 v20, v22
  v_mfma_f32_16x16x32_bf16 v[180:183], a[212:215], a[244:247], v[180:183]
  s_waitcnt lgkmcnt(4)
  v_mov_b32 v21, v20
  v_mov_b32 v23, v22
  v_mfma_f32_16x16x32_bf16 v[124:127], a[216:219], a[248:251], v[124:127]
  ds_read_b64_tr_b16 a[240:241], v193 offset:10304
  ds_read_b64_tr_b16 a[242:243], v193 offset:11584
  v_mfma_f32_16x16x32_bf16 v[124:127], a[228:231], a[252:255], v[124:127]
  v_permlane32_swap_b32 v20, v21
  v_mfma_f32_16x16x32_bf16 v[128:131], a[232:235], a[252:255], v[128:131]
  ds_read_b64_tr_b16 a[244:245], v193 offset:15424
  ds_read_b64_tr_b16 a[246:247], v193 offset:16704
  v_mfma_f32_16x16x32_bf16 v[128:131], a[220:223], a[248:251], v[128:131]
  buffer_load_dwordx4 a[188:191], v248, s[36:39], s67 offen offset:2048 sc1
  v_permlane32_swap_b32 v22, v23
  v_pk_mul_f32 v[84:85], v[84:85], v[20:21] op_sel:[0,0] op_sel_hi:[1,0]
  v_pk_mul_f32 v[86:87], v[86:87], v[20:21] op_sel:[0,0] op_sel_hi:[1,0]
  v_cvt_pk_bf16_f32 v44, v84, v85
  v_cvt_pk_bf16_f32 v45, v86, v87
  v_and_b32 v42, v44, v208
  v_and_b32 v43, v45, v209
  v_xor_b32 v44, v44, v42
  v_xor_b32 v45, v45, v43
  v_pk_mul_f32 v[88:89], v[88:89], v[20:21] op_sel:[0,1] op_sel_hi:[1,1]
  v_pk_mul_f32 v[90:91], v[90:91], v[20:21] op_sel:[0,1] op_sel_hi:[1,1]
  v_cvt_pk_bf16_f32 v48, v88, v89
  v_cvt_pk_bf16_f32 v49, v90, v91
  v_and_b32 v46, v48, v208
  v_and_b32 v47, v49, v209
  v_xor_b32 v48, v48, v46
  v_xor_b32 v49, v49, v47
  v_pk_mul_f32 v[92:93], v[92:93], v[22:23] op_sel:[0,0] op_sel_hi:[1,0]
  v_pk_mul_f32 v[94:95], v[94:95], v[22:23] op_sel:[0,0] op_sel_hi:[1,0]
  v_cvt_pk_bf16_f32 v52, v92, v93
  v_cvt_pk_bf16_f32 v53, v94, v95
  v_and_b32 v50, v52, v208
  v_and_b32 v51, v53, v209
  v_xor_b32 v52, v52, v50
  v_xor_b32 v53, v53, v51
  v_pk_mul_f32 v[96:97], v[96:97], v[22:23] op_sel:[0,1] op_sel_hi:[1,1]
  v_pk_mul_f32 v[98:99], v[98:99], v[22:23] op_sel:[0,1] op_sel_hi:[1,1]
  v_mfma_f32_16x16x32_bf16 v[132:135], a[224:227], a[248:251], v[132:135]
  v_cvt_pk_bf16_f32 v102, v96, v97
  v_cvt_pk_bf16_f32 v103, v98, v99
  v_mfma_f32_16x16x32_bf16 v[132:135], a[236:239], a[252:255], v[132:135]
  s_waitcnt lgkmcnt(4)
  v_and_b32 v100, v102, v208
  v_and_b32 v101, v103, v209
  v_mfma_f32_16x16x32_bf16 v[136:139], a[216:219], v[184:187], v[136:139]
  ds_read_b64_tr_b16 a[248:249], v193 offset:10336
  ds_read_b64_tr_b16 a[250:251], v193 offset:11616
  v_mfma_f32_16x16x32_bf16 v[136:139], a[228:231], v[188:191], v[136:139]
  buffer_load_dwordx4 a[192:195], v248, s[36:39], s67 offen offset:3072 sc1
  v_xor_b32 v102, v102, v100
  v_mfma_f32_16x16x32_bf16 v[140:143], a[232:235], v[188:191], v[140:143]
  s_add_u32 s67, s67, 4096
  ds_read_b64_tr_b16 a[252:253], v193 offset:15456
  ds_read_b64_tr_b16 a[254:255], v193 offset:16736
  ds_read_b64 v[14:15], v212 offset:0
  v_xor_b32 v103, v103, v101
  v_mfma_f32_16x16x32_bf16 v[140:143], a[220:223], v[184:187], v[140:143]
  ds_read_b64 v[16:17], v212 offset:512
  ds_read_b64 v[18:19], v212 offset:1024
  v_mfma_f32_16x16x32_bf16 v[144:147], a[224:227], v[184:187], v[144:147]
  buffer_load_dwordx4 a[196:199], v248, s[36:39], s67 offen offset:0 sc1
  v_mfma_f32_16x16x32_bf16 v[144:147], a[236:239], v[188:191], v[144:147]
  s_waitcnt lgkmcnt(7)
  ds_read_b64 v[20:21], v212 offset:1536
  ds_read_b64 v[22:23], v212 offset:2048
  v_mfma_f32_16x16x32_bf16 v[148:151], a[216:219], a[240:243], v[148:151]
  s_bfe_u32 s67, s23, 0x4000c
  ds_read_b64_tr_b16 v[184:185], v193 offset:10368
  ds_read_b64_tr_b16 v[186:187], v193 offset:11648
  v_cvt_pk_bf16_f32 v84, v64, v65
  v_mfma_f32_16x16x32_bf16 v[148:151], a[228:231], a[244:247], v[148:151]
  s_mul_i32 s67, s67, 5120
  s_add_u32 s67, s67, s65
  v_cvt_pk_bf16_f32 v98, v80, v81
  v_mfma_f32_16x16x32_bf16 v[152:155], a[232:235], a[244:247], v[152:155]
  ds_read_b64_tr_b16 v[188:189], v193 offset:15488
  ds_read_b64_tr_b16 v[190:191], v193 offset:16768
  v_cvt_pk_bf16_f32 v85, v66, v67
  v_cvt_pk_bf16_f32 v99, v82, v83
  v_mfma_f32_16x16x32_bf16 v[152:155], a[220:223], a[240:243], v[152:155]
  buffer_load_dwordx4 a[200:203], v248, s[36:39], s67 offen offset:0 sc1
  v_cvt_pk_bf16_f32 v86, v68, v69
  v_mfma_f32_16x16x32_bf16 v[156:159], a[224:227], a[240:243], v[156:159]
  v_cndmask_b32 v88, v86, 0, s[76:77]
  v_cndmask_b32 v86, 0, v86, s[76:77]
  v_mfma_f32_16x16x32_bf16 v[156:159], a[236:239], a[244:247], v[156:159]
  s_waitcnt lgkmcnt(9)
  v_cvt_pk_bf16_f32 v87, v70, v71
  v_cndmask_b32 v89, v87, 0, s[76:77]
  v_mfma_f32_16x16x32_bf16 v[160:163], a[216:219], a[248:251], v[160:163]
  buffer_load_dwordx4 a[204:207], v248, s[36:39], s67 offen offset:1024 sc1
  v_mfma_f32_16x16x32_bf16 v[160:163], a[228:231], a[252:255], v[160:163]
  v_cndmask_b32 v87, 0, v87, s[76:77]
  v_cvt_pk_bf16_f32 v90, v72, v73
  v_mfma_f32_16x16x32_bf16 v[164:167], a[232:235], a[252:255], v[164:167]
  v_cndmask_b32 v92, v90, 0, s[78:79]
  v_cndmask_b32 v90, 0, v90, s[78:79]
  v_mfma_f32_16x16x32_bf16 v[164:167], a[220:223], a[248:251], v[164:167]
  v_cvt_pk_bf16_f32 v91, v74, v75
  v_cndmask_b32 v93, v91, 0, s[78:79]
  v_mfma_f32_16x16x32_bf16 v[168:171], a[224:227], a[248:251], v[168:171]
  s_waitcnt vmcnt(9)
  buffer_load_dwordx4 a[208:211], v248, s[36:39], s67 offen offset:2048 sc1
  v_mfma_f32_16x16x32_bf16 v[168:171], a[236:239], a[252:255], v[168:171]
  s_waitcnt lgkmcnt(0)
  v_cndmask_b32 v91, 0, v91, s[78:79]
  v_cvt_pk_bf16_f32 v94, v76, v77
  v_mfma_f32_16x16x32_bf16 v[172:175], a[216:219], v[184:187], v[172:175]
  v_cndmask_b32 v96, v94, 0, s[80:81]
  v_cmp_ne_u32 vcc, v254, v249
  v_mfma_f32_16x16x32_bf16 v[172:175], a[228:231], v[188:191], v[172:175]
  s_cmp_lg_u32 vcc_hi, 0
  s_cbranch_scc1 SA0
BA0:
  v_cndmask_b32 v94, 0, v94, s[80:81]
  v_cvt_pk_bf16_f32 v95, v78, v79
  v_mfma_f32_16x16x32_bf16 v[176:179], a[232:235], v[188:191], v[176:179]
  buffer_load_dwordx4 a[212:215], v248, s[36:39], s67 offen offset:3072 sc1
  v_mfma_f32_16x16x32_bf16 v[176:179], a[220:223], v[184:187], v[176:179]
  v_cndmask_b32 v97, v95, 0, s[80:81]
  v_cndmask_b32 v95, 0, v95, s[80:81]
  v_mfma_f32_16x16x32_bf16 v[180:183], a[224:227], v[184:187], v[180:183]
  v_mfma_f32_16x16x32_bf16 v[24:27], v[14:17], v[84:87], 0
  v_mfma_f32_16x16x32_bf16 v[62:65], v[4:7], v[84:87], 0
  v_mfma_f32_16x16x32_bf16 v[28:31], v[16:19], v[88:91], 0
  v_mfma_f32_16x16x32_bf16 v[66:69], v[6:9], v[88:91], 0
  v_mfma_f32_16x16x32_bf16 v[32:35], v[18:21], v[92:95], 0
  v_mfma_f32_16x16x32_bf16 v[70:73], v[8:11], v[92:95], 0
  v_mfma_f32_16x16x32_bf16 v[36:39], v[20:23], v[96:99], 0
  v_mfma_f32_16x16x32_bf16 v[74:77], v[10:13], v[96:99], 0
  v_mfma_f32_16x16x32_bf16 v[180:183], a[236:239], v[188:191], v[180:183]
  v_and_b32 v199, 15, v0
  v_lshlrev_b32 v199, 2, v199
  ds_read_b128 v[20:23], v210 offset:64
  s_add_u32 s12, s4, s57
  ds_read_b128 v[120:123], v210 offset:320
  buffer_load_dwordx4 v[84:87], v248, s[36:39], s12 offen sc1
  ds_read_b128 v[112:115], v210 offset:128
  ds_read_b128 v[184:187], v210 offset:384
  ds_read_b128 v[116:119], v210 offset:192
  ds_read_b128 v[188:191], v210 offset:448
  ds_bpermute_b32 v192, v199, v124
  ds_bpermute_b32 v193, v199, v136
  ds_bpermute_b32 v194, v199, v148
  ds_bpermute_b32 v195, v199, v160
  ds_bpermute_b32 v196, v199, v172
  v_subrev_u32 v211, 147456, v211
  v_subrev_u32 v212, 147456, v212
  v_cndmask_b32 v62, v62, v24, s[82:83]
  s_add_u32 s12, s5, s57
  v_cndmask_b32 v63, v63, v25, s[84:85]
  buffer_load_dwordx4 v[88:91], v248, s[36:39], s12 offen sc1
  v_cndmask_b32 v64, v64, v26, s[86:87]
  v_cndmask_b32 v65, v65, v27, s[88:89]
  v_pk_fma_f32 v[62:63], v[62:63], v[214:215], v[218:219]
  v_pk_fma_f32 v[64:65], v[64:65], v[216:217], v[220:221]
  v_max3_f32 v78, v62, v63, v64
  v_max_f32 v78, v78, v65
  v_cndmask_b32 v66, v66, v28, s[82:83]
  v_cndmask_b32 v67, v67, v29, s[84:85]
  v_cndmask_b32 v68, v68, v30, s[86:87]
  v_cndmask_b32 v69, v69, v31, s[88:89]
  v_pk_fma_f32 v[66:67], v[66:67], v[214:215], v[218:219]
  v_pk_fma_f32 v[68:69], v[68:69], v[216:217], v[220:221]
  s_add_u32 s12, s6, s57
  v_max3_f32 v79, v66, v67, v68
  buffer_load_dwordx4 v[92:95], v248, s[36:39], s12 offen sc1
  v_max_f32 v79, v79, v69
  v_cndmask_b32 v70, v70, v32, s[82:83]
  v_cndmask_b32 v71, v71, v33, s[84:85]
  v_cndmask_b32 v72, v72, v34, s[86:87]
  v_cndmask_b32 v73, v73, v35, s[88:89]
  v_pk_fma_f32 v[70:71], v[70:71], v[214:215], v[218:219]
  v_pk_fma_f32 v[72:73], v[72:73], v[216:217], v[220:221]
  v_max3_f32 v80, v70, v71, v72
  v_max_f32 v80, v80, v73
  v_cndmask_b32 v74, v74, v36, s[82:83]
  v_cndmask_b32 v75, v75, v37, s[84:85]
  v_cndmask_b32 v76, v76, v38, s[86:87]
  s_add_u32 s12, s7, s57
  v_cndmask_b32 v77, v77, v39, s[88:89]
  buffer_load_dwordx4 v[96:99], v248, s[36:39], s12 offen sc1
  v_pk_fma_f32 v[74:75], v[74:75], v[214:215], v[218:219]
  v_pk_fma_f32 v[76:77], v[76:77], v[216:217], v[220:221]
  v_max3_f32 v81, v74, v75, v76
  v_max_f32 v81, v81, v77
  v_permlane32_swap_b32 v78, v79
  v_max_f32 v78, v78, v79
  v_permlane32_swap_b32 v80, v81
  v_max_f32 v80, v80, v81
  s_nop 1
  v_permlane16_swap_b32 v78, v80
  s_add_u32 s12, s4, s59
  v_max_f32 v78, v78, v80
  buffer_load_dwordx4 v[4:7], v248, s[36:39], s12 offen sc1
  v_mov_b32 v80, v78
  s_nop 1
  v_permlane16_swap_b32 v78, v80
  v_mov_b32 v79, v78
  v_mov_b32 v81, v80
  s_nop 0
  v_permlane32_swap_b32 v78, v79
  v_permlane32_swap_b32 v80, v81
  v_pk_add_f32 v[62:63], v[62:63], v[78:79] op_sel:[0,0] op_sel_hi:[1,0] neg_lo:[0,1] neg_hi:[0,1]
  v_pk_add_f32 v[64:65], v[64:65], v[78:79] op_sel:[0,0] op_sel_hi:[1,0] neg_lo:[0,1] neg_hi:[0,1]
  v_pk_add_f32 v[66:67], v[66:67], v[78:79] op_sel:[0,1] op_sel_hi:[1,1] neg_lo:[0,1] neg_hi:[0,1]
  s_add_u32 s12, s5, s59
  v_pk_add_f32 v[68:69], v[68:69], v[78:79] op_sel:[0,1] op_sel_hi:[1,1] neg_lo:[0,1] neg_hi:[0,1]
  buffer_load_dwordx4 v[8:11], v248, s[36:39], s12 offen sc1
  v_pk_add_f32 v[70:71], v[70:71], v[80:81] op_sel:[0,0] op_sel_hi:[1,0] neg_lo:[0,1] neg_hi:[0,1]
  v_pk_add_f32 v[72:73], v[72:73], v[80:81] op_sel:[0,0] op_sel_hi:[1,0] neg_lo:[0,1] neg_hi:[0,1]
  v_pk_add_f32 v[74:75], v[74:75], v[80:81] op_sel:[0,1] op_sel_hi:[1,1] neg_lo:[0,1] neg_hi:[0,1]
  v_pk_add_f32 v[76:77], v[76:77], v[80:81] op_sel:[0,1] op_sel_hi:[1,1] neg_lo:[0,1] neg_hi:[0,1]
  s_waitcnt lgkmcnt(0)
  v_pk_fma_f32 v[128:129], v[112:113], v[192:193], v[128:129] op_sel:[0,0,0] op_sel_hi:[1,0,1]
  v_pk_fma_f32 v[130:131], v[114:115], v[192:193], v[130:131] op_sel:[0,0,0] op_sel_hi:[1,0,1]
  v_pk_mul_f32 v[128:129], v[128:129], v[184:185]
  v_pk_mul_f32 v[130:131], v[130:131], v[186:187]
  v_cvt_pk_bf16_f32 v128, v128, v129
  v_cvt_pk_bf16_f32 v129, v130, v131
  v_pk_fma_f32 v[140:141], v[112:113], v[192:193], v[140:141] op_sel:[0,1,0] op_sel_hi:[1,1,1]
  s_add_u32 s12, s6, s59
  v_pk_fma_f32 v[142:143], v[114:115], v[192:193], v[142:143] op_sel:[0,1,0] op_sel_hi:[1,1,1]
  buffer_load_dwordx4 v[12:15], v248, s[36:39], s12 offen sc1
  v_pk_mul_f32 v[140:141], v[140:141], v[184:185]
  v_pk_mul_f32 v[142:143], v[142:143], v[186:187]
  v_cvt_pk_bf16_f32 v140, v140, v141
  v_cvt_pk_bf16_f32 v141, v142, v143
  v_pk_fma_f32 v[152:153], v[112:113], v[194:195], v[152:153] op_sel:[0,0,0] op_sel_hi:[1,0,1]
  v_pk_fma_f32 v[154:155], v[114:115], v[194:195], v[154:155] op_sel:[0,0,0] op_sel_hi:[1,0,1]
  v_pk_mul_f32 v[152:153], v[152:153], v[184:185]
  v_pk_mul_f32 v[154:155], v[154:155], v[186:187]
  v_cvt_pk_bf16_f32 v152, v152, v153
  v_cvt_pk_bf16_f32 v153, v154, v155
  v_pk_fma_f32 v[164:165], v[112:113], v[194:195], v[164:165] op_sel:[0,1,0] op_sel_hi:[1,1,1]
  v_pk_fma_f32 v[166:167], v[114:115], v[194:195], v[166:167] op_sel:[0,1,0] op_sel_hi:[1,1,1]
  s_add_u32 s12, s7, s59
  v_pk_mul_f32 v[164:165], v[164:165], v[184:185]
  buffer_load_dwordx4 v[16:19], v248, s[36:39], s12 offen sc1
  v_pk_mul_f32 v[166:167], v[166:167], v[186:187]
  v_cvt_pk_bf16_f32 v164, v164, v165
  v_cvt_pk_bf16_f32 v165, v166, v167
  v_pk_fma_f32 v[176:177], v[112:113], v[196:197], v[176:177] op_sel:[0,0,0] op_sel_hi:[1,0,1]
  v_pk_fma_f32 v[178:179], v[114:115], v[196:197], v[178:179] op_sel:[0,0,0] op_sel_hi:[1,0,1]
  v_pk_mul_f32 v[176:177], v[176:177], v[184:185]
  v_pk_mul_f32 v[178:179], v[178:179], v[186:187]
  v_cvt_pk_bf16_f32 v176, v176, v177
  v_cvt_pk_bf16_f32 v177, v178, v179
  v_pk_fma_f32 v[132:133], v[116:117], v[192:193], v[132:133] op_sel:[0,0,0] op_sel_hi:[1,0,1]
  v_pk_fma_f32 v[134:135], v[118:119], v[192:193], v[134:135] op_sel:[0,0,0] op_sel_hi:[1,0,1]
  v_pk_mul_f32 v[132:133], v[132:133], v[188:189]
  s_add_u32 s12, s4, s56
  v_pk_mul_f32 v[134:135], v[134:135], v[190:191]
  buffer_load_dwordx4 a[240:243], v248, s[36:39], s12 offen sc1
  v_cvt_pk_bf16_f32 v130, v132, v133
  v_cvt_pk_bf16_f32 v131, v134, v135
  v_pk_fma_f32 v[144:145], v[116:117], v[192:193], v[144:145] op_sel:[0,1,0] op_sel_hi:[1,1,1]
  v_pk_fma_f32 v[146:147], v[118:119], v[192:193], v[146:147] op_sel:[0,1,0] op_sel_hi:[1,1,1]
  v_pk_mul_f32 v[144:145], v[144:145], v[188:189]
  v_pk_mul_f32 v[146:147], v[146:147], v[190:191]
  v_cvt_pk_bf16_f32 v142, v144, v145
  v_cvt_pk_bf16_f32 v143, v146, v147
  v_pk_fma_f32 v[156:157], v[116:117], v[194:195], v[156:157] op_sel:[0,0,0] op_sel_hi:[1,0,1]
  v_pk_fma_f32 v[158:159], v[118:119], v[194:195], v[158:159] op_sel:[0,0,0] op_sel_hi:[1,0,1]
  v_pk_mul_f32 v[156:157], v[156:157], v[188:189]
  v_pk_mul_f32 v[158:159], v[158:159], v[190:191]
  s_add_u32 s12, s5, s56
  v_cvt_pk_bf16_f32 v154, v156, v157
  buffer_load_dwordx4 a[244:247], v248, s[36:39], s12 offen sc1
  v_cvt_pk_bf16_f32 v155, v158, v159
  v_pk_fma_f32 v[168:169], v[116:117], v[194:195], v[168:169] op_sel:[0,1,0] op_sel_hi:[1,1,1]
  v_pk_fma_f32 v[170:171], v[118:119], v[194:195], v[170:171] op_sel:[0,1,0] op_sel_hi:[1,1,1]
  v_pk_mul_f32 v[168:169], v[168:169], v[188:189]
  v_pk_mul_f32 v[170:171], v[170:171], v[190:191]
  v_cvt_pk_bf16_f32 v166, v168, v169
  v_cvt_pk_bf16_f32 v167, v170, v171
  v_pk_fma_f32 v[180:181], v[116:117], v[196:197], v[180:181] op_sel:[0,0,0] op_sel_hi:[1,0,1]
  v_pk_fma_f32 v[182:183], v[118:119], v[196:197], v[182:183] op_sel:[0,0,0] op_sel_hi:[1,0,1]
  v_pk_mul_f32 v[180:181], v[180:181], v[188:189]
  v_pk_mul_f32 v[182:183], v[182:183], v[190:191]
  v_cvt_pk_bf16_f32 v178, v180, v181
  s_add_u32 s12, s6, s56
  v_cvt_pk_bf16_f32 v179, v182, v183
  buffer_load_dwordx4 a[248:251], v248, s[36:39], s12 offen sc1
  ds_write_b64 v211, v[130:131] offset:0
  ds_write_b64 v211, v[142:143] offset:512
  ds_write_b64 v211, v[154:155] offset:1024
  ds_write_b64 v211, v[166:167] offset:1536
  s_add_u32 s12, s7, s56
  ds_write_b64 v211, v[178:179] offset:2048
  buffer_load_dwordx4 a[252:255], v248, s[36:39], s12 offen sc1
  v_pk_fma_f32 v[124:125], v[20:21], v[192:193], v[124:125] op_sel:[0,0,0] op_sel_hi:[1,0,1]
  v_pk_fma_f32 v[126:127], v[22:23], v[192:193], v[126:127] op_sel:[0,0,0] op_sel_hi:[1,0,1]
  v_pk_mul_f32 v[124:125], v[124:125], v[120:121]
  v_pk_mul_f32 v[126:127], v[126:127], v[122:123]
  v_cvt_pk_bf16_f32 v127, v126, v127
  v_cvt_pk_bf16_f32 v126, v124, v125
  v_pk_fma_f32 v[136:137], v[20:21], v[192:193], v[136:137] op_sel:[0,1,0] op_sel_hi:[1,1,1]
  v_pk_fma_f32 v[138:139], v[22:23], v[192:193], v[138:139] op_sel:[0,1,0] op_sel_hi:[1,1,1]
  v_pk_mul_f32 v[136:137], v[136:137], v[120:121]
  v_pk_mul_f32 v[138:139], v[138:139], v[122:123]
  v_cvt_pk_bf16_f32 v139, v138, v139
  v_cvt_pk_bf16_f32 v138, v136, v137
  s_add_u32 s67, s67, 4096
AHOP5:
  s_cbranch_execz AHRET
  v_pk_fma_f32 v[148:149], v[20:21], v[194:195], v[148:149] op_sel:[0,0,0] op_sel_hi:[1,0,1]
  buffer_load_dwordx4 a[216:219], v248, s[36:39], s67 offen offset:0 sc1
  v_pk_fma_f32 v[150:151], v[22:23], v[194:195], v[150:151] op_sel:[0,0,0] op_sel_hi:[1,0,1]
  v_pk_mul_f32 v[148:149], v[148:149], v[120:121]
  v_pk_mul_f32 v[150:151], v[150:151], v[122:123]
  v_cvt_pk_bf16_f32 v151, v150, v151
  v_cvt_pk_bf16_f32 v150, v148, v149
  v_pk_fma_f32 v[160:161], v[20:21], v[194:195], v[160:161] op_sel:[0,1,0] op_sel_hi:[1,1,1]
  v_pk_fma_f32 v[162:163], v[22:23], v[194:195], v[162:163] op_sel:[0,1,0] op_sel_hi:[1,1,1]
  v_pk_mul_f32 v[160:161], v[160:161], v[120:121]
  v_pk_mul_f32 v[162:163], v[162:163], v[122:123]
  v_cvt_pk_bf16_f32 v163, v162, v163
  v_cvt_pk_bf16_f32 v162, v160, v161
  v_pk_fma_f32 v[172:173], v[20:21], v[196:197], v[172:173] op_sel:[0,0,0] op_sel_hi:[1,0,1]
  s_bfe_u32 s67, s23, 0x40010
  s_mul_i32 s67, s67, 5120
  s_add_u32 s67, s67, s65
  v_pk_fma_f32 v[174:175], v[22:23], v[196:197], v[174:175] op_sel:[0,0,0] op_sel_hi:[1,0,1]
  buffer_load_dwordx4 a[220:223], v248, s[36:39], s67 offen offset:0 sc1
  v_pk_mul_f32 v[172:173], v[172:173], v[120:121]
  v_pk_mul_f32 v[174:175], v[174:175], v[122:123]
  v_cvt_pk_bf16_f32 v175, v174, v175
  v_cvt_pk_bf16_f32 v174, v172, v173
  s_bfm_b64 exec, 32, 0
  buffer_load_dword v254, v252, s[36:39], 0 offen sc1
  s_mov_b64 exec, -1
  s_waitcnt lgkmcnt(0)
  s_barrier
  ds_read_b64 v[124:125], v212 offset:0
  ds_read_b64 v[136:137], v212 offset:512
  ds_read_b64 v[148:149], v212 offset:1024
  ds_read_b64 v[160:161], v212 offset:1536
  ds_read_b64 v[172:173], v212 offset:2048
  buffer_load_dwordx4 a[224:227], v248, s[36:39], s67 offen offset:1024 sc1
  v_mfma_f32_16x16x32_bf16 v[20:23], v[128:131], v[54:57], 0
  v_exp_f32 v62, v62
  v_mfma_f32_16x16x32_bf16 v[112:115], v[140:143], v[54:57], 0
  v_exp_f32 v63, v63
  v_mfma_f32_16x16x32_bf16 v[116:119], v[140:143], v[58:61], 0
  buffer_load_dwordx4 a[228:231], v248, s[36:39], s67 offen offset:2048 sc1
  v_exp_f32 v64, v64
  v_mfma_f32_16x16x32_bf16 v[120:123], v[152:155], v[58:61], 0
  v_exp_f32 v65, v65
  v_mfma_f32_16x16x32_bf16 v[132:135], v[152:155], v[104:107], 0
  v_exp_f32 v66, v66
  buffer_load_dwordx4 a[232:235], v248, s[36:39], s67 offen offset:3072 sc1
  v_mfma_f32_16x16x32_bf16 v[144:147], v[164:167], v[104:107], 0
  v_exp_f32 v67, v67
  v_mfma_f32_16x16x32_bf16 v[156:159], v[164:167], v[108:111], 0
  v_exp_f32 v68, v68
  s_add_u32 s67, s67, 4096
  v_mfma_f32_16x16x32_bf16 v[168:171], v[176:179], v[108:111], 0
  buffer_load_dwordx4 a[236:239], v248, s[36:39], s67 offen offset:0 sc1
  v_exp_f32 v69, v69
  v_mfma_f32_16x16x32_bf16 v[180:183], v[126:129], v[42:45], 0
  v_exp_f32 v70, v70
  v_mfma_f32_16x16x32_bf16 v[184:187], v[138:141], v[42:45], 0
  v_exp_f32 v71, v71
  v_mfma_f32_16x16x32_bf16 v[188:191], v[138:141], v[46:49], 0
  v_exp_f32 v72, v72
  v_mfma_f32_16x16x32_bf16 v[192:195], v[150:153], v[46:49], 0
  v_exp_f32 v73, v73
  v_mfma_f32_16x16x32_bf16 v[200:203], v[150:153], v[50:53], 0
  v_exp_f32 v74, v74
  v_mfma_f32_16x16x32_bf16 v[222:225], v[162:165], v[50:53], 0
  v_exp_f32 v75, v75
  v_mfma_f32_16x16x32_bf16 v[226:229], v[162:165], v[100:103], 0
  v_exp_f32 v76, v76
  v_mfma_f32_16x16x32_bf16 v[230:233], v[174:177], v[100:103], 0
  v_exp_f32 v77, v77
  v_cvt_pk_bf16_f32 v54, v20, v21
  v_cvt_pk_bf16_f32 v55, v22, v23
  v_cndmask_b32 v116, v116, v112, s[76:77]
  v_cndmask_b32 v117, v117, v113, s[76:77]
  v_cndmask_b32 v118, v118, v114, s[76:77]
  v_cndmask_b32 v119, v119, v115, s[76:77]
  v_cvt_pk_bf16_f32 v56, v116, v117
  v_cvt_pk_bf16_f32 v57, v118, v119
  buffer_store_dwordx4 v[54:57], v3, s[36:39], s70 offen sc1
  v_cndmask_b32 v132, v132, v120, s[78:79]
  v_cndmask_b32 v133, v133, v121, s[78:79]
  v_cndmask_b32 v134, v134, v122, s[78:79]
  v_cndmask_b32 v135, v135, v123, s[78:79]
  v_cvt_pk_bf16_f32 v58, v132, v133
  v_cvt_pk_bf16_f32 v59, v134, v135
  v_cndmask_b32 v156, v156, v144, s[80:81]
  v_cndmask_b32 v157, v157, v145, s[80:81]
  v_cndmask_b32 v158, v158, v146, s[80:81]
  v_cndmask_b32 v159, v159, v147, s[80:81]
  v_cvt_pk_bf16_f32 v60, v156, v157
  v_cvt_pk_bf16_f32 v61, v158, v159
  buffer_store_dwordx4 v[58:61], v3, s[36:39], s71 offen sc1
  v_cvt_pk_bf16_f32 v104, v168, v169
  v_cvt_pk_bf16_f32 v105, v170, v171
  v_add_u32 v3, v213, v3
  buffer_store_dwordx2 v[104:105], v3, s[36:39], s72 offen sc1
  v_pk_add_f32 v[24:25], v[62:63], v[64:65]
  v_pk_add_f32 v[28:29], v[66:67], v[68:69]
  v_pk_add_f32 v[32:33], v[70:71], v[72:73]
  v_pk_add_f32 v[36:37], v[74:75], v[76:77]
  v_add_f32 v78, v24, v25
  v_add_f32 v79, v28, v29
  v_add_f32 v80, v32, v33
  v_add_f32 v81, v36, v37
  v_permlane32_swap_b32 v78, v79
  v_add_f32 v78, v78, v79
  v_permlane32_swap_b32 v80, v81
  v_add_f32 v80, v80, v81
  v_cvt_pk_bf16_f32 v42, v180, v181
  v_cvt_pk_bf16_f32 v43, v182, v183
  v_permlane16_swap_b32 v78, v80
  v_add_f32 v78, v78, v80
  v_rcp_f32 v78, v78
  v_cndmask_b32 v188, v188, v184, s[76:77]
  v_mov_b32 v80, v78
  v_cndmask_b32 v189, v189, v185, s[76:77]
  v_cndmask_b32 v190, v190, v186, s[76:77]
  v_permlane16_swap_b32 v78, v80
  v_mov_b32 v79, v78
  v_mov_b32 v81, v80
  v_cndmask_b32 v191, v191, v187, s[76:77]
  v_permlane32_swap_b32 v78, v79
  v_permlane32_swap_b32 v80, v81
  v_cvt_pk_bf16_f32 v44, v188, v189
  v_cvt_pk_bf16_f32 v45, v190, v191
  buffer_store_dwordx4 v[42:45], v2, s[36:39], s70 offen sc1
  v_cndmask_b32 v200, v200, v192, s[78:79]
  v_cndmask_b32 v201, v201, v193, s[78:79]
  v_cndmask_b32 v202, v202, v194, s[78:79]
  v_cndmask_b32 v203, v203, v195, s[78:79]
  v_cvt_pk_bf16_f32 v46, v200, v201
  v_cvt_pk_bf16_f32 v47, v202, v203
  v_cndmask_b32 v226, v226, v222, s[80:81]
  v_cndmask_b32 v227, v227, v223, s[80:81]
  v_cndmask_b32 v228, v228, v224, s[80:81]
  v_cndmask_b32 v229, v229, v225, s[80:81]
  v_cvt_pk_bf16_f32 v48, v226, v227
  v_cvt_pk_bf16_f32 v49, v228, v229
  buffer_store_dwordx4 v[46:49], v2, s[36:39], s71 offen sc1
  v_cvt_pk_bf16_f32 v50, v230, v231
  v_cvt_pk_bf16_f32 v51, v232, v233
  v_add_u32 v2, v213, v2
  buffer_store_dwordx2 v[50:51], v2, s[36:39], s72 offen sc1
  s_waitcnt lgkmcnt(0)
  v_pk_mul_f32 v[62:63], v[62:63], v[78:79] op_sel:[0,0] op_sel_hi:[1,0]
  v_pk_mul_f32 v[64:65], v[64:65], v[78:79] op_sel:[0,0] op_sel_hi:[1,0]
  v_cvt_pk_bf16_f32 v26, v62, v63
  v_cvt_pk_bf16_f32 v27, v64, v65
  v_and_b32 v24, v26, v206
  v_and_b32 v25, v27, v207
  v_xor_b32 v26, v26, v24
  v_xor_b32 v27, v27, v25
  v_pk_mul_f32 v[66:67], v[66:67], v[78:79] op_sel:[0,1] op_sel_hi:[1,1]
  v_pk_mul_f32 v[68:69], v[68:69], v[78:79] op_sel:[0,1] op_sel_hi:[1,1]
  v_cvt_pk_bf16_f32 v30, v66, v67
  v_cvt_pk_bf16_f32 v31, v68, v69
  v_and_b32 v28, v30, v206
  v_and_b32 v29, v31, v207
  v_xor_b32 v30, v30, v28
  v_xor_b32 v31, v31, v29
  v_mfma_f32_16x16x32_bf16 v[20:23], v[124:127], v[24:27], 0
  v_mfma_f32_16x16x32_bf16 v[112:115], v[136:139], v[24:27], 0
  v_pk_mul_f32 v[70:71], v[70:71], v[80:81] op_sel:[0,0] op_sel_hi:[1,0]
  v_pk_mul_f32 v[72:73], v[72:73], v[80:81] op_sel:[0,0] op_sel_hi:[1,0]
  v_cvt_pk_bf16_f32 v34, v70, v71
  v_cvt_pk_bf16_f32 v35, v72, v73
  v_and_b32 v32, v34, v206
  v_and_b32 v33, v35, v207
  v_xor_b32 v34, v34, v32
  v_xor_b32 v35, v35, v33
  v_mfma_f32_16x16x32_bf16 v[116:119], v[136:139], v[28:31], 0
  v_mfma_f32_16x16x32_bf16 v[120:123], v[148:151], v[28:31], 0
  v_pk_mul_f32 v[74:75], v[74:75], v[80:81] op_sel:[0,1] op_sel_hi:[1,1]
  v_pk_mul_f32 v[76:77], v[76:77], v[80:81] op_sel:[0,1] op_sel_hi:[1,1]
  v_cvt_pk_bf16_f32 v38, v74, v75
  v_cvt_pk_bf16_f32 v39, v76, v77
  v_and_b32 v36, v38, v206
  v_and_b32 v37, v39, v207
  v_xor_b32 v38, v38, v36
  v_xor_b32 v39, v39, v37
  v_mfma_f32_16x16x32_bf16 v[132:135], v[148:151], v[32:35], 0
  v_mfma_f32_16x16x32_bf16 v[144:147], v[160:163], v[32:35], 0
  v_mfma_f32_16x16x32_bf16 v[156:159], v[160:163], v[36:39], 0
  v_mfma_f32_16x16x32_bf16 v[168:171], v[172:175], v[36:39], 0
  v_cvt_pk_bf16_f32 v24, v20, v21
  v_cvt_pk_bf16_f32 v25, v22, v23
  v_cndmask_b32 v116, v116, v112, s[76:77]
  v_cndmask_b32 v117, v117, v113, s[76:77]
  v_cndmask_b32 v118, v118, v114, s[76:77]
  v_cndmask_b32 v119, v119, v115, s[76:77]
  v_cvt_pk_bf16_f32 v26, v116, v117
  v_cvt_pk_bf16_f32 v27, v118, v119
  buffer_store_dwordx4 v[24:27], v1, s[36:39], s70 offen sc1
  v_cndmask_b32 v132, v132, v120, s[78:79]
  v_cndmask_b32 v133, v133, v121, s[78:79]
  v_cndmask_b32 v134, v134, v122, s[78:79]
  v_cndmask_b32 v135, v135, v123, s[78:79]
  v_cvt_pk_bf16_f32 v28, v132, v133
  v_cvt_pk_bf16_f32 v29, v134, v135
  v_cndmask_b32 v156, v156, v144, s[80:81]
  v_cndmask_b32 v157, v157, v145, s[80:81]
  v_cndmask_b32 v158, v158, v146, s[80:81]
  v_cndmask_b32 v159, v159, v147, s[80:81]
  v_cvt_pk_bf16_f32 v30, v156, v157
  v_cvt_pk_bf16_f32 v31, v158, v159
  buffer_store_dwordx4 v[28:31], v1, s[36:39], s71 offen sc1
  v_cvt_pk_bf16_f32 v32, v168, v169
  v_cvt_pk_bf16_f32 v33, v170, v171
  v_add_u32 v1, v213, v1
  buffer_store_dwordx2 v[32:33], v1, s[36:39], s72 offen sc1
  s_waitcnt vmcnt(16)
  s_waitcnt vmcnt(13)
  v_cmp_ne_u32 vcc, v254, v249
  s_cmp_lg_u32 vcc_lo, 0
  s_cbranch_scc1 SAe
BAe:
  s_branch JOIN
HELPER:
  s_mov_b64 exec, -1
  s_waitcnt lgkmcnt(0)
  s_mov_b64 s[40:41], s[4:5]
  s_mov_b32 s42, 0x280000
  s_mov_b32 s43, 0x20000
  s_mov_b64 s[36:37], s[22:23]
  s_mov_b32 s38, 0x1000000
  s_mov_b32 s39, 0x20000
  s_lshr_b32 s55, s2, 3
  s_and_b32 s68, s2, 3
  s_lshl2_add_u32 s55, s55, s68
  s_lshl2_add_u32 s55, s55, s44
  s_bfe_u32 s68, s2, 0x10002
  s_lshl2_add_u32 s55, s55, s68
  v_lshrrev_b32 v138, 5, v0
  v_lshl_add_u32 v138, v138, 1, s55
  v_mul_u32_u24 v136, 1280, v138
  v_and_b32 v139, 31, v0
  v_lshl_add_u32 v136, v139, 4, v136
  v_and_b32 v139, 16, v0
  v_lshl_add_u32 v137, v139, 26, v136
  v_mov_b32 v249, 0
  buffer_load_dwordx4 v[124:127], v136, s[40:43], 0 offen
  buffer_load_dwordx4 v[128:131], v136, s[40:43], 0 offen offset:512
  buffer_load_dwordx4 v[132:135], v137, s[40:43], 0 offen offset:1024
  buffer_load_dword v249, v249, s[36:39], 0 offen sc1
  v_lshlrev_b32 v248, 4, v0
  s_bfe_u32 s55, s2, 0x30003
  s_mul_i32 s56, s55, 378880
  s_add_u32 s56, s56, 0xb00000
  s_mul_i32 s57, s44, 7
  s_mul_i32 s64, s57, 5120
  s_add_u32 s64, s64, s56
  s_mul_i32 s58, s44, 6
  s_mul_i32 s65, s58, 5120
  s_add_u32 s65, s65, s56
  s_add_u32 s65, s65, 143360
  s_mul_i32 s66, s44, 25600
  s_add_u32 s66, s66, s56
  s_add_u32 s66, s66, 276480
  s_mul_i32 s55, s55, 5
  s_lshr_b32 s55, s55, 2
  v_lshrrev_b32 v10, 1, v0
  v_min_u32 v10, 13, v10
  s_and_b32 s56, s44, 1
  s_add_u32 s56, s56, 39
  v_mov_b32 v11, s56
  s_add_u32 s56, s58, 21
  v_mov_b32 v12, s56
  v_cmp_gt_u32 vcc, 13, v10
  s_nop 1
  v_cndmask_b32 v11, v11, v12, vcc
  v_mov_b32 v12, s57
  v_cmp_gt_u32 vcc, 7, v10
  s_nop 1
  v_cndmask_b32 v11, v11, v12, vcc
  v_add_u32 v10, v10, v11
  v_and_b32 v11, 1, v0
  v_lshl_add_u32 v10, v10, 4, v11
  v_add_u32 v10, s55, v10
  v_lshlrev_b32 v10, 6, v10
  v_add_u32 v251, 0x10000, v10
  s_and_b32 s55, s2, 7
  s_and_b32 s62, s55, 3
  s_lshl_b32 s62, s62, 2
  s_lshr_b32 s62, 0x02103210, s62
  s_and_b32 s62, s62, 0xffff
  s_or_b32 s62, s62, 0x40000
  s_lshl_b32 s56, s55, 2
  s_lshr_b32 s56, 0x40840840, s56
  s_and_b32 s56, s56, 15
  s_lshr_b32 s69, 0x20420, s56
  s_and_b32 s69, s69, 0xfff
  s_bitcmp1_b32 s44, 0
  s_cselect_b32 s56, 0x111, 0
  s_mov_b32 s59, 0x3165316
  s_cselect_b32 s59, 0x4206420, s59
  s_add_u32 s69, s69, s56
  s_and_b32 s56, s55, 3
  s_lshl_b32 s56, s56, 2
  s_lshr_b32 s59, s59, s56
  s_lshl_b32 s59, s59, 12
  s_or_b32 s69, s69, s59
  s_cmp_ge_u32 s55, 6
  s_cselect_b32 s56, 6, 0
  s_sub_u32 s55, s55, s56
  s_lshl_b32 s55, s55, 2
  s_lshr_b32 s23, 0x543210, s55
  s_sub_u32 s55, 24, s55
  s_lshl_b32 s55, 0x543210, s55
  s_or_b32 s23, s23, s55
  s_and_b32 s23, s23, 0xffffff
  s_and_b32 s55, s44, 1
  s_add_u32 s55, s55, 24
  s_sub_u32 s55, s55, s58
  s_lshl_b32 s55, s55, 24
  s_or_b32 s23, s23, s55
  s_mul_i32 s22, s44, 5120
  s_and_b32 s55, s2, 3
  s_lshl_b32 s55, s55, 2
  s_lshr_b32 s56, s2, 6
  s_add_u32 s55, s55, s56
  s_lshl_b32 s55, s55, 6
  s_bfe_u32 s59, s2, 0x10002
  s_lshl1_add_u32 s56, s59, s55
  s_mul_i32 s56, s56, 1395
  s_lshr_b32 s56, s56, 16
  v_bfe_u32 v10, v0, 3, 2
  v_add_u32 v11, s56, v10
  s_lshl1_add_u32 s56, s59, s55
  s_add_u32 s56, s56, 63
  s_mul_i32 s56, s56, 1395
  s_lshr_b32 s56, s56, 16
  v_min_u32 v11, s56, v11
  s_mul_i32 s56, s59, 22
  v_add_u32 v11, s56, v11
  v_and_b32 v12, 7, v0
  v_min_u32 v252, 6, v12
  v_add_u32 v252, s57, v252
  v_lshrrev_b32 v252, 1, v252
  v_lshl_add_u32 v252, v252, 6, v11
  v_lshlrev_b32 v252, 6, v252
  v_add_u32 v252, 0x40000, v252
  v_add_u32 v253, s58, v12
  v_lshrrev_b32 v253, 1, v253
  v_cmp_gt_u32 vcc, 6, v12
  s_nop 1
  v_cndmask_b32 v253, 12, v253, vcc
  v_lshl_add_u32 v253, v253, 6, v11
  v_lshlrev_b32 v253, 6, v253
  v_add_u32 v253, 0x50000, v253
  s_mul_i32 s56, s55, 3049
  s_lshr_b32 s56, s56, 19
  s_mul_i32 s57, s56, 172
  s_sub_u32 s57, s55, s57
  s_add_u32 s57, s57, 4
  s_mul_i32 s57, s57, 1490
  s_lshr_b32 s57, s57, 16
  s_lshl_b32 s56, s56, 2
  s_add_u32 s56, s56, s57
  v_add_u32 v10, s56, v10
  s_add_u32 s55, s55, 63
  s_mul_i32 s56, s55, 3049
  s_lshr_b32 s56, s56, 19
  s_mul_i32 s57, s56, 172
  s_sub_u32 s57, s55, s57
  s_add_u32 s57, s57, 4
  s_mul_i32 s57, s57, 1490
  s_lshr_b32 s57, s57, 16
  s_lshl_b32 s56, s56, 2
  s_add_u32 s56, s56, s57
  v_min_u32 v10, s56, v10
  s_mul_i32 s59, s59, 24
  s_lshl_b32 s56, s44, 7
  s_add_u32 s59, s59, s56
  v_add_u32 v10, s59, v10
  v_and_b32 v11, 1, v0
  v_lshl_add_u32 v10, v11, 6, v10
  v_lshlrev_b32 v10, 6, v10
  v_add_u32 v10, 0xa0000, v10
  v_cmp_gt_u32 vcc, 32, v0
  v_add_u32 v11, 131072, v252
  s_nop 0
  v_cndmask_b32 v253, v10, v253, vcc
  s_mul_i32 s55, s44, 5
  s_add_u32 s55, s55, 54
  v_min_u32 v10, 3, v12
  v_add_u32 v10, s55, v10
  v_lshlrev_b32 v10, 10, v10
  v_add_u32 v10, 0x10000, v10
  v_cndmask_b32 v251, v10, v251, vcc
  v_cndmask_b32 v252, v11, v252, vcc
  v_add_u32 v10, 1024, v10
  v_cmp_eq_u32 vcc, 7, v0
  s_nop 1
  v_cndmask_b32 v252, v252, v10, vcc
  s_waitcnt vmcnt(0)
  s_mov_b32 s55, 1664525
  v_lshlrev_b32 v140, 16, v124
  v_and_b32 v141, 0xffff0000, v124
  v_lshlrev_b32 v142, 16, v125
  v_and_b32 v143, 0xffff0000, v125
  v_lshlrev_b32 v144, 16, v126
  v_and_b32 v145, 0xffff0000, v126
  v_lshlrev_b32 v146, 16, v127
  v_and_b32 v147, 0xffff0000, v127
  v_lshlrev_b32 v148, 16, v128
  v_and_b32 v149, 0xffff0000, v128
  v_lshlrev_b32 v150, 16, v129
  v_and_b32 v151, 0xffff0000, v129
  v_lshlrev_b32 v152, 16, v130
  v_and_b32 v153, 0xffff0000, v130
  v_lshlrev_b32 v154, 16, v131
  v_and_b32 v155, 0xffff0000, v131
  v_lshlrev_b32 v156, 16, v132
  v_and_b32 v157, 0xffff0000, v132
  v_lshlrev_b32 v158, 16, v133
  v_and_b32 v159, 0xffff0000, v133
  v_lshlrev_b32 v160, 16, v134
  v_and_b32 v161, 0xffff0000, v134
  v_lshlrev_b32 v162, 16, v135
  v_and_b32 v163, 0xffff0000, v135
  v_pk_add_f32 v[164:165], v[140:141], v[142:143]
  v_pk_add_f32 v[166:167], v[144:145], v[146:147]
  v_pk_add_f32 v[164:165], v[164:165], v[148:149]
  v_pk_add_f32 v[166:167], v[166:167], v[150:151]
  v_pk_add_f32 v[164:165], v[164:165], v[152:153]
  v_pk_add_f32 v[166:167], v[166:167], v[154:155]
  v_pk_add_f32 v[164:165], v[164:165], v[156:157]
  v_pk_add_f32 v[166:167], v[166:167], v[158:159]
  v_pk_add_f32 v[164:165], v[164:165], v[160:161]
  v_pk_add_f32 v[166:167], v[166:167], v[162:163]
  v_pk_add_f32 v[164:165], v[164:165], v[166:167]
  v_add_f32 v164, v164, v165
  v_mul_lo_u32 v249, v249, s55
  v_and_b32 v137, 16, v0
  v_add_f32_dpp v164, v164, v164 quad_perm:[1,0,3,2] row_mask:0xf bank_mask:0xf
  v_add_u32 v249, 1013904223, v249
  v_cmp_eq_u32 vcc, 0, v137
  v_add_f32_dpp v164, v164, v164 quad_perm:[2,3,0,1] row_mask:0xf bank_mask:0xf
  v_and_b32 v137, 1, v138
  v_lshrrev_b32 v138, 1, v138
  v_add_f32_dpp v164, v164, v164 row_half_mirror row_mask:0xf bank_mask:0xf
  v_lshl_add_u32 v138, v137, 10, v138
  v_lshlrev_b32 v138, 4, v138
  v_add_f32_dpp v164, v164, v164 row_mirror row_mask:0xf bank_mask:0xf
  v_mov_b32 v139, v164
  s_nop 1
  v_permlane16_swap_b32 v164, v139
  v_add_f32 v164, v164, v139
  v_mul_f32 v164, 0xbacccccd, v164
  v_pk_add_f32 v[140:141], v[140:141], v[164:165] op_sel_hi:[1,0]
  v_pk_add_f32 v[142:143], v[142:143], v[164:165] op_sel_hi:[1,0]
  v_pk_add_f32 v[144:145], v[144:145], v[164:165] op_sel_hi:[1,0]
  v_pk_add_f32 v[146:147], v[146:147], v[164:165] op_sel_hi:[1,0]
  v_pk_add_f32 v[148:149], v[148:149], v[164:165] op_sel_hi:[1,0]
  v_pk_add_f32 v[150:151], v[150:151], v[164:165] op_sel_hi:[1,0]
  v_pk_add_f32 v[152:153], v[152:153], v[164:165] op_sel_hi:[1,0]
  v_pk_add_f32 v[154:155], v[154:155], v[164:165] op_sel_hi:[1,0]
  v_cndmask_b32 v165, 0, v164, vcc
  v_pk_add_f32 v[156:157], v[156:157], v[164:165] op_sel:[0,1] op_sel_hi:[1,1]
  v_pk_add_f32 v[158:159], v[158:159], v[164:165] op_sel:[0,1] op_sel_hi:[1,1]
  v_pk_add_f32 v[160:161], v[160:161], v[164:165] op_sel:[0,1] op_sel_hi:[1,1]
  v_pk_add_f32 v[162:163], v[162:163], v[164:165] op_sel:[0,1] op_sel_hi:[1,1]
  v_pk_mul_f32 v[166:167], v[140:141], v[140:141]
  v_pk_fma_f32 v[166:167], v[142:143], v[142:143], v[166:167]
  v_pk_fma_f32 v[166:167], v[144:145], v[144:145], v[166:167]
  v_pk_fma_f32 v[166:167], v[146:147], v[146:147], v[166:167]
  v_pk_fma_f32 v[166:167], v[148:149], v[148:149], v[166:167]
  v_pk_fma_f32 v[166:167], v[150:151], v[150:151], v[166:167]
  v_pk_fma_f32 v[166:167], v[152:153], v[152:153], v[166:167]
  v_pk_fma_f32 v[166:167], v[154:155], v[154:155], v[166:167]
  v_pk_fma_f32 v[166:167], v[156:157], v[156:157], v[166:167]
  v_pk_fma_f32 v[166:167], v[158:159], v[158:159], v[166:167]
  v_pk_fma_f32 v[166:167], v[160:161], v[160:161], v[166:167]
  v_pk_fma_f32 v[166:167], v[162:163], v[162:163], v[166:167]
  v_add_f32 v166, v166, v167
  v_cvt_pk_bf16_f32 v164, v164, v164
  v_and_b32 v137, 31, v0
  v_add_f32_dpp v166, v166, v166 quad_perm:[1,0,3,2] row_mask:0xf bank_mask:0xf
  v_lshlrev_b32 v124, 16, v164
  v_lshl_add_u32 v138, v137, 25, v138
  v_add_f32_dpp v166, v166, v166 quad_perm:[2,3,0,1] row_mask:0xf bank_mask:0xf
  v_mov_b32 v125, v249
  v_add_u32 v138, 4096, v138
  v_add_f32_dpp v166, v166, v166 row_half_mirror row_mask:0xf bank_mask:0xf
  v_mov_b32 v127, v249
  s_nop 0
  v_add_f32_dpp v166, v166, v166 row_mirror row_mask:0xf bank_mask:0xf
  v_mov_b32 v139, v166
  s_nop 1
  v_permlane16_swap_b32 v166, v139
  v_add_f32 v166, v166, v139
  v_mul_f32 v166, 0x3acccccd, v166
  v_cvt_pk_bf16_f32 v166, v166, v166
  v_lshlrev_b32 v166, 16, v166
  v_add_f32 v166, 0x3727c5ac, v166
  v_cvt_pk_bf16_f32 v166, v166, v166
  v_lshlrev_b32 v166, 16, v166
  v_sqrt_f32 v166, v166
  s_nop 0
  v_cvt_pk_bf16_f32 v166, v166, v166
  v_lshlrev_b32 v126, 16, v166
  buffer_store_dwordx4 v[124:127], v138, s[36:39], 0 offen sc1
  v_mov_b32 v250, 0
  s_mul_i32 s80, s44, 6
  s_add_u32 s80, s80, s53
  s_lshr_b32 s55, s80, 2
  s_add_u32 s80, s80, s55
  s_add_u32 s80, s80, 54
HJOB:
  s_cmp_ge_u32 s80, 74
  s_cbranch_scc1 HJ_none
  s_sub_u32 s72, s80, 54
  s_mul_i32 s73, s72, 52
  s_lshr_b32 s73, s73, 8
  s_mul_i32 s70, s73, 5
  s_sub_u32 s72, s72, s70
  s_mul_i32 s73, s73, 160
  s_lshr_b32 s70, s72, 1
  s_mul_i32 s70, s70, 80
  s_and_b32 s71, s72, 1
  s_lshl_b32 s71, s71, 5
  s_add_u32 s70, s70, s71
  s_add_u32 s71, s70, 16
  s_cmp_eq_u32 s72, 4
  s_cselect_b32 s70, 64, s70
  s_cselect_b32 s71, 0x90, s71
  s_add_u32 s70, s70, s73
  s_add_u32 s71, s71, s73
  s_mov_b64 s[28:29], s[8:9]
  s_mov_b32 s30, 0xc8000
  s_mov_b32 s31, 0x20000
  s_mul_i32 s74, s70, 1280
  s_add_u32 s75, s74, 10240
  s_mul_i32 s76, s71, 1280
  s_add_u32 s77, s76, 10240
  s_mul_i32 s78, s44, 40960
  v_lshrrev_b32 v1, 3, v0
  v_mul_u32_u24 v1, 1280, v1
  v_bfe_u32 v2, v0, 1, 2
  v_bfe_u32 v3, v0, 4, 2
  v_xor_b32 v2, v2, v3
  v_lshl_add_u32 v1, v2, 5, v1
  v_and_b32 v2, 1, v0
  v_lshl_add_u32 v1, v2, 4, v1
  v_lshrrev_b32 v2, 2, v0
  v_lshlrev_b32 v2, 7, v2
  v_and_b32 v3, 3, v0
  v_lshl_add_u32 v2, v3, 3, v2
  v_add_u32 v2, s78, v2
  v_bfe_u32 v3, v0, 3, 2
  v_xor_b32 v4, 0, v3
  v_lshl_add_u32 v4, v4, 5, v2
  v_xor_b32 v5, 1, v3
  v_lshl_add_u32 v5, v5, 5, v2
  v_xor_b32 v6, 2, v3
  v_lshl_add_u32 v6, v6, 5, v2
  v_xor_b32 v7, 3, v3
  v_lshl_add_u32 v7, v7, 5, v2
  s_mul_i32 s72, s80, 5120
  s_add_u32 s72, s72, 0xb00000
  v_lshlrev_b32 v8, 4, v0
  v_add_u32 v8, s72, v8
  s_add_u32 m0, s78, 0
  s_nop 0
  buffer_load_dwordx4 v1, s[28:31], s74 offen offset:0 nt lds
  s_add_u32 m0, s78, 1024
  s_nop 0
  buffer_load_dwordx4 v1, s[28:31], s75 offen offset:0 nt lds
  s_add_u32 m0, s78, 2048
  s_nop 0
  buffer_load_dwordx4 v1, s[28:31], s76 offen offset:0 nt lds
  s_add_u32 m0, s78, 3072
  s_nop 0
  buffer_load_dwordx4 v1, s[28:31], s77 offen offset:0 nt lds
  s_add_u32 m0, s78, 3968
  s_nop 0
  buffer_load_dwordx4 v1, s[28:31], s74 offen offset:128 nt lds
  s_add_u32 m0, s78, 4992
  s_nop 0
  buffer_load_dwordx4 v1, s[28:31], s75 offen offset:128 nt lds
  s_add_u32 m0, s78, 6016
  s_nop 0
  buffer_load_dwordx4 v1, s[28:31], s76 offen offset:128 nt lds
  s_add_u32 m0, s78, 7040
  s_nop 0
  buffer_load_dwordx4 v1, s[28:31], s77 offen offset:128 nt lds
  s_add_u32 m0, s78, 7936
  s_nop 0
  buffer_load_dwordx4 v1, s[28:31], s74 offen offset:256 nt lds
  s_add_u32 m0, s78, 8960
  s_nop 0
  buffer_load_dwordx4 v1, s[28:31], s75 offen offset:256 nt lds
  s_add_u32 m0, s78, 9984
  s_nop 0
  buffer_load_dwordx4 v1, s[28:31], s76 offen offset:256 nt lds
  s_add_u32 m0, s78, 11008
  s_nop 0
  buffer_load_dwordx4 v1, s[28:31], s77 offen offset:256 nt lds
  s_add_u32 m0, s78, 11904
  s_nop 0
  buffer_load_dwordx4 v1, s[28:31], s74 offen offset:384 nt lds
  s_add_u32 m0, s78, 12928
  s_nop 0
  buffer_load_dwordx4 v1, s[28:31], s75 offen offset:384 nt lds
  s_add_u32 m0, s78, 13952
  s_nop 0
  buffer_load_dwordx4 v1, s[28:31], s76 offen offset:384 nt lds
  s_add_u32 m0, s78, 14976
  s_nop 0
  buffer_load_dwordx4 v1, s[28:31], s77 offen offset:384 nt lds
  s_add_u32 m0, s78, 15872
  s_nop 0
  buffer_load_dwordx4 v1, s[28:31], s74 offen offset:512 nt lds
  s_add_u32 m0, s78, 16896
  s_nop 0
  buffer_load_dwordx4 v1, s[28:31], s75 offen offset:512 nt lds
  s_add_u32 m0, s78, 17920
  s_nop 0
  buffer_load_dwordx4 v1, s[28:31], s76 offen offset:512 nt lds
  s_add_u32 m0, s78, 18944
  s_nop 0
  buffer_load_dwordx4 v1, s[28:31], s77 offen offset:512 nt lds
  s_add_u32 m0, s78, 19840
  s_nop 0
  buffer_load_dwordx4 v1, s[28:31], s74 offen offset:640 nt lds
  s_add_u32 m0, s78, 20864
  s_nop 0
  buffer_load_dwordx4 v1, s[28:31], s75 offen offset:640 nt lds
  s_add_u32 m0, s78, 21888
  s_nop 0
  buffer_load_dwordx4 v1, s[28:31], s76 offen offset:640 nt lds
  s_add_u32 m0, s78, 22912
  s_nop 0
  buffer_load_dwordx4 v1, s[28:31], s77 offen offset:640 nt lds
  s_add_u32 m0, s78, 23808
  s_nop 0
  buffer_load_dwordx4 v1, s[28:31], s74 offen offset:768 nt lds
  s_add_u32 m0, s78, 24832
  s_nop 0
  buffer_load_dwordx4 v1, s[28:31], s75 offen offset:768 nt lds
  s_add_u32 m0, s78, 25856
  s_nop 0
  buffer_load_dwordx4 v1, s[28:31], s76 offen offset:768 nt lds
  s_add_u32 m0, s78, 26880
  s_nop 0
  buffer_load_dwordx4 v1, s[28:31], s77 offen offset:768 nt lds
  s_add_u32 m0, s78, 27776
  s_nop 0
  buffer_load_dwordx4 v1, s[28:31], s74 offen offset:896 nt lds
  s_add_u32 m0, s78, 28800
  s_nop 0
  buffer_load_dwordx4 v1, s[28:31], s75 offen offset:896 nt lds
  s_add_u32 m0, s78, 29824
  s_nop 0
  buffer_load_dwordx4 v1, s[28:31], s76 offen offset:896 nt lds
  s_add_u32 m0, s78, 30848
  s_nop 0
  buffer_load_dwordx4 v1, s[28:31], s77 offen offset:896 nt lds
  s_add_u32 m0, s78, 31744
  s_nop 0
  buffer_load_dwordx4 v1, s[28:31], s74 offen offset:1024 nt lds
  s_add_u32 m0, s78, 32768
  s_nop 0
  buffer_load_dwordx4 v1, s[28:31], s75 offen offset:1024 nt lds
  s_add_u32 m0, s78, 33792
  s_nop 0
  buffer_load_dwordx4 v1, s[28:31], s76 offen offset:1024 nt lds
  s_add_u32 m0, s78, 34816
  s_nop 0
  buffer_load_dwordx4 v1, s[28:31], s77 offen offset:1024 nt lds
  s_add_u32 m0, s78, 35712
  s_nop 0
  buffer_load_dwordx4 v1, s[28:31], s74 offen offset:1152 nt lds
  s_add_u32 m0, s78, 36736
  s_nop 0
  buffer_load_dwordx4 v1, s[28:31], s75 offen offset:1152 nt lds
  s_add_u32 m0, s78, 37760
  s_nop 0
  buffer_load_dwordx4 v1, s[28:31], s76 offen offset:1152 nt lds
  s_add_u32 m0, s78, 38784
  s_nop 0
  buffer_load_dwordx4 v1, s[28:31], s77 offen offset:1152 nt lds
  s_waitcnt vmcnt(36)
  ds_read_b64_tr_b16 a[0:1], v4 offset:0
  ds_read_b64_tr_b16 a[2:3], v4 offset:2048
  ds_read_b64_tr_b16 a[4:5], v5 offset:0
  ds_read_b64_tr_b16 a[6:7], v5 offset:2048
  ds_read_b64_tr_b16 a[8:9], v6 offset:0
  ds_read_b64_tr_b16 a[10:11], v6 offset:2048
  ds_read_b64_tr_b16 a[12:13], v7 offset:0
  ds_read_b64_tr_b16 a[14:15], v7 offset:2048
  s_waitcnt vmcnt(32)
  ds_read_b64_tr_b16 a[16:17], v4 offset:4096
  ds_read_b64_tr_b16 a[18:19], v4 offset:6144
  ds_read_b64_tr_b16 a[20:21], v5 offset:4096
  ds_read_b64_tr_b16 a[22:23], v5 offset:6144
  ds_read_b64_tr_b16 a[24:25], v6 offset:4096
  ds_read_b64_tr_b16 a[26:27], v6 offset:6144
  ds_read_b64_tr_b16 a[28:29], v7 offset:4096
  ds_read_b64_tr_b16 a[30:31], v7 offset:6144
  s_waitcnt vmcnt(28)
  ds_read_b64_tr_b16 a[32:33], v4 offset:8192
  ds_read_b64_tr_b16 a[34:35], v4 offset:10240
  ds_read_b64_tr_b16 a[36:37], v5 offset:8192
  ds_read_b64_tr_b16 a[38:39], v5 offset:10240
  ds_read_b64_tr_b16 a[40:41], v6 offset:8192
  ds_read_b64_tr_b16 a[42:43], v6 offset:10240
  ds_read_b64_tr_b16 a[44:45], v7 offset:8192
  ds_read_b64_tr_b16 a[46:47], v7 offset:10240
  s_waitcnt vmcnt(24)
  ds_read_b64_tr_b16 a[48:49], v4 offset:12288
  ds_read_b64_tr_b16 a[50:51], v4 offset:14336
  ds_read_b64_tr_b16 a[52:53], v5 offset:12288
  ds_read_b64_tr_b16 a[54:55], v5 offset:14336
  ds_read_b64_tr_b16 a[56:57], v6 offset:12288
  ds_read_b64_tr_b16 a[58:59], v6 offset:14336
  ds_read_b64_tr_b16 a[60:61], v7 offset:12288
  ds_read_b64_tr_b16 a[62:63], v7 offset:14336
  s_waitcnt vmcnt(20)
  ds_read_b64_tr_b16 a[64:65], v4 offset:16384
  ds_read_b64_tr_b16 a[66:67], v4 offset:18432
  ds_read_b64_tr_b16 a[68:69], v5 offset:16384
  ds_read_b64_tr_b16 a[70:71], v5 offset:18432
  ds_read_b64_tr_b16 a[72:73], v6 offset:16384
  ds_read_b64_tr_b16 a[74:75], v6 offset:18432
  ds_read_b64_tr_b16 a[76:77], v7 offset:16384
  ds_read_b64_tr_b16 a[78:79], v7 offset:18432
  s_waitcnt vmcnt(16)
  ds_read_b64_tr_b16 a[80:81], v4 offset:20480
  ds_read_b64_tr_b16 a[82:83], v4 offset:22528
  ds_read_b64_tr_b16 a[84:85], v5 offset:20480
  ds_read_b64_tr_b16 a[86:87], v5 offset:22528
  ds_read_b64_tr_b16 a[88:89], v6 offset:20480
  ds_read_b64_tr_b16 a[90:91], v6 offset:22528
  ds_read_b64_tr_b16 a[92:93], v7 offset:20480
  ds_read_b64_tr_b16 a[94:95], v7 offset:22528
  s_waitcnt vmcnt(12)
  ds_read_b64_tr_b16 a[96:97], v4 offset:24576
  ds_read_b64_tr_b16 a[98:99], v4 offset:26624
  ds_read_b64_tr_b16 a[100:101], v5 offset:24576
  ds_read_b64_tr_b16 a[102:103], v5 offset:26624
  ds_read_b64_tr_b16 a[104:105], v6 offset:24576
  ds_read_b64_tr_b16 a[106:107], v6 offset:26624
  ds_read_b64_tr_b16 a[108:109], v7 offset:24576
  ds_read_b64_tr_b16 a[110:111], v7 offset:26624
  s_waitcnt vmcnt(8)
  ds_read_b64_tr_b16 a[112:113], v4 offset:28672
  ds_read_b64_tr_b16 a[114:115], v4 offset:30720
  ds_read_b64_tr_b16 a[116:117], v5 offset:28672
  ds_read_b64_tr_b16 a[118:119], v5 offset:30720
  ds_read_b64_tr_b16 a[120:121], v6 offset:28672
  ds_read_b64_tr_b16 a[122:123], v6 offset:30720
  ds_read_b64_tr_b16 a[124:125], v7 offset:28672
  ds_read_b64_tr_b16 a[126:127], v7 offset:30720
  s_waitcnt vmcnt(4)
  ds_read_b64_tr_b16 a[128:129], v4 offset:32768
  ds_read_b64_tr_b16 a[130:131], v4 offset:34816
  ds_read_b64_tr_b16 a[132:133], v5 offset:32768
  ds_read_b64_tr_b16 a[134:135], v5 offset:34816
  ds_read_b64_tr_b16 a[136:137], v6 offset:32768
  ds_read_b64_tr_b16 a[138:139], v6 offset:34816
  ds_read_b64_tr_b16 a[140:141], v7 offset:32768
  ds_read_b64_tr_b16 a[142:143], v7 offset:34816
  s_waitcnt vmcnt(0)
  ds_read_b64_tr_b16 a[144:145], v4 offset:36864
  ds_read_b64_tr_b16 a[146:147], v4 offset:38912
  ds_read_b64_tr_b16 a[148:149], v5 offset:36864
  ds_read_b64_tr_b16 a[150:151], v5 offset:38912
  ds_read_b64_tr_b16 a[152:153], v6 offset:36864
  ds_read_b64_tr_b16 a[154:155], v6 offset:38912
  ds_read_b64_tr_b16 a[156:157], v7 offset:36864
  ds_read_b64_tr_b16 a[158:159], v7 offset:38912
  s_waitcnt lgkmcnt(15)
  s_mov_b32 s73, 0x0
  buffer_store_dwordx4 a[0:3], v8, s[36:39], s73 offen sc1
  s_mov_b32 s73, 0x400
  buffer_store_dwordx4 a[4:7], v8, s[36:39], s73 offen sc1
  s_mov_b32 s73, 0x800
  buffer_store_dwordx4 a[8:11], v8, s[36:39], s73 offen sc1
  s_mov_b32 s73, 0xc00
  buffer_store_dwordx4 a[12:15], v8, s[36:39], s73 offen sc1
  s_mov_b32 s73, 0x1000
  buffer_store_dwordx4 a[16:19], v8, s[36:39], s73 offen sc1
  s_mov_b32 s73, 0x5c800
  buffer_store_dwordx4 a[20:23], v8, s[36:39], s73 offen sc1
  s_mov_b32 s73, 0x5cc00
  buffer_store_dwordx4 a[24:27], v8, s[36:39], s73 offen sc1
  s_mov_b32 s73, 0x5d000
  buffer_store_dwordx4 a[28:31], v8, s[36:39], s73 offen sc1
  s_mov_b32 s73, 0x5d400
  buffer_store_dwordx4 a[32:35], v8, s[36:39], s73 offen sc1
  s_mov_b32 s73, 0x5d800
  buffer_store_dwordx4 a[36:39], v8, s[36:39], s73 offen sc1
  s_mov_b32 s73, 0xb9000
  buffer_store_dwordx4 a[40:43], v8, s[36:39], s73 offen sc1
  s_mov_b32 s73, 0xb9400
  buffer_store_dwordx4 a[44:47], v8, s[36:39], s73 offen sc1
  s_mov_b32 s73, 0xb9800
  buffer_store_dwordx4 a[48:51], v8, s[36:39], s73 offen sc1
  s_mov_b32 s73, 0xb9c00
  buffer_store_dwordx4 a[52:55], v8, s[36:39], s73 offen sc1
  s_mov_b32 s73, 0xba000
  buffer_store_dwordx4 a[56:59], v8, s[36:39], s73 offen sc1
  s_mov_b32 s73, 0x115800
  buffer_store_dwordx4 a[60:63], v8, s[36:39], s73 offen sc1
  s_mov_b32 s73, 0x115c00
  buffer_store_dwordx4 a[64:67], v8, s[36:39], s73 offen sc1
  s_mov_b32 s73, 0x116000
  buffer_store_dwordx4 a[68:71], v8, s[36:39], s73 offen sc1
  s_mov_b32 s73, 0x116400
  buffer_store_dwordx4 a[72:75], v8, s[36:39], s73 offen sc1
  s_mov_b32 s73, 0x116800
  buffer_store_dwordx4 a[76:79], v8, s[36:39], s73 offen sc1
  s_mov_b32 s73, 0x172000
  buffer_store_dwordx4 a[80:83], v8, s[36:39], s73 offen sc1
  s_mov_b32 s73, 0x172400
  buffer_store_dwordx4 a[84:87], v8, s[36:39], s73 offen sc1
  s_mov_b32 s73, 0x172800
  buffer_store_dwordx4 a[88:91], v8, s[36:39], s73 offen sc1
  s_mov_b32 s73, 0x172c00
  buffer_store_dwordx4 a[92:95], v8, s[36:39], s73 offen sc1
  s_mov_b32 s73, 0x173000
  buffer_store_dwordx4 a[96:99], v8, s[36:39], s73 offen sc1
  s_mov_b32 s73, 0x1ce800
  buffer_store_dwordx4 a[100:103], v8, s[36:39], s73 offen sc1
  s_mov_b32 s73, 0x1cec00
  buffer_store_dwordx4 a[104:107], v8, s[36:39], s73 offen sc1
  s_mov_b32 s73, 0x1cf000
  buffer_store_dwordx4 a[108:111], v8, s[36:39], s73 offen sc1
  s_mov_b32 s73, 0x1cf400
  buffer_store_dwordx4 a[112:115], v8, s[36:39], s73 offen sc1
  s_mov_b32 s73, 0x1cf800
  buffer_store_dwordx4 a[116:119], v8, s[36:39], s73 offen sc1
  s_mov_b32 s73, 0x22b000
  buffer_store_dwordx4 a[120:123], v8, s[36:39], s73 offen sc1
  s_mov_b32 s73, 0x22b400
  buffer_store_dwordx4 a[124:127], v8, s[36:39], s73 offen sc1
  s_waitcnt lgkmcnt(8)
  s_mov_b32 s73, 0x22b800
  buffer_store_dwordx4 a[128:131], v8, s[36:39], s73 offen sc1
  s_mov_b32 s73, 0x22bc00
  buffer_store_dwordx4 a[132:135], v8, s[36:39], s73 offen sc1
  s_mov_b32 s73, 0x22c000
  buffer_store_dwordx4 a[136:139], v8, s[36:39], s73 offen sc1
  s_mov_b32 s73, 0x287800
  buffer_store_dwordx4 a[140:143], v8, s[36:39], s73 offen sc1
  s_waitcnt lgkmcnt(0)
  s_mov_b32 s73, 0x287c00
  buffer_store_dwordx4 a[144:147], v8, s[36:39], s73 offen sc1
  s_mov_b32 s73, 0x288000
  buffer_store_dwordx4 a[148:151], v8, s[36:39], s73 offen sc1
  s_mov_b32 s73, 0x288400
  buffer_store_dwordx4 a[152:155], v8, s[36:39], s73 offen sc1
  s_mov_b32 s73, 0x288800
  buffer_store_dwordx4 a[156:159], v8, s[36:39], s73 offen sc1
  s_lshl_b32 s55, s80, 10
  s_add_u32 s55, s55, 0x10000
  v_lshrrev_b32 v1, 5, v0
  v_lshlrev_b32 v1, 22, v1
  v_add_lshl_u32 v1, v1, v0, 2
  s_waitcnt vmcnt(0)
  buffer_store_dword v249, v1, s[36:39], s55 offen sc1
HJ_none:
  s_cmp_lg_u32 s80, 82
  s_cbranch_scc1 HG_done
  v_lshlrev_b32 v30, 5, v0
  v_add_u32 v30, 4100, v30
  v_add_u32 v31, 4096, v30
  v_add_u32 v32, 8192, v30
  v_add_u32 v33, 12288, v30
  v_add_u32 v34, 16384, v30
  v_add_u32 v35, 20480, v30
  v_add_u32 v36, 24576, v30
  v_add_u32 v37, 28672, v30
HG:
  s_mov_b32 s68, 20000
  s_branch HG_f
HG_l:
  s_sleep 64
  s_sub_u32 s68, s68, 1
  s_cbranch_scc1 HG_d
HG_f:
  buffer_load_dword v8, v30, s[36:39], 0 offen offset:0 sc1
  buffer_load_dword v9, v30, s[36:39], 0 offen offset:2048 sc1
  buffer_load_dword v10, v31, s[36:39], 0 offen offset:0 sc1
  buffer_load_dword v11, v31, s[36:39], 0 offen offset:2048 sc1
  buffer_load_dword v12, v32, s[36:39], 0 offen offset:0 sc1
  buffer_load_dword v13, v32, s[36:39], 0 offen offset:2048 sc1
  buffer_load_dword v14, v33, s[36:39], 0 offen offset:0 sc1
  buffer_load_dword v15, v33, s[36:39], 0 offen offset:2048 sc1
  buffer_load_dword v16, v34, s[36:39], 0 offen offset:0 sc1
  buffer_load_dword v17, v34, s[36:39], 0 offen offset:2048 sc1
  buffer_load_dword v18, v35, s[36:39], 0 offen offset:0 sc1
  buffer_load_dword v19, v35, s[36:39], 0 offen offset:2048 sc1
  buffer_load_dword v20, v36, s[36:39], 0 offen offset:0 sc1
  buffer_load_dword v21, v36, s[36:39], 0 offen offset:2048 sc1
  buffer_load_dword v22, v37, s[36:39], 0 offen offset:0 sc1
  buffer_load_dword v23, v37, s[36:39], 0 offen offset:2048 sc1
  s_waitcnt vmcnt(0)
  v_xor_b32 v8, v8, v249
  v_xor_b32 v9, v9, v249
  v_xor_b32 v10, v10, v249
  v_xor_b32 v11, v11, v249
  v_xor_b32 v12, v12, v249
  v_xor_b32 v13, v13, v249
  v_xor_b32 v14, v14, v249
  v_xor_b32 v15, v15, v249
  v_xor_b32 v16, v16, v249
  v_xor_b32 v17, v17, v249
  v_xor_b32 v18, v18, v249
  v_xor_b32 v19, v19, v249
  v_xor_b32 v20, v20, v249
  v_xor_b32 v21, v21, v249
  v_xor_b32 v22, v22, v249
  v_xor_b32 v23, v23, v249
  v_or_b32 v8, v8, v9
  v_or_b32 v8, v8, v10
  v_or_b32 v8, v8, v11
  v_or_b32 v8, v8, v12
  v_or_b32 v8, v8, v13
  v_or_b32 v8, v8, v14
  v_or_b32 v8, v8, v15
  v_or_b32 v8, v8, v16
  v_or_b32 v8, v8, v17
  v_or_b32 v8, v8, v18
  v_or_b32 v8, v8, v19
  v_or_b32 v8, v8, v20
  v_or_b32 v8, v8, v21
  v_or_b32 v8, v8, v22
  v_or_b32 v8, v8, v23
  v_cmp_ne_u32 vcc, 0, v8
  s_cbranch_vccnz HG_l
HG_d:
  v_lshlrev_b32 v1, 24, v0
  buffer_store_dword v249, v1, s[36:39], 0 offen sc1
HG_done:
  s_waitcnt vmcnt(0) lgkmcnt(0)
  s_branch SLOWJOIN
SLOWJOIN:
  s_mov_b32 s63, 0x40000000
  s_barrier
SJb:
  s_mov_b32 s68, 20000
  s_branch SJb_f
SJb_l:
  s_sleep 24
  s_sub_u32 s68, s68, 1
  s_cbranch_scc1 SJb_d
SJb_f:
  buffer_load_dword v254, v251, s[36:39], 0 offen sc1
  s_waitcnt vmcnt(0)
  v_cmp_ne_u32 vcc, v254, v249
  s_cbranch_vccnz SJb_l
SJb_d:
  s_bfe_u32 s49, s62, 0x40000
  s_mul_i32 s49, s49, 5120
  s_add_u32 s49, s49, s66
  s_add_u32 m0, s22, 126976
  s_nop 0
  buffer_load_dwordx4 v248, s[36:39], s49 offen offset:0 sc1 lds
  buffer_load_dwordx4 v248, s[36:39], s49 offen offset:1024 sc1 lds
  buffer_load_dwordx4 v248, s[36:39], s49 offen offset:2048 sc1 lds
  buffer_load_dwordx4 v248, s[36:39], s49 offen offset:3072 sc1 lds
  s_add_u32 s49, s49, 4096
  s_add_u32 m0, s22, 131072
  s_nop 0
  buffer_load_dwordx4 v248, s[36:39], s49 offen offset:0 sc1 lds
  s_bfe_u32 s49, s62, 0x40004
  s_mul_i32 s49, s49, 5120
  s_add_u32 s49, s49, s66
  s_add_u32 m0, s22, 106496
  s_nop 0
  buffer_load_dwordx4 v248, s[36:39], s49 offen offset:0 sc1 lds
  buffer_load_dwordx4 v248, s[36:39], s49 offen offset:1024 sc1 lds
  buffer_load_dwordx4 v248, s[36:39], s49 offen offset:2048 sc1 lds
  buffer_load_dwordx4 v248, s[36:39], s49 offen offset:3072 sc1 lds
  s_add_u32 s49, s49, 4096
  s_add_u32 m0, s22, 110592
  s_nop 0
  buffer_load_dwordx4 v248, s[36:39], s49 offen offset:0 sc1 lds
  s_bfe_u32 s49, s62, 0x40008
  s_mul_i32 s49, s49, 5120
  s_add_u32 s49, s49, s66
  s_add_u32 m0, s22, 86016
  s_nop 0
  buffer_load_dwordx4 v248, s[36:39], s49 offen offset:0 sc1 lds
  buffer_load_dwordx4 v248, s[36:39], s49 offen offset:1024 sc1 lds
  buffer_load_dwordx4 v248, s[36:39], s49 offen offset:2048 sc1 lds
  buffer_load_dwordx4 v248, s[36:39], s49 offen offset:3072 sc1 lds
  s_add_u32 s49, s49, 4096
  s_add_u32 m0, s22, 90112
  s_nop 0
  buffer_load_dwordx4 v248, s[36:39], s49 offen offset:0 sc1 lds
  s_bfe_u32 s49, s62, 0x4000c
  s_mul_i32 s49, s49, 5120
  s_add_u32 s49, s49, s66
  s_add_u32 m0, s22, 65536
  s_nop 0
  buffer_load_dwordx4 v248, s[36:39], s49 offen offset:0 sc1 lds
  buffer_load_dwordx4 v248, s[36:39], s49 offen offset:1024 sc1 lds
  buffer_load_dwordx4 v248, s[36:39], s49 offen offset:2048 sc1 lds
  buffer_load_dwordx4 v248, s[36:39], s49 offen offset:3072 sc1 lds
  s_add_u32 s49, s49, 4096
  s_add_u32 m0, s22, 69632
  s_nop 0
  buffer_load_dwordx4 v248, s[36:39], s49 offen offset:0 sc1 lds
  s_bfe_u32 s67, s69, 0x40000
  s_mul_i32 s67, s67, 5120
  s_add_u32 s67, s67, s64
  buffer_load_dwordx4 a[0:3], v248, s[36:39], s67 offen offset:0 sc1
  buffer_load_dwordx4 a[4:7], v248, s[36:39], s67 offen offset:1024 sc1
  buffer_load_dwordx4 a[8:11], v248, s[36:39], s67 offen offset:2048 sc1
  buffer_load_dwordx4 a[12:15], v248, s[36:39], s67 offen offset:3072 sc1
  s_add_u32 s67, s67, 4096
  buffer_load_dwordx4 a[16:19], v248, s[36:39], s67 offen offset:0 sc1
  s_bfe_u32 s67, s69, 0x40004
  s_mul_i32 s67, s67, 5120
  s_add_u32 s67, s67, s64
  buffer_load_dwordx4 a[20:23], v248, s[36:39], s67 offen offset:0 sc1
  buffer_load_dwordx4 a[24:27], v248, s[36:39], s67 offen offset:1024 sc1
  buffer_load_dwordx4 a[28:31], v248, s[36:39], s67 offen offset:2048 sc1
  buffer_load_dwordx4 a[32:35], v248, s[36:39], s67 offen offset:3072 sc1
  s_add_u32 s67, s67, 4096
  buffer_load_dwordx4 a[36:39], v248, s[36:39], s67 offen offset:0 sc1
  s_bfe_u32 s67, s69, 0x40008
  s_mul_i32 s67, s67, 5120
  s_add_u32 s67, s67, s64
  buffer_load_dwordx4 a[40:43], v248, s[36:39], s67 offen offset:0 sc1
  buffer_load_dwordx4 a[44:47], v248, s[36:39], s67 offen offset:1024 sc1
  buffer_load_dwordx4 a[48:51], v248, s[36:39], s67 offen offset:2048 sc1
  buffer_load_dwordx4 a[52:55], v248, s[36:39], s67 offen offset:3072 sc1
  s_add_u32 s67, s67, 4096
  buffer_load_dwordx4 a[56:59], v248, s[36:39], s67 offen offset:0 sc1
  s_bfe_u32 s67, s69, 0x4000c
  s_mul_i32 s67, s67, 5120
  s_add_u32 s67, s67, s64
  buffer_load_dwordx4 a[60:63], v248, s[36:39], s67 offen offset:0 sc1
  buffer_load_dwordx4 a[64:67], v248, s[36:39], s67 offen offset:1024 sc1
  buffer_load_dwordx4 a[68:71], v248, s[36:39], s67 offen offset:2048 sc1
  buffer_load_dwordx4 a[72:75], v248, s[36:39], s67 offen offset:3072 sc1
  s_add_u32 s67, s67, 4096
  buffer_load_dwordx4 a[76:79], v248, s[36:39], s67 offen offset:0 sc1
  s_bfe_u32 s67, s69, 0x40010
  s_mul_i32 s67, s67, 5120
  s_add_u32 s67, s67, s64
  buffer_load_dwordx4 a[80:83], v248, s[36:39], s67 offen offset:0 sc1
  buffer_load_dwordx4 a[84:87], v248, s[36:39], s67 offen offset:1024 sc1
  buffer_load_dwordx4 a[88:91], v248, s[36:39], s67 offen offset:2048 sc1
  buffer_load_dwordx4 a[92:95], v248, s[36:39], s67 offen offset:3072 sc1
  s_add_u32 s67, s67, 4096
  buffer_load_dwordx4 a[96:99], v248, s[36:39], s67 offen offset:0 sc1
  s_bfe_u32 s67, s69, 0x40014
  s_mul_i32 s67, s67, 5120
  s_add_u32 s67, s67, s64
  buffer_load_dwordx4 a[100:103], v248, s[36:39], s67 offen offset:0 sc1
  buffer_load_dwordx4 a[104:107], v248, s[36:39], s67 offen offset:1024 sc1
  buffer_load_dwordx4 a[108:111], v248, s[36:39], s67 offen offset:2048 sc1
  buffer_load_dwordx4 a[112:115], v248, s[36:39], s67 offen offset:3072 sc1
  s_add_u32 s67, s67, 4096
  buffer_load_dwordx4 a[116:119], v248, s[36:39], s67 offen offset:0 sc1
  s_bfe_u32 s67, s69, 0x40018
  s_mul_i32 s67, s67, 5120
  s_add_u32 s67, s67, s64
  buffer_load_dwordx4 a[120:123], v248, s[36:39], s67 offen offset:0 sc1
  buffer_load_dwordx4 a[124:127], v248, s[36:39], s67 offen offset:1024 sc1
  buffer_load_dwordx4 a[128:131], v248, s[36:39], s67 offen offset:2048 sc1
  buffer_load_dwordx4 a[132:135], v248, s[36:39], s67 offen offset:3072 sc1
  s_add_u32 s67, s67, 4096
  buffer_load_dwordx4 a[136:139], v248, s[36:39], s67 offen offset:0 sc1
  s_bfe_u32 s67, s23, 0x40000
  s_mul_i32 s67, s67, 5120
  s_add_u32 s67, s67, s65
  buffer_load_dwordx4 a[140:143], v248, s[36:39], s67 offen offset:0 sc1
  buffer_load_dwordx4 a[144:147], v248, s[36:39], s67 offen offset:1024 sc1
  buffer_load_dwordx4 a[148:151], v248, s[36:39], s67 offen offset:2048 sc1
  buffer_load_dwordx4 a[152:155], v248, s[36:39], s67 offen offset:3072 sc1
  s_add_u32 s67, s67, 4096
  buffer_load_dwordx4 a[156:159], v248, s[36:39], s67 offen offset:0 sc1
  s_bfe_u32 s67, s23, 0x40004
  s_mul_i32 s67, s67, 5120
  s_add_u32 s67, s67, s65
  buffer_load_dwordx4 a[160:163], v248, s[36:39], s67 offen offset:0 sc1
  buffer_load_dwordx4 a[164:167], v248, s[36:39], s67 offen offset:1024 sc1
  buffer_load_dwordx4 a[168:171], v248, s[36:39], s67 offen offset:2048 sc1
  buffer_load_dwordx4 a[172:175], v248, s[36:39], s67 offen offset:3072 sc1
  s_add_u32 s67, s67, 4096
  buffer_load_dwordx4 a[176:179], v248, s[36:39], s67 offen offset:0 sc1
  s_bfe_u32 s67, s23, 0x40008
  s_mul_i32 s67, s67, 5120
  s_add_u32 s67, s67, s65
  buffer_load_dwordx4 a[180:183], v248, s[36:39], s67 offen offset:0 sc1
  buffer_load_dwordx4 a[184:187], v248, s[36:39], s67 offen offset:1024 sc1
  buffer_load_dwordx4 a[188:191], v248, s[36:39], s67 offen offset:2048 sc1
  buffer_load_dwordx4 a[192:195], v248, s[36:39], s67 offen offset:3072 sc1
  s_add_u32 s67, s67, 4096
  buffer_load_dwordx4 a[196:199], v248, s[36:39], s67 offen offset:0 sc1
  s_bfe_u32 s67, s23, 0x4000c
  s_mul_i32 s67, s67, 5120
  s_add_u32 s67, s67, s65
  buffer_load_dwordx4 a[200:203], v248, s[36:39], s67 offen offset:0 sc1
  buffer_load_dwordx4 a[204:207], v248, s[36:39], s67 offen offset:1024 sc1
  buffer_load_dwordx4 a[208:211], v248, s[36:39], s67 offen offset:2048 sc1
  buffer_load_dwordx4 a[212:215], v248, s[36:39], s67 offen offset:3072 sc1
  s_add_u32 s67, s67, 4096
  buffer_load_dwordx4 a[216:219], v248, s[36:39], s67 offen offset:0 sc1
  s_bfe_u32 s67, s23, 0x40010
  s_mul_i32 s67, s67, 5120
  s_add_u32 s67, s67, s65
  buffer_load_dwordx4 a[220:223], v248, s[36:39], s67 offen offset:0 sc1
  buffer_load_dwordx4 a[224:227], v248, s[36:39], s67 offen offset:1024 sc1
  buffer_load_dwordx4 a[228:231], v248, s[36:39], s67 offen offset:2048 sc1
  buffer_load_dwordx4 a[232:235], v248, s[36:39], s67 offen offset:3072 sc1
  s_add_u32 s67, s67, 4096
  buffer_load_dwordx4 a[236:239], v248, s[36:39], s67 offen offset:0 sc1
  s_and_b32 s58, s2, 7
  s_lshr_b32 s13, s2, 6
  s_lshl2_add_u32 s58, s58, s13
  s_mul_i32 s12, s58, 303104
  s_add_u32 s12, s12, 0x100000
  s_mul_i32 s14, s44, 28672
  s_mul_i32 s16, s44, 24576
  s_add_u32 s16, s16, 114688
  s_mul_i32 s17, s44, 20480
  s_add_u32 s17, s17, 221184
  s_sub_u32 s17, s17, s14
  s_sub_u32 s16, s16, s14
  s_add_u32 s12, s12, s14
  s_mov_b32 s14, 0xbfb8aa3b
  s_add_u32 s13, s44, 0
  s_and_b32 s13, s13, 3
  s_lshl_b32 s13, s13, 10
  s_add_u32 s4, s12, s13
  s_add_u32 s13, s44, 1
  s_and_b32 s13, s13, 3
  s_lshl_b32 s13, s13, 10
  s_add_u32 s5, s12, s13
  s_add_u32 s13, s44, 2
  s_and_b32 s13, s13, 3
  s_lshl_b32 s13, s13, 10
  s_add_u32 s6, s12, s13
  s_add_u32 s13, s44, 3
  s_and_b32 s13, s13, 3
  s_lshl_b32 s13, s13, 10
  s_add_u32 s7, s12, s13
  s_bfe_u32 s56, s69, 0x40000
  s_lshl_b32 s56, s56, 12
  s_bfe_u32 s57, s69, 0x40004
  s_lshl_b32 s57, s57, 12
  s_bfe_u32 s59, s69, 0x40008
  s_lshl_b32 s59, s59, 12
  s_bfe_u32 s20, s69, 0x4000c
  s_lshl_b32 s20, s20, 12
  s_bfe_u32 s21, s69, 0x40010
  s_lshl_b32 s21, s21, 12
  s_bfe_u32 s45, s69, 0x40014
  s_lshl_b32 s45, s45, 12
  s_bfe_u32 s46, s69, 0x40018
  s_lshl_b32 s46, s46, 12
SJ0:
  s_mov_b32 s68, 20000
  s_branch SJ0_f
SJ0_l:
  s_sleep 12
  s_sub_u32 s68, s68, 1
  s_cbranch_scc1 SJ0_d
SJ0_f:
  s_bfm_b64 exec, 32, 32
  buffer_load_dword v254, v252, s[36:39], 0 offen sc1
  s_mov_b64 exec, -1
  s_waitcnt vmcnt(0)
  v_cmp_ne_u32 vcc, v254, v249
  s_nop 0
  s_cmp_lg_u32 vcc_hi, 0
  s_cbranch_scc1 SJ0_l
SJ0_d:
  s_add_u32 s12, s4, s57
  buffer_load_dwordx4 v[84:87], v248, s[36:39], s12 offen sc1
  s_add_u32 s12, s5, s57
  buffer_load_dwordx4 v[88:91], v248, s[36:39], s12 offen sc1
  s_add_u32 s12, s6, s57
  buffer_load_dwordx4 v[92:95], v248, s[36:39], s12 offen sc1
  s_add_u32 s12, s7, s57
  buffer_load_dwordx4 v[96:99], v248, s[36:39], s12 offen sc1
  s_add_u32 s12, s4, s59
  buffer_load_dwordx4 v[4:7], v248, s[36:39], s12 offen sc1
  s_add_u32 s12, s5, s59
  buffer_load_dwordx4 v[8:11], v248, s[36:39], s12 offen sc1
  s_add_u32 s12, s6, s59
  buffer_load_dwordx4 v[12:15], v248, s[36:39], s12 offen sc1
  s_add_u32 s12, s7, s59
  buffer_load_dwordx4 v[16:19], v248, s[36:39], s12 offen sc1
  s_add_u32 s12, s4, s56
  buffer_load_dwordx4 a[240:243], v248, s[36:39], s12 offen sc1
  s_add_u32 s12, s5, s56
  buffer_load_dwordx4 a[244:247], v248, s[36:39], s12 offen sc1
  s_add_u32 s12, s6, s56
  buffer_load_dwordx4 a[248:251], v248, s[36:39], s12 offen sc1
  s_add_u32 s12, s7, s56
  buffer_load_dwordx4 a[252:255], v248, s[36:39], s12 offen sc1
SJe:
  s_mov_b32 s68, 20000
  s_branch SJe_f
SJe_l:
  s_sleep 12
  s_sub_u32 s68, s68, 1
  s_cbranch_scc1 SJe_d
SJe_f:
  s_bfm_b64 exec, 32, 0
  buffer_load_dword v254, v252, s[36:39], 0 offen sc1
  s_mov_b64 exec, -1
  s_waitcnt vmcnt(0)
  v_cmp_ne_u32 vcc, v254, v249
  s_nop 0
  s_cmp_lg_u32 vcc_lo, 0
  s_cbranch_scc1 SJe_l
SJe_d:
  s_branch JOIN
SINGLE:
  s_bfm_b64 exec, 32, 32
  buffer_load_dword v254, v251, s[36:39], 0 offen sc1
  s_mov_b64 exec, -1
  v_mfma_f32_16x16x32_bf16 v[20:23], v[200:203], a[232:235], v[20:23]
  ds_read_b64_tr_b16 a[252:253], v206 offset:24576
  ds_read_b64_tr_b16 a[254:255], v206 offset:25088
  v_mfma_f32_16x16x32_bf16 v[20:23], v[196:199], a[220:223], v[20:23]
  v_mfma_f32_16x16x32_bf16 v[24:27], v[196:199], a[224:227], v[24:27]
  v_mfma_f32_16x16x32_bf16 v[24:27], v[200:203], a[236:239], v[24:27]
  s_waitcnt lgkmcnt(4)
  v_mfma_f32_16x16x32_bf16 v[64:67], a[240:243], a[216:219], v[64:67]
  ds_read_b64_tr_b16 v[196:197], v206 offset:18432
  ds_read_b64_tr_b16 v[198:199], v206 offset:18944
  v_mfma_f32_16x16x32_bf16 v[64:67], a[244:247], a[228:231], v[64:67]
  v_mfma_f32_16x16x32_bf16 v[68:71], a[244:247], a[232:235], v[68:71]
  ds_read_b64_tr_b16 v[200:201], v206 offset:26624
  ds_read_b64_tr_b16 v[202:203], v206 offset:27136
  v_mfma_f32_16x16x32_bf16 v[68:71], a[240:243], a[220:223], v[68:71]
  v_mfma_f32_16x16x32_bf16 v[72:75], a[240:243], a[224:227], v[72:75]
  v_mfma_f32_16x16x32_bf16 v[72:75], a[244:247], a[236:239], v[72:75]
  s_waitcnt lgkmcnt(4)
  v_mfma_f32_16x16x32_bf16 v[28:31], a[248:251], a[216:219], v[28:31]
  ds_read_b64_tr_b16 a[240:241], v207 offset:16384
  ds_read_b64_tr_b16 a[242:243], v207 offset:16896
  v_mfma_f32_16x16x32_bf16 v[28:31], a[252:255], a[228:231], v[28:31]
  v_mfma_f32_16x16x32_bf16 v[32:35], a[252:255], a[232:235], v[32:35]
  ds_read_b64_tr_b16 a[244:245], v207 offset:24576
  ds_read_b64_tr_b16 a[246:247], v207 offset:25088
  v_mfma_f32_16x16x32_bf16 v[32:35], a[248:251], a[220:223], v[32:35]
  v_mfma_f32_16x16x32_bf16 v[36:39], a[248:251], a[224:227], v[36:39]
  v_mfma_f32_16x16x32_bf16 v[36:39], a[252:255], a[236:239], v[36:39]
  s_waitcnt lgkmcnt(4)
  v_mfma_f32_16x16x32_bf16 v[76:79], v[196:199], a[216:219], v[76:79]
  ds_read_b64_tr_b16 a[248:249], v207 offset:18432
  ds_read_b64_tr_b16 a[250:251], v207 offset:18944
  v_mfma_f32_16x16x32_bf16 v[76:79], v[200:203], a[228:231], v[76:79]
  v_mfma_f32_16x16x32_bf16 v[80:83], v[200:203], a[232:235], v[80:83]
  ds_read_b64_tr_b16 a[252:253], v207 offset:26624
  ds_read_b64_tr_b16 a[254:255], v207 offset:27136
  v_mfma_f32_16x16x32_bf16 v[80:83], v[196:199], a[220:223], v[80:83]
  v_mfma_f32_16x16x32_bf16 v[84:87], v[196:199], a[224:227], v[84:87]
  s_waitcnt vmcnt(4)
  v_mfma_f32_16x16x32_bf16 v[84:87], v[200:203], a[236:239], v[84:87]
  s_waitcnt lgkmcnt(4)
  v_mfma_f32_16x16x32_bf16 v[40:43], a[240:243], a[216:219], v[40:43]
  s_barrier
  ds_read_b64_tr_b16 v[196:197], v204 offset:32768
  ds_read_b64_tr_b16 v[198:199], v204 offset:33280
  v_mfma_f32_16x16x32_bf16 v[40:43], a[244:247], a[228:231], v[40:43]
  s_bfe_u32 s51, s60, 0x40008
  v_mfma_f32_16x16x32_bf16 v[44:47], a[244:247], a[232:235], v[44:47]
  s_mul_i32 s51, s51, 221184
  ds_read_b64_tr_b16 v[200:201], v204 offset:40960
  ds_read_b64_tr_b16 v[202:203], v204 offset:41472
  v_mfma_f32_16x16x32_bf16 v[44:47], a[240:243], a[220:223], v[44:47]
  s_add_u32 m0, s50, 0
  v_mfma_f32_16x16x32_bf16 v[48:51], a[240:243], a[224:227], v[48:51]
  s_add_u32 s51, s51, s77
  buffer_load_dwordx4 v208, s[28:31], s51 offen offset:0 lds
  v_mfma_f32_16x16x32_bf16 v[48:51], a[244:247], a[236:239], v[48:51]
  s_waitcnt lgkmcnt(4)
  buffer_load_dwordx4 v209, s[28:31], s51 offen offset:1024 lds
  v_mfma_f32_16x16x32_bf16 v[88:91], a[248:251], a[216:219], v[88:91]
  ds_read_b64_tr_b16 a[240:241], v204 offset:34816
  ds_read_b64_tr_b16 a[242:243], v204 offset:35328
  v_mfma_f32_16x16x32_bf16 v[88:91], a[252:255], a[228:231], v[88:91]
  v_mfma_f32_16x16x32_bf16 v[92:95], a[252:255], a[232:235], v[92:95]
  ds_read_b64_tr_b16 a[244:245], v204 offset:43008
  ds_read_b64_tr_b16 a[246:247], v204 offset:43520
  v_mfma_f32_16x16x32_bf16 v[92:95], a[248:251], a[220:223], v[92:95]
  v_mfma_f32_16x16x32_bf16 v[96:99], a[248:251], a[224:227], v[96:99]
  buffer_load_dwordx4 v208, s[32:35], s51 offen offset:2048 lds
  v_mfma_f32_16x16x32_bf16 v[96:99], a[252:255], a[236:239], v[96:99]
  s_waitcnt vmcnt(0) lgkmcnt(0)
  s_barrier
  v_lshrrev_b32 v227, 4, v0
  v_lshlrev_b32 v227, 22, v227
  v_add_lshl_u32 v227, v227, v0, 2
  buffer_store_dword v249, v227, s[36:39], s76 offen sc1
  v_fmac_f32_dpp v8, v4, v216 row_newbcast:0 row_mask:0xf bank_mask:0xf
  v_fmac_f32_dpp v9, v5, v216 row_newbcast:0 row_mask:0xf bank_mask:0xf
  v_fmac_f32_dpp v10, v6, v216 row_newbcast:0 row_mask:0xf bank_mask:0xf
  v_fmac_f32_dpp v11, v7, v216 row_newbcast:0 row_mask:0xf bank_mask:0xf
  v_fmac_f32_dpp v56, v52, v216 row_newbcast:0 row_mask:0xf bank_mask:0xf
  v_fmac_f32_dpp v57, v53, v216 row_newbcast:0 row_mask:0xf bank_mask:0xf
  v_fmac_f32_dpp v58, v54, v216 row_newbcast:0 row_mask:0xf bank_mask:0xf
  v_fmac_f32_dpp v59, v55, v216 row_newbcast:0 row_mask:0xf bank_mask:0xf
  v_fmac_f32_dpp v12, v4, v220 row_newbcast:0 row_mask:0xf bank_mask:0xf
  v_fmac_f32_dpp v13, v5, v220 row_newbcast:0 row_mask:0xf bank_mask:0xf
  v_fmac_f32_dpp v14, v6, v220 row_newbcast:0 row_mask:0xf bank_mask:0xf
  v_fmac_f32_dpp v15, v7, v220 row_newbcast:0 row_mask:0xf bank_mask:0xf
  v_fmac_f32_dpp v60, v52, v220 row_newbcast:0 row_mask:0xf bank_mask:0xf
  v_fmac_f32_dpp v61, v53, v220 row_newbcast:0 row_mask:0xf bank_mask:0xf
  v_fmac_f32_dpp v62, v54, v220 row_newbcast:0 row_mask:0xf bank_mask:0xf
  v_fmac_f32_dpp v63, v55, v220 row_newbcast:0 row_mask:0xf bank_mask:0xf
  v_fmac_f32_dpp v4, v4, v212 row_newbcast:0 row_mask:0xf bank_mask:0xf
  v_fmac_f32_dpp v5, v5, v212 row_newbcast:0 row_mask:0xf bank_mask:0xf
  v_fmac_f32_dpp v6, v6, v212 row_newbcast:0 row_mask:0xf bank_mask:0xf
  v_fmac_f32_dpp v7, v7, v212 row_newbcast:0 row_mask:0xf bank_mask:0xf
  v_fmac_f32_dpp v52, v52, v212 row_newbcast:0 row_mask:0xf bank_mask:0xf
  v_fmac_f32_dpp v53, v53, v212 row_newbcast:0 row_mask:0xf bank_mask:0xf
  v_fmac_f32_dpp v54, v54, v212 row_newbcast:0 row_mask:0xf bank_mask:0xf
  v_fmac_f32_dpp v55, v55, v212 row_newbcast:0 row_mask:0xf bank_mask:0xf
  v_fmac_f32_dpp v20, v16, v216 row_newbcast:0 row_mask:0xf bank_mask:0xf
  v_fmac_f32_dpp v21, v17, v216 row_newbcast:0 row_mask:0xf bank_mask:0xf
  v_fmac_f32_dpp v22, v18, v216 row_newbcast:0 row_mask:0xf bank_mask:0xf
  v_fmac_f32_dpp v23, v19, v216 row_newbcast:0 row_mask:0xf bank_mask:0xf
  v_fmac_f32_dpp v68, v64, v216 row_newbcast:0 row_mask:0xf bank_mask:0xf
  v_fmac_f32_dpp v69, v65, v216 row_newbcast:0 row_mask:0xf bank_mask:0xf
  v_fmac_f32_dpp v70, v66, v216 row_newbcast:0 row_mask:0xf bank_mask:0xf
  v_fmac_f32_dpp v71, v67, v216 row_newbcast:0 row_mask:0xf bank_mask:0xf
  v_fmac_f32_dpp v24, v16, v220 row_newbcast:0 row_mask:0xf bank_mask:0xf
  v_fmac_f32_dpp v25, v17, v220 row_newbcast:0 row_mask:0xf bank_mask:0xf
  v_fmac_f32_dpp v26, v18, v220 row_newbcast:0 row_mask:0xf bank_mask:0xf
  v_fmac_f32_dpp v27, v19, v220 row_newbcast:0 row_mask:0xf bank_mask:0xf
  v_fmac_f32_dpp v72, v64, v220 row_newbcast:0 row_mask:0xf bank_mask:0xf
  v_fmac_f32_dpp v73, v65, v220 row_newbcast:0 row_mask:0xf bank_mask:0xf
  v_fmac_f32_dpp v74, v66, v220 row_newbcast:0 row_mask:0xf bank_mask:0xf
  v_fmac_f32_dpp v75, v67, v220 row_newbcast:0 row_mask:0xf bank_mask:0xf
  v_fmac_f32_dpp v16, v16, v212 row_newbcast:0 row_mask:0xf bank_mask:0xf
  v_fmac_f32_dpp v17, v17, v212 row_newbcast:0 row_mask:0xf bank_mask:0xf
  v_fmac_f32_dpp v18, v18, v212 row_newbcast:0 row_mask:0xf bank_mask:0xf
  v_fmac_f32_dpp v19, v19, v212 row_newbcast:0 row_mask:0xf bank_mask:0xf
  v_fmac_f32_dpp v64, v64, v212 row_newbcast:0 row_mask:0xf bank_mask:0xf
  v_fmac_f32_dpp v65, v65, v212 row_newbcast:0 row_mask:0xf bank_mask:0xf
  v_fmac_f32_dpp v66, v66, v212 row_newbcast:0 row_mask:0xf bank_mask:0xf
  v_fmac_f32_dpp v67, v67, v212 row_newbcast:0 row_mask:0xf bank_mask:0xf
  v_pk_mul_f32 v[232:233], v[4:5], v[4:5]
  v_pk_mul_f32 v[234:235], v[6:7], v[6:7]
  v_pk_fma_f32 v[232:233], v[232:233], v[214:215], v[212:213] op_sel:[0,0,1] op_sel_hi:[1,0,1]
  v_pk_fma_f32 v[234:235], v[234:235], v[214:215], v[212:213] op_sel:[0,0,1] op_sel_hi:[1,0,1]
  v_pk_mul_f32 v[232:233], v[232:233], v[4:5]
  v_pk_mul_f32 v[234:235], v[234:235], v[6:7]
  v_exp_f32 v232, v232
  v_exp_f32 v233, v233
  v_exp_f32 v234, v234
  v_exp_f32 v235, v235
  v_pk_mul_f32 v[4:5], v[4:5], v[52:53]
  v_pk_mul_f32 v[6:7], v[6:7], v[54:55]
  v_pk_fma_f32 v[232:233], v[232:233], v[214:215], v[214:215] op_sel:[0,1,1] op_sel_hi:[1,1,1]
  v_pk_fma_f32 v[234:235], v[234:235], v[214:215], v[214:215] op_sel:[0,1,1] op_sel_hi:[1,1,1]
  v_rcp_f32 v232, v232
  v_rcp_f32 v234, v234
  v_rcp_f32 v233, v233
  v_rcp_f32 v235, v235
  v_pk_mul_f32 v[4:5], v[4:5], v[232:233]
  v_pk_mul_f32 v[6:7], v[6:7], v[234:235]
  v_cvt_pk_bf16_f32 v52, v4, v5
  v_cvt_pk_bf16_f32 v53, v6, v7
  v_pk_mul_f32 v[236:237], v[16:17], v[16:17]
  v_pk_mul_f32 v[238:239], v[18:19], v[18:19]
  v_pk_fma_f32 v[236:237], v[236:237], v[214:215], v[212:213] op_sel:[0,0,1] op_sel_hi:[1,0,1]
  v_pk_fma_f32 v[238:239], v[238:239], v[214:215], v[212:213] op_sel:[0,0,1] op_sel_hi:[1,0,1]
  v_pk_mul_f32 v[236:237], v[236:237], v[16:17]
  v_pk_mul_f32 v[238:239], v[238:239], v[18:19]
  v_exp_f32 v236, v236
  v_exp_f32 v237, v237
  v_exp_f32 v238, v238
  v_exp_f32 v239, v239
  v_pk_mul_f32 v[16:17], v[16:17], v[64:65]
  v_pk_mul_f32 v[18:19], v[18:19], v[66:67]
  v_pk_fma_f32 v[236:237], v[236:237], v[214:215], v[214:215] op_sel:[0,1,1] op_sel_hi:[1,1,1]
  v_pk_fma_f32 v[238:239], v[238:239], v[214:215], v[214:215] op_sel:[0,1,1] op_sel_hi:[1,1,1]
  v_rcp_f32 v236, v236
  v_rcp_f32 v238, v238
  v_rcp_f32 v237, v237
  v_rcp_f32 v239, v239
  v_pk_mul_f32 v[16:17], v[16:17], v[236:237]
  v_pk_mul_f32 v[18:19], v[18:19], v[238:239]
  v_cvt_pk_bf16_f32 v54, v16, v17
  v_cvt_pk_bf16_f32 v55, v18, v19
  buffer_store_dwordx4 v[52:55], v1, s[36:39], s70 offen sc1
  v_pk_mul_f32 v[240:241], v[8:9], v[8:9]
  v_pk_mul_f32 v[242:243], v[10:11], v[10:11]
  v_pk_fma_f32 v[240:241], v[240:241], v[218:219], v[216:217] op_sel:[0,0,1] op_sel_hi:[1,0,1]
  v_pk_fma_f32 v[242:243], v[242:243], v[218:219], v[216:217] op_sel:[0,0,1] op_sel_hi:[1,0,1]
  v_pk_mul_f32 v[240:241], v[240:241], v[8:9]
  v_pk_mul_f32 v[242:243], v[242:243], v[10:11]
  v_exp_f32 v240, v240
  v_exp_f32 v241, v241
  v_exp_f32 v242, v242
  v_exp_f32 v243, v243
  v_pk_mul_f32 v[8:9], v[8:9], v[56:57]
  v_pk_mul_f32 v[10:11], v[10:11], v[58:59]
  v_pk_fma_f32 v[240:241], v[240:241], v[218:219], v[218:219] op_sel:[0,1,1] op_sel_hi:[1,1,1]
  v_pk_fma_f32 v[242:243], v[242:243], v[218:219], v[218:219] op_sel:[0,1,1] op_sel_hi:[1,1,1]
  v_rcp_f32 v240, v240
  v_rcp_f32 v242, v242
  v_rcp_f32 v241, v241
  v_rcp_f32 v243, v243
  v_pk_mul_f32 v[8:9], v[8:9], v[240:241]
  v_pk_mul_f32 v[10:11], v[10:11], v[242:243]
  v_cvt_pk_bf16_f32 v56, v8, v9
  v_cvt_pk_bf16_f32 v57, v10, v11
  v_pk_mul_f32 v[244:245], v[20:21], v[20:21]
  v_pk_mul_f32 v[246:247], v[22:23], v[22:23]
  v_pk_fma_f32 v[244:245], v[244:245], v[218:219], v[216:217] op_sel:[0,0,1] op_sel_hi:[1,0,1]
  v_pk_fma_f32 v[246:247], v[246:247], v[218:219], v[216:217] op_sel:[0,0,1] op_sel_hi:[1,0,1]
  v_pk_mul_f32 v[244:245], v[244:245], v[20:21]
  v_pk_mul_f32 v[246:247], v[246:247], v[22:23]
  v_exp_f32 v244, v244
  v_exp_f32 v245, v245
  v_exp_f32 v246, v246
  v_exp_f32 v247, v247
  v_pk_mul_f32 v[20:21], v[20:21], v[68:69]
  v_pk_mul_f32 v[22:23], v[22:23], v[70:71]
  v_pk_fma_f32 v[244:245], v[244:245], v[218:219], v[218:219] op_sel:[0,1,1] op_sel_hi:[1,1,1]
  v_pk_fma_f32 v[246:247], v[246:247], v[218:219], v[218:219] op_sel:[0,1,1] op_sel_hi:[1,1,1]
  v_rcp_f32 v244, v244
  v_rcp_f32 v246, v246
  v_rcp_f32 v245, v245
  v_rcp_f32 v247, v247
  v_pk_mul_f32 v[20:21], v[20:21], v[244:245]
  v_pk_mul_f32 v[22:23], v[22:23], v[246:247]
  v_cvt_pk_bf16_f32 v58, v20, v21
  v_cvt_pk_bf16_f32 v59, v22, v23
  buffer_store_dwordx4 v[56:59], v2, s[36:39], s70 offen sc1
  v_pk_mul_f32 v[232:233], v[12:13], v[12:13]
  v_pk_mul_f32 v[234:235], v[14:15], v[14:15]
  v_pk_fma_f32 v[232:233], v[232:233], v[222:223], v[220:221] op_sel:[0,0,1] op_sel_hi:[1,0,1]
  v_pk_fma_f32 v[234:235], v[234:235], v[222:223], v[220:221] op_sel:[0,0,1] op_sel_hi:[1,0,1]
  v_pk_mul_f32 v[232:233], v[232:233], v[12:13]
  v_pk_mul_f32 v[234:235], v[234:235], v[14:15]
  v_exp_f32 v232, v232
  v_exp_f32 v233, v233
  v_exp_f32 v234, v234
  v_exp_f32 v235, v235
  v_pk_mul_f32 v[12:13], v[12:13], v[60:61]
  v_pk_mul_f32 v[14:15], v[14:15], v[62:63]
  v_pk_fma_f32 v[232:233], v[232:233], v[222:223], v[222:223] op_sel:[0,1,1] op_sel_hi:[1,1,1]
  v_pk_fma_f32 v[234:235], v[234:235], v[222:223], v[222:223] op_sel:[0,1,1] op_sel_hi:[1,1,1]
  v_rcp_f32 v232, v232
  v_rcp_f32 v234, v234
  v_rcp_f32 v233, v233
  v_rcp_f32 v235, v235
  v_pk_mul_f32 v[12:13], v[12:13], v[232:233]
  v_pk_mul_f32 v[14:15], v[14:15], v[234:235]
  v_cvt_pk_bf16_f32 v60, v12, v13
  v_cvt_pk_bf16_f32 v61, v14, v15
  v_pk_mul_f32 v[236:237], v[24:25], v[24:25]
  v_pk_mul_f32 v[238:239], v[26:27], v[26:27]
  v_pk_fma_f32 v[236:237], v[236:237], v[222:223], v[220:221] op_sel:[0,0,1] op_sel_hi:[1,0,1]
  v_pk_fma_f32 v[238:239], v[238:239], v[222:223], v[220:221] op_sel:[0,0,1] op_sel_hi:[1,0,1]
  v_pk_mul_f32 v[236:237], v[236:237], v[24:25]
  v_pk_mul_f32 v[238:239], v[238:239], v[26:27]
  v_exp_f32 v236, v236
  v_exp_f32 v237, v237
  v_exp_f32 v238, v238
  v_exp_f32 v239, v239
  v_pk_mul_f32 v[24:25], v[24:25], v[72:73]
  v_pk_mul_f32 v[26:27], v[26:27], v[74:75]
  v_pk_fma_f32 v[236:237], v[236:237], v[222:223], v[222:223] op_sel:[0,1,1] op_sel_hi:[1,1,1]
  v_pk_fma_f32 v[238:239], v[238:239], v[222:223], v[222:223] op_sel:[0,1,1] op_sel_hi:[1,1,1]
  v_rcp_f32 v236, v236
  v_rcp_f32 v238, v238
  v_rcp_f32 v237, v237
  v_rcp_f32 v239, v239
  v_pk_mul_f32 v[24:25], v[24:25], v[236:237]
  v_pk_mul_f32 v[26:27], v[26:27], v[238:239]
  v_cvt_pk_bf16_f32 v62, v24, v25
  v_cvt_pk_bf16_f32 v63, v26, v27
  buffer_store_dwordx4 v[60:63], v3, s[36:39], s70 offen sc1
  v_fmac_f32_dpp v32, v28, v216 row_newbcast:0 row_mask:0xf bank_mask:0xf
  v_fmac_f32_dpp v33, v29, v216 row_newbcast:0 row_mask:0xf bank_mask:0xf
  v_fmac_f32_dpp v34, v30, v216 row_newbcast:0 row_mask:0xf bank_mask:0xf
  v_fmac_f32_dpp v35, v31, v216 row_newbcast:0 row_mask:0xf bank_mask:0xf
  v_fmac_f32_dpp v80, v76, v216 row_newbcast:0 row_mask:0xf bank_mask:0xf
  v_fmac_f32_dpp v81, v77, v216 row_newbcast:0 row_mask:0xf bank_mask:0xf
  v_fmac_f32_dpp v82, v78, v216 row_newbcast:0 row_mask:0xf bank_mask:0xf
  v_fmac_f32_dpp v83, v79, v216 row_newbcast:0 row_mask:0xf bank_mask:0xf
  v_fmac_f32_dpp v36, v28, v220 row_newbcast:0 row_mask:0xf bank_mask:0xf
  v_fmac_f32_dpp v37, v29, v220 row_newbcast:0 row_mask:0xf bank_mask:0xf
  v_fmac_f32_dpp v38, v30, v220 row_newbcast:0 row_mask:0xf bank_mask:0xf
  v_fmac_f32_dpp v39, v31, v220 row_newbcast:0 row_mask:0xf bank_mask:0xf
  v_fmac_f32_dpp v84, v76, v220 row_newbcast:0 row_mask:0xf bank_mask:0xf
  v_fmac_f32_dpp v85, v77, v220 row_newbcast:0 row_mask:0xf bank_mask:0xf
  v_fmac_f32_dpp v86, v78, v220 row_newbcast:0 row_mask:0xf bank_mask:0xf
  v_fmac_f32_dpp v87, v79, v220 row_newbcast:0 row_mask:0xf bank_mask:0xf
  v_fmac_f32_dpp v28, v28, v212 row_newbcast:0 row_mask:0xf bank_mask:0xf
  v_fmac_f32_dpp v29, v29, v212 row_newbcast:0 row_mask:0xf bank_mask:0xf
  v_fmac_f32_dpp v30, v30, v212 row_newbcast:0 row_mask:0xf bank_mask:0xf
  v_fmac_f32_dpp v31, v31, v212 row_newbcast:0 row_mask:0xf bank_mask:0xf
  v_fmac_f32_dpp v76, v76, v212 row_newbcast:0 row_mask:0xf bank_mask:0xf
  v_fmac_f32_dpp v77, v77, v212 row_newbcast:0 row_mask:0xf bank_mask:0xf
  v_fmac_f32_dpp v78, v78, v212 row_newbcast:0 row_mask:0xf bank_mask:0xf
  v_fmac_f32_dpp v79, v79, v212 row_newbcast:0 row_mask:0xf bank_mask:0xf
  v_fmac_f32_dpp v44, v40, v216 row_newbcast:0 row_mask:0xf bank_mask:0xf
  v_fmac_f32_dpp v45, v41, v216 row_newbcast:0 row_mask:0xf bank_mask:0xf
  v_fmac_f32_dpp v46, v42, v216 row_newbcast:0 row_mask:0xf bank_mask:0xf
  v_fmac_f32_dpp v47, v43, v216 row_newbcast:0 row_mask:0xf bank_mask:0xf
  v_fmac_f32_dpp v92, v88, v216 row_newbcast:0 row_mask:0xf bank_mask:0xf
  v_fmac_f32_dpp v93, v89, v216 row_newbcast:0 row_mask:0xf bank_mask:0xf
  v_fmac_f32_dpp v94, v90, v216 row_newbcast:0 row_mask:0xf bank_mask:0xf
  v_fmac_f32_dpp v95, v91, v216 row_newbcast:0 row_mask:0xf bank_mask:0xf
  v_fmac_f32_dpp v48, v40, v220 row_newbcast:0 row_mask:0xf bank_mask:0xf
  v_fmac_f32_dpp v49, v41, v220 row_newbcast:0 row_mask:0xf bank_mask:0xf
  v_fmac_f32_dpp v50, v42, v220 row_newbcast:0 row_mask:0xf bank_mask:0xf
  v_fmac_f32_dpp v51, v43, v220 row_newbcast:0 row_mask:0xf bank_mask:0xf
  v_fmac_f32_dpp v96, v88, v220 row_newbcast:0 row_mask:0xf bank_mask:0xf
  v_fmac_f32_dpp v97, v89, v220 row_newbcast:0 row_mask:0xf bank_mask:0xf
  v_fmac_f32_dpp v98, v90, v220 row_newbcast:0 row_mask:0xf bank_mask:0xf
  v_fmac_f32_dpp v99, v91, v220 row_newbcast:0 row_mask:0xf bank_mask:0xf
  v_fmac_f32_dpp v40, v40, v212 row_newbcast:0 row_mask:0xf bank_mask:0xf
  v_fmac_f32_dpp v41, v41, v212 row_newbcast:0 row_mask:0xf bank_mask:0xf
  v_fmac_f32_dpp v42, v42, v212 row_newbcast:0 row_mask:0xf bank_mask:0xf
  v_fmac_f32_dpp v43, v43, v212 row_newbcast:0 row_mask:0xf bank_mask:0xf
  v_fmac_f32_dpp v88, v88, v212 row_newbcast:0 row_mask:0xf bank_mask:0xf
  v_fmac_f32_dpp v89, v89, v212 row_newbcast:0 row_mask:0xf bank_mask:0xf
  v_fmac_f32_dpp v90, v90, v212 row_newbcast:0 row_mask:0xf bank_mask:0xf
  v_fmac_f32_dpp v91, v91, v212 row_newbcast:0 row_mask:0xf bank_mask:0xf
  v_pk_mul_f32 v[240:241], v[28:29], v[28:29]
  v_pk_mul_f32 v[242:243], v[30:31], v[30:31]
  v_pk_fma_f32 v[240:241], v[240:241], v[214:215], v[212:213] op_sel:[0,0,1] op_sel_hi:[1,0,1]
  v_pk_fma_f32 v[242:243], v[242:243], v[214:215], v[212:213] op_sel:[0,0,1] op_sel_hi:[1,0,1]
  v_pk_mul_f32 v[240:241], v[240:241], v[28:29]
  v_pk_mul_f32 v[242:243], v[242:243], v[30:31]
  v_exp_f32 v240, v240
  v_exp_f32 v241, v241
  v_exp_f32 v242, v242
  v_exp_f32 v243, v243
  v_pk_mul_f32 v[28:29], v[28:29], v[76:77]
  v_pk_mul_f32 v[30:31], v[30:31], v[78:79]
  v_pk_fma_f32 v[240:241], v[240:241], v[214:215], v[214:215] op_sel:[0,1,1] op_sel_hi:[1,1,1]
  v_pk_fma_f32 v[242:243], v[242:243], v[214:215], v[214:215] op_sel:[0,1,1] op_sel_hi:[1,1,1]
  v_rcp_f32 v240, v240
  v_rcp_f32 v242, v242
  v_rcp_f32 v241, v241
  v_rcp_f32 v243, v243
  v_pk_mul_f32 v[28:29], v[28:29], v[240:241]
  v_pk_mul_f32 v[30:31], v[30:31], v[242:243]
  v_cvt_pk_bf16_f32 v76, v28, v29
  v_cvt_pk_bf16_f32 v77, v30, v31
  v_pk_mul_f32 v[244:245], v[40:41], v[40:41]
  v_pk_mul_f32 v[246:247], v[42:43], v[42:43]
  v_pk_fma_f32 v[244:245], v[244:245], v[214:215], v[212:213] op_sel:[0,0,1] op_sel_hi:[1,0,1]
  v_pk_fma_f32 v[246:247], v[246:247], v[214:215], v[212:213] op_sel:[0,0,1] op_sel_hi:[1,0,1]
  v_pk_mul_f32 v[244:245], v[244:245], v[40:41]
  v_pk_mul_f32 v[246:247], v[246:247], v[42:43]
  v_exp_f32 v244, v244
  v_exp_f32 v245, v245
  v_exp_f32 v246, v246
  v_exp_f32 v247, v247
  v_pk_mul_f32 v[40:41], v[40:41], v[88:89]
  v_pk_mul_f32 v[42:43], v[42:43], v[90:91]
  v_pk_fma_f32 v[244:245], v[244:245], v[214:215], v[214:215] op_sel:[0,1,1] op_sel_hi:[1,1,1]
  v_pk_fma_f32 v[246:247], v[246:247], v[214:215], v[214:215] op_sel:[0,1,1] op_sel_hi:[1,1,1]
  v_rcp_f32 v244, v244
  v_rcp_f32 v246, v246
  v_rcp_f32 v245, v245
  v_rcp_f32 v247, v247
  v_pk_mul_f32 v[40:41], v[40:41], v[244:245]
  v_pk_mul_f32 v[42:43], v[42:43], v[246:247]
  v_cvt_pk_bf16_f32 v78, v40, v41
  v_cvt_pk_bf16_f32 v79, v42, v43
  buffer_store_dwordx4 v[76:79], v1, s[36:39], s71 offen sc1
  v_pk_mul_f32 v[232:233], v[32:33], v[32:33]
  v_pk_mul_f32 v[234:235], v[34:35], v[34:35]
  v_pk_fma_f32 v[232:233], v[232:233], v[218:219], v[216:217] op_sel:[0,0,1] op_sel_hi:[1,0,1]
  v_pk_fma_f32 v[234:235], v[234:235], v[218:219], v[216:217] op_sel:[0,0,1] op_sel_hi:[1,0,1]
  v_pk_mul_f32 v[232:233], v[232:233], v[32:33]
  v_pk_mul_f32 v[234:235], v[234:235], v[34:35]
  v_exp_f32 v232, v232
  v_exp_f32 v233, v233
  v_exp_f32 v234, v234
  v_exp_f32 v235, v235
  v_pk_mul_f32 v[32:33], v[32:33], v[80:81]
  v_pk_mul_f32 v[34:35], v[34:35], v[82:83]
  v_pk_fma_f32 v[232:233], v[232:233], v[218:219], v[218:219] op_sel:[0,1,1] op_sel_hi:[1,1,1]
  v_pk_fma_f32 v[234:235], v[234:235], v[218:219], v[218:219] op_sel:[0,1,1] op_sel_hi:[1,1,1]
  v_rcp_f32 v232, v232
  v_rcp_f32 v234, v234
  v_rcp_f32 v233, v233
  v_rcp_f32 v235, v235
  v_pk_mul_f32 v[32:33], v[32:33], v[232:233]
  v_pk_mul_f32 v[34:35], v[34:35], v[234:235]
  v_cvt_pk_bf16_f32 v80, v32, v33
  v_cvt_pk_bf16_f32 v81, v34, v35
  v_pk_mul_f32 v[236:237], v[44:45], v[44:45]
  v_pk_mul_f32 v[238:239], v[46:47], v[46:47]
  v_pk_fma_f32 v[236:237], v[236:237], v[218:219], v[216:217] op_sel:[0,0,1] op_sel_hi:[1,0,1]
  v_pk_fma_f32 v[238:239], v[238:239], v[218:219], v[216:217] op_sel:[0,0,1] op_sel_hi:[1,0,1]
  v_pk_mul_f32 v[236:237], v[236:237], v[44:45]
  v_pk_mul_f32 v[238:239], v[238:239], v[46:47]
  v_exp_f32 v236, v236
  v_exp_f32 v237, v237
  v_exp_f32 v238, v238
  v_exp_f32 v239, v239
  v_pk_mul_f32 v[44:45], v[44:45], v[92:93]
  v_pk_mul_f32 v[46:47], v[46:47], v[94:95]
  v_pk_fma_f32 v[236:237], v[236:237], v[218:219], v[218:219] op_sel:[0,1,1] op_sel_hi:[1,1,1]
  v_pk_fma_f32 v[238:239], v[238:239], v[218:219], v[218:219] op_sel:[0,1,1] op_sel_hi:[1,1,1]
  v_rcp_f32 v236, v236
  v_rcp_f32 v238, v238
  v_rcp_f32 v237, v237
  v_rcp_f32 v239, v239
  v_pk_mul_f32 v[44:45], v[44:45], v[236:237]
  v_pk_mul_f32 v[46:47], v[46:47], v[238:239]
  v_cvt_pk_bf16_f32 v82, v44, v45
  v_cvt_pk_bf16_f32 v83, v46, v47
  buffer_store_dwordx4 v[80:83], v2, s[36:39], s71 offen sc1
  v_pk_mul_f32 v[240:241], v[36:37], v[36:37]
  v_pk_mul_f32 v[242:243], v[38:39], v[38:39]
  v_pk_fma_f32 v[240:241], v[240:241], v[222:223], v[220:221] op_sel:[0,0,1] op_sel_hi:[1,0,1]
  v_pk_fma_f32 v[242:243], v[242:243], v[222:223], v[220:221] op_sel:[0,0,1] op_sel_hi:[1,0,1]
  v_pk_mul_f32 v[240:241], v[240:241], v[36:37]
  v_pk_mul_f32 v[242:243], v[242:243], v[38:39]
  v_exp_f32 v240, v240
  v_exp_f32 v241, v241
  v_exp_f32 v242, v242
  v_exp_f32 v243, v243
  v_pk_mul_f32 v[36:37], v[36:37], v[84:85]
  v_pk_mul_f32 v[38:39], v[38:39], v[86:87]
  v_pk_fma_f32 v[240:241], v[240:241], v[222:223], v[222:223] op_sel:[0,1,1] op_sel_hi:[1,1,1]
  v_pk_fma_f32 v[242:243], v[242:243], v[222:223], v[222:223] op_sel:[0,1,1] op_sel_hi:[1,1,1]
  v_rcp_f32 v240, v240
  v_rcp_f32 v242, v242
  v_rcp_f32 v241, v241
  v_rcp_f32 v243, v243
  v_pk_mul_f32 v[36:37], v[36:37], v[240:241]
  v_pk_mul_f32 v[38:39], v[38:39], v[242:243]
  v_cvt_pk_bf16_f32 v84, v36, v37
  v_cvt_pk_bf16_f32 v85, v38, v39
  v_pk_mul_f32 v[244:245], v[48:49], v[48:49]
  v_pk_mul_f32 v[246:247], v[50:51], v[50:51]
  v_pk_fma_f32 v[244:245], v[244:245], v[222:223], v[220:221] op_sel:[0,0,1] op_sel_hi:[1,0,1]
  v_pk_fma_f32 v[246:247], v[246:247], v[222:223], v[220:221] op_sel:[0,0,1] op_sel_hi:[1,0,1]
  v_pk_mul_f32 v[244:245], v[244:245], v[48:49]
  v_pk_mul_f32 v[246:247], v[246:247], v[50:51]
  v_exp_f32 v244, v244
  v_exp_f32 v245, v245
  v_exp_f32 v246, v246
  v_exp_f32 v247, v247
  v_pk_mul_f32 v[48:49], v[48:49], v[96:97]
  v_pk_mul_f32 v[50:51], v[50:51], v[98:99]
  v_pk_fma_f32 v[244:245], v[244:245], v[222:223], v[222:223] op_sel:[0,1,1] op_sel_hi:[1,1,1]
  v_pk_fma_f32 v[246:247], v[246:247], v[222:223], v[222:223] op_sel:[0,1,1] op_sel_hi:[1,1,1]
  v_rcp_f32 v244, v244
  v_rcp_f32 v246, v246
  v_rcp_f32 v245, v245
  v_rcp_f32 v247, v247
  v_pk_mul_f32 v[48:49], v[48:49], v[244:245]
  v_pk_mul_f32 v[50:51], v[50:51], v[246:247]
  v_cvt_pk_bf16_f32 v86, v48, v49
  v_cvt_pk_bf16_f32 v87, v50, v51
  buffer_store_dwordx4 v[84:87], v3, s[36:39], s71 offen sc1
  s_waitcnt vmcnt(0)
  buffer_store_dword v249, v250, s[36:39], 0 offen sc1
  s_mov_b32 s48, 131072
  buffer_store_dword v249, v250, s[36:39], s48 offen sc1
  s_mul_i32 s80, s53, 5
  s_mul_i32 s55, s44, 100
  s_add_u32 s80, s80, s55
  s_add_u32 s80, s80, 58
  s_branch HJOB
SFo:
  s_mov_b32 s68, 20000
  s_branch SFo_f
SFo_l:
  s_sleep 2
  s_sub_u32 s68, s68, 1
  s_cbranch_scc1 SFo_d
SFo_f:
  s_bfm_b64 exec, 32, 32
  buffer_load_dword v254, v251, s[36:39], 0 offen sc1
  s_mov_b64 exec, -1
  s_waitcnt vmcnt(0)
  v_cmp_ne_u32 vcc, v254, v249
  s_nop 0
  s_cmp_lg_u32 vcc_hi, 0
  s_cbranch_scc1 SFo_l
SFo_d:
  s_branch BFo
SFs:
  s_mov_b32 s68, 20000
  s_branch SFs_f
SFs_l:
  s_sleep 2
  s_sub_u32 s68, s68, 1
  s_cbranch_scc1 SFs_d
SFs_f:
  buffer_load_dwordx4 v[212:215], v229, s[36:39], s81 offen sc1
  buffer_load_dwordx4 v[216:219], v230, s[36:39], s81 offen sc1
  buffer_load_dwordx4 v[220:223], v231, s[36:39], s81 offen sc1
  s_waitcnt vmcnt(0)
  v_xor_b32 v213, v213, v249
  v_xor_b32 v215, v215, v249
  v_xor_b32 v217, v217, v249
  v_xor_b32 v219, v219, v249
  v_xor_b32 v221, v221, v249
  v_xor_b32 v223, v223, v249
  v_or3_b32 v224, v213, v215, v217
  v_or3_b32 v224, v224, v219, v221
  v_or_b32 v224, v224, v223
  v_cmp_ne_u32 vcc, 0, v224
  s_cbranch_vccnz SFs_l
SFs_d:
  s_branch BFs
SFb:
  s_mov_b32 s68, 20000
  s_branch SFb_f
SFb_l:
  s_sleep 2
  s_sub_u32 s68, s68, 1
  s_cbranch_scc1 SFb_d
SFb_f:
  s_bfm_b64 exec, 32, 0
  buffer_load_dword v254, v251, s[36:39], 0 offen sc1
  s_mov_b64 exec, -1
  s_waitcnt vmcnt(0)
  v_cmp_ne_u32 vcc, v254, v249
  s_nop 0
  s_cmp_lg_u32 vcc_lo, 0
  s_cbranch_scc1 SFb_l
SFb_d:
  s_branch BFb
SF0:
  s_mov_b32 s68, 20000
  s_branch SF0_f
SF0_l:
  s_sleep 2
  s_sub_u32 s68, s68, 1
  s_cbranch_scc1 SF0_d
SF0_f:
  s_bfm_b64 exec, 32, 32
  buffer_load_dword v254, v252, s[36:39], 0 offen sc1
  s_mov_b64 exec, -1
  s_waitcnt vmcnt(0)
  v_cmp_ne_u32 vcc, v254, v249
  s_nop 0
  s_cmp_lg_u32 vcc_hi, 0
  s_cbranch_scc1 SF0_l
SF0_d:
  s_branch BF0
SFe:
  s_waitcnt vmcnt(0)
  buffer_store_dword v249, v250, s[36:39], s63 offen sc1
  s_mov_b32 s68, 20000
  s_branch SFe_f
SFe_l:
  s_sleep 2
  s_sub_u32 s68, s68, 1
  s_cbranch_scc1 SFe_d
SFe_f:
  s_bfm_b64 exec, 32, 0
  buffer_load_dword v254, v252, s[36:39], 0 offen sc1
  s_mov_b64 exec, -1
  s_waitcnt vmcnt(0)
  v_cmp_ne_u32 vcc, v254, v249
  s_nop 0
  s_cmp_lg_u32 vcc_lo, 0
  s_cbranch_scc1 SFe_l
SFe_d:
  s_branch BFe
SPo:
  s_mov_b32 s68, 20000
  s_branch SPo_f
SPo_l:
  s_sleep 2
  s_sub_u32 s68, s68, 1
  s_cbranch_scc1 SPo_d
SPo_f:
  s_bfm_b64 exec, 32, 32
  buffer_load_dword v254, v253, s[36:39], 0 offen sc1
  s_mov_b64 exec, -1
  s_waitcnt vmcnt(0)
  v_cmp_ne_u32 vcc, v254, v249
  s_nop 0
  s_cmp_lg_u32 vcc_hi, 0
  s_cbranch_scc1 SPo_l
SPo_d:
  s_branch BPo
SPl:
  s_mov_b32 s68, 20000
  s_branch SPl_f
SPl_l:
  s_sleep 2
  s_sub_u32 s68, s68, 1
  s_cbranch_scc1 SPl_d
SPl_f:
  s_bfm_b64 exec, 32, 0
  buffer_load_dword v254, v253, s[36:39], 0 offen sc1
  s_mov_b64 exec, -1
  s_waitcnt vmcnt(0)
  v_cmp_ne_u32 vcc, v254, v249
  s_nop 0
  s_cmp_lg_u32 vcc_lo, 0
  s_cbranch_scc1 SPl_l
SPl_d:
  s_branch BPl
SAo:
  s_mov_b32 s68, 20000
  s_branch SAo_f
SAo_l:
  s_sleep 2
  s_sub_u32 s68, s68, 1
  s_cbranch_scc1 SAo_d
SAo_f:
  s_bfm_b64 exec, 32, 32
  buffer_load_dword v254, v251, s[36:39], 0 offen sc1
  s_mov_b64 exec, -1
  s_waitcnt vmcnt(0)
  v_cmp_ne_u32 vcc, v254, v249
  s_nop 0
  s_cmp_lg_u32 vcc_hi, 0
  s_cbranch_scc1 SAo_l
SAo_d:
  s_branch BAo
SAs:
  s_mov_b32 s68, 20000
  s_branch SAs_f
SAs_l:
  s_sleep 2
  s_sub_u32 s68, s68, 1
  s_cbranch_scc1 SAs_d
SAs_f:
  buffer_load_dwordx4 v[172:175], v168, s[36:39], s59 offen sc1
  s_waitcnt vmcnt(0)
  v_xor_b32 v173, v173, v249
  v_xor_b32 v175, v175, v249
  v_or_b32 v173, v173, v175
  v_cmp_ne_u32 vcc, 0, v173
  s_cbranch_vccnz SAs_l
SAs_d:
  s_branch BAs
SAb:
  s_mov_b32 s68, 20000
  s_branch SAb_f
SAb_l:
  s_sleep 2
  s_sub_u32 s68, s68, 1
  s_cbranch_scc1 SAb_d
SAb_f:
  s_bfm_b64 exec, 32, 0
  buffer_load_dword v254, v251, s[36:39], 0 offen sc1
  s_mov_b64 exec, -1
  s_waitcnt vmcnt(0)
  v_cmp_ne_u32 vcc, v254, v249
  s_nop 0
  s_cmp_lg_u32 vcc_lo, 0
  s_cbranch_scc1 SAb_l
SAb_d:
  s_branch BAb
SA0:
  s_mov_b32 s68, 20000
  s_branch SA0_f
SA0_l:
  s_sleep 2
  s_sub_u32 s68, s68, 1
  s_cbranch_scc1 SA0_d
SA0_f:
  s_bfm_b64 exec, 32, 32
  buffer_load_dword v254, v252, s[36:39], 0 offen sc1
  s_mov_b64 exec, -1
  s_waitcnt vmcnt(0)
  v_cmp_ne_u32 vcc, v254, v249
  s_nop 0
  s_cmp_lg_u32 vcc_hi, 0
  s_cbranch_scc1 SA0_l
SA0_d:
  s_branch BA0
SAe:
  s_waitcnt vmcnt(0)
  buffer_store_dword v249, v250, s[36:39], s63 offen sc1
  s_mov_b32 s68, 20000
  s_branch SAe_f
SAe_l:
  s_sleep 2
  s_sub_u32 s68, s68, 1
  s_cbranch_scc1 SAe_d
SAe_f:
  s_bfm_b64 exec, 32, 0
  buffer_load_dword v254, v252, s[36:39], 0 offen sc1
  s_mov_b64 exec, -1
  s_waitcnt vmcnt(0)
  v_cmp_ne_u32 vcc, v254, v249
  s_nop 0
  s_cmp_lg_u32 vcc_lo, 0
  s_cbranch_scc1 SAe_l
SAe_d:
  s_branch BAe
END:
  s_endpgm
CODE_END:
.section .rodata,"a"
.p2align 6
.amdhsa_kernel recurrent_scan__sliding_local_dilated__glu_gated_geglu__prompt_kernel
  .amdhsa_next_free_vgpr 512
  .amdhsa_next_free_sgpr 102
  .amdhsa_accum_offset 256
  .amdhsa_group_segment_fixed_size 0
  .amdhsa_kernarg_size 80
  .amdhsa_user_sgpr_count 2
  .amdhsa_user_sgpr_kernarg_segment_ptr 1
  .amdhsa_system_sgpr_workgroup_id_x 1
  .amdhsa_float_denorm_mode_32 3
.end_amdhsa_kernel
```
